```python
import torch

def _softmax(x, axis=-1):
    return torch.softmax(x, dim=axis)
def _gelu(x):
    return torch.nn.functional.gelu(x, approximate="tanh")
def _silu(x):
    return torch.nn.functional.silu(x)
def _sigmoid(x):
    return torch.sigmoid(x)
def _layernorm(x, axis=-1, eps=1e-5):
    m = x.mean(dim=axis, keepdim=True)
    v = x.var(dim=axis, keepdim=True, unbiased=False)
    return (x - m) / torch.sqrt(v + eps)
def _scatter_add(tgt, idx, src, axis=0):
    return tgt.clone().index_add_(axis, idx, src)
def _segment_sum(src, seg, n):
    out = torch.zeros((n,) + src.shape[1:], dtype=src.dtype)
    return out.index_add_(0, seg, src)
def _pad(x, pw):
    flat = tuple(v for pair in reversed(pw) for v in pair)
    return torch.nn.functional.pad(x, flat)

kernel_name = 'concat_heads__gqa_block_cached__gqa_block_cached__near_ridge'

def setup_inputs():

    _w = (lambda a: (lambda t: t.to(torch.bfloat16) if t.is_floating_point() else t)(torch.as_tensor(a)))
    def _A_setup():
        B, Sq, D = 16, 128, 448
        Hq, Hkv, Sk, Dh = 16, 8, 1024, 256
        assert Hq % Hkv == 0, (Hq, Hkv)
        return {
            "x": _w((lambda *s: torch.randn(*s, dtype=torch.bfloat16) * 0.8)(B, Sq, D)),
            "k_cache": _w((lambda *s: torch.randn(*s, dtype=torch.bfloat16) * 0.8)(B, Hkv, Sk, Dh)),
            "v_cache": _w((lambda *s: torch.randn(*s, dtype=torch.bfloat16) * 0.05)(B, Hkv, Sk, Dh)),
            "wq": _w((lambda *s: torch.randn(*s, dtype=torch.bfloat16) * 0.8)(D, Hq * Dh) * (D ** -0.5)),
            "wo": _w((lambda *s: torch.randn(*s, dtype=torch.bfloat16) * 0.05)(Hq * Dh, D) * ((Hq * Dh) ** -0.5)),
        }
    _A_in = _A_setup()

    def _B_setup():
        B, Sq, D = 16, 128, 448
        Hq, Hkv, Sk, Dh = 16, 8, 1024, 256
        assert Hq % Hkv == 0, (Hq, Hkv)
        return {
            "x": _w((lambda *s: torch.randn(*s, dtype=torch.bfloat16) * 0.8)(B, Sq, D)),
            "k_cache": _w((lambda *s: torch.randn(*s, dtype=torch.bfloat16) * 0.8)(B, Hkv, Sk, Dh)),
            "v_cache": _w((lambda *s: torch.randn(*s, dtype=torch.bfloat16) * 0.05)(B, Hkv, Sk, Dh)),
            "wq": _w((lambda *s: torch.randn(*s, dtype=torch.bfloat16) * 0.8)(D, Hq * Dh) * (D ** -0.5)),
            "wo": _w((lambda *s: torch.randn(*s, dtype=torch.bfloat16) * 0.05)(Hq * Dh, D) * ((Hq * Dh) ** -0.5)),
        }
    _B_in = _B_setup()

    return {
        "A_x": _A_in["x"],
        "A_k_cache": _A_in["k_cache"],
        "A_v_cache": _A_in["v_cache"],
        "A_wq": _A_in["wq"],
        "A_wo": _A_in["wo"],
        "B_x": _B_in["x"],
        "B_k_cache": _B_in["k_cache"],
        "B_v_cache": _B_in["v_cache"],
        "B_wq": _B_in["wq"],
        "B_wo": _B_in["wo"],
    }

def reference(A_x, A_k_cache, A_v_cache, A_wq, A_wo, B_x, B_k_cache, B_v_cache, B_wq, B_wo):
    def _A_ref(x, k_cache, v_cache, wq, wo):
        B, Sq, D = x.shape
        Hq, Dh = 16, 256
        Hkv = k_cache.shape[1]
        rep = Hq // Hkv
        q = (lambda x, *d: x.permute(*d))((x @ wq).reshape(B, Sq, Hq, Dh), 0, 2, 1, 3)
        k = (lambda x, n, axis: torch.repeat_interleave(x, n, dim=axis))(k_cache, rep, axis=1)
        v = (lambda x, n, axis: torch.repeat_interleave(x, n, dim=axis))(v_cache, rep, axis=1)
        scores = torch.einsum("bhqd,bhkd->bhqk", q, k) * (Dh ** -0.5)
        p = _softmax(scores, axis=-1)
        o = torch.einsum("bhqk,bhkd->bhqd", p, v)
        return (lambda x, *d: x.permute(*d))(o, 0, 2, 1, 3).reshape(B, Sq, Hq * Dh) @ wo

    def _B_ref(x, k_cache, v_cache, wq, wo):
        B, Sq, D = x.shape
        Hq, Dh = 16, 256
        Hkv = k_cache.shape[1]
        rep = Hq // Hkv
        q = (lambda x, *d: x.permute(*d))((x @ wq).reshape(B, Sq, Hq, Dh), 0, 2, 1, 3)
        k = (lambda x, n, axis: torch.repeat_interleave(x, n, dim=axis))(k_cache, rep, axis=1)
        v = (lambda x, n, axis: torch.repeat_interleave(x, n, dim=axis))(v_cache, rep, axis=1)
        scores = torch.einsum("bhqd,bhkd->bhqk", q, k) * (Dh ** -0.5)
        p = _softmax(scores, axis=-1)
        o = torch.einsum("bhqk,bhkd->bhqd", p, v)
        return (lambda x, *d: x.permute(*d))(o, 0, 2, 1, 3).reshape(B, Sq, Hq * Dh) @ wo

    a = _A_ref(A_x, A_k_cache, A_v_cache, A_wq, A_wo)
    b = _B_ref(B_x, B_k_cache, B_v_cache, B_wq, B_wo)
    return torch.concatenate([a, b], axis=-1)
```

```asm
; @launch grid=(256,1,1) block=(256,1,1) lds=154112
.amdgcn_target "amdgcn-amd-amdhsa--gfx950"
.text
.globl concat_heads__gqa_block_cached__gqa_block_cached__near_ridge_kernel
.p2align 8
.type concat_heads__gqa_block_cached__gqa_block_cached__near_ridge_kernel,@function
concat_heads__gqa_block_cached__gqa_block_cached__near_ridge_kernel:
  s_cmp_ge_u32 s2, 256
  s_cbranch_scc1 L_end
  s_load_dwordx16 s[32:47], s[0:1], 0
  s_load_dwordx8 s[48:55], s[0:1], 64
  s_load_dwordx2 s[56:57], s[0:1], 96
  v_lshrrev_b32 v1, 6, v0
  v_and_b32 v26, 63, v0
  v_readfirstlane_b32 s3, v1
  s_getpc_b64 s[24:25]
L_pc:
  s_mov_b32 s26, L_codeend-L_pc
  s_mov_b32 s27, 0x20000
  s_lshr_b32 s63, s2, 3
  s_lshl_b32 s63, s63, 2
  s_add_u32 s63, s63, s3
  s_lshl_b32 s63, s63, 10
  v_add_u32 v5, 56, v26
  v_lshrrev_b32 v5, 6, v5
  v_lshlrev_b32 v5, 30, v5
  v_lshl_add_u32 v5, v26, 7, v5
  buffer_load_dword v31, v5, s[24:27], s63 offen
  s_and_b32 s28, s2, 3
  s_lshl_b32 s28, s28, 1
  s_bfe_u32 s29, s2, 0x10003
  s_or_b32 s28, s28, s29
  s_lshr_b32 s29, s2, 4
  s_bfe_u32 s30, s2, 0x10002
  s_mul_i32 s31, s3, 4224
  s_lshl_b32 s62, s28, 10
  v_lshrrev_b32 v27, 4, v26
  v_lshlrev_b32 v27, 7, v27
  v_and_b32 v28, 7, v26
  v_lshl_add_u32 v27, v28, 4, v27
  v_bfe_u32 v28, v26, 3, 1
  s_and_b32 s63, s3, 1
  s_lshl_b32 s63, s63, 17
  s_lshr_b32 s60, s3, 1
  s_lshl_b32 s60, s60, 15
  s_add_u32 s63, s63, s60
  v_lshl_add_u32 v20, v28, 13, v27
  v_add_u32 v20, s63, v20
  v_add_u32 v21, 16384, v20
  v_add_u32 v22, 65536, v20
  v_add_u32 v23, 81920, v20
  v_lshrrev_b32 v3, 3, v26
  s_lshl_b32 s63, s3, 5
  v_add_u32 v3, s63, v3
  v_mul_u32_u24 v3, 896, v3
  v_lshrrev_b32 v4, 4, v26
  v_and_b32 v5, 7, v26
  v_xor_b32 v4, v4, v5
  v_lshl_add_u32 v24, v4, 4, v3
  s_mov_b32 s60, 7168
  s_mov_b32 s61, 14336
  s_mov_b32 s65, 21504
  s_mul_i32 s63, s29, 114688
  s_waitcnt lgkmcnt(0)
  s_cmp_eq_u32 s30, 0
  s_cselect_b64 s[8:9], s[38:39], s[48:49]
  s_cselect_b64 s[4:5], s[32:33], s[42:43]
  s_cselect_b64 s[12:13], s[34:35], s[44:45]
  s_cselect_b64 s[16:17], s[36:37], s[46:47]
  s_cselect_b64 s[20:21], s[40:41], s[50:51]
  s_mov_b32 s10, 3670016
  s_mov_b32 s11, 0x20000
  s_add_u32 s4, s4, s63
  s_addc_u32 s5, s5, 0
  s_mov_b32 s6, 114688
  s_mov_b32 s7, 0x20000
  s_add_u32 s63, s62, 0
  s_add_u32 m0, s31, 2048
  s_nop 0
  buffer_load_dwordx4 v20, s[8:11], s63 offen  lds
  s_add_u32 m0, s31, 3104
  s_nop 0
  buffer_load_dwordx4 v21, s[8:11], s63 offen  lds
  s_add_u32 m0, s31, 4160
  s_nop 0
  buffer_load_dwordx4 v22, s[8:11], s63 offen  lds
  s_add_u32 m0, s31, 5216
  s_nop 0
  buffer_load_dwordx4 v23, s[8:11], s63 offen  lds
  s_add_u32 m0, s31, 120320
  s_nop 0
  buffer_load_dwordx4 v24, s[4:7], 0 offen offset:0  lds
  s_add_u32 m0, s31, 121408
  s_nop 0
  buffer_load_dwordx4 v24, s[4:7], s60 offen offset:0  lds
  s_add_u32 m0, s31, 122432
  s_nop 0
  buffer_load_dwordx4 v24, s[4:7], s61 offen offset:0  lds
  s_add_u32 m0, s31, 123520
  s_nop 0
  buffer_load_dwordx4 v24, s[4:7], s65 offen offset:0  lds
  s_add_u32 s63, s62, 262144
  s_add_u32 m0, s31, 69632
  s_nop 0
  buffer_load_dwordx4 v20, s[8:11], s63 offen  lds
  s_add_u32 m0, s31, 70688
  s_nop 0
  buffer_load_dwordx4 v21, s[8:11], s63 offen  lds
  s_add_u32 m0, s31, 71744
  s_nop 0
  buffer_load_dwordx4 v22, s[8:11], s63 offen  lds
  s_add_u32 m0, s31, 72800
  s_nop 0
  buffer_load_dwordx4 v23, s[8:11], s63 offen  lds
  v_bfe_u32 v5, v26, 3, 1
  v_mul_u32_u24 v5, 1088, v5
  v_and_b32 v6, 7, v26
  v_lshl_add_u32 v5, v6, 7, v5
  v_lshrrev_b32 v6, 4, v26
  v_bfe_u32 v7, v26, 1, 2
  v_xor_b32 v6, v6, v7
  v_lshl_add_u32 v5, v6, 4, v5
  v_add_u32 v25, s31, v5
  s_mul_i32 s64, s28, 458752
  s_mov_b32 s58, 0x3db8aa3b
  s_mov_b32 s66, 0x3f803f80
  s_mov_b32 s59, 0x41a00000
  s_lshl_b32 s63, s29, 3
  s_add_u32 s63, s63, s28
  s_lshl_b32 s63, s63, 19
  s_add_u32 s12, s12, s63
  s_addc_u32 s13, s13, 0
  s_mov_b32 s14, 0x80000
  s_mov_b32 s15, 0x20000
  s_add_u32 s16, s16, s63
  s_addc_u32 s17, s17, 0
  s_mov_b32 s18, 0x80000
  s_mov_b32 s19, 0x20000
  s_mov_b32 s22, 3670016
  s_mov_b32 s23, 0x20000
  s_lshl_b32 s37, s30, 4
  s_add_u32 s37, s37, s29
  s_mul_i32 s63, s37, 917504
  s_add_u32 s24, s56, s63
  s_addc_u32 s25, s57, 0
  s_mov_b32 s26, 917504
  s_mov_b32 s27, 0x20000
  s_lshl_b32 s63, s37, 10
  s_add_u32 s63, s63, 31457280
  s_add_u32 s40, s56, s63
  s_addc_u32 s41, s57, 0
  s_mov_b32 s42, 1024
  s_mov_b32 s43, 0x20000
  s_mov_b64 s[44:45], s[54:55]
  s_mov_b32 s46, 256
  s_mov_b32 s47, 0x20000
  s_mov_b64 s[48:49], s[52:53]
  s_mov_b32 s50, 3670016
  s_mov_b32 s51, 0x20000
  s_lshl_b32 s63, s3, 12
  v_lshl_add_u32 v8, v28, 9, v27
  v_add_u32 v8, s63, v8
  v_and_b32 v5, 0xffffffcf, v8
  v_bfe_u32 v6, v26, 1, 1
  v_lshl_add_u32 v5, v6, 4, v5
  v_and_b32 v6, 1, v26
  v_lshl_add_u32 v3, v6, 5, v5
  v_bfe_u32 v5, v26, 1, 3
  v_mul_u32_u24 v5, 1056, v5
  v_and_b32 v6, 1, v26
  v_lshl_add_u32 v5, v6, 7, v5
  v_lshrrev_b32 v6, 4, v26
  v_lshl_add_u32 v5, v6, 4, v5
  v_add_u32 v9, 2048, v5
  v_add_u32 v1, 69632, v5
  v_lshrrev_b32 v5, 3, v26
  v_mul_u32_u24 v5, 1056, v5
  v_bfe_u32 v6, v26, 2, 1
  v_lshl_add_u32 v5, v6, 7, v5
  v_and_b32 v6, 3, v26
  v_lshl_add_u32 v5, v6, 3, v5
  v_add_u32 v2, 2048, v5
  v_add_u32 v14, 69632, v5
  v_lshrrev_b32 v5, 4, v26
  v_lshl_add_u32 v5, v5, 5, v28
  v_mul_u32_u24 v5, 896, v5
  v_and_b32 v6, 127, v27
  s_mul_i32 s63, s3, 7168
  v_add3_u32 v0, v5, v6, s63
  v_mov_b32 v4, 0
  v_mov_b32 v6, 0
  v_mov_b32 v7, 0
  s_add_u32 s63, s62, 512
  s_add_u32 m0, s31, 18944
  s_nop 0
  buffer_load_dwordx4 v20, s[8:11], s63 offen  lds
  s_add_u32 m0, s31, 20000
  s_nop 0
  buffer_load_dwordx4 v21, s[8:11], s63 offen  lds
  s_add_u32 m0, s31, 21056
  s_nop 0
  buffer_load_dwordx4 v22, s[8:11], s63 offen  lds
  s_add_u32 m0, s31, 22112
  s_nop 0
  buffer_load_dwordx4 v23, s[8:11], s63 offen  lds
  s_add_u32 s63, s62, 262656
  s_add_u32 m0, s31, 86528
  s_nop 0
  buffer_load_dwordx4 v20, s[8:11], s63 offen  lds
  s_add_u32 m0, s31, 87584
  s_nop 0
  buffer_load_dwordx4 v21, s[8:11], s63 offen  lds
  s_add_u32 m0, s31, 88640
  s_nop 0
  buffer_load_dwordx4 v22, s[8:11], s63 offen  lds
  s_add_u32 m0, s31, 89696
  s_nop 0
  buffer_load_dwordx4 v23, s[8:11], s63 offen  lds
  v_mov_b32 v5, 0
  s_waitcnt vmcnt(12)
  v_add_u32 v29, 120320, v25
  ds_read_b128 a[128:131], v29 offset:0
  ds_read_b128 a[132:135], v29 offset:2112
  ds_read_b128 a[136:139], v29 offset:64
  ds_read_b128 a[140:143], v29 offset:2176
  s_barrier
  s_waitcnt lgkmcnt(0)
  ds_read_b64_tr_b16 v[32:33], v2 offset:0
  ds_read_b64_tr_b16 v[34:35], v2 offset:8448
  ds_read_b64_tr_b16 v[36:37], v2 offset:32
  ds_read_b64_tr_b16 v[38:39], v2 offset:8480
  ds_read_b64_tr_b16 v[40:41], v2 offset:64
  ds_read_b64_tr_b16 v[42:43], v2 offset:8512
  ds_read_b64_tr_b16 v[44:45], v2 offset:96
  ds_read_b64_tr_b16 v[46:47], v2 offset:8544
  ds_read_b64_tr_b16 v[48:49], v2 offset:256
  ds_read_b64_tr_b16 v[50:51], v2 offset:8704
  ds_read_b64_tr_b16 v[52:53], v2 offset:288
  ds_read_b64_tr_b16 v[54:55], v2 offset:8736
  s_waitcnt lgkmcnt(8)
  v_mfma_f32_16x16x32_bf16 v[128:131], v[32:35], a[128:131], 0
  ds_read_b64_tr_b16 v[56:57], v2 offset:320
  v_mfma_f32_16x16x32_bf16 v[160:163], v[32:35], a[132:135], 0
  ds_read_b64_tr_b16 v[58:59], v2 offset:8768
  v_mfma_f32_16x16x32_bf16 a[4:7], v[36:39], a[128:131], 0
  ds_read_b64_tr_b16 v[60:61], v2 offset:352
  v_mfma_f32_16x16x32_bf16 a[68:71], v[36:39], a[132:135], 0
  ds_read_b64_tr_b16 v[62:63], v2 offset:8800
  s_waitcnt lgkmcnt(8)
  v_mfma_f32_16x16x32_bf16 v[132:135], v[40:43], a[128:131], 0
  ds_read_b64_tr_b16 v[32:33], v2 offset:512
  s_add_u32 s38, s62, 524288
  s_add_u32 m0, s31, 35840
  v_mfma_f32_16x16x32_bf16 v[164:167], v[40:43], a[132:135], 0
  ds_read_b64_tr_b16 v[34:35], v2 offset:8960
  buffer_load_dwordx4 v20, s[8:11], s38 offen  lds
  v_mfma_f32_16x16x32_bf16 a[12:15], v[44:47], a[128:131], 0
  ds_read_b64_tr_b16 v[36:37], v2 offset:544
  v_mfma_f32_16x16x32_bf16 a[76:79], v[44:47], a[132:135], 0
  ds_read_b64_tr_b16 v[38:39], v2 offset:8992
  s_waitcnt lgkmcnt(8)
  v_mfma_f32_16x16x32_bf16 v[136:139], v[48:51], a[128:131], 0
  ds_read_b64_tr_b16 v[40:41], v2 offset:576
  s_add_u32 m0, s31, 36896
  v_mfma_f32_16x16x32_bf16 v[168:171], v[48:51], a[132:135], 0
  ds_read_b64_tr_b16 v[42:43], v2 offset:9024
  buffer_load_dwordx4 v21, s[8:11], s38 offen  lds
  v_mfma_f32_16x16x32_bf16 a[20:23], v[52:55], a[128:131], 0
  ds_read_b64_tr_b16 v[44:45], v2 offset:608
  v_mfma_f32_16x16x32_bf16 a[84:87], v[52:55], a[132:135], 0
  ds_read_b64_tr_b16 v[46:47], v2 offset:9056
  s_waitcnt lgkmcnt(8)
  v_mfma_f32_16x16x32_bf16 v[140:143], v[56:59], a[128:131], 0
  ds_read_b64_tr_b16 v[48:49], v2 offset:768
  s_add_u32 m0, s31, 37952
  v_mfma_f32_16x16x32_bf16 v[172:175], v[56:59], a[132:135], 0
  ds_read_b64_tr_b16 v[50:51], v2 offset:9216
  buffer_load_dwordx4 v22, s[8:11], s38 offen  lds
  v_mfma_f32_16x16x32_bf16 a[28:31], v[60:63], a[128:131], 0
  ds_read_b64_tr_b16 v[52:53], v2 offset:800
  v_mfma_f32_16x16x32_bf16 a[92:95], v[60:63], a[132:135], 0
  ds_read_b64_tr_b16 v[54:55], v2 offset:9248
  s_waitcnt lgkmcnt(8)
  v_mfma_f32_16x16x32_bf16 v[144:147], v[32:35], a[128:131], 0
  ds_read_b64_tr_b16 v[56:57], v2 offset:832
  s_add_u32 m0, s31, 39008
  v_mfma_f32_16x16x32_bf16 v[176:179], v[32:35], a[132:135], 0
  ds_read_b64_tr_b16 v[58:59], v2 offset:9280
  buffer_load_dwordx4 v23, s[8:11], s38 offen  lds
  s_waitcnt vmcnt(12)
  v_mfma_f32_16x16x32_bf16 a[36:39], v[36:39], a[128:131], 0
  ds_read_b64_tr_b16 v[60:61], v2 offset:864
  s_barrier
  v_mfma_f32_16x16x32_bf16 a[100:103], v[36:39], a[132:135], 0
  ds_read_b64_tr_b16 v[62:63], v2 offset:9312
  s_waitcnt lgkmcnt(8)
  v_mfma_f32_16x16x32_bf16 v[148:151], v[40:43], a[128:131], 0
  ds_read_b64_tr_b16 v[32:33], v14 offset:0
  s_add_u32 m0, s31, 137088
  v_mfma_f32_16x16x32_bf16 v[180:183], v[40:43], a[132:135], 0
  ds_read_b64_tr_b16 v[34:35], v14 offset:8448
  buffer_load_dwordx4 v24, s[4:7], 0 offen offset:128  lds
  v_mfma_f32_16x16x32_bf16 a[44:47], v[44:47], a[128:131], 0
  ds_read_b64_tr_b16 v[36:37], v14 offset:32
  v_mfma_f32_16x16x32_bf16 a[108:111], v[44:47], a[132:135], 0
  ds_read_b64_tr_b16 v[38:39], v14 offset:8480
  s_waitcnt lgkmcnt(8)
  v_mfma_f32_16x16x32_bf16 v[152:155], v[48:51], a[128:131], 0
  ds_read_b64_tr_b16 v[40:41], v14 offset:64
  s_add_u32 m0, s31, 138176
  v_mfma_f32_16x16x32_bf16 v[184:187], v[48:51], a[132:135], 0
  ds_read_b64_tr_b16 v[42:43], v14 offset:8512
  buffer_load_dwordx4 v24, s[4:7], s60 offen offset:128  lds
  v_mfma_f32_16x16x32_bf16 a[52:55], v[52:55], a[128:131], 0
  ds_read_b64_tr_b16 v[44:45], v14 offset:96
  v_mfma_f32_16x16x32_bf16 a[116:119], v[52:55], a[132:135], 0
  ds_read_b64_tr_b16 v[46:47], v14 offset:8544
  s_waitcnt lgkmcnt(8)
  v_mfma_f32_16x16x32_bf16 v[156:159], v[56:59], a[128:131], 0
  ds_read_b64_tr_b16 v[48:49], v14 offset:256
  s_add_u32 m0, s31, 139200
  v_mfma_f32_16x16x32_bf16 v[188:191], v[56:59], a[132:135], 0
  ds_read_b64_tr_b16 v[50:51], v14 offset:8704
  buffer_load_dwordx4 v24, s[4:7], s61 offen offset:128  lds
  v_mfma_f32_16x16x32_bf16 a[60:63], v[60:63], a[128:131], 0
  ds_read_b64_tr_b16 v[52:53], v14 offset:288
  v_mfma_f32_16x16x32_bf16 a[124:127], v[60:63], a[132:135], 0
  ds_read_b64_tr_b16 v[54:55], v14 offset:8736
  s_waitcnt lgkmcnt(8)
  v_mfma_f32_16x16x32_bf16 v[128:131], v[32:35], a[136:139], v[128:131]
  ds_read_b64_tr_b16 v[56:57], v14 offset:320
  s_add_u32 m0, s31, 140288
  v_mfma_f32_16x16x32_bf16 v[160:163], v[32:35], a[140:143], v[160:163]
  ds_read_b64_tr_b16 v[58:59], v14 offset:8768
  buffer_load_dwordx4 v24, s[4:7], s65 offen offset:128  lds
  v_mfma_f32_16x16x32_bf16 a[4:7], v[36:39], a[136:139], a[4:7]
  ds_read_b64_tr_b16 v[60:61], v14 offset:352
  v_mfma_f32_16x16x32_bf16 a[68:71], v[36:39], a[140:143], a[68:71]
  ds_read_b64_tr_b16 v[62:63], v14 offset:8800
  s_waitcnt lgkmcnt(8)
  v_mfma_f32_16x16x32_bf16 v[132:135], v[40:43], a[136:139], v[132:135]
  ds_read_b64_tr_b16 v[32:33], v14 offset:512
  s_add_u32 s38, s62, 786432
  s_add_u32 m0, s31, 103424
  v_mfma_f32_16x16x32_bf16 v[164:167], v[40:43], a[140:143], v[164:167]
  ds_read_b64_tr_b16 v[34:35], v14 offset:8960
  buffer_load_dwordx4 v20, s[8:11], s38 offen  lds
  v_mfma_f32_16x16x32_bf16 a[12:15], v[44:47], a[136:139], a[12:15]
  ds_read_b64_tr_b16 v[36:37], v14 offset:544
  v_mfma_f32_16x16x32_bf16 a[76:79], v[44:47], a[140:143], a[76:79]
  ds_read_b64_tr_b16 v[38:39], v14 offset:8992
  s_waitcnt lgkmcnt(8)
  v_mfma_f32_16x16x32_bf16 v[136:139], v[48:51], a[136:139], v[136:139]
  ds_read_b64_tr_b16 v[40:41], v14 offset:576
  s_add_u32 m0, s31, 104480
  v_mfma_f32_16x16x32_bf16 v[168:171], v[48:51], a[140:143], v[168:171]
  ds_read_b64_tr_b16 v[42:43], v14 offset:9024
  buffer_load_dwordx4 v21, s[8:11], s38 offen  lds
  v_mfma_f32_16x16x32_bf16 a[20:23], v[52:55], a[136:139], a[20:23]
  ds_read_b64_tr_b16 v[44:45], v14 offset:608
  v_mfma_f32_16x16x32_bf16 a[84:87], v[52:55], a[140:143], a[84:87]
  ds_read_b64_tr_b16 v[46:47], v14 offset:9056
  s_waitcnt lgkmcnt(8)
  v_mfma_f32_16x16x32_bf16 v[140:143], v[56:59], a[136:139], v[140:143]
  ds_read_b64_tr_b16 v[48:49], v14 offset:768
  s_add_u32 m0, s31, 105536
  v_mfma_f32_16x16x32_bf16 v[172:175], v[56:59], a[140:143], v[172:175]
  ds_read_b64_tr_b16 v[50:51], v14 offset:9216
  buffer_load_dwordx4 v22, s[8:11], s38 offen  lds
  v_mfma_f32_16x16x32_bf16 a[28:31], v[60:63], a[136:139], a[28:31]
  ds_read_b64_tr_b16 v[52:53], v14 offset:800
  v_mfma_f32_16x16x32_bf16 a[92:95], v[60:63], a[140:143], a[92:95]
  ds_read_b64_tr_b16 v[54:55], v14 offset:9248
  s_waitcnt lgkmcnt(8)
  v_mfma_f32_16x16x32_bf16 v[144:147], v[32:35], a[136:139], v[144:147]
  ds_read_b64_tr_b16 v[56:57], v14 offset:832
  s_add_u32 m0, s31, 106592
  v_mfma_f32_16x16x32_bf16 v[176:179], v[32:35], a[140:143], v[176:179]
  ds_read_b64_tr_b16 v[58:59], v14 offset:9280
  buffer_load_dwordx4 v23, s[8:11], s38 offen  lds
  s_waitcnt vmcnt(16)
  v_mfma_f32_16x16x32_bf16 a[36:39], v[36:39], a[136:139], a[36:39]
  ds_read_b64_tr_b16 v[60:61], v14 offset:864
  s_barrier
  v_mfma_f32_16x16x32_bf16 a[100:103], v[36:39], a[140:143], a[100:103]
  ds_read_b64_tr_b16 v[62:63], v14 offset:9312
  s_waitcnt lgkmcnt(8)
  v_mfma_f32_16x16x32_bf16 v[148:151], v[40:43], a[136:139], v[148:151]
  ds_read_b64_tr_b16 v[32:33], v2 offset:16896
  s_add_u32 s63, s62, 524800
  v_mfma_f32_16x16x32_bf16 v[180:183], v[40:43], a[140:143], v[180:183]
  ds_read_b64_tr_b16 v[34:35], v2 offset:25344
  s_add_u32 m0, s31, 52736
  v_mfma_f32_16x16x32_bf16 a[44:47], v[44:47], a[136:139], a[44:47]
  ds_read_b64_tr_b16 v[36:37], v2 offset:16928
  buffer_load_dwordx4 v20, s[8:11], s63 offen  lds
  v_mfma_f32_16x16x32_bf16 a[108:111], v[44:47], a[140:143], a[108:111]
  ds_read_b64_tr_b16 v[38:39], v2 offset:25376
  s_waitcnt lgkmcnt(8)
  v_mfma_f32_16x16x32_bf16 v[152:155], v[48:51], a[136:139], v[152:155]
  ds_read_b64_tr_b16 v[40:41], v2 offset:16960
  v_mfma_f32_16x16x32_bf16 v[184:187], v[48:51], a[140:143], v[184:187]
  ds_read_b64_tr_b16 v[42:43], v2 offset:25408
  v_mfma_f32_16x16x32_bf16 a[52:55], v[52:55], a[136:139], a[52:55]
  ds_read_b64_tr_b16 v[44:45], v2 offset:16992
  v_mfma_f32_16x16x32_bf16 a[116:119], v[52:55], a[140:143], a[116:119]
  ds_read_b64_tr_b16 v[46:47], v2 offset:25440
  s_waitcnt lgkmcnt(8)
  v_mfma_f32_16x16x32_bf16 v[156:159], v[56:59], a[136:139], v[156:159]
  ds_read_b64_tr_b16 v[48:49], v2 offset:17152
  s_add_u32 m0, s31, 53792
  v_mfma_f32_16x16x32_bf16 v[188:191], v[56:59], a[140:143], v[188:191]
  ds_read_b64_tr_b16 v[50:51], v2 offset:25600
  buffer_load_dwordx4 v21, s[8:11], s63 offen  lds
  v_mfma_f32_16x16x32_bf16 a[60:63], v[60:63], a[136:139], a[60:63]
  ds_read_b64_tr_b16 v[52:53], v2 offset:17184
  v_mfma_f32_16x16x32_bf16 a[124:127], v[60:63], a[140:143], a[124:127]
  ds_read_b64_tr_b16 v[54:55], v2 offset:25632
  s_waitcnt lgkmcnt(8)
  v_mfma_f32_16x16x32_bf16 v[192:195], v[32:35], a[128:131], 0
  ds_read_b64_tr_b16 v[56:57], v2 offset:17216
  v_mfma_f32_16x16x32_bf16 v[224:227], v[32:35], a[132:135], 0
  ds_read_b64_tr_b16 v[58:59], v2 offset:25664
  v_mfma_f32_16x16x32_bf16 v[64:67], v[36:39], a[128:131], 0
  ds_read_b64_tr_b16 v[60:61], v2 offset:17248
  v_mfma_f32_16x16x32_bf16 v[68:71], v[36:39], a[132:135], 0
  ds_read_b64_tr_b16 v[62:63], v2 offset:25696
  s_waitcnt lgkmcnt(8)
  v_mfma_f32_16x16x32_bf16 v[196:199], v[40:43], a[128:131], 0
  ds_read_b64_tr_b16 v[32:33], v2 offset:17408
  s_add_u32 m0, s31, 54848
  v_mfma_f32_16x16x32_bf16 v[228:231], v[40:43], a[132:135], 0
  ds_read_b64_tr_b16 v[34:35], v2 offset:25856
  buffer_load_dwordx4 v22, s[8:11], s63 offen  lds
  v_mfma_f32_16x16x32_bf16 v[72:75], v[44:47], a[128:131], 0
  ds_read_b64_tr_b16 v[36:37], v2 offset:17440
  v_mfma_f32_16x16x32_bf16 v[76:79], v[44:47], a[132:135], 0
  ds_read_b64_tr_b16 v[38:39], v2 offset:25888
  s_waitcnt lgkmcnt(8)
  v_mfma_f32_16x16x32_bf16 v[200:203], v[48:51], a[128:131], 0
  ds_read_b64_tr_b16 v[40:41], v2 offset:17472
  v_mfma_f32_16x16x32_bf16 v[232:235], v[48:51], a[132:135], 0
  ds_read_b64_tr_b16 v[42:43], v2 offset:25920
  v_mfma_f32_16x16x32_bf16 v[80:83], v[52:55], a[128:131], 0
  ds_read_b64_tr_b16 v[44:45], v2 offset:17504
  v_mfma_f32_16x16x32_bf16 v[84:87], v[52:55], a[132:135], 0
  ds_read_b64_tr_b16 v[46:47], v2 offset:25952
  s_waitcnt lgkmcnt(8)
  v_mfma_f32_16x16x32_bf16 v[204:207], v[56:59], a[128:131], 0
  ds_read_b64_tr_b16 v[48:49], v2 offset:17664
  s_add_u32 m0, s31, 55904
  v_mfma_f32_16x16x32_bf16 v[236:239], v[56:59], a[132:135], 0
  ds_read_b64_tr_b16 v[50:51], v2 offset:26112
  buffer_load_dwordx4 v23, s[8:11], s63 offen  lds
  v_mfma_f32_16x16x32_bf16 v[88:91], v[60:63], a[128:131], 0
  ds_read_b64_tr_b16 v[52:53], v2 offset:17696
  v_mfma_f32_16x16x32_bf16 v[92:95], v[60:63], a[132:135], 0
  ds_read_b64_tr_b16 v[54:55], v2 offset:26144
  s_waitcnt lgkmcnt(8)
  v_mfma_f32_16x16x32_bf16 v[208:211], v[32:35], a[128:131], 0
  ds_read_b64_tr_b16 v[56:57], v2 offset:17728
  v_mfma_f32_16x16x32_bf16 v[240:243], v[32:35], a[132:135], 0
  ds_read_b64_tr_b16 v[58:59], v2 offset:26176
  s_waitcnt vmcnt(16)
  v_mfma_f32_16x16x32_bf16 v[96:99], v[36:39], a[128:131], 0
  ds_read_b64_tr_b16 v[60:61], v2 offset:17760
  s_barrier
  v_mfma_f32_16x16x32_bf16 v[100:103], v[36:39], a[132:135], 0
  ds_read_b64_tr_b16 v[62:63], v2 offset:26208
  s_waitcnt lgkmcnt(8)
  v_mfma_f32_16x16x32_bf16 v[212:215], v[40:43], a[128:131], 0
  ds_read_b64_tr_b16 v[32:33], v14 offset:16896
  s_add_u32 s63, s62, 786944
  v_mfma_f32_16x16x32_bf16 v[244:247], v[40:43], a[132:135], 0
  ds_read_b64_tr_b16 v[34:35], v14 offset:25344
  s_add_u32 m0, s31, 120320
  v_mfma_f32_16x16x32_bf16 v[104:107], v[44:47], a[128:131], 0
  ds_read_b64_tr_b16 v[36:37], v14 offset:16928
  buffer_load_dwordx4 v20, s[8:11], s63 offen  lds
  v_mfma_f32_16x16x32_bf16 v[108:111], v[44:47], a[132:135], 0
  ds_read_b64_tr_b16 v[38:39], v14 offset:25376
  s_waitcnt lgkmcnt(8)
  v_mfma_f32_16x16x32_bf16 v[216:219], v[48:51], a[128:131], 0
  ds_read_b64_tr_b16 v[40:41], v14 offset:16960
  s_add_u32 m0, s31, 121376
  v_mfma_f32_16x16x32_bf16 v[248:251], v[48:51], a[132:135], 0
  ds_read_b64_tr_b16 v[42:43], v14 offset:25408
  buffer_load_dwordx4 v21, s[8:11], s63 offen  lds
  v_mfma_f32_16x16x32_bf16 v[112:115], v[52:55], a[128:131], 0
  ds_read_b64_tr_b16 v[44:45], v14 offset:16992
  v_mfma_f32_16x16x32_bf16 v[116:119], v[52:55], a[132:135], 0
  ds_read_b64_tr_b16 v[46:47], v14 offset:25440
  s_waitcnt lgkmcnt(8)
  v_mfma_f32_16x16x32_bf16 v[220:223], v[56:59], a[128:131], 0
  ds_read_b64_tr_b16 v[48:49], v14 offset:17152
  v_mfma_f32_16x16x32_bf16 v[252:255], v[56:59], a[132:135], 0
  ds_read_b64_tr_b16 v[50:51], v14 offset:25600
  v_mfma_f32_16x16x32_bf16 v[120:123], v[60:63], a[128:131], 0
  ds_read_b64_tr_b16 v[52:53], v14 offset:17184
  v_mfma_f32_16x16x32_bf16 v[124:127], v[60:63], a[132:135], 0
  ds_read_b64_tr_b16 v[54:55], v14 offset:25632
  s_waitcnt lgkmcnt(8)
  v_mfma_f32_16x16x32_bf16 v[192:195], v[32:35], a[136:139], v[192:195]
  ds_read_b64_tr_b16 v[56:57], v14 offset:17216
  s_add_u32 m0, s31, 122432
  v_mfma_f32_16x16x32_bf16 v[224:227], v[32:35], a[140:143], v[224:227]
  ds_read_b64_tr_b16 v[58:59], v14 offset:25664
  buffer_load_dwordx4 v22, s[8:11], s63 offen  lds
  v_mfma_f32_16x16x32_bf16 v[64:67], v[36:39], a[136:139], v[64:67]
  ds_read_b64_tr_b16 v[60:61], v14 offset:17248
  v_mfma_f32_16x16x32_bf16 v[68:71], v[36:39], a[140:143], v[68:71]
  ds_read_b64_tr_b16 v[62:63], v14 offset:25696
  s_waitcnt lgkmcnt(8)
  v_mfma_f32_16x16x32_bf16 v[196:199], v[40:43], a[136:139], v[196:199]
  ds_read_b64_tr_b16 v[32:33], v14 offset:17408
  s_waitcnt vmcnt(11)
  v_add_u32 v29, 137216, v25
  v_mfma_f32_16x16x32_bf16 v[228:231], v[40:43], a[140:143], v[228:231]
  ds_read_b64_tr_b16 v[34:35], v14 offset:25856
  ds_read_b128 a[144:147], v29 offset:0
  ds_read_b128 a[148:151], v29 offset:2112
  v_mfma_f32_16x16x32_bf16 v[72:75], v[44:47], a[136:139], v[72:75]
  ds_read_b64_tr_b16 v[36:37], v14 offset:17440
  v_mfma_f32_16x16x32_bf16 v[76:79], v[44:47], a[140:143], v[76:79]
  ds_read_b64_tr_b16 v[38:39], v14 offset:25888
  s_waitcnt lgkmcnt(10)
  v_mfma_f32_16x16x32_bf16 v[200:203], v[48:51], a[136:139], v[200:203]
  ds_read_b64_tr_b16 v[40:41], v14 offset:17472
  s_add_u32 m0, s31, 123488
  v_mfma_f32_16x16x32_bf16 v[232:235], v[48:51], a[140:143], v[232:235]
  ds_read_b64_tr_b16 v[42:43], v14 offset:25920
  buffer_load_dwordx4 v23, s[8:11], s63 offen  lds
  v_mfma_f32_16x16x32_bf16 v[80:83], v[52:55], a[136:139], v[80:83]
  ds_read_b64_tr_b16 v[44:45], v14 offset:17504
  v_mfma_f32_16x16x32_bf16 v[84:87], v[52:55], a[140:143], v[84:87]
  ds_read_b64_tr_b16 v[46:47], v14 offset:25952
  s_waitcnt lgkmcnt(10)
  v_mfma_f32_16x16x32_bf16 v[204:207], v[56:59], a[136:139], v[204:207]
  ds_read_b64_tr_b16 v[48:49], v14 offset:17664
  v_mfma_f32_16x16x32_bf16 v[236:239], v[56:59], a[140:143], v[236:239]
  ds_read_b64_tr_b16 v[50:51], v14 offset:26112
  v_mfma_f32_16x16x32_bf16 v[88:91], v[60:63], a[136:139], v[88:91]
  ds_read_b64_tr_b16 v[52:53], v14 offset:17696
  v_mfma_f32_16x16x32_bf16 v[92:95], v[60:63], a[140:143], v[92:95]
  ds_read_b64_tr_b16 v[54:55], v14 offset:26144
  s_waitcnt lgkmcnt(8)
  v_mfma_f32_16x16x32_bf16 v[208:211], v[32:35], a[136:139], v[208:211]
  ds_read_b64_tr_b16 v[56:57], v14 offset:17728
  v_mfma_f32_16x16x32_bf16 v[240:243], v[32:35], a[140:143], v[240:243]
  ds_read_b64_tr_b16 v[58:59], v14 offset:26176
  s_waitcnt vmcnt(8)
  v_mfma_f32_16x16x32_bf16 v[96:99], v[36:39], a[136:139], v[96:99]
  ds_read_b64_tr_b16 v[60:61], v14 offset:17760
  ds_read_b128 a[152:155], v29 offset:64
  s_barrier
  v_mfma_f32_16x16x32_bf16 v[100:103], v[36:39], a[140:143], v[100:103]
  ds_read_b64_tr_b16 v[62:63], v14 offset:26208
  ds_read_b128 a[156:159], v29 offset:2176
  s_waitcnt lgkmcnt(10)
  v_mfma_f32_16x16x32_bf16 v[212:215], v[40:43], a[136:139], v[212:215]
  ds_read_b64_tr_b16 v[32:33], v2 offset:33792
  s_add_u32 s63, s62, 1048576
  v_mfma_f32_16x16x32_bf16 v[244:247], v[40:43], a[140:143], v[244:247]
  ds_read_b64_tr_b16 v[34:35], v2 offset:42240
  s_add_u32 m0, s31, 2048
  v_mfma_f32_16x16x32_bf16 v[104:107], v[44:47], a[136:139], v[104:107]
  ds_read_b64_tr_b16 v[36:37], v14 offset:33792
  buffer_load_dwordx4 v20, s[8:11], s63 offen  lds
  v_mfma_f32_16x16x32_bf16 v[108:111], v[44:47], a[140:143], v[108:111]
  ds_read_b64_tr_b16 v[38:39], v14 offset:42240
  s_waitcnt lgkmcnt(10)
  v_mfma_f32_16x16x32_bf16 v[216:219], v[48:51], a[136:139], v[216:219]
  ds_read_b64_tr_b16 v[40:41], v2 offset:33824
  v_mfma_f32_16x16x32_bf16 v[248:251], v[48:51], a[140:143], v[248:251]
  ds_read_b64_tr_b16 v[42:43], v2 offset:42272
  v_mfma_f32_16x16x32_bf16 v[112:115], v[52:55], a[136:139], v[112:115]
  ds_read_b64_tr_b16 v[44:45], v14 offset:33824
  v_mfma_f32_16x16x32_bf16 v[116:119], v[52:55], a[140:143], v[116:119]
  ds_read_b64_tr_b16 v[46:47], v14 offset:42272
  s_waitcnt lgkmcnt(9)
  v_mfma_f32_16x16x32_bf16 v[220:223], v[56:59], a[136:139], v[220:223]
  ds_read_b64_tr_b16 v[48:49], v2 offset:33856
  s_add_u32 m0, s31, 3104
  v_mfma_f32_16x16x32_bf16 v[252:255], v[56:59], a[140:143], v[252:255]
  ds_read_b64_tr_b16 v[50:51], v2 offset:42304
  buffer_load_dwordx4 v21, s[8:11], s63 offen  lds
  v_mfma_f32_16x16x32_bf16 v[120:123], v[60:63], a[136:139], v[120:123]
  ds_read_b64_tr_b16 v[52:53], v14 offset:33856
  v_mfma_f32_16x16x32_bf16 v[124:127], v[60:63], a[140:143], v[124:127]
  ds_read_b64_tr_b16 v[54:55], v14 offset:42304
  s_waitcnt lgkmcnt(8)
  v_mfma_f32_16x16x32_bf16 v[128:131], v[32:35], a[144:147], v[128:131]
  ds_read_b64_tr_b16 v[56:57], v2 offset:33888
  s_add_u32 m0, s31, 136960
  v_mfma_f32_16x16x32_bf16 v[128:131], v[36:39], a[152:155], v[128:131]
  ds_read_b64_tr_b16 v[58:59], v2 offset:42336
  buffer_load_dwordx4 v24, s[4:7], 0 offen offset:256  lds
  v_mfma_f32_16x16x32_bf16 v[160:163], v[32:35], a[148:151], v[160:163]
  ds_read_b64_tr_b16 v[60:61], v14 offset:33888
  v_mfma_f32_16x16x32_bf16 v[160:163], v[36:39], a[156:159], v[160:163]
  ds_read_b64_tr_b16 v[62:63], v14 offset:42336
  s_waitcnt lgkmcnt(8)
  v_mfma_f32_16x16x32_bf16 a[4:7], v[40:43], a[144:147], a[4:7]
  ds_read_b64_tr_b16 v[32:33], v2 offset:34048
  v_mfma_f32_16x16x32_bf16 a[4:7], v[44:47], a[152:155], a[4:7]
  ds_read_b64_tr_b16 v[34:35], v2 offset:42496
  s_add_u32 m0, s31, 138048
  v_mfma_f32_16x16x32_bf16 a[68:71], v[40:43], a[148:151], a[68:71]
  ds_read_b64_tr_b16 v[36:37], v14 offset:34048
  buffer_load_dwordx4 v24, s[4:7], s60 offen offset:256  lds
  v_mfma_f32_16x16x32_bf16 a[68:71], v[44:47], a[156:159], a[68:71]
  ds_read_b64_tr_b16 v[38:39], v14 offset:42496
  s_waitcnt lgkmcnt(8)
  v_mfma_f32_16x16x32_bf16 v[132:135], v[48:51], a[144:147], v[132:135]
  ds_read_b64_tr_b16 v[40:41], v2 offset:34080
  s_add_u32 m0, s31, 4160
  v_mfma_f32_16x16x32_bf16 v[132:135], v[52:55], a[152:155], v[132:135]
  ds_read_b64_tr_b16 v[42:43], v2 offset:42528
  buffer_load_dwordx4 v22, s[8:11], s63 offen  lds
  v_mfma_f32_16x16x32_bf16 v[164:167], v[48:51], a[148:151], v[164:167]
  ds_read_b64_tr_b16 v[44:45], v14 offset:34080
  s_add_u32 m0, s31, 139072
  v_mfma_f32_16x16x32_bf16 v[164:167], v[52:55], a[156:159], v[164:167]
  ds_read_b64_tr_b16 v[46:47], v14 offset:42528
  buffer_load_dwordx4 v24, s[4:7], s61 offen offset:256  lds
  s_waitcnt lgkmcnt(8)
  v_mfma_f32_16x16x32_bf16 a[12:15], v[56:59], a[144:147], a[12:15]
  ds_read_b64_tr_b16 v[48:49], v2 offset:34112
  s_add_u32 m0, s31, 5216
  v_mfma_f32_16x16x32_bf16 a[12:15], v[60:63], a[152:155], a[12:15]
  ds_read_b64_tr_b16 v[50:51], v2 offset:42560
  buffer_load_dwordx4 v23, s[8:11], s63 offen  lds
  v_mfma_f32_16x16x32_bf16 a[76:79], v[56:59], a[148:151], a[76:79]
  ds_read_b64_tr_b16 v[52:53], v14 offset:34112
  v_mfma_f32_16x16x32_bf16 a[76:79], v[60:63], a[156:159], a[76:79]
  ds_read_b64_tr_b16 v[54:55], v14 offset:42560
  s_add_u32 m0, s31, 140160
  s_waitcnt lgkmcnt(8)
  v_mfma_f32_16x16x32_bf16 v[136:139], v[32:35], a[144:147], v[136:139]
  ds_read_b64_tr_b16 v[56:57], v2 offset:34144
  buffer_load_dwordx4 v24, s[4:7], s65 offen offset:256  lds
  v_mfma_f32_16x16x32_bf16 v[136:139], v[36:39], a[152:155], v[136:139]
  ds_read_b64_tr_b16 v[58:59], v2 offset:42592
  s_add_u32 s63, s62, 1310720
  v_mfma_f32_16x16x32_bf16 v[168:171], v[32:35], a[148:151], v[168:171]
  ds_read_b64_tr_b16 v[60:61], v14 offset:34144
  v_mfma_f32_16x16x32_bf16 v[168:171], v[36:39], a[156:159], v[168:171]
  ds_read_b64_tr_b16 v[62:63], v14 offset:42592
  s_waitcnt lgkmcnt(8)
  v_mfma_f32_16x16x32_bf16 a[20:23], v[40:43], a[144:147], a[20:23]
  ds_read_b64_tr_b16 v[32:33], v2 offset:34304
  s_add_u32 m0, s31, 69632
  v_mfma_f32_16x16x32_bf16 a[20:23], v[44:47], a[152:155], a[20:23]
  ds_read_b64_tr_b16 v[34:35], v2 offset:42752
  buffer_load_dwordx4 v20, s[8:11], s63 offen  lds
  v_mfma_f32_16x16x32_bf16 a[84:87], v[40:43], a[148:151], a[84:87]
  ds_read_b64_tr_b16 v[36:37], v14 offset:34304
  v_mfma_f32_16x16x32_bf16 a[84:87], v[44:47], a[156:159], a[84:87]
  ds_read_b64_tr_b16 v[38:39], v14 offset:42752
  s_waitcnt lgkmcnt(8)
  v_mfma_f32_16x16x32_bf16 v[140:143], v[48:51], a[144:147], v[140:143]
  ds_read_b64_tr_b16 v[40:41], v2 offset:34336
  s_add_u32 m0, s31, 70688
  v_mfma_f32_16x16x32_bf16 v[140:143], v[52:55], a[152:155], v[140:143]
  ds_read_b64_tr_b16 v[42:43], v2 offset:42784
  buffer_load_dwordx4 v21, s[8:11], s63 offen  lds
  v_mfma_f32_16x16x32_bf16 v[172:175], v[48:51], a[148:151], v[172:175]
  ds_read_b64_tr_b16 v[44:45], v14 offset:34336
  v_mfma_f32_16x16x32_bf16 v[172:175], v[52:55], a[156:159], v[172:175]
  ds_read_b64_tr_b16 v[46:47], v14 offset:42784
  s_waitcnt lgkmcnt(8)
  v_mfma_f32_16x16x32_bf16 a[28:31], v[56:59], a[144:147], a[28:31]
  ds_read_b64_tr_b16 v[48:49], v2 offset:34368
  v_mfma_f32_16x16x32_bf16 a[28:31], v[60:63], a[152:155], a[28:31]
  ds_read_b64_tr_b16 v[50:51], v2 offset:42816
  v_mfma_f32_16x16x32_bf16 a[92:95], v[56:59], a[148:151], a[92:95]
  ds_read_b64_tr_b16 v[52:53], v14 offset:34368
  v_mfma_f32_16x16x32_bf16 a[92:95], v[60:63], a[156:159], a[92:95]
  ds_read_b64_tr_b16 v[54:55], v14 offset:42816
  s_waitcnt lgkmcnt(8)
  v_mfma_f32_16x16x32_bf16 v[144:147], v[32:35], a[144:147], v[144:147]
  ds_read_b64_tr_b16 v[56:57], v2 offset:34400
  s_add_u32 m0, s31, 71744
  v_mfma_f32_16x16x32_bf16 v[144:147], v[36:39], a[152:155], v[144:147]
  ds_read_b64_tr_b16 v[58:59], v2 offset:42848
  buffer_load_dwordx4 v22, s[8:11], s63 offen  lds
  v_mfma_f32_16x16x32_bf16 v[176:179], v[32:35], a[148:151], v[176:179]
  ds_read_b64_tr_b16 v[60:61], v14 offset:34400
  v_mfma_f32_16x16x32_bf16 v[176:179], v[36:39], a[156:159], v[176:179]
  ds_read_b64_tr_b16 v[62:63], v14 offset:42848
  s_waitcnt lgkmcnt(8)
  v_mfma_f32_16x16x32_bf16 a[36:39], v[40:43], a[144:147], a[36:39]
  ds_read_b64_tr_b16 v[32:33], v2 offset:34560
  v_mfma_f32_16x16x32_bf16 a[36:39], v[44:47], a[152:155], a[36:39]
  ds_read_b64_tr_b16 v[34:35], v2 offset:43008
  v_mfma_f32_16x16x32_bf16 a[100:103], v[40:43], a[148:151], a[100:103]
  ds_read_b64_tr_b16 v[36:37], v14 offset:34560
  v_mfma_f32_16x16x32_bf16 a[100:103], v[44:47], a[156:159], a[100:103]
  ds_read_b64_tr_b16 v[38:39], v14 offset:43008
  s_waitcnt lgkmcnt(8)
  v_mfma_f32_16x16x32_bf16 v[148:151], v[48:51], a[144:147], v[148:151]
  ds_read_b64_tr_b16 v[40:41], v2 offset:34592
  s_add_u32 m0, s31, 72800
  v_mfma_f32_16x16x32_bf16 v[148:151], v[52:55], a[152:155], v[148:151]
  ds_read_b64_tr_b16 v[42:43], v2 offset:43040
  buffer_load_dwordx4 v23, s[8:11], s63 offen  lds
  v_mfma_f32_16x16x32_bf16 v[180:183], v[48:51], a[148:151], v[180:183]
  ds_read_b64_tr_b16 v[44:45], v14 offset:34592
  v_mfma_f32_16x16x32_bf16 v[180:183], v[52:55], a[156:159], v[180:183]
  ds_read_b64_tr_b16 v[46:47], v14 offset:43040
  s_waitcnt lgkmcnt(8)
  v_mfma_f32_16x16x32_bf16 a[44:47], v[56:59], a[144:147], a[44:47]
  ds_read_b64_tr_b16 v[48:49], v2 offset:34624
  v_mfma_f32_16x16x32_bf16 a[44:47], v[60:63], a[152:155], a[44:47]
  ds_read_b64_tr_b16 v[50:51], v2 offset:43072
  v_mfma_f32_16x16x32_bf16 a[108:111], v[56:59], a[148:151], a[108:111]
  ds_read_b64_tr_b16 v[52:53], v14 offset:34624
  v_mfma_f32_16x16x32_bf16 a[108:111], v[60:63], a[156:159], a[108:111]
  ds_read_b64_tr_b16 v[54:55], v14 offset:43072
  s_waitcnt lgkmcnt(8)
  v_mfma_f32_16x16x32_bf16 v[152:155], v[32:35], a[144:147], v[152:155]
  ds_read_b64_tr_b16 v[56:57], v2 offset:34656
  v_mfma_f32_16x16x32_bf16 v[152:155], v[36:39], a[152:155], v[152:155]
  ds_read_b64_tr_b16 v[58:59], v2 offset:43104
  s_waitcnt vmcnt(12)
  v_mfma_f32_16x16x32_bf16 v[184:187], v[32:35], a[148:151], v[184:187]
  ds_read_b64_tr_b16 v[60:61], v14 offset:34656
  s_barrier
  v_mfma_f32_16x16x32_bf16 v[184:187], v[36:39], a[156:159], v[184:187]
  ds_read_b64_tr_b16 v[62:63], v14 offset:43104
  s_waitcnt lgkmcnt(8)
  v_mfma_f32_16x16x32_bf16 a[52:55], v[40:43], a[144:147], a[52:55]
  ds_read_b64_tr_b16 v[32:33], v2 offset:50688
  s_add_u32 s63, s62, 1049088
  v_mfma_f32_16x16x32_bf16 a[52:55], v[44:47], a[152:155], a[52:55]
  ds_read_b64_tr_b16 v[34:35], v2 offset:59136
  s_add_u32 m0, s31, 18944
  v_mfma_f32_16x16x32_bf16 a[116:119], v[40:43], a[148:151], a[116:119]
  ds_read_b64_tr_b16 v[36:37], v14 offset:50688
  buffer_load_dwordx4 v20, s[8:11], s63 offen  lds
  v_mfma_f32_16x16x32_bf16 a[116:119], v[44:47], a[156:159], a[116:119]
  ds_read_b64_tr_b16 v[38:39], v14 offset:59136
  s_waitcnt lgkmcnt(8)
  v_mfma_f32_16x16x32_bf16 v[156:159], v[48:51], a[144:147], v[156:159]
  ds_read_b64_tr_b16 v[40:41], v2 offset:50720
  v_mfma_f32_16x16x32_bf16 v[156:159], v[52:55], a[152:155], v[156:159]
  ds_read_b64_tr_b16 v[42:43], v2 offset:59168
  v_mfma_f32_16x16x32_bf16 v[188:191], v[48:51], a[148:151], v[188:191]
  ds_read_b64_tr_b16 v[44:45], v14 offset:50720
  v_mfma_f32_16x16x32_bf16 v[188:191], v[52:55], a[156:159], v[188:191]
  ds_read_b64_tr_b16 v[46:47], v14 offset:59168
  s_waitcnt lgkmcnt(8)
  v_mfma_f32_16x16x32_bf16 a[60:63], v[56:59], a[144:147], a[60:63]
  ds_read_b64_tr_b16 v[48:49], v2 offset:50752
  s_add_u32 m0, s31, 20000
  v_mfma_f32_16x16x32_bf16 a[60:63], v[60:63], a[152:155], a[60:63]
  ds_read_b64_tr_b16 v[50:51], v2 offset:59200
  buffer_load_dwordx4 v21, s[8:11], s63 offen  lds
  v_mfma_f32_16x16x32_bf16 a[124:127], v[56:59], a[148:151], a[124:127]
  ds_read_b64_tr_b16 v[52:53], v14 offset:50752
  v_mfma_f32_16x16x32_bf16 a[124:127], v[60:63], a[156:159], a[124:127]
  ds_read_b64_tr_b16 v[54:55], v14 offset:59200
  s_waitcnt lgkmcnt(8)
  v_mfma_f32_16x16x32_bf16 v[192:195], v[32:35], a[144:147], v[192:195]
  ds_read_b64_tr_b16 v[56:57], v2 offset:50784
  v_mfma_f32_16x16x32_bf16 v[192:195], v[36:39], a[152:155], v[192:195]
  ds_read_b64_tr_b16 v[58:59], v2 offset:59232
  v_mfma_f32_16x16x32_bf16 v[224:227], v[32:35], a[148:151], v[224:227]
  ds_read_b64_tr_b16 v[60:61], v14 offset:50784
  v_mfma_f32_16x16x32_bf16 v[224:227], v[36:39], a[156:159], v[224:227]
  ds_read_b64_tr_b16 v[62:63], v14 offset:59232
  s_waitcnt lgkmcnt(8)
  v_mfma_f32_16x16x32_bf16 v[64:67], v[40:43], a[144:147], v[64:67]
  ds_read_b64_tr_b16 v[32:33], v2 offset:50944
  s_add_u32 m0, s31, 21056
  v_mfma_f32_16x16x32_bf16 v[64:67], v[44:47], a[152:155], v[64:67]
  ds_read_b64_tr_b16 v[34:35], v2 offset:59392
  buffer_load_dwordx4 v22, s[8:11], s63 offen  lds
  v_mfma_f32_16x16x32_bf16 v[68:71], v[40:43], a[148:151], v[68:71]
  ds_read_b64_tr_b16 v[36:37], v14 offset:50944
  v_mfma_f32_16x16x32_bf16 v[68:71], v[44:47], a[156:159], v[68:71]
  ds_read_b64_tr_b16 v[38:39], v14 offset:59392
  s_waitcnt lgkmcnt(8)
  v_mfma_f32_16x16x32_bf16 v[196:199], v[48:51], a[144:147], v[196:199]
  ds_read_b64_tr_b16 v[40:41], v2 offset:50976
  v_mfma_f32_16x16x32_bf16 v[196:199], v[52:55], a[152:155], v[196:199]
  ds_read_b64_tr_b16 v[42:43], v2 offset:59424
  v_mfma_f32_16x16x32_bf16 v[228:231], v[48:51], a[148:151], v[228:231]
  ds_read_b64_tr_b16 v[44:45], v14 offset:50976
  v_mfma_f32_16x16x32_bf16 v[228:231], v[52:55], a[156:159], v[228:231]
  ds_read_b64_tr_b16 v[46:47], v14 offset:59424
  s_waitcnt lgkmcnt(8)
  v_mfma_f32_16x16x32_bf16 v[72:75], v[56:59], a[144:147], v[72:75]
  ds_read_b64_tr_b16 v[48:49], v2 offset:51008
  s_add_u32 m0, s31, 22112
  v_mfma_f32_16x16x32_bf16 v[72:75], v[60:63], a[152:155], v[72:75]
  ds_read_b64_tr_b16 v[50:51], v2 offset:59456
  buffer_load_dwordx4 v23, s[8:11], s63 offen  lds
  v_mfma_f32_16x16x32_bf16 v[76:79], v[56:59], a[148:151], v[76:79]
  ds_read_b64_tr_b16 v[52:53], v14 offset:51008
  v_mfma_f32_16x16x32_bf16 v[76:79], v[60:63], a[156:159], v[76:79]
  ds_read_b64_tr_b16 v[54:55], v14 offset:59456
  s_waitcnt lgkmcnt(8)
  v_mfma_f32_16x16x32_bf16 v[200:203], v[32:35], a[144:147], v[200:203]
  ds_read_b64_tr_b16 v[56:57], v2 offset:51040
  v_mfma_f32_16x16x32_bf16 v[200:203], v[36:39], a[152:155], v[200:203]
  ds_read_b64_tr_b16 v[58:59], v2 offset:59488
  s_add_u32 s63, s62, 1311232
  v_mfma_f32_16x16x32_bf16 v[232:235], v[32:35], a[148:151], v[232:235]
  ds_read_b64_tr_b16 v[60:61], v14 offset:51040
  v_mfma_f32_16x16x32_bf16 v[232:235], v[36:39], a[156:159], v[232:235]
  ds_read_b64_tr_b16 v[62:63], v14 offset:59488
  s_waitcnt lgkmcnt(8)
  v_mfma_f32_16x16x32_bf16 v[80:83], v[40:43], a[144:147], v[80:83]
  ds_read_b64_tr_b16 v[32:33], v2 offset:51200
  s_waitcnt vmcnt(8)
  v_add_u32 v29, 137216, v25
  v_mfma_f32_16x16x32_bf16 v[80:83], v[44:47], a[152:155], v[80:83]
  ds_read_b64_tr_b16 v[34:35], v2 offset:59648
  ds_read_b128 a[160:163], v29 offset:0
  ds_read_b128 a[164:167], v29 offset:2112
  v_mfma_f32_16x16x32_bf16 v[84:87], v[40:43], a[148:151], v[84:87]
  ds_read_b64_tr_b16 v[36:37], v14 offset:51200
  v_mfma_f32_16x16x32_bf16 v[84:87], v[44:47], a[156:159], v[84:87]
  ds_read_b64_tr_b16 v[38:39], v14 offset:59648
  s_waitcnt lgkmcnt(10)
  v_mfma_f32_16x16x32_bf16 v[204:207], v[48:51], a[144:147], v[204:207]
  ds_read_b64_tr_b16 v[40:41], v2 offset:51232
  s_add_u32 m0, s31, 86528
  v_mfma_f32_16x16x32_bf16 v[204:207], v[52:55], a[152:155], v[204:207]
  ds_read_b64_tr_b16 v[42:43], v2 offset:59680
  buffer_load_dwordx4 v20, s[8:11], s63 offen  lds
  v_mfma_f32_16x16x32_bf16 v[236:239], v[48:51], a[148:151], v[236:239]
  ds_read_b64_tr_b16 v[44:45], v14 offset:51232
  v_mfma_f32_16x16x32_bf16 v[236:239], v[52:55], a[156:159], v[236:239]
  ds_read_b64_tr_b16 v[46:47], v14 offset:59680
  s_waitcnt lgkmcnt(10)
  v_mfma_f32_16x16x32_bf16 v[88:91], v[56:59], a[144:147], v[88:91]
  ds_read_b64_tr_b16 v[48:49], v2 offset:51264
  s_add_u32 m0, s31, 87584
  v_mfma_f32_16x16x32_bf16 v[88:91], v[60:63], a[152:155], v[88:91]
  ds_read_b64_tr_b16 v[50:51], v2 offset:59712
  buffer_load_dwordx4 v21, s[8:11], s63 offen  lds
  v_mfma_f32_16x16x32_bf16 v[92:95], v[56:59], a[148:151], v[92:95]
  ds_read_b64_tr_b16 v[52:53], v14 offset:51264
  v_mfma_f32_16x16x32_bf16 v[92:95], v[60:63], a[156:159], v[92:95]
  ds_read_b64_tr_b16 v[54:55], v14 offset:59712
  s_waitcnt lgkmcnt(8)
  v_mfma_f32_16x16x32_bf16 v[208:211], v[32:35], a[144:147], v[208:211]
  ds_read_b64_tr_b16 v[56:57], v2 offset:51296
  s_add_u32 m0, s31, 88640
  v_mfma_f32_16x16x32_bf16 v[208:211], v[36:39], a[152:155], v[208:211]
  ds_read_b64_tr_b16 v[58:59], v2 offset:59744
  buffer_load_dwordx4 v22, s[8:11], s63 offen  lds
  v_mfma_f32_16x16x32_bf16 v[240:243], v[32:35], a[148:151], v[240:243]
  ds_read_b64_tr_b16 v[60:61], v14 offset:51296
  ds_read_b128 a[168:171], v29 offset:64
  ds_read_b128 a[172:175], v29 offset:2176
  v_mfma_f32_16x16x32_bf16 v[240:243], v[36:39], a[156:159], v[240:243]
  ds_read_b64_tr_b16 v[62:63], v14 offset:59744
  s_waitcnt lgkmcnt(10)
  v_mfma_f32_16x16x32_bf16 v[96:99], v[40:43], a[144:147], v[96:99]
  ds_read_b64_tr_b16 v[32:33], v2 offset:51456
  v_mfma_f32_16x16x32_bf16 v[96:99], v[44:47], a[152:155], v[96:99]
  ds_read_b64_tr_b16 v[34:35], v2 offset:59904
  v_mfma_f32_16x16x32_bf16 v[100:103], v[40:43], a[148:151], v[100:103]
  ds_read_b64_tr_b16 v[36:37], v14 offset:51456
  v_mfma_f32_16x16x32_bf16 v[100:103], v[44:47], a[156:159], v[100:103]
  ds_read_b64_tr_b16 v[38:39], v14 offset:59904
  s_waitcnt lgkmcnt(10)
  v_mfma_f32_16x16x32_bf16 v[212:215], v[48:51], a[144:147], v[212:215]
  ds_read_b64_tr_b16 v[40:41], v2 offset:51488
  s_add_u32 m0, s31, 89696
  v_mfma_f32_16x16x32_bf16 v[212:215], v[52:55], a[152:155], v[212:215]
  ds_read_b64_tr_b16 v[42:43], v2 offset:59936
  buffer_load_dwordx4 v23, s[8:11], s63 offen  lds
  v_mfma_f32_16x16x32_bf16 v[244:247], v[48:51], a[148:151], v[244:247]
  ds_read_b64_tr_b16 v[44:45], v14 offset:51488
  v_mfma_f32_16x16x32_bf16 v[244:247], v[52:55], a[156:159], v[244:247]
  ds_read_b64_tr_b16 v[46:47], v14 offset:59936
  s_waitcnt lgkmcnt(8)
  v_mfma_f32_16x16x32_bf16 v[104:107], v[56:59], a[144:147], v[104:107]
  ds_read_b64_tr_b16 v[48:49], v2 offset:51520
  v_mfma_f32_16x16x32_bf16 v[104:107], v[60:63], a[152:155], v[104:107]
  ds_read_b64_tr_b16 v[50:51], v2 offset:59968
  v_mfma_f32_16x16x32_bf16 v[108:111], v[56:59], a[148:151], v[108:111]
  ds_read_b64_tr_b16 v[52:53], v14 offset:51520
  v_mfma_f32_16x16x32_bf16 v[108:111], v[60:63], a[156:159], v[108:111]
  ds_read_b64_tr_b16 v[54:55], v14 offset:59968
  s_add_u32 m0, s31, 136832
  s_waitcnt lgkmcnt(8)
  v_mfma_f32_16x16x32_bf16 v[216:219], v[32:35], a[144:147], v[216:219]
  ds_read_b64_tr_b16 v[56:57], v2 offset:51552
  buffer_load_dwordx4 v24, s[4:7], 0 offen offset:384  lds
  v_mfma_f32_16x16x32_bf16 v[216:219], v[36:39], a[152:155], v[216:219]
  ds_read_b64_tr_b16 v[58:59], v2 offset:60000
  s_waitcnt vmcnt(9)
  v_mfma_f32_16x16x32_bf16 v[248:251], v[32:35], a[148:151], v[248:251]
  ds_read_b64_tr_b16 v[60:61], v14 offset:51552
  s_barrier
  v_mfma_f32_16x16x32_bf16 v[248:251], v[36:39], a[156:159], v[248:251]
  ds_read_b64_tr_b16 v[62:63], v14 offset:60000
  s_waitcnt lgkmcnt(8)
  v_mfma_f32_16x16x32_bf16 v[112:115], v[40:43], a[144:147], v[112:115]
  ds_read_b64_tr_b16 v[32:33], v2 offset:0
  s_add_u32 m0, s31, 137920
  v_mfma_f32_16x16x32_bf16 v[112:115], v[44:47], a[152:155], v[112:115]
  ds_read_b64_tr_b16 v[34:35], v2 offset:8448
  buffer_load_dwordx4 v24, s[4:7], s60 offen offset:384  lds
  v_mfma_f32_16x16x32_bf16 v[116:119], v[40:43], a[148:151], v[116:119]
  ds_read_b64_tr_b16 v[36:37], v14 offset:0
  s_add_u32 s63, s62, 1572864
  v_mfma_f32_16x16x32_bf16 v[116:119], v[44:47], a[156:159], v[116:119]
  ds_read_b64_tr_b16 v[38:39], v14 offset:8448
  s_waitcnt lgkmcnt(8)
  v_mfma_f32_16x16x32_bf16 v[220:223], v[48:51], a[144:147], v[220:223]
  ds_read_b64_tr_b16 v[40:41], v2 offset:32
  v_mfma_f32_16x16x32_bf16 v[220:223], v[52:55], a[152:155], v[220:223]
  ds_read_b64_tr_b16 v[42:43], v2 offset:8480
  s_add_u32 m0, s31, 138944
  v_mfma_f32_16x16x32_bf16 v[252:255], v[48:51], a[148:151], v[252:255]
  ds_read_b64_tr_b16 v[44:45], v14 offset:32
  buffer_load_dwordx4 v24, s[4:7], s61 offen offset:384  lds
  v_mfma_f32_16x16x32_bf16 v[252:255], v[52:55], a[156:159], v[252:255]
  ds_read_b64_tr_b16 v[46:47], v14 offset:8480
  s_waitcnt lgkmcnt(8)
  v_mfma_f32_16x16x32_bf16 v[120:123], v[56:59], a[144:147], v[120:123]
  ds_read_b64_tr_b16 v[48:49], v2 offset:64
  s_add_u32 m0, s31, 35840
  v_mfma_f32_16x16x32_bf16 v[120:123], v[60:63], a[152:155], v[120:123]
  ds_read_b64_tr_b16 v[50:51], v2 offset:8512
  buffer_load_dwordx4 v20, s[8:11], s63 offen  lds
  v_mfma_f32_16x16x32_bf16 v[124:127], v[56:59], a[148:151], v[124:127]
  ds_read_b64_tr_b16 v[52:53], v14 offset:64
  s_add_u32 m0, s31, 140032
  v_mfma_f32_16x16x32_bf16 v[124:127], v[60:63], a[156:159], v[124:127]
  ds_read_b64_tr_b16 v[54:55], v14 offset:8512
  buffer_load_dwordx4 v24, s[4:7], s65 offen offset:384  lds
  s_waitcnt lgkmcnt(8)
  v_mfma_f32_16x16x32_bf16 v[128:131], v[32:35], a[160:163], v[128:131]
  ds_read_b64_tr_b16 v[56:57], v2 offset:96
  s_add_u32 m0, s31, 36896
  v_mfma_f32_16x16x32_bf16 v[128:131], v[36:39], a[168:171], v[128:131]
  ds_read_b64_tr_b16 v[58:59], v2 offset:8544
  buffer_load_dwordx4 v21, s[8:11], s63 offen  lds
  v_mfma_f32_16x16x32_bf16 v[160:163], v[32:35], a[164:167], v[160:163]
  ds_read_b64_tr_b16 v[60:61], v14 offset:96
  v_mfma_f32_16x16x32_bf16 v[160:163], v[36:39], a[172:175], v[160:163]
  ds_read_b64_tr_b16 v[62:63], v14 offset:8544
  s_waitcnt lgkmcnt(8)
  v_mfma_f32_16x16x32_bf16 a[4:7], v[40:43], a[160:163], a[4:7]
  ds_read_b64_tr_b16 v[32:33], v2 offset:256
  s_add_u32 m0, s31, 37952
  v_mfma_f32_16x16x32_bf16 a[4:7], v[44:47], a[168:171], a[4:7]
  ds_read_b64_tr_b16 v[34:35], v2 offset:8704
  buffer_load_dwordx4 v22, s[8:11], s63 offen  lds
  v_mfma_f32_16x16x32_bf16 a[68:71], v[40:43], a[164:167], a[68:71]
  ds_read_b64_tr_b16 v[36:37], v14 offset:256
  v_mfma_f32_16x16x32_bf16 a[68:71], v[44:47], a[172:175], a[68:71]
  ds_read_b64_tr_b16 v[38:39], v14 offset:8704
  s_waitcnt lgkmcnt(8)
  v_mfma_f32_16x16x32_bf16 v[132:135], v[48:51], a[160:163], v[132:135]
  ds_read_b64_tr_b16 v[40:41], v2 offset:288
  v_mfma_f32_16x16x32_bf16 v[132:135], v[52:55], a[168:171], v[132:135]
  ds_read_b64_tr_b16 v[42:43], v2 offset:8736
  v_mfma_f32_16x16x32_bf16 v[164:167], v[48:51], a[164:167], v[164:167]
  ds_read_b64_tr_b16 v[44:45], v14 offset:288
  v_mfma_f32_16x16x32_bf16 v[164:167], v[52:55], a[172:175], v[164:167]
  ds_read_b64_tr_b16 v[46:47], v14 offset:8736
  s_waitcnt lgkmcnt(8)
  v_mfma_f32_16x16x32_bf16 a[12:15], v[56:59], a[160:163], a[12:15]
  ds_read_b64_tr_b16 v[48:49], v2 offset:320
  s_add_u32 m0, s31, 39008
  v_mfma_f32_16x16x32_bf16 a[12:15], v[60:63], a[168:171], a[12:15]
  ds_read_b64_tr_b16 v[50:51], v2 offset:8768
  buffer_load_dwordx4 v23, s[8:11], s63 offen  lds
  v_mfma_f32_16x16x32_bf16 a[76:79], v[56:59], a[164:167], a[76:79]
  ds_read_b64_tr_b16 v[52:53], v14 offset:320
  v_mfma_f32_16x16x32_bf16 a[76:79], v[60:63], a[172:175], a[76:79]
  ds_read_b64_tr_b16 v[54:55], v14 offset:8768
  s_waitcnt lgkmcnt(8)
  v_mfma_f32_16x16x32_bf16 v[136:139], v[32:35], a[160:163], v[136:139]
  ds_read_b64_tr_b16 v[56:57], v2 offset:352
  v_mfma_f32_16x16x32_bf16 v[136:139], v[36:39], a[168:171], v[136:139]
  ds_read_b64_tr_b16 v[58:59], v2 offset:8800
  s_add_u32 s63, s62, 1835008
  v_mfma_f32_16x16x32_bf16 v[168:171], v[32:35], a[164:167], v[168:171]
  ds_read_b64_tr_b16 v[60:61], v14 offset:352
  v_mfma_f32_16x16x32_bf16 v[168:171], v[36:39], a[172:175], v[168:171]
  ds_read_b64_tr_b16 v[62:63], v14 offset:8800
  s_waitcnt lgkmcnt(8)
  v_mfma_f32_16x16x32_bf16 a[20:23], v[40:43], a[160:163], a[20:23]
  ds_read_b64_tr_b16 v[32:33], v2 offset:512
  s_add_u32 m0, s31, 103424
  v_mfma_f32_16x16x32_bf16 a[20:23], v[44:47], a[168:171], a[20:23]
  ds_read_b64_tr_b16 v[34:35], v2 offset:8960
  buffer_load_dwordx4 v20, s[8:11], s63 offen  lds
  v_mfma_f32_16x16x32_bf16 a[84:87], v[40:43], a[164:167], a[84:87]
  ds_read_b64_tr_b16 v[36:37], v14 offset:512
  v_mfma_f32_16x16x32_bf16 a[84:87], v[44:47], a[172:175], a[84:87]
  ds_read_b64_tr_b16 v[38:39], v14 offset:8960
  s_waitcnt lgkmcnt(8)
  v_mfma_f32_16x16x32_bf16 v[140:143], v[48:51], a[160:163], v[140:143]
  ds_read_b64_tr_b16 v[40:41], v2 offset:544
  s_add_u32 m0, s31, 104480
  v_mfma_f32_16x16x32_bf16 v[140:143], v[52:55], a[168:171], v[140:143]
  ds_read_b64_tr_b16 v[42:43], v2 offset:8992
  buffer_load_dwordx4 v21, s[8:11], s63 offen  lds
  v_mfma_f32_16x16x32_bf16 v[172:175], v[48:51], a[164:167], v[172:175]
  ds_read_b64_tr_b16 v[44:45], v14 offset:544
  v_mfma_f32_16x16x32_bf16 v[172:175], v[52:55], a[172:175], v[172:175]
  ds_read_b64_tr_b16 v[46:47], v14 offset:8992
  s_waitcnt lgkmcnt(8)
  v_mfma_f32_16x16x32_bf16 a[28:31], v[56:59], a[160:163], a[28:31]
  ds_read_b64_tr_b16 v[48:49], v2 offset:576
  v_mfma_f32_16x16x32_bf16 a[28:31], v[60:63], a[168:171], a[28:31]
  ds_read_b64_tr_b16 v[50:51], v2 offset:9024
  v_mfma_f32_16x16x32_bf16 a[92:95], v[56:59], a[164:167], a[92:95]
  ds_read_b64_tr_b16 v[52:53], v14 offset:576
  v_mfma_f32_16x16x32_bf16 a[92:95], v[60:63], a[172:175], a[92:95]
  ds_read_b64_tr_b16 v[54:55], v14 offset:9024
  s_waitcnt lgkmcnt(8)
  v_mfma_f32_16x16x32_bf16 v[144:147], v[32:35], a[160:163], v[144:147]
  ds_read_b64_tr_b16 v[56:57], v2 offset:608
  s_add_u32 m0, s31, 105536
  v_mfma_f32_16x16x32_bf16 v[144:147], v[36:39], a[168:171], v[144:147]
  ds_read_b64_tr_b16 v[58:59], v2 offset:9056
  buffer_load_dwordx4 v22, s[8:11], s63 offen  lds
  v_mfma_f32_16x16x32_bf16 v[176:179], v[32:35], a[164:167], v[176:179]
  ds_read_b64_tr_b16 v[60:61], v14 offset:608
  v_mfma_f32_16x16x32_bf16 v[176:179], v[36:39], a[172:175], v[176:179]
  ds_read_b64_tr_b16 v[62:63], v14 offset:9056
  s_waitcnt lgkmcnt(8)
  v_mfma_f32_16x16x32_bf16 a[36:39], v[40:43], a[160:163], a[36:39]
  ds_read_b64_tr_b16 v[32:33], v2 offset:768
  v_mfma_f32_16x16x32_bf16 a[36:39], v[44:47], a[168:171], a[36:39]
  ds_read_b64_tr_b16 v[34:35], v2 offset:9216
  v_mfma_f32_16x16x32_bf16 a[100:103], v[40:43], a[164:167], a[100:103]
  ds_read_b64_tr_b16 v[36:37], v14 offset:768
  v_mfma_f32_16x16x32_bf16 a[100:103], v[44:47], a[172:175], a[100:103]
  ds_read_b64_tr_b16 v[38:39], v14 offset:9216
  s_waitcnt lgkmcnt(8)
  v_mfma_f32_16x16x32_bf16 v[148:151], v[48:51], a[160:163], v[148:151]
  ds_read_b64_tr_b16 v[40:41], v2 offset:800
  s_add_u32 m0, s31, 106592
  v_mfma_f32_16x16x32_bf16 v[148:151], v[52:55], a[168:171], v[148:151]
  ds_read_b64_tr_b16 v[42:43], v2 offset:9248
  buffer_load_dwordx4 v23, s[8:11], s63 offen  lds
  v_mfma_f32_16x16x32_bf16 v[180:183], v[48:51], a[164:167], v[180:183]
  ds_read_b64_tr_b16 v[44:45], v14 offset:800
  v_mfma_f32_16x16x32_bf16 v[180:183], v[52:55], a[172:175], v[180:183]
  ds_read_b64_tr_b16 v[46:47], v14 offset:9248
  s_waitcnt lgkmcnt(8)
  v_mfma_f32_16x16x32_bf16 a[44:47], v[56:59], a[160:163], a[44:47]
  ds_read_b64_tr_b16 v[48:49], v2 offset:832
  v_mfma_f32_16x16x32_bf16 a[44:47], v[60:63], a[168:171], a[44:47]
  ds_read_b64_tr_b16 v[50:51], v2 offset:9280
  v_mfma_f32_16x16x32_bf16 a[108:111], v[56:59], a[164:167], a[108:111]
  ds_read_b64_tr_b16 v[52:53], v14 offset:832
  v_mfma_f32_16x16x32_bf16 a[108:111], v[60:63], a[172:175], a[108:111]
  ds_read_b64_tr_b16 v[54:55], v14 offset:9280
  s_waitcnt lgkmcnt(8)
  v_mfma_f32_16x16x32_bf16 v[152:155], v[32:35], a[160:163], v[152:155]
  ds_read_b64_tr_b16 v[56:57], v2 offset:864
  v_mfma_f32_16x16x32_bf16 v[152:155], v[36:39], a[168:171], v[152:155]
  ds_read_b64_tr_b16 v[58:59], v2 offset:9312
  s_waitcnt vmcnt(12)
  v_mfma_f32_16x16x32_bf16 v[184:187], v[32:35], a[164:167], v[184:187]
  ds_read_b64_tr_b16 v[60:61], v14 offset:864
  s_barrier
  v_mfma_f32_16x16x32_bf16 v[184:187], v[36:39], a[172:175], v[184:187]
  ds_read_b64_tr_b16 v[62:63], v14 offset:9312
  s_waitcnt lgkmcnt(8)
  v_mfma_f32_16x16x32_bf16 a[52:55], v[40:43], a[160:163], a[52:55]
  ds_read_b64_tr_b16 v[32:33], v2 offset:16896
  s_add_u32 s63, s62, 1573376
  v_mfma_f32_16x16x32_bf16 a[52:55], v[44:47], a[168:171], a[52:55]
  ds_read_b64_tr_b16 v[34:35], v2 offset:25344
  s_add_u32 m0, s31, 52736
  v_mfma_f32_16x16x32_bf16 a[116:119], v[40:43], a[164:167], a[116:119]
  ds_read_b64_tr_b16 v[36:37], v14 offset:16896
  buffer_load_dwordx4 v20, s[8:11], s63 offen  lds
  v_mfma_f32_16x16x32_bf16 a[116:119], v[44:47], a[172:175], a[116:119]
  ds_read_b64_tr_b16 v[38:39], v14 offset:25344
  s_waitcnt lgkmcnt(8)
  v_mfma_f32_16x16x32_bf16 v[156:159], v[48:51], a[160:163], v[156:159]
  ds_read_b64_tr_b16 v[40:41], v2 offset:16928
  v_mfma_f32_16x16x32_bf16 v[156:159], v[52:55], a[168:171], v[156:159]
  ds_read_b64_tr_b16 v[42:43], v2 offset:25376
  v_mfma_f32_16x16x32_bf16 v[188:191], v[48:51], a[164:167], v[188:191]
  ds_read_b64_tr_b16 v[44:45], v14 offset:16928
  v_mfma_f32_16x16x32_bf16 v[188:191], v[52:55], a[172:175], v[188:191]
  ds_read_b64_tr_b16 v[46:47], v14 offset:25376
  s_waitcnt lgkmcnt(8)
  v_mfma_f32_16x16x32_bf16 a[60:63], v[56:59], a[160:163], a[60:63]
  ds_read_b64_tr_b16 v[48:49], v2 offset:16960
  s_add_u32 m0, s31, 53792
  v_mfma_f32_16x16x32_bf16 a[60:63], v[60:63], a[168:171], a[60:63]
  ds_read_b64_tr_b16 v[50:51], v2 offset:25408
  buffer_load_dwordx4 v21, s[8:11], s63 offen  lds
  v_mfma_f32_16x16x32_bf16 a[124:127], v[56:59], a[164:167], a[124:127]
  ds_read_b64_tr_b16 v[52:53], v14 offset:16960
  v_mfma_f32_16x16x32_bf16 a[124:127], v[60:63], a[172:175], a[124:127]
  ds_read_b64_tr_b16 v[54:55], v14 offset:25408
  s_waitcnt lgkmcnt(8)
  v_mfma_f32_16x16x32_bf16 v[192:195], v[32:35], a[160:163], v[192:195]
  ds_read_b64_tr_b16 v[56:57], v2 offset:16992
  v_mfma_f32_16x16x32_bf16 v[192:195], v[36:39], a[168:171], v[192:195]
  ds_read_b64_tr_b16 v[58:59], v2 offset:25440
  v_mfma_f32_16x16x32_bf16 v[224:227], v[32:35], a[164:167], v[224:227]
  ds_read_b64_tr_b16 v[60:61], v14 offset:16992
  v_mfma_f32_16x16x32_bf16 v[224:227], v[36:39], a[172:175], v[224:227]
  ds_read_b64_tr_b16 v[62:63], v14 offset:25440
  s_waitcnt lgkmcnt(8)
  v_mfma_f32_16x16x32_bf16 v[64:67], v[40:43], a[160:163], v[64:67]
  ds_read_b64_tr_b16 v[32:33], v2 offset:17152
  v_mfma_f32_16x16x32_bf16 v[64:67], v[44:47], a[168:171], v[64:67]
  ds_read_b64_tr_b16 v[34:35], v2 offset:25600
  s_waitcnt vmcnt(9)
  v_add_u32 v29, 137216, v25
  v_mfma_f32_16x16x32_bf16 v[68:71], v[40:43], a[164:167], v[68:71]
  ds_read_b64_tr_b16 v[36:37], v14 offset:17152
  ds_read_b128 a[176:179], v29 offset:0
  ds_read_b128 a[180:183], v29 offset:2112
  v_mfma_f32_16x16x32_bf16 v[68:71], v[44:47], a[172:175], v[68:71]
  ds_read_b64_tr_b16 v[38:39], v14 offset:25600
  s_waitcnt lgkmcnt(10)
  v_mfma_f32_16x16x32_bf16 v[196:199], v[48:51], a[160:163], v[196:199]
  ds_read_b64_tr_b16 v[40:41], v2 offset:17184
  s_add_u32 m0, s31, 54848
  v_mfma_f32_16x16x32_bf16 v[196:199], v[52:55], a[168:171], v[196:199]
  ds_read_b64_tr_b16 v[42:43], v2 offset:25632
  buffer_load_dwordx4 v22, s[8:11], s63 offen  lds
  v_mfma_f32_16x16x32_bf16 v[228:231], v[48:51], a[164:167], v[228:231]
  ds_read_b64_tr_b16 v[44:45], v14 offset:17184
  v_mfma_f32_16x16x32_bf16 v[228:231], v[52:55], a[172:175], v[228:231]
  ds_read_b64_tr_b16 v[46:47], v14 offset:25632
  s_waitcnt lgkmcnt(10)
  v_mfma_f32_16x16x32_bf16 v[72:75], v[56:59], a[160:163], v[72:75]
  ds_read_b64_tr_b16 v[48:49], v2 offset:17216
  s_add_u32 m0, s31, 55904
  v_mfma_f32_16x16x32_bf16 v[72:75], v[60:63], a[168:171], v[72:75]
  ds_read_b64_tr_b16 v[50:51], v2 offset:25664
  buffer_load_dwordx4 v23, s[8:11], s63 offen  lds
  v_mfma_f32_16x16x32_bf16 v[76:79], v[56:59], a[164:167], v[76:79]
  ds_read_b64_tr_b16 v[52:53], v14 offset:17216
  v_mfma_f32_16x16x32_bf16 v[76:79], v[60:63], a[172:175], v[76:79]
  ds_read_b64_tr_b16 v[54:55], v14 offset:25664
  s_waitcnt lgkmcnt(8)
  v_mfma_f32_16x16x32_bf16 v[200:203], v[32:35], a[160:163], v[200:203]
  ds_read_b64_tr_b16 v[56:57], v2 offset:17248
  v_mfma_f32_16x16x32_bf16 v[200:203], v[36:39], a[168:171], v[200:203]
  ds_read_b64_tr_b16 v[58:59], v2 offset:25696
  s_add_u32 s63, s62, 1835520
  v_mfma_f32_16x16x32_bf16 v[232:235], v[32:35], a[164:167], v[232:235]
  ds_read_b64_tr_b16 v[60:61], v14 offset:17248
  v_mfma_f32_16x16x32_bf16 v[232:235], v[36:39], a[172:175], v[232:235]
  ds_read_b64_tr_b16 v[62:63], v14 offset:25696
  ds_read_b128 a[184:187], v29 offset:64
  s_waitcnt lgkmcnt(9)
  v_mfma_f32_16x16x32_bf16 v[80:83], v[40:43], a[160:163], v[80:83]
  ds_read_b64_tr_b16 v[32:33], v2 offset:17408
  ds_read_b128 a[188:191], v29 offset:2176
  v_mfma_f32_16x16x32_bf16 v[80:83], v[44:47], a[168:171], v[80:83]
  ds_read_b64_tr_b16 v[34:35], v2 offset:25856
  s_add_u32 m0, s31, 120320
  v_mfma_f32_16x16x32_bf16 v[84:87], v[40:43], a[164:167], v[84:87]
  ds_read_b64_tr_b16 v[36:37], v14 offset:17408
  buffer_load_dwordx4 v20, s[8:11], s63 offen  lds
  v_mfma_f32_16x16x32_bf16 v[84:87], v[44:47], a[172:175], v[84:87]
  ds_read_b64_tr_b16 v[38:39], v14 offset:25856
  s_waitcnt lgkmcnt(10)
  v_mfma_f32_16x16x32_bf16 v[204:207], v[48:51], a[160:163], v[204:207]
  ds_read_b64_tr_b16 v[40:41], v2 offset:17440
  s_add_u32 m0, s31, 121376
  v_mfma_f32_16x16x32_bf16 v[204:207], v[52:55], a[168:171], v[204:207]
  ds_read_b64_tr_b16 v[42:43], v2 offset:25888
  buffer_load_dwordx4 v21, s[8:11], s63 offen  lds
  v_mfma_f32_16x16x32_bf16 v[236:239], v[48:51], a[164:167], v[236:239]
  ds_read_b64_tr_b16 v[44:45], v14 offset:17440
  v_mfma_f32_16x16x32_bf16 v[236:239], v[52:55], a[172:175], v[236:239]
  ds_read_b64_tr_b16 v[46:47], v14 offset:25888
  s_waitcnt lgkmcnt(10)
  v_mfma_f32_16x16x32_bf16 v[88:91], v[56:59], a[160:163], v[88:91]
  ds_read_b64_tr_b16 v[48:49], v2 offset:17472
  v_mfma_f32_16x16x32_bf16 v[88:91], v[60:63], a[168:171], v[88:91]
  ds_read_b64_tr_b16 v[50:51], v2 offset:25920
  v_mfma_f32_16x16x32_bf16 v[92:95], v[56:59], a[164:167], v[92:95]
  ds_read_b64_tr_b16 v[52:53], v14 offset:17472
  v_mfma_f32_16x16x32_bf16 v[92:95], v[60:63], a[172:175], v[92:95]
  ds_read_b64_tr_b16 v[54:55], v14 offset:25920
  s_waitcnt lgkmcnt(8)
  v_mfma_f32_16x16x32_bf16 v[208:211], v[32:35], a[160:163], v[208:211]
  ds_read_b64_tr_b16 v[56:57], v2 offset:17504
  v_mfma_f32_16x16x32_bf16 v[208:211], v[36:39], a[168:171], v[208:211]
  ds_read_b64_tr_b16 v[58:59], v2 offset:25952
  s_add_u32 m0, s31, 136704
  v_mfma_f32_16x16x32_bf16 v[240:243], v[32:35], a[164:167], v[240:243]
  ds_read_b64_tr_b16 v[60:61], v14 offset:17504
  buffer_load_dwordx4 v24, s[4:7], 0 offen offset:512  lds
  v_mfma_f32_16x16x32_bf16 v[240:243], v[36:39], a[172:175], v[240:243]
  ds_read_b64_tr_b16 v[62:63], v14 offset:25952
  s_waitcnt lgkmcnt(8)
  v_mfma_f32_16x16x32_bf16 v[96:99], v[40:43], a[160:163], v[96:99]
  ds_read_b64_tr_b16 v[32:33], v2 offset:17664
  s_add_u32 m0, s31, 122432
  v_mfma_f32_16x16x32_bf16 v[96:99], v[44:47], a[168:171], v[96:99]
  ds_read_b64_tr_b16 v[34:35], v2 offset:26112
  buffer_load_dwordx4 v22, s[8:11], s63 offen  lds
  v_mfma_f32_16x16x32_bf16 v[100:103], v[40:43], a[164:167], v[100:103]
  ds_read_b64_tr_b16 v[36:37], v14 offset:17664
  s_add_u32 m0, s31, 137792
  v_mfma_f32_16x16x32_bf16 v[100:103], v[44:47], a[172:175], v[100:103]
  ds_read_b64_tr_b16 v[38:39], v14 offset:26112
  buffer_load_dwordx4 v24, s[4:7], s60 offen offset:512  lds
  s_waitcnt lgkmcnt(8)
  v_mfma_f32_16x16x32_bf16 v[212:215], v[48:51], a[160:163], v[212:215]
  ds_read_b64_tr_b16 v[40:41], v2 offset:17696
  s_add_u32 m0, s31, 123488
  v_mfma_f32_16x16x32_bf16 v[212:215], v[52:55], a[168:171], v[212:215]
  ds_read_b64_tr_b16 v[42:43], v2 offset:26144
  buffer_load_dwordx4 v23, s[8:11], s63 offen  lds
  v_mfma_f32_16x16x32_bf16 v[244:247], v[48:51], a[164:167], v[244:247]
  ds_read_b64_tr_b16 v[44:45], v14 offset:17696
  v_mfma_f32_16x16x32_bf16 v[244:247], v[52:55], a[172:175], v[244:247]
  ds_read_b64_tr_b16 v[46:47], v14 offset:26144
  s_add_u32 m0, s31, 138816
  s_waitcnt lgkmcnt(8)
  v_mfma_f32_16x16x32_bf16 v[104:107], v[56:59], a[160:163], v[104:107]
  ds_read_b64_tr_b16 v[48:49], v2 offset:17728
  buffer_load_dwordx4 v24, s[4:7], s61 offen offset:512  lds
  v_mfma_f32_16x16x32_bf16 v[104:107], v[60:63], a[168:171], v[104:107]
  ds_read_b64_tr_b16 v[50:51], v2 offset:26176
  v_mfma_f32_16x16x32_bf16 v[108:111], v[56:59], a[164:167], v[108:111]
  ds_read_b64_tr_b16 v[52:53], v14 offset:17728
  v_mfma_f32_16x16x32_bf16 v[108:111], v[60:63], a[172:175], v[108:111]
  ds_read_b64_tr_b16 v[54:55], v14 offset:26176
  s_waitcnt lgkmcnt(8)
  v_mfma_f32_16x16x32_bf16 v[216:219], v[32:35], a[160:163], v[216:219]
  ds_read_b64_tr_b16 v[56:57], v2 offset:17760
  s_add_u32 m0, s31, 139904
  v_mfma_f32_16x16x32_bf16 v[216:219], v[36:39], a[168:171], v[216:219]
  ds_read_b64_tr_b16 v[58:59], v2 offset:26208
  buffer_load_dwordx4 v24, s[4:7], s65 offen offset:512  lds
  s_waitcnt vmcnt(12)
  v_mfma_f32_16x16x32_bf16 v[248:251], v[32:35], a[164:167], v[248:251]
  ds_read_b64_tr_b16 v[60:61], v14 offset:17760
  s_barrier
  v_mfma_f32_16x16x32_bf16 v[248:251], v[36:39], a[172:175], v[248:251]
  ds_read_b64_tr_b16 v[62:63], v14 offset:26208
  s_waitcnt lgkmcnt(8)
  v_mfma_f32_16x16x32_bf16 v[112:115], v[40:43], a[160:163], v[112:115]
  ds_read_b64_tr_b16 v[32:33], v2 offset:33792
  s_add_u32 s63, s62, 2097152
  v_mfma_f32_16x16x32_bf16 v[112:115], v[44:47], a[168:171], v[112:115]
  ds_read_b64_tr_b16 v[34:35], v2 offset:42240
  s_add_u32 m0, s31, 2048
  v_mfma_f32_16x16x32_bf16 v[116:119], v[40:43], a[164:167], v[116:119]
  ds_read_b64_tr_b16 v[36:37], v14 offset:33792
  buffer_load_dwordx4 v20, s[8:11], s63 offen  lds
  v_mfma_f32_16x16x32_bf16 v[116:119], v[44:47], a[172:175], v[116:119]
  ds_read_b64_tr_b16 v[38:39], v14 offset:42240
  s_waitcnt lgkmcnt(8)
  v_mfma_f32_16x16x32_bf16 v[220:223], v[48:51], a[160:163], v[220:223]
  ds_read_b64_tr_b16 v[40:41], v2 offset:33824
  v_mfma_f32_16x16x32_bf16 v[220:223], v[52:55], a[168:171], v[220:223]
  ds_read_b64_tr_b16 v[42:43], v2 offset:42272
  v_mfma_f32_16x16x32_bf16 v[252:255], v[48:51], a[164:167], v[252:255]
  ds_read_b64_tr_b16 v[44:45], v14 offset:33824
  v_mfma_f32_16x16x32_bf16 v[252:255], v[52:55], a[172:175], v[252:255]
  ds_read_b64_tr_b16 v[46:47], v14 offset:42272
  s_waitcnt lgkmcnt(8)
  v_mfma_f32_16x16x32_bf16 v[120:123], v[56:59], a[160:163], v[120:123]
  ds_read_b64_tr_b16 v[48:49], v2 offset:33856
  s_add_u32 m0, s31, 3104
  v_mfma_f32_16x16x32_bf16 v[120:123], v[60:63], a[168:171], v[120:123]
  ds_read_b64_tr_b16 v[50:51], v2 offset:42304
  buffer_load_dwordx4 v21, s[8:11], s63 offen  lds
  v_mfma_f32_16x16x32_bf16 v[124:127], v[56:59], a[164:167], v[124:127]
  ds_read_b64_tr_b16 v[52:53], v14 offset:33856
  v_mfma_f32_16x16x32_bf16 v[124:127], v[60:63], a[172:175], v[124:127]
  ds_read_b64_tr_b16 v[54:55], v14 offset:42304
  s_waitcnt lgkmcnt(8)
  v_mfma_f32_16x16x32_bf16 v[128:131], v[32:35], a[176:179], v[128:131]
  ds_read_b64_tr_b16 v[56:57], v2 offset:33888
  v_mfma_f32_16x16x32_bf16 v[128:131], v[36:39], a[184:187], v[128:131]
  ds_read_b64_tr_b16 v[58:59], v2 offset:42336
  v_mfma_f32_16x16x32_bf16 v[160:163], v[32:35], a[180:183], v[160:163]
  ds_read_b64_tr_b16 v[60:61], v14 offset:33888
  v_mfma_f32_16x16x32_bf16 v[160:163], v[36:39], a[188:191], v[160:163]
  ds_read_b64_tr_b16 v[62:63], v14 offset:42336
  s_waitcnt lgkmcnt(8)
  v_mfma_f32_16x16x32_bf16 a[4:7], v[40:43], a[176:179], a[4:7]
  ds_read_b64_tr_b16 v[32:33], v2 offset:34048
  s_add_u32 m0, s31, 4160
  v_mfma_f32_16x16x32_bf16 a[4:7], v[44:47], a[184:187], a[4:7]
  ds_read_b64_tr_b16 v[34:35], v2 offset:42496
  buffer_load_dwordx4 v22, s[8:11], s63 offen  lds
  v_mfma_f32_16x16x32_bf16 a[68:71], v[40:43], a[180:183], a[68:71]
  ds_read_b64_tr_b16 v[36:37], v14 offset:34048
  v_mfma_f32_16x16x32_bf16 a[68:71], v[44:47], a[188:191], a[68:71]
  ds_read_b64_tr_b16 v[38:39], v14 offset:42496
  s_waitcnt lgkmcnt(8)
  v_mfma_f32_16x16x32_bf16 v[132:135], v[48:51], a[176:179], v[132:135]
  ds_read_b64_tr_b16 v[40:41], v2 offset:34080
  v_mfma_f32_16x16x32_bf16 v[132:135], v[52:55], a[184:187], v[132:135]
  ds_read_b64_tr_b16 v[42:43], v2 offset:42528
  v_mfma_f32_16x16x32_bf16 v[164:167], v[48:51], a[180:183], v[164:167]
  ds_read_b64_tr_b16 v[44:45], v14 offset:34080
  v_mfma_f32_16x16x32_bf16 v[164:167], v[52:55], a[188:191], v[164:167]
  ds_read_b64_tr_b16 v[46:47], v14 offset:42528
  s_waitcnt lgkmcnt(8)
  v_mfma_f32_16x16x32_bf16 a[12:15], v[56:59], a[176:179], a[12:15]
  ds_read_b64_tr_b16 v[48:49], v2 offset:34112
  s_add_u32 m0, s31, 5216
  v_mfma_f32_16x16x32_bf16 a[12:15], v[60:63], a[184:187], a[12:15]
  ds_read_b64_tr_b16 v[50:51], v2 offset:42560
  buffer_load_dwordx4 v23, s[8:11], s63 offen  lds
  v_mfma_f32_16x16x32_bf16 a[76:79], v[56:59], a[180:183], a[76:79]
  ds_read_b64_tr_b16 v[52:53], v14 offset:34112
  v_mfma_f32_16x16x32_bf16 a[76:79], v[60:63], a[188:191], a[76:79]
  ds_read_b64_tr_b16 v[54:55], v14 offset:42560
  s_waitcnt lgkmcnt(8)
  v_mfma_f32_16x16x32_bf16 v[136:139], v[32:35], a[176:179], v[136:139]
  ds_read_b64_tr_b16 v[56:57], v2 offset:34144
  v_mfma_f32_16x16x32_bf16 v[136:139], v[36:39], a[184:187], v[136:139]
  ds_read_b64_tr_b16 v[58:59], v2 offset:42592
  s_add_u32 s63, s62, 2359296
  v_mfma_f32_16x16x32_bf16 v[168:171], v[32:35], a[180:183], v[168:171]
  ds_read_b64_tr_b16 v[60:61], v14 offset:34144
  v_mfma_f32_16x16x32_bf16 v[168:171], v[36:39], a[188:191], v[168:171]
  ds_read_b64_tr_b16 v[62:63], v14 offset:42592
  s_waitcnt lgkmcnt(8)
  v_mfma_f32_16x16x32_bf16 a[20:23], v[40:43], a[176:179], a[20:23]
  ds_read_b64_tr_b16 v[32:33], v2 offset:34304
  s_add_u32 m0, s31, 69632
  v_mfma_f32_16x16x32_bf16 a[20:23], v[44:47], a[184:187], a[20:23]
  ds_read_b64_tr_b16 v[34:35], v2 offset:42752
  buffer_load_dwordx4 v20, s[8:11], s63 offen  lds
  v_mfma_f32_16x16x32_bf16 a[84:87], v[40:43], a[180:183], a[84:87]
  ds_read_b64_tr_b16 v[36:37], v14 offset:34304
  v_mfma_f32_16x16x32_bf16 a[84:87], v[44:47], a[188:191], a[84:87]
  ds_read_b64_tr_b16 v[38:39], v14 offset:42752
  s_waitcnt lgkmcnt(8)
  v_mfma_f32_16x16x32_bf16 v[140:143], v[48:51], a[176:179], v[140:143]
  ds_read_b64_tr_b16 v[40:41], v2 offset:34336
  s_add_u32 m0, s31, 70688
  v_mfma_f32_16x16x32_bf16 v[140:143], v[52:55], a[184:187], v[140:143]
  ds_read_b64_tr_b16 v[42:43], v2 offset:42784
  buffer_load_dwordx4 v21, s[8:11], s63 offen  lds
  v_mfma_f32_16x16x32_bf16 v[172:175], v[48:51], a[180:183], v[172:175]
  ds_read_b64_tr_b16 v[44:45], v14 offset:34336
  v_mfma_f32_16x16x32_bf16 v[172:175], v[52:55], a[188:191], v[172:175]
  ds_read_b64_tr_b16 v[46:47], v14 offset:42784
  s_waitcnt lgkmcnt(8)
  v_mfma_f32_16x16x32_bf16 a[28:31], v[56:59], a[176:179], a[28:31]
  ds_read_b64_tr_b16 v[48:49], v2 offset:34368
  v_mfma_f32_16x16x32_bf16 a[28:31], v[60:63], a[184:187], a[28:31]
  ds_read_b64_tr_b16 v[50:51], v2 offset:42816
  v_mfma_f32_16x16x32_bf16 a[92:95], v[56:59], a[180:183], a[92:95]
  ds_read_b64_tr_b16 v[52:53], v14 offset:34368
  v_mfma_f32_16x16x32_bf16 a[92:95], v[60:63], a[188:191], a[92:95]
  ds_read_b64_tr_b16 v[54:55], v14 offset:42816
  s_waitcnt lgkmcnt(8)
  v_mfma_f32_16x16x32_bf16 v[144:147], v[32:35], a[176:179], v[144:147]
  ds_read_b64_tr_b16 v[56:57], v2 offset:34400
  s_add_u32 m0, s31, 71744
  v_mfma_f32_16x16x32_bf16 v[144:147], v[36:39], a[184:187], v[144:147]
  ds_read_b64_tr_b16 v[58:59], v2 offset:42848
  buffer_load_dwordx4 v22, s[8:11], s63 offen  lds
  v_mfma_f32_16x16x32_bf16 v[176:179], v[32:35], a[180:183], v[176:179]
  ds_read_b64_tr_b16 v[60:61], v14 offset:34400
  v_mfma_f32_16x16x32_bf16 v[176:179], v[36:39], a[188:191], v[176:179]
  ds_read_b64_tr_b16 v[62:63], v14 offset:42848
  s_waitcnt lgkmcnt(8)
  v_mfma_f32_16x16x32_bf16 a[36:39], v[40:43], a[176:179], a[36:39]
  ds_read_b64_tr_b16 v[32:33], v2 offset:34560
  v_mfma_f32_16x16x32_bf16 a[36:39], v[44:47], a[184:187], a[36:39]
  ds_read_b64_tr_b16 v[34:35], v2 offset:43008
  v_mfma_f32_16x16x32_bf16 a[100:103], v[40:43], a[180:183], a[100:103]
  ds_read_b64_tr_b16 v[36:37], v14 offset:34560
  v_mfma_f32_16x16x32_bf16 a[100:103], v[44:47], a[188:191], a[100:103]
  ds_read_b64_tr_b16 v[38:39], v14 offset:43008
  s_waitcnt lgkmcnt(8)
  v_mfma_f32_16x16x32_bf16 v[148:151], v[48:51], a[176:179], v[148:151]
  ds_read_b64_tr_b16 v[40:41], v2 offset:34592
  s_add_u32 m0, s31, 72800
  v_mfma_f32_16x16x32_bf16 v[148:151], v[52:55], a[184:187], v[148:151]
  ds_read_b64_tr_b16 v[42:43], v2 offset:43040
  buffer_load_dwordx4 v23, s[8:11], s63 offen  lds
  v_mfma_f32_16x16x32_bf16 v[180:183], v[48:51], a[180:183], v[180:183]
  ds_read_b64_tr_b16 v[44:45], v14 offset:34592
  v_mfma_f32_16x16x32_bf16 v[180:183], v[52:55], a[188:191], v[180:183]
  ds_read_b64_tr_b16 v[46:47], v14 offset:43040
  s_waitcnt lgkmcnt(8)
  v_mfma_f32_16x16x32_bf16 a[44:47], v[56:59], a[176:179], a[44:47]
  ds_read_b64_tr_b16 v[48:49], v2 offset:34624
  v_mfma_f32_16x16x32_bf16 a[44:47], v[60:63], a[184:187], a[44:47]
  ds_read_b64_tr_b16 v[50:51], v2 offset:43072
  v_mfma_f32_16x16x32_bf16 a[108:111], v[56:59], a[180:183], a[108:111]
  ds_read_b64_tr_b16 v[52:53], v14 offset:34624
  v_mfma_f32_16x16x32_bf16 a[108:111], v[60:63], a[188:191], a[108:111]
  ds_read_b64_tr_b16 v[54:55], v14 offset:43072
  s_waitcnt lgkmcnt(8)
  v_mfma_f32_16x16x32_bf16 v[152:155], v[32:35], a[176:179], v[152:155]
  ds_read_b64_tr_b16 v[56:57], v2 offset:34656
  v_mfma_f32_16x16x32_bf16 v[152:155], v[36:39], a[184:187], v[152:155]
  ds_read_b64_tr_b16 v[58:59], v2 offset:43104
  s_waitcnt vmcnt(10)
  v_mfma_f32_16x16x32_bf16 v[184:187], v[32:35], a[180:183], v[184:187]
  ds_read_b64_tr_b16 v[60:61], v14 offset:34656
  s_barrier
  v_mfma_f32_16x16x32_bf16 v[184:187], v[36:39], a[188:191], v[184:187]
  ds_read_b64_tr_b16 v[62:63], v14 offset:43104
  s_waitcnt vmcnt(8)
  s_waitcnt lgkmcnt(8)
  v_mfma_f32_16x16x32_bf16 a[52:55], v[40:43], a[176:179], a[52:55]
  ds_read_b64_tr_b16 v[32:33], v2 offset:50688
  v_add_u32 v29, 137216, v25
  ds_read_b128 a[192:195], v29 offset:0
  v_mfma_f32_16x16x32_bf16 a[52:55], v[44:47], a[184:187], a[52:55]
  ds_read_b64_tr_b16 v[34:35], v2 offset:59136
  ds_read_b128 a[196:199], v29 offset:2112
  v_mfma_f32_16x16x32_bf16 a[116:119], v[40:43], a[180:183], a[116:119]
  ds_read_b64_tr_b16 v[36:37], v14 offset:50688
  s_add_u32 s63, s62, 2097664
  v_mfma_f32_16x16x32_bf16 a[116:119], v[44:47], a[188:191], a[116:119]
  ds_read_b64_tr_b16 v[38:39], v14 offset:59136
  s_waitcnt lgkmcnt(10)
  v_mfma_f32_16x16x32_bf16 v[156:159], v[48:51], a[176:179], v[156:159]
  ds_read_b64_tr_b16 v[40:41], v2 offset:50720
  s_add_u32 m0, s31, 18944
  v_mfma_f32_16x16x32_bf16 v[156:159], v[52:55], a[184:187], v[156:159]
  ds_read_b64_tr_b16 v[42:43], v2 offset:59168
  buffer_load_dwordx4 v20, s[8:11], s63 offen  lds
  v_mfma_f32_16x16x32_bf16 v[188:191], v[48:51], a[180:183], v[188:191]
  ds_read_b64_tr_b16 v[44:45], v14 offset:50720
  v_mfma_f32_16x16x32_bf16 v[188:191], v[52:55], a[188:191], v[188:191]
  ds_read_b64_tr_b16 v[46:47], v14 offset:59168
  s_waitcnt lgkmcnt(10)
  v_mfma_f32_16x16x32_bf16 a[60:63], v[56:59], a[176:179], a[60:63]
  ds_read_b64_tr_b16 v[48:49], v2 offset:50752
  s_add_u32 m0, s31, 20000
  v_mfma_f32_16x16x32_bf16 a[60:63], v[60:63], a[184:187], a[60:63]
  ds_read_b64_tr_b16 v[50:51], v2 offset:59200
  buffer_load_dwordx4 v21, s[8:11], s63 offen  lds
  v_mfma_f32_16x16x32_bf16 a[124:127], v[56:59], a[180:183], a[124:127]
  ds_read_b64_tr_b16 v[52:53], v14 offset:50752
  v_mfma_f32_16x16x32_bf16 a[124:127], v[60:63], a[188:191], a[124:127]
  ds_read_b64_tr_b16 v[54:55], v14 offset:59200
  s_waitcnt lgkmcnt(8)
  v_mfma_f32_16x16x32_bf16 v[192:195], v[32:35], a[176:179], v[192:195]
  ds_read_b64_tr_b16 v[56:57], v2 offset:50784
  v_mfma_f32_16x16x32_bf16 v[192:195], v[36:39], a[184:187], v[192:195]
  ds_read_b64_tr_b16 v[58:59], v2 offset:59232
  v_mfma_f32_16x16x32_bf16 v[224:227], v[32:35], a[180:183], v[224:227]
  ds_read_b64_tr_b16 v[60:61], v14 offset:50784
  ds_read_b128 a[200:203], v29 offset:64
  ds_read_b128 a[204:207], v29 offset:2176
  v_mfma_f32_16x16x32_bf16 v[224:227], v[36:39], a[188:191], v[224:227]
  ds_read_b64_tr_b16 v[62:63], v14 offset:59232
  s_waitcnt lgkmcnt(10)
  v_mfma_f32_16x16x32_bf16 v[64:67], v[40:43], a[176:179], v[64:67]
  ds_read_b64_tr_b16 v[32:33], v2 offset:50944
  s_add_u32 m0, s31, 21056
  v_mfma_f32_16x16x32_bf16 v[64:67], v[44:47], a[184:187], v[64:67]
  ds_read_b64_tr_b16 v[34:35], v2 offset:59392
  buffer_load_dwordx4 v22, s[8:11], s63 offen  lds
  v_mfma_f32_16x16x32_bf16 v[68:71], v[40:43], a[180:183], v[68:71]
  ds_read_b64_tr_b16 v[36:37], v14 offset:50944
  v_mfma_f32_16x16x32_bf16 v[68:71], v[44:47], a[188:191], v[68:71]
  ds_read_b64_tr_b16 v[38:39], v14 offset:59392
  s_waitcnt lgkmcnt(10)
  v_mfma_f32_16x16x32_bf16 v[196:199], v[48:51], a[176:179], v[196:199]
  ds_read_b64_tr_b16 v[40:41], v2 offset:50976
  v_mfma_f32_16x16x32_bf16 v[196:199], v[52:55], a[184:187], v[196:199]
  ds_read_b64_tr_b16 v[42:43], v2 offset:59424
  v_mfma_f32_16x16x32_bf16 v[228:231], v[48:51], a[180:183], v[228:231]
  ds_read_b64_tr_b16 v[44:45], v14 offset:50976
  v_mfma_f32_16x16x32_bf16 v[228:231], v[52:55], a[188:191], v[228:231]
  ds_read_b64_tr_b16 v[46:47], v14 offset:59424
  s_waitcnt lgkmcnt(8)
  v_mfma_f32_16x16x32_bf16 v[72:75], v[56:59], a[176:179], v[72:75]
  ds_read_b64_tr_b16 v[48:49], v2 offset:51008
  s_add_u32 m0, s31, 22112
  v_mfma_f32_16x16x32_bf16 v[72:75], v[60:63], a[184:187], v[72:75]
  ds_read_b64_tr_b16 v[50:51], v2 offset:59456
  buffer_load_dwordx4 v23, s[8:11], s63 offen  lds
  v_mfma_f32_16x16x32_bf16 v[76:79], v[56:59], a[180:183], v[76:79]
  ds_read_b64_tr_b16 v[52:53], v14 offset:51008
  v_mfma_f32_16x16x32_bf16 v[76:79], v[60:63], a[188:191], v[76:79]
  ds_read_b64_tr_b16 v[54:55], v14 offset:59456
  s_add_u32 m0, s31, 136576
  s_waitcnt lgkmcnt(8)
  v_mfma_f32_16x16x32_bf16 v[200:203], v[32:35], a[176:179], v[200:203]
  ds_read_b64_tr_b16 v[56:57], v2 offset:51040
  buffer_load_dwordx4 v24, s[4:7], 0 offen offset:640  lds
  v_mfma_f32_16x16x32_bf16 v[200:203], v[36:39], a[184:187], v[200:203]
  ds_read_b64_tr_b16 v[58:59], v2 offset:59488
  s_add_u32 s63, s62, 2359808
  v_mfma_f32_16x16x32_bf16 v[232:235], v[32:35], a[180:183], v[232:235]
  ds_read_b64_tr_b16 v[60:61], v14 offset:51040
  v_mfma_f32_16x16x32_bf16 v[232:235], v[36:39], a[188:191], v[232:235]
  ds_read_b64_tr_b16 v[62:63], v14 offset:59488
  s_waitcnt lgkmcnt(8)
  v_mfma_f32_16x16x32_bf16 v[80:83], v[40:43], a[176:179], v[80:83]
  ds_read_b64_tr_b16 v[32:33], v2 offset:51200
  s_add_u32 m0, s31, 137664
  v_mfma_f32_16x16x32_bf16 v[80:83], v[44:47], a[184:187], v[80:83]
  ds_read_b64_tr_b16 v[34:35], v2 offset:59648
  buffer_load_dwordx4 v24, s[4:7], s60 offen offset:640  lds
  v_mfma_f32_16x16x32_bf16 v[84:87], v[40:43], a[180:183], v[84:87]
  ds_read_b64_tr_b16 v[36:37], v14 offset:51200
  v_mfma_f32_16x16x32_bf16 v[84:87], v[44:47], a[188:191], v[84:87]
  ds_read_b64_tr_b16 v[38:39], v14 offset:59648
  s_waitcnt lgkmcnt(8)
  v_mfma_f32_16x16x32_bf16 v[204:207], v[48:51], a[176:179], v[204:207]
  ds_read_b64_tr_b16 v[40:41], v2 offset:51232
  v_mfma_f32_16x16x32_bf16 v[204:207], v[52:55], a[184:187], v[204:207]
  ds_read_b64_tr_b16 v[42:43], v2 offset:59680
  s_add_u32 m0, s31, 138688
  v_mfma_f32_16x16x32_bf16 v[236:239], v[48:51], a[180:183], v[236:239]
  ds_read_b64_tr_b16 v[44:45], v14 offset:51232
  buffer_load_dwordx4 v24, s[4:7], s61 offen offset:640  lds
  v_mfma_f32_16x16x32_bf16 v[236:239], v[52:55], a[188:191], v[236:239]
  ds_read_b64_tr_b16 v[46:47], v14 offset:59680
  s_waitcnt lgkmcnt(8)
  v_mfma_f32_16x16x32_bf16 v[88:91], v[56:59], a[176:179], v[88:91]
  ds_read_b64_tr_b16 v[48:49], v2 offset:51264
  s_add_u32 m0, s31, 86528
  v_mfma_f32_16x16x32_bf16 v[88:91], v[60:63], a[184:187], v[88:91]
  ds_read_b64_tr_b16 v[50:51], v2 offset:59712
  buffer_load_dwordx4 v20, s[8:11], s63 offen  lds
  v_mfma_f32_16x16x32_bf16 v[92:95], v[56:59], a[180:183], v[92:95]
  ds_read_b64_tr_b16 v[52:53], v14 offset:51264
  s_add_u32 m0, s31, 139776
  v_mfma_f32_16x16x32_bf16 v[92:95], v[60:63], a[188:191], v[92:95]
  ds_read_b64_tr_b16 v[54:55], v14 offset:59712
  buffer_load_dwordx4 v24, s[4:7], s65 offen offset:640  lds
  s_waitcnt lgkmcnt(8)
  v_mfma_f32_16x16x32_bf16 v[208:211], v[32:35], a[176:179], v[208:211]
  ds_read_b64_tr_b16 v[56:57], v2 offset:51296
  s_add_u32 m0, s31, 87584
  v_mfma_f32_16x16x32_bf16 v[208:211], v[36:39], a[184:187], v[208:211]
  ds_read_b64_tr_b16 v[58:59], v2 offset:59744
  buffer_load_dwordx4 v21, s[8:11], s63 offen  lds
  v_mfma_f32_16x16x32_bf16 v[240:243], v[32:35], a[180:183], v[240:243]
  ds_read_b64_tr_b16 v[60:61], v14 offset:51296
  v_mfma_f32_16x16x32_bf16 v[240:243], v[36:39], a[188:191], v[240:243]
  ds_read_b64_tr_b16 v[62:63], v14 offset:59744
  s_waitcnt lgkmcnt(8)
  v_mfma_f32_16x16x32_bf16 v[96:99], v[40:43], a[176:179], v[96:99]
  ds_read_b64_tr_b16 v[32:33], v2 offset:51456
  s_add_u32 m0, s31, 88640
  v_mfma_f32_16x16x32_bf16 v[96:99], v[44:47], a[184:187], v[96:99]
  ds_read_b64_tr_b16 v[34:35], v2 offset:59904
  buffer_load_dwordx4 v22, s[8:11], s63 offen  lds
  v_mfma_f32_16x16x32_bf16 v[100:103], v[40:43], a[180:183], v[100:103]
  ds_read_b64_tr_b16 v[36:37], v14 offset:51456
  v_mfma_f32_16x16x32_bf16 v[100:103], v[44:47], a[188:191], v[100:103]
  ds_read_b64_tr_b16 v[38:39], v14 offset:59904
  s_waitcnt lgkmcnt(8)
  v_mfma_f32_16x16x32_bf16 v[212:215], v[48:51], a[176:179], v[212:215]
  ds_read_b64_tr_b16 v[40:41], v2 offset:51488
  s_add_u32 m0, s31, 89696
  v_mfma_f32_16x16x32_bf16 v[212:215], v[52:55], a[184:187], v[212:215]
  ds_read_b64_tr_b16 v[42:43], v2 offset:59936
  buffer_load_dwordx4 v23, s[8:11], s63 offen  lds
  v_mfma_f32_16x16x32_bf16 v[244:247], v[48:51], a[180:183], v[244:247]
  ds_read_b64_tr_b16 v[44:45], v14 offset:51488
  v_mfma_f32_16x16x32_bf16 v[244:247], v[52:55], a[188:191], v[244:247]
  ds_read_b64_tr_b16 v[46:47], v14 offset:59936
  s_waitcnt lgkmcnt(8)
  v_mfma_f32_16x16x32_bf16 v[104:107], v[56:59], a[176:179], v[104:107]
  ds_read_b64_tr_b16 v[48:49], v2 offset:51520
  v_mfma_f32_16x16x32_bf16 v[104:107], v[60:63], a[184:187], v[104:107]
  ds_read_b64_tr_b16 v[50:51], v2 offset:59968
  v_mfma_f32_16x16x32_bf16 v[108:111], v[56:59], a[180:183], v[108:111]
  ds_read_b64_tr_b16 v[52:53], v14 offset:51520
  v_mfma_f32_16x16x32_bf16 v[108:111], v[60:63], a[188:191], v[108:111]
  ds_read_b64_tr_b16 v[54:55], v14 offset:59968
  s_waitcnt lgkmcnt(8)
  v_mfma_f32_16x16x32_bf16 v[216:219], v[32:35], a[176:179], v[216:219]
  ds_read_b64_tr_b16 v[56:57], v2 offset:51552
  v_mfma_f32_16x16x32_bf16 v[216:219], v[36:39], a[184:187], v[216:219]
  ds_read_b64_tr_b16 v[58:59], v2 offset:60000
  s_waitcnt vmcnt(12)
  v_mfma_f32_16x16x32_bf16 v[248:251], v[32:35], a[180:183], v[248:251]
  ds_read_b64_tr_b16 v[60:61], v14 offset:51552
  s_barrier
  v_mfma_f32_16x16x32_bf16 v[248:251], v[36:39], a[188:191], v[248:251]
  ds_read_b64_tr_b16 v[62:63], v14 offset:60000
  s_waitcnt lgkmcnt(8)
  v_mfma_f32_16x16x32_bf16 v[112:115], v[40:43], a[176:179], v[112:115]
  ds_read_b64_tr_b16 v[32:33], v2 offset:0
  s_add_u32 s63, s62, 2621440
  v_mfma_f32_16x16x32_bf16 v[112:115], v[44:47], a[184:187], v[112:115]
  ds_read_b64_tr_b16 v[34:35], v2 offset:8448
  s_add_u32 m0, s31, 35840
  v_mfma_f32_16x16x32_bf16 v[116:119], v[40:43], a[180:183], v[116:119]
  ds_read_b64_tr_b16 v[36:37], v14 offset:0
  buffer_load_dwordx4 v20, s[8:11], s63 offen  lds
  v_mfma_f32_16x16x32_bf16 v[116:119], v[44:47], a[188:191], v[116:119]
  ds_read_b64_tr_b16 v[38:39], v14 offset:8448
  s_waitcnt lgkmcnt(8)
  v_mfma_f32_16x16x32_bf16 v[220:223], v[48:51], a[176:179], v[220:223]
  ds_read_b64_tr_b16 v[40:41], v2 offset:32
  v_mfma_f32_16x16x32_bf16 v[220:223], v[52:55], a[184:187], v[220:223]
  ds_read_b64_tr_b16 v[42:43], v2 offset:8480
  v_mfma_f32_16x16x32_bf16 v[252:255], v[48:51], a[180:183], v[252:255]
  ds_read_b64_tr_b16 v[44:45], v14 offset:32
  v_mfma_f32_16x16x32_bf16 v[252:255], v[52:55], a[188:191], v[252:255]
  ds_read_b64_tr_b16 v[46:47], v14 offset:8480
  s_waitcnt lgkmcnt(8)
  v_mfma_f32_16x16x32_bf16 v[120:123], v[56:59], a[176:179], v[120:123]
  ds_read_b64_tr_b16 v[48:49], v2 offset:64
  s_add_u32 m0, s31, 36896
  v_mfma_f32_16x16x32_bf16 v[120:123], v[60:63], a[184:187], v[120:123]
  ds_read_b64_tr_b16 v[50:51], v2 offset:8512
  buffer_load_dwordx4 v21, s[8:11], s63 offen  lds
  v_mfma_f32_16x16x32_bf16 v[124:127], v[56:59], a[180:183], v[124:127]
  ds_read_b64_tr_b16 v[52:53], v14 offset:64
  v_mfma_f32_16x16x32_bf16 v[124:127], v[60:63], a[188:191], v[124:127]
  ds_read_b64_tr_b16 v[54:55], v14 offset:8512
  s_waitcnt lgkmcnt(8)
  v_mfma_f32_16x16x32_bf16 v[128:131], v[32:35], a[192:195], v[128:131]
  ds_read_b64_tr_b16 v[56:57], v2 offset:96
  v_mfma_f32_16x16x32_bf16 v[128:131], v[36:39], a[200:203], v[128:131]
  ds_read_b64_tr_b16 v[58:59], v2 offset:8544
  v_mfma_f32_16x16x32_bf16 v[160:163], v[32:35], a[196:199], v[160:163]
  ds_read_b64_tr_b16 v[60:61], v14 offset:96
  v_mfma_f32_16x16x32_bf16 v[160:163], v[36:39], a[204:207], v[160:163]
  ds_read_b64_tr_b16 v[62:63], v14 offset:8544
  s_waitcnt lgkmcnt(8)
  v_mfma_f32_16x16x32_bf16 a[4:7], v[40:43], a[192:195], a[4:7]
  ds_read_b64_tr_b16 v[32:33], v2 offset:256
  s_add_u32 m0, s31, 37952
  v_mfma_f32_16x16x32_bf16 a[4:7], v[44:47], a[200:203], a[4:7]
  ds_read_b64_tr_b16 v[34:35], v2 offset:8704
  buffer_load_dwordx4 v22, s[8:11], s63 offen  lds
  v_mfma_f32_16x16x32_bf16 a[68:71], v[40:43], a[196:199], a[68:71]
  ds_read_b64_tr_b16 v[36:37], v14 offset:256
  v_mfma_f32_16x16x32_bf16 a[68:71], v[44:47], a[204:207], a[68:71]
  ds_read_b64_tr_b16 v[38:39], v14 offset:8704
  s_waitcnt lgkmcnt(8)
  v_mfma_f32_16x16x32_bf16 v[132:135], v[48:51], a[192:195], v[132:135]
  ds_read_b64_tr_b16 v[40:41], v2 offset:288
  v_mfma_f32_16x16x32_bf16 v[132:135], v[52:55], a[200:203], v[132:135]
  ds_read_b64_tr_b16 v[42:43], v2 offset:8736
  v_mfma_f32_16x16x32_bf16 v[164:167], v[48:51], a[196:199], v[164:167]
  ds_read_b64_tr_b16 v[44:45], v14 offset:288
  v_mfma_f32_16x16x32_bf16 v[164:167], v[52:55], a[204:207], v[164:167]
  ds_read_b64_tr_b16 v[46:47], v14 offset:8736
  s_waitcnt lgkmcnt(8)
  v_mfma_f32_16x16x32_bf16 a[12:15], v[56:59], a[192:195], a[12:15]
  ds_read_b64_tr_b16 v[48:49], v2 offset:320
  s_add_u32 m0, s31, 39008
  v_mfma_f32_16x16x32_bf16 a[12:15], v[60:63], a[200:203], a[12:15]
  ds_read_b64_tr_b16 v[50:51], v2 offset:8768
  buffer_load_dwordx4 v23, s[8:11], s63 offen  lds
  v_mfma_f32_16x16x32_bf16 a[76:79], v[56:59], a[196:199], a[76:79]
  ds_read_b64_tr_b16 v[52:53], v14 offset:320
  v_mfma_f32_16x16x32_bf16 a[76:79], v[60:63], a[204:207], a[76:79]
  ds_read_b64_tr_b16 v[54:55], v14 offset:8768
  s_waitcnt lgkmcnt(8)
  v_mfma_f32_16x16x32_bf16 v[136:139], v[32:35], a[192:195], v[136:139]
  ds_read_b64_tr_b16 v[56:57], v2 offset:352
  v_mfma_f32_16x16x32_bf16 v[136:139], v[36:39], a[200:203], v[136:139]
  ds_read_b64_tr_b16 v[58:59], v2 offset:8800
  s_add_u32 s63, s62, 2883584
  v_mfma_f32_16x16x32_bf16 v[168:171], v[32:35], a[196:199], v[168:171]
  ds_read_b64_tr_b16 v[60:61], v14 offset:352
  v_mfma_f32_16x16x32_bf16 v[168:171], v[36:39], a[204:207], v[168:171]
  ds_read_b64_tr_b16 v[62:63], v14 offset:8800
  s_waitcnt lgkmcnt(8)
  v_mfma_f32_16x16x32_bf16 a[20:23], v[40:43], a[192:195], a[20:23]
  ds_read_b64_tr_b16 v[32:33], v2 offset:512
  s_add_u32 m0, s31, 103424
  v_mfma_f32_16x16x32_bf16 a[20:23], v[44:47], a[200:203], a[20:23]
  ds_read_b64_tr_b16 v[34:35], v2 offset:8960
  buffer_load_dwordx4 v20, s[8:11], s63 offen  lds
  v_mfma_f32_16x16x32_bf16 a[84:87], v[40:43], a[196:199], a[84:87]
  ds_read_b64_tr_b16 v[36:37], v14 offset:512
  v_mfma_f32_16x16x32_bf16 a[84:87], v[44:47], a[204:207], a[84:87]
  ds_read_b64_tr_b16 v[38:39], v14 offset:8960
  s_waitcnt lgkmcnt(8)
  v_mfma_f32_16x16x32_bf16 v[140:143], v[48:51], a[192:195], v[140:143]
  ds_read_b64_tr_b16 v[40:41], v2 offset:544
  s_add_u32 m0, s31, 104480
  v_mfma_f32_16x16x32_bf16 v[140:143], v[52:55], a[200:203], v[140:143]
  ds_read_b64_tr_b16 v[42:43], v2 offset:8992
  buffer_load_dwordx4 v21, s[8:11], s63 offen  lds
  v_mfma_f32_16x16x32_bf16 v[172:175], v[48:51], a[196:199], v[172:175]
  ds_read_b64_tr_b16 v[44:45], v14 offset:544
  v_mfma_f32_16x16x32_bf16 v[172:175], v[52:55], a[204:207], v[172:175]
  ds_read_b64_tr_b16 v[46:47], v14 offset:8992
  s_waitcnt lgkmcnt(8)
  v_mfma_f32_16x16x32_bf16 a[28:31], v[56:59], a[192:195], a[28:31]
  ds_read_b64_tr_b16 v[48:49], v2 offset:576
  v_mfma_f32_16x16x32_bf16 a[28:31], v[60:63], a[200:203], a[28:31]
  ds_read_b64_tr_b16 v[50:51], v2 offset:9024
  v_mfma_f32_16x16x32_bf16 a[92:95], v[56:59], a[196:199], a[92:95]
  ds_read_b64_tr_b16 v[52:53], v14 offset:576
  v_mfma_f32_16x16x32_bf16 a[92:95], v[60:63], a[204:207], a[92:95]
  ds_read_b64_tr_b16 v[54:55], v14 offset:9024
  s_waitcnt lgkmcnt(8)
  v_mfma_f32_16x16x32_bf16 v[144:147], v[32:35], a[192:195], v[144:147]
  ds_read_b64_tr_b16 v[56:57], v2 offset:608
  v_mfma_f32_16x16x32_bf16 v[144:147], v[36:39], a[200:203], v[144:147]
  ds_read_b64_tr_b16 v[58:59], v2 offset:9056
  s_waitcnt vmcnt(9)
  v_add_u32 v29, 137216, v25
  v_mfma_f32_16x16x32_bf16 v[176:179], v[32:35], a[196:199], v[176:179]
  ds_read_b64_tr_b16 v[60:61], v14 offset:608
  ds_read_b128 a[208:211], v29 offset:0
  ds_read_b128 a[212:215], v29 offset:2112
  v_mfma_f32_16x16x32_bf16 v[176:179], v[36:39], a[204:207], v[176:179]
  ds_read_b64_tr_b16 v[62:63], v14 offset:9056
  s_waitcnt lgkmcnt(10)
  v_mfma_f32_16x16x32_bf16 a[36:39], v[40:43], a[192:195], a[36:39]
  ds_read_b64_tr_b16 v[32:33], v2 offset:768
  s_add_u32 m0, s31, 105536
  v_mfma_f32_16x16x32_bf16 a[36:39], v[44:47], a[200:203], a[36:39]
  ds_read_b64_tr_b16 v[34:35], v2 offset:9216
  buffer_load_dwordx4 v22, s[8:11], s63 offen  lds
  v_mfma_f32_16x16x32_bf16 a[100:103], v[40:43], a[196:199], a[100:103]
  ds_read_b64_tr_b16 v[36:37], v14 offset:768
  v_mfma_f32_16x16x32_bf16 a[100:103], v[44:47], a[204:207], a[100:103]
  ds_read_b64_tr_b16 v[38:39], v14 offset:9216
  s_waitcnt lgkmcnt(10)
  v_mfma_f32_16x16x32_bf16 v[148:151], v[48:51], a[192:195], v[148:151]
  ds_read_b64_tr_b16 v[40:41], v2 offset:800
  s_add_u32 m0, s31, 106592
  v_mfma_f32_16x16x32_bf16 v[148:151], v[52:55], a[200:203], v[148:151]
  ds_read_b64_tr_b16 v[42:43], v2 offset:9248
  buffer_load_dwordx4 v23, s[8:11], s63 offen  lds
  v_mfma_f32_16x16x32_bf16 v[180:183], v[48:51], a[196:199], v[180:183]
  ds_read_b64_tr_b16 v[44:45], v14 offset:800
  v_mfma_f32_16x16x32_bf16 v[180:183], v[52:55], a[204:207], v[180:183]
  ds_read_b64_tr_b16 v[46:47], v14 offset:9248
  s_waitcnt lgkmcnt(8)
  v_mfma_f32_16x16x32_bf16 a[44:47], v[56:59], a[192:195], a[44:47]
  ds_read_b64_tr_b16 v[48:49], v2 offset:832
  v_mfma_f32_16x16x32_bf16 a[44:47], v[60:63], a[200:203], a[44:47]
  ds_read_b64_tr_b16 v[50:51], v2 offset:9280
  v_mfma_f32_16x16x32_bf16 a[108:111], v[56:59], a[196:199], a[108:111]
  ds_read_b64_tr_b16 v[52:53], v14 offset:832
  v_mfma_f32_16x16x32_bf16 a[108:111], v[60:63], a[204:207], a[108:111]
  ds_read_b64_tr_b16 v[54:55], v14 offset:9280
  ds_read_b128 a[216:219], v29 offset:64
  s_waitcnt lgkmcnt(9)
  v_mfma_f32_16x16x32_bf16 v[152:155], v[32:35], a[192:195], v[152:155]
  ds_read_b64_tr_b16 v[56:57], v2 offset:864
  ds_read_b128 a[220:223], v29 offset:2176
  v_mfma_f32_16x16x32_bf16 v[152:155], v[36:39], a[200:203], v[152:155]
  ds_read_b64_tr_b16 v[58:59], v2 offset:9312
  s_waitcnt vmcnt(8)
  v_mfma_f32_16x16x32_bf16 v[184:187], v[32:35], a[196:199], v[184:187]
  ds_read_b64_tr_b16 v[60:61], v14 offset:864
  s_barrier
  v_mfma_f32_16x16x32_bf16 v[184:187], v[36:39], a[204:207], v[184:187]
  ds_read_b64_tr_b16 v[62:63], v14 offset:9312
  s_waitcnt lgkmcnt(10)
  v_mfma_f32_16x16x32_bf16 a[52:55], v[40:43], a[192:195], a[52:55]
  ds_read_b64_tr_b16 v[32:33], v2 offset:16896
  s_add_u32 s63, s62, 3145728
  v_mfma_f32_16x16x32_bf16 a[52:55], v[44:47], a[200:203], a[52:55]
  ds_read_b64_tr_b16 v[34:35], v2 offset:25344
  s_add_u32 m0, s31, 52736
  v_mfma_f32_16x16x32_bf16 a[116:119], v[40:43], a[196:199], a[116:119]
  ds_read_b64_tr_b16 v[36:37], v14 offset:16896
  buffer_load_dwordx4 v20, s[8:11], s63 offen  lds
  v_mfma_f32_16x16x32_bf16 a[116:119], v[44:47], a[204:207], a[116:119]
  ds_read_b64_tr_b16 v[38:39], v14 offset:25344
  s_waitcnt lgkmcnt(10)
  v_mfma_f32_16x16x32_bf16 v[156:159], v[48:51], a[192:195], v[156:159]
  ds_read_b64_tr_b16 v[40:41], v2 offset:16928
  v_mfma_f32_16x16x32_bf16 v[156:159], v[52:55], a[200:203], v[156:159]
  ds_read_b64_tr_b16 v[42:43], v2 offset:25376
  v_mfma_f32_16x16x32_bf16 v[188:191], v[48:51], a[196:199], v[188:191]
  ds_read_b64_tr_b16 v[44:45], v14 offset:16928
  v_mfma_f32_16x16x32_bf16 v[188:191], v[52:55], a[204:207], v[188:191]
  ds_read_b64_tr_b16 v[46:47], v14 offset:25376
  s_waitcnt lgkmcnt(8)
  v_mfma_f32_16x16x32_bf16 a[60:63], v[56:59], a[192:195], a[60:63]
  ds_read_b64_tr_b16 v[48:49], v2 offset:16960
  v_mfma_f32_16x16x32_bf16 a[60:63], v[60:63], a[200:203], a[60:63]
  ds_read_b64_tr_b16 v[50:51], v2 offset:25408
  s_add_u32 m0, s31, 136448
  v_mfma_f32_16x16x32_bf16 a[124:127], v[56:59], a[196:199], a[124:127]
  ds_read_b64_tr_b16 v[52:53], v14 offset:16960
  buffer_load_dwordx4 v24, s[4:7], 0 offen offset:768  lds
  v_mfma_f32_16x16x32_bf16 a[124:127], v[60:63], a[204:207], a[124:127]
  ds_read_b64_tr_b16 v[54:55], v14 offset:25408
  s_waitcnt lgkmcnt(8)
  v_mfma_f32_16x16x32_bf16 v[192:195], v[32:35], a[192:195], v[192:195]
  ds_read_b64_tr_b16 v[56:57], v2 offset:16992
  s_add_u32 m0, s31, 53792
  v_mfma_f32_16x16x32_bf16 v[192:195], v[36:39], a[200:203], v[192:195]
  ds_read_b64_tr_b16 v[58:59], v2 offset:25440
  buffer_load_dwordx4 v21, s[8:11], s63 offen  lds
  v_mfma_f32_16x16x32_bf16 v[224:227], v[32:35], a[196:199], v[224:227]
  ds_read_b64_tr_b16 v[60:61], v14 offset:16992
  s_add_u32 m0, s31, 137536
  v_mfma_f32_16x16x32_bf16 v[224:227], v[36:39], a[204:207], v[224:227]
  ds_read_b64_tr_b16 v[62:63], v14 offset:25440
  buffer_load_dwordx4 v24, s[4:7], s60 offen offset:768  lds
  s_waitcnt lgkmcnt(8)
  v_mfma_f32_16x16x32_bf16 v[64:67], v[40:43], a[192:195], v[64:67]
  ds_read_b64_tr_b16 v[32:33], v2 offset:17152
  s_add_u32 m0, s31, 54848
  v_mfma_f32_16x16x32_bf16 v[64:67], v[44:47], a[200:203], v[64:67]
  ds_read_b64_tr_b16 v[34:35], v2 offset:25600
  buffer_load_dwordx4 v22, s[8:11], s63 offen  lds
  v_mfma_f32_16x16x32_bf16 v[68:71], v[40:43], a[196:199], v[68:71]
  ds_read_b64_tr_b16 v[36:37], v14 offset:17152
  v_mfma_f32_16x16x32_bf16 v[68:71], v[44:47], a[204:207], v[68:71]
  ds_read_b64_tr_b16 v[38:39], v14 offset:25600
  s_add_u32 m0, s31, 138560
  s_waitcnt lgkmcnt(8)
  v_mfma_f32_16x16x32_bf16 v[196:199], v[48:51], a[192:195], v[196:199]
  ds_read_b64_tr_b16 v[40:41], v2 offset:17184
  buffer_load_dwordx4 v24, s[4:7], s61 offen offset:768  lds
  v_mfma_f32_16x16x32_bf16 v[196:199], v[52:55], a[200:203], v[196:199]
  ds_read_b64_tr_b16 v[42:43], v2 offset:25632
  v_mfma_f32_16x16x32_bf16 v[228:231], v[48:51], a[196:199], v[228:231]
  ds_read_b64_tr_b16 v[44:45], v14 offset:17184
  v_mfma_f32_16x16x32_bf16 v[228:231], v[52:55], a[204:207], v[228:231]
  ds_read_b64_tr_b16 v[46:47], v14 offset:25632
  s_waitcnt lgkmcnt(8)
  v_mfma_f32_16x16x32_bf16 v[72:75], v[56:59], a[192:195], v[72:75]
  ds_read_b64_tr_b16 v[48:49], v2 offset:17216
  s_add_u32 m0, s31, 139648
  v_mfma_f32_16x16x32_bf16 v[72:75], v[60:63], a[200:203], v[72:75]
  ds_read_b64_tr_b16 v[50:51], v2 offset:25664
  buffer_load_dwordx4 v24, s[4:7], s65 offen offset:768  lds
  v_mfma_f32_16x16x32_bf16 v[76:79], v[56:59], a[196:199], v[76:79]
  ds_read_b64_tr_b16 v[52:53], v14 offset:17216
  v_mfma_f32_16x16x32_bf16 v[76:79], v[60:63], a[204:207], v[76:79]
  ds_read_b64_tr_b16 v[54:55], v14 offset:25664
  s_waitcnt lgkmcnt(8)
  v_mfma_f32_16x16x32_bf16 v[200:203], v[32:35], a[192:195], v[200:203]
  ds_read_b64_tr_b16 v[56:57], v2 offset:17248
  s_add_u32 m0, s31, 55904
  v_mfma_f32_16x16x32_bf16 v[200:203], v[36:39], a[200:203], v[200:203]
  ds_read_b64_tr_b16 v[58:59], v2 offset:25696
  buffer_load_dwordx4 v23, s[8:11], s63 offen  lds
  v_mfma_f32_16x16x32_bf16 v[232:235], v[32:35], a[196:199], v[232:235]
  ds_read_b64_tr_b16 v[60:61], v14 offset:17248
  s_add_u32 s63, s62, 3407872
  v_mfma_f32_16x16x32_bf16 v[232:235], v[36:39], a[204:207], v[232:235]
  ds_read_b64_tr_b16 v[62:63], v14 offset:25696
  s_waitcnt lgkmcnt(8)
  v_mfma_f32_16x16x32_bf16 v[80:83], v[40:43], a[192:195], v[80:83]
  ds_read_b64_tr_b16 v[32:33], v2 offset:17408
  s_add_u32 m0, s31, 120320
  v_mfma_f32_16x16x32_bf16 v[80:83], v[44:47], a[200:203], v[80:83]
  ds_read_b64_tr_b16 v[34:35], v2 offset:25856
  buffer_load_dwordx4 v20, s[8:11], s63 offen  lds
  v_mfma_f32_16x16x32_bf16 v[84:87], v[40:43], a[196:199], v[84:87]
  ds_read_b64_tr_b16 v[36:37], v14 offset:17408
  v_mfma_f32_16x16x32_bf16 v[84:87], v[44:47], a[204:207], v[84:87]
  ds_read_b64_tr_b16 v[38:39], v14 offset:25856
  s_waitcnt lgkmcnt(8)
  v_mfma_f32_16x16x32_bf16 v[204:207], v[48:51], a[192:195], v[204:207]
  ds_read_b64_tr_b16 v[40:41], v2 offset:17440
  s_add_u32 m0, s31, 121376
  v_mfma_f32_16x16x32_bf16 v[204:207], v[52:55], a[200:203], v[204:207]
  ds_read_b64_tr_b16 v[42:43], v2 offset:25888
  buffer_load_dwordx4 v21, s[8:11], s63 offen  lds
  v_mfma_f32_16x16x32_bf16 v[236:239], v[48:51], a[196:199], v[236:239]
  ds_read_b64_tr_b16 v[44:45], v14 offset:17440
  v_mfma_f32_16x16x32_bf16 v[236:239], v[52:55], a[204:207], v[236:239]
  ds_read_b64_tr_b16 v[46:47], v14 offset:25888
  s_waitcnt lgkmcnt(8)
  v_mfma_f32_16x16x32_bf16 v[88:91], v[56:59], a[192:195], v[88:91]
  ds_read_b64_tr_b16 v[48:49], v2 offset:17472
  v_mfma_f32_16x16x32_bf16 v[88:91], v[60:63], a[200:203], v[88:91]
  ds_read_b64_tr_b16 v[50:51], v2 offset:25920
  v_mfma_f32_16x16x32_bf16 v[92:95], v[56:59], a[196:199], v[92:95]
  ds_read_b64_tr_b16 v[52:53], v14 offset:17472
  v_mfma_f32_16x16x32_bf16 v[92:95], v[60:63], a[204:207], v[92:95]
  ds_read_b64_tr_b16 v[54:55], v14 offset:25920
  s_waitcnt lgkmcnt(8)
  v_mfma_f32_16x16x32_bf16 v[208:211], v[32:35], a[192:195], v[208:211]
  ds_read_b64_tr_b16 v[56:57], v2 offset:17504
  s_add_u32 m0, s31, 122432
  v_mfma_f32_16x16x32_bf16 v[208:211], v[36:39], a[200:203], v[208:211]
  ds_read_b64_tr_b16 v[58:59], v2 offset:25952
  buffer_load_dwordx4 v22, s[8:11], s63 offen  lds
  v_mfma_f32_16x16x32_bf16 v[240:243], v[32:35], a[196:199], v[240:243]
  ds_read_b64_tr_b16 v[60:61], v14 offset:17504
  v_mfma_f32_16x16x32_bf16 v[240:243], v[36:39], a[204:207], v[240:243]
  ds_read_b64_tr_b16 v[62:63], v14 offset:25952
  s_waitcnt lgkmcnt(8)
  v_mfma_f32_16x16x32_bf16 v[96:99], v[40:43], a[192:195], v[96:99]
  ds_read_b64_tr_b16 v[32:33], v2 offset:17664
  v_mfma_f32_16x16x32_bf16 v[96:99], v[44:47], a[200:203], v[96:99]
  ds_read_b64_tr_b16 v[34:35], v2 offset:26112
  v_mfma_f32_16x16x32_bf16 v[100:103], v[40:43], a[196:199], v[100:103]
  ds_read_b64_tr_b16 v[36:37], v14 offset:17664
  v_mfma_f32_16x16x32_bf16 v[100:103], v[44:47], a[204:207], v[100:103]
  ds_read_b64_tr_b16 v[38:39], v14 offset:26112
  s_waitcnt lgkmcnt(8)
  v_mfma_f32_16x16x32_bf16 v[212:215], v[48:51], a[192:195], v[212:215]
  ds_read_b64_tr_b16 v[40:41], v2 offset:17696
  s_add_u32 m0, s31, 123488
  v_mfma_f32_16x16x32_bf16 v[212:215], v[52:55], a[200:203], v[212:215]
  ds_read_b64_tr_b16 v[42:43], v2 offset:26144
  buffer_load_dwordx4 v23, s[8:11], s63 offen  lds
  v_mfma_f32_16x16x32_bf16 v[244:247], v[48:51], a[196:199], v[244:247]
  ds_read_b64_tr_b16 v[44:45], v14 offset:17696
  v_mfma_f32_16x16x32_bf16 v[244:247], v[52:55], a[204:207], v[244:247]
  ds_read_b64_tr_b16 v[46:47], v14 offset:26144
  s_waitcnt lgkmcnt(8)
  v_mfma_f32_16x16x32_bf16 v[104:107], v[56:59], a[192:195], v[104:107]
  ds_read_b64_tr_b16 v[48:49], v2 offset:17728
  v_mfma_f32_16x16x32_bf16 v[104:107], v[60:63], a[200:203], v[104:107]
  ds_read_b64_tr_b16 v[50:51], v2 offset:26176
  v_mfma_f32_16x16x32_bf16 v[108:111], v[56:59], a[196:199], v[108:111]
  ds_read_b64_tr_b16 v[52:53], v14 offset:17728
  v_mfma_f32_16x16x32_bf16 v[108:111], v[60:63], a[204:207], v[108:111]
  ds_read_b64_tr_b16 v[54:55], v14 offset:26176
  s_waitcnt lgkmcnt(8)
  v_mfma_f32_16x16x32_bf16 v[216:219], v[32:35], a[192:195], v[216:219]
  ds_read_b64_tr_b16 v[56:57], v2 offset:17760
  v_mfma_f32_16x16x32_bf16 v[216:219], v[36:39], a[200:203], v[216:219]
  ds_read_b64_tr_b16 v[58:59], v2 offset:26208
  s_waitcnt vmcnt(12)
  v_mfma_f32_16x16x32_bf16 v[248:251], v[32:35], a[196:199], v[248:251]
  ds_read_b64_tr_b16 v[60:61], v14 offset:17760
  s_barrier
  v_mfma_f32_16x16x32_bf16 v[248:251], v[36:39], a[204:207], v[248:251]
  ds_read_b64_tr_b16 v[62:63], v14 offset:26208
  s_waitcnt lgkmcnt(8)
  v_mfma_f32_16x16x32_bf16 v[112:115], v[40:43], a[192:195], v[112:115]
  ds_read_b64_tr_b16 v[32:33], v2 offset:33792
  s_add_u32 s63, s62, 2621952
  v_mfma_f32_16x16x32_bf16 v[112:115], v[44:47], a[200:203], v[112:115]
  ds_read_b64_tr_b16 v[34:35], v2 offset:42240
  s_add_u32 m0, s31, 2048
  v_mfma_f32_16x16x32_bf16 v[116:119], v[40:43], a[196:199], v[116:119]
  ds_read_b64_tr_b16 v[36:37], v14 offset:33792
  buffer_load_dwordx4 v20, s[8:11], s63 offen  lds
  v_mfma_f32_16x16x32_bf16 v[116:119], v[44:47], a[204:207], v[116:119]
  ds_read_b64_tr_b16 v[38:39], v14 offset:42240
  s_waitcnt lgkmcnt(8)
  v_mfma_f32_16x16x32_bf16 v[220:223], v[48:51], a[192:195], v[220:223]
  ds_read_b64_tr_b16 v[40:41], v2 offset:33824
  v_mfma_f32_16x16x32_bf16 v[220:223], v[52:55], a[200:203], v[220:223]
  ds_read_b64_tr_b16 v[42:43], v2 offset:42272
  v_mfma_f32_16x16x32_bf16 v[252:255], v[48:51], a[196:199], v[252:255]
  ds_read_b64_tr_b16 v[44:45], v14 offset:33824
  v_mfma_f32_16x16x32_bf16 v[252:255], v[52:55], a[204:207], v[252:255]
  ds_read_b64_tr_b16 v[46:47], v14 offset:42272
  s_waitcnt lgkmcnt(8)
  v_mfma_f32_16x16x32_bf16 v[120:123], v[56:59], a[192:195], v[120:123]
  ds_read_b64_tr_b16 v[48:49], v2 offset:33856
  s_add_u32 m0, s31, 3104
  v_mfma_f32_16x16x32_bf16 v[120:123], v[60:63], a[200:203], v[120:123]
  ds_read_b64_tr_b16 v[50:51], v2 offset:42304
  buffer_load_dwordx4 v21, s[8:11], s63 offen  lds
  v_mfma_f32_16x16x32_bf16 v[124:127], v[56:59], a[196:199], v[124:127]
  ds_read_b64_tr_b16 v[52:53], v14 offset:33856
  v_mfma_f32_16x16x32_bf16 v[124:127], v[60:63], a[204:207], v[124:127]
  ds_read_b64_tr_b16 v[54:55], v14 offset:42304
  s_waitcnt lgkmcnt(8)
  v_mfma_f32_16x16x32_bf16 v[128:131], v[32:35], a[208:211], v[128:131]
  ds_read_b64_tr_b16 v[56:57], v2 offset:33888
  v_mfma_f32_16x16x32_bf16 v[128:131], v[36:39], a[216:219], v[128:131]
  ds_read_b64_tr_b16 v[58:59], v2 offset:42336
  v_mfma_f32_16x16x32_bf16 v[160:163], v[32:35], a[212:215], v[160:163]
  ds_read_b64_tr_b16 v[60:61], v14 offset:33888
  v_mfma_f32_16x16x32_bf16 v[160:163], v[36:39], a[220:223], v[160:163]
  ds_read_b64_tr_b16 v[62:63], v14 offset:42336
  s_waitcnt lgkmcnt(8)
  v_mfma_f32_16x16x32_bf16 a[4:7], v[40:43], a[208:211], a[4:7]
  ds_read_b64_tr_b16 v[32:33], v2 offset:34048
  s_add_u32 m0, s31, 4160
  v_mfma_f32_16x16x32_bf16 a[4:7], v[44:47], a[216:219], a[4:7]
  ds_read_b64_tr_b16 v[34:35], v2 offset:42496
  buffer_load_dwordx4 v22, s[8:11], s63 offen  lds
  v_mfma_f32_16x16x32_bf16 a[68:71], v[40:43], a[212:215], a[68:71]
  ds_read_b64_tr_b16 v[36:37], v14 offset:34048
  v_mfma_f32_16x16x32_bf16 a[68:71], v[44:47], a[220:223], a[68:71]
  ds_read_b64_tr_b16 v[38:39], v14 offset:42496
  s_waitcnt lgkmcnt(8)
  v_mfma_f32_16x16x32_bf16 v[132:135], v[48:51], a[208:211], v[132:135]
  ds_read_b64_tr_b16 v[40:41], v2 offset:34080
  v_mfma_f32_16x16x32_bf16 v[132:135], v[52:55], a[216:219], v[132:135]
  ds_read_b64_tr_b16 v[42:43], v2 offset:42528
  v_mfma_f32_16x16x32_bf16 v[164:167], v[48:51], a[212:215], v[164:167]
  ds_read_b64_tr_b16 v[44:45], v14 offset:34080
  v_mfma_f32_16x16x32_bf16 v[164:167], v[52:55], a[220:223], v[164:167]
  ds_read_b64_tr_b16 v[46:47], v14 offset:42528
  s_waitcnt lgkmcnt(8)
  v_mfma_f32_16x16x32_bf16 a[12:15], v[56:59], a[208:211], a[12:15]
  ds_read_b64_tr_b16 v[48:49], v2 offset:34112
  s_add_u32 m0, s31, 5216
  v_mfma_f32_16x16x32_bf16 a[12:15], v[60:63], a[216:219], a[12:15]
  ds_read_b64_tr_b16 v[50:51], v2 offset:42560
  buffer_load_dwordx4 v23, s[8:11], s63 offen  lds
  v_mfma_f32_16x16x32_bf16 a[76:79], v[56:59], a[212:215], a[76:79]
  ds_read_b64_tr_b16 v[52:53], v14 offset:34112
  v_mfma_f32_16x16x32_bf16 a[76:79], v[60:63], a[220:223], a[76:79]
  ds_read_b64_tr_b16 v[54:55], v14 offset:42560
  s_waitcnt vmcnt(9)
  s_waitcnt lgkmcnt(8)
  v_mfma_f32_16x16x32_bf16 v[136:139], v[32:35], a[208:211], v[136:139]
  ds_read_b64_tr_b16 v[56:57], v2 offset:34144
  v_add_u32 v29, 137216, v25
  ds_read_b128 a[224:227], v29 offset:0
  v_mfma_f32_16x16x32_bf16 v[136:139], v[36:39], a[216:219], v[136:139]
  ds_read_b64_tr_b16 v[58:59], v2 offset:42592
  ds_read_b128 a[228:231], v29 offset:2112
  v_mfma_f32_16x16x32_bf16 v[168:171], v[32:35], a[212:215], v[168:171]
  ds_read_b64_tr_b16 v[60:61], v14 offset:34144
  s_add_u32 s63, s62, 2884096
  v_mfma_f32_16x16x32_bf16 v[168:171], v[36:39], a[220:223], v[168:171]
  ds_read_b64_tr_b16 v[62:63], v14 offset:42592
  s_waitcnt lgkmcnt(10)
  v_mfma_f32_16x16x32_bf16 a[20:23], v[40:43], a[208:211], a[20:23]
  ds_read_b64_tr_b16 v[32:33], v2 offset:34304
  s_add_u32 m0, s31, 69632
  v_mfma_f32_16x16x32_bf16 a[20:23], v[44:47], a[216:219], a[20:23]
  ds_read_b64_tr_b16 v[34:35], v2 offset:42752
  buffer_load_dwordx4 v20, s[8:11], s63 offen  lds
  v_mfma_f32_16x16x32_bf16 a[84:87], v[40:43], a[212:215], a[84:87]
  ds_read_b64_tr_b16 v[36:37], v14 offset:34304
  v_mfma_f32_16x16x32_bf16 a[84:87], v[44:47], a[220:223], a[84:87]
  ds_read_b64_tr_b16 v[38:39], v14 offset:42752
  s_waitcnt lgkmcnt(10)
  v_mfma_f32_16x16x32_bf16 v[140:143], v[48:51], a[208:211], v[140:143]
  ds_read_b64_tr_b16 v[40:41], v2 offset:34336
  s_add_u32 m0, s31, 70688
  v_mfma_f32_16x16x32_bf16 v[140:143], v[52:55], a[216:219], v[140:143]
  ds_read_b64_tr_b16 v[42:43], v2 offset:42784
  buffer_load_dwordx4 v21, s[8:11], s63 offen  lds
  v_mfma_f32_16x16x32_bf16 v[172:175], v[48:51], a[212:215], v[172:175]
  ds_read_b64_tr_b16 v[44:45], v14 offset:34336
  v_mfma_f32_16x16x32_bf16 v[172:175], v[52:55], a[220:223], v[172:175]
  ds_read_b64_tr_b16 v[46:47], v14 offset:42784
  s_waitcnt lgkmcnt(8)
  v_mfma_f32_16x16x32_bf16 a[28:31], v[56:59], a[208:211], a[28:31]
  ds_read_b64_tr_b16 v[48:49], v2 offset:34368
  v_mfma_f32_16x16x32_bf16 a[28:31], v[60:63], a[216:219], a[28:31]
  ds_read_b64_tr_b16 v[50:51], v2 offset:42816
  v_mfma_f32_16x16x32_bf16 a[92:95], v[56:59], a[212:215], a[92:95]
  ds_read_b64_tr_b16 v[52:53], v14 offset:34368
  ds_read_b128 a[232:235], v29 offset:64
  ds_read_b128 a[236:239], v29 offset:2176
  v_mfma_f32_16x16x32_bf16 a[92:95], v[60:63], a[220:223], a[92:95]
  ds_read_b64_tr_b16 v[54:55], v14 offset:42816
  s_waitcnt lgkmcnt(10)
  v_mfma_f32_16x16x32_bf16 v[144:147], v[32:35], a[208:211], v[144:147]
  ds_read_b64_tr_b16 v[56:57], v2 offset:34400
  s_add_u32 m0, s31, 71744
  v_mfma_f32_16x16x32_bf16 v[144:147], v[36:39], a[216:219], v[144:147]
  ds_read_b64_tr_b16 v[58:59], v2 offset:42848
  buffer_load_dwordx4 v22, s[8:11], s63 offen  lds
  v_mfma_f32_16x16x32_bf16 v[176:179], v[32:35], a[212:215], v[176:179]
  ds_read_b64_tr_b16 v[60:61], v14 offset:34400
  v_mfma_f32_16x16x32_bf16 v[176:179], v[36:39], a[220:223], v[176:179]
  ds_read_b64_tr_b16 v[62:63], v14 offset:42848
  s_waitcnt lgkmcnt(10)
  v_mfma_f32_16x16x32_bf16 a[36:39], v[40:43], a[208:211], a[36:39]
  ds_read_b64_tr_b16 v[32:33], v2 offset:34560
  v_mfma_f32_16x16x32_bf16 a[36:39], v[44:47], a[216:219], a[36:39]
  ds_read_b64_tr_b16 v[34:35], v2 offset:43008
  v_mfma_f32_16x16x32_bf16 a[100:103], v[40:43], a[212:215], a[100:103]
  ds_read_b64_tr_b16 v[36:37], v14 offset:34560
  v_mfma_f32_16x16x32_bf16 a[100:103], v[44:47], a[220:223], a[100:103]
  ds_read_b64_tr_b16 v[38:39], v14 offset:43008
  s_waitcnt lgkmcnt(8)
  v_mfma_f32_16x16x32_bf16 v[148:151], v[48:51], a[208:211], v[148:151]
  ds_read_b64_tr_b16 v[40:41], v2 offset:34592
  s_add_u32 m0, s31, 72800
  v_mfma_f32_16x16x32_bf16 v[148:151], v[52:55], a[216:219], v[148:151]
  ds_read_b64_tr_b16 v[42:43], v2 offset:43040
  buffer_load_dwordx4 v23, s[8:11], s63 offen  lds
  v_mfma_f32_16x16x32_bf16 v[180:183], v[48:51], a[212:215], v[180:183]
  ds_read_b64_tr_b16 v[44:45], v14 offset:34592
  v_mfma_f32_16x16x32_bf16 v[180:183], v[52:55], a[220:223], v[180:183]
  ds_read_b64_tr_b16 v[46:47], v14 offset:43040
  s_waitcnt lgkmcnt(8)
  v_mfma_f32_16x16x32_bf16 a[44:47], v[56:59], a[208:211], a[44:47]
  ds_read_b64_tr_b16 v[48:49], v2 offset:34624
  v_mfma_f32_16x16x32_bf16 a[44:47], v[60:63], a[216:219], a[44:47]
  ds_read_b64_tr_b16 v[50:51], v2 offset:43072
  v_mfma_f32_16x16x32_bf16 a[108:111], v[56:59], a[212:215], a[108:111]
  ds_read_b64_tr_b16 v[52:53], v14 offset:34624
  v_mfma_f32_16x16x32_bf16 a[108:111], v[60:63], a[220:223], a[108:111]
  ds_read_b64_tr_b16 v[54:55], v14 offset:43072
  s_waitcnt lgkmcnt(8)
  v_mfma_f32_16x16x32_bf16 v[152:155], v[32:35], a[208:211], v[152:155]
  ds_read_b64_tr_b16 v[56:57], v2 offset:34656
  v_mfma_f32_16x16x32_bf16 v[152:155], v[36:39], a[216:219], v[152:155]
  ds_read_b64_tr_b16 v[58:59], v2 offset:43104
  s_waitcnt vmcnt(8)
  v_mfma_f32_16x16x32_bf16 v[184:187], v[32:35], a[212:215], v[184:187]
  ds_read_b64_tr_b16 v[60:61], v14 offset:34656
  s_barrier
  v_mfma_f32_16x16x32_bf16 v[184:187], v[36:39], a[220:223], v[184:187]
  ds_read_b64_tr_b16 v[62:63], v14 offset:43104
  s_waitcnt lgkmcnt(8)
  v_mfma_f32_16x16x32_bf16 a[52:55], v[40:43], a[208:211], a[52:55]
  ds_read_b64_tr_b16 v[32:33], v2 offset:50688
  s_add_u32 s63, s62, 3146240
  v_mfma_f32_16x16x32_bf16 a[52:55], v[44:47], a[216:219], a[52:55]
  ds_read_b64_tr_b16 v[34:35], v2 offset:59136
  s_add_u32 m0, s31, 18944
  v_mfma_f32_16x16x32_bf16 a[116:119], v[40:43], a[212:215], a[116:119]
  ds_read_b64_tr_b16 v[36:37], v14 offset:50688
  buffer_load_dwordx4 v20, s[8:11], s63 offen  lds
  v_mfma_f32_16x16x32_bf16 a[116:119], v[44:47], a[220:223], a[116:119]
  ds_read_b64_tr_b16 v[38:39], v14 offset:59136
  s_waitcnt lgkmcnt(8)
  v_mfma_f32_16x16x32_bf16 v[156:159], v[48:51], a[208:211], v[156:159]
  ds_read_b64_tr_b16 v[40:41], v2 offset:50720
  v_mfma_f32_16x16x32_bf16 v[156:159], v[52:55], a[216:219], v[156:159]
  ds_read_b64_tr_b16 v[42:43], v2 offset:59168
  v_mfma_f32_16x16x32_bf16 v[188:191], v[48:51], a[212:215], v[188:191]
  ds_read_b64_tr_b16 v[44:45], v14 offset:50720
  v_mfma_f32_16x16x32_bf16 v[188:191], v[52:55], a[220:223], v[188:191]
  ds_read_b64_tr_b16 v[46:47], v14 offset:59168
  s_waitcnt lgkmcnt(8)
  v_mfma_f32_16x16x32_bf16 a[60:63], v[56:59], a[208:211], a[60:63]
  ds_read_b64_tr_b16 v[48:49], v2 offset:50752
  s_add_u32 m0, s31, 20000
  v_mfma_f32_16x16x32_bf16 a[60:63], v[60:63], a[216:219], a[60:63]
  ds_read_b64_tr_b16 v[50:51], v2 offset:59200
  buffer_load_dwordx4 v21, s[8:11], s63 offen  lds
  v_mfma_f32_16x16x32_bf16 a[124:127], v[56:59], a[212:215], a[124:127]
  ds_read_b64_tr_b16 v[52:53], v14 offset:50752
  v_mfma_f32_16x16x32_bf16 a[124:127], v[60:63], a[220:223], a[124:127]
  ds_read_b64_tr_b16 v[54:55], v14 offset:59200
  s_waitcnt lgkmcnt(8)
  v_mfma_f32_16x16x32_bf16 v[128:131], v[32:35], a[224:227], v[128:131]
  ds_read_b64_tr_b16 v[56:57], v2 offset:50784
  v_mfma_f32_16x16x32_bf16 v[128:131], v[36:39], a[232:235], v[128:131]
  ds_read_b64_tr_b16 v[58:59], v2 offset:59232
  v_mfma_f32_16x16x32_bf16 v[160:163], v[32:35], a[228:231], v[160:163]
  ds_read_b64_tr_b16 v[60:61], v14 offset:50784
  v_mfma_f32_16x16x32_bf16 v[160:163], v[36:39], a[236:239], v[160:163]
  ds_read_b64_tr_b16 v[62:63], v14 offset:59232
  s_waitcnt lgkmcnt(8)
  v_mfma_f32_16x16x32_bf16 a[4:7], v[40:43], a[224:227], a[4:7]
  ds_read_b64_tr_b16 v[32:33], v2 offset:50944
  s_add_u32 m0, s31, 21056
  v_mfma_f32_16x16x32_bf16 a[4:7], v[44:47], a[232:235], a[4:7]
  ds_read_b64_tr_b16 v[34:35], v2 offset:59392
  buffer_load_dwordx4 v22, s[8:11], s63 offen  lds
  v_mfma_f32_16x16x32_bf16 a[68:71], v[40:43], a[228:231], a[68:71]
  ds_read_b64_tr_b16 v[36:37], v14 offset:50944
  v_mfma_f32_16x16x32_bf16 a[68:71], v[44:47], a[236:239], a[68:71]
  ds_read_b64_tr_b16 v[38:39], v14 offset:59392
  s_waitcnt lgkmcnt(8)
  v_mfma_f32_16x16x32_bf16 v[132:135], v[48:51], a[224:227], v[132:135]
  ds_read_b64_tr_b16 v[40:41], v2 offset:50976
  v_mfma_f32_16x16x32_bf16 v[132:135], v[52:55], a[232:235], v[132:135]
  ds_read_b64_tr_b16 v[42:43], v2 offset:59424
  v_mfma_f32_16x16x32_bf16 v[164:167], v[48:51], a[228:231], v[164:167]
  ds_read_b64_tr_b16 v[44:45], v14 offset:50976
  v_mfma_f32_16x16x32_bf16 v[164:167], v[52:55], a[236:239], v[164:167]
  ds_read_b64_tr_b16 v[46:47], v14 offset:59424
  s_waitcnt lgkmcnt(8)
  v_mfma_f32_16x16x32_bf16 a[12:15], v[56:59], a[224:227], a[12:15]
  ds_read_b64_tr_b16 v[48:49], v2 offset:51008
  s_add_u32 m0, s31, 22112
  v_mfma_f32_16x16x32_bf16 a[12:15], v[60:63], a[232:235], a[12:15]
  ds_read_b64_tr_b16 v[50:51], v2 offset:59456
  buffer_load_dwordx4 v23, s[8:11], s63 offen  lds
  v_mfma_f32_16x16x32_bf16 a[76:79], v[56:59], a[228:231], a[76:79]
  ds_read_b64_tr_b16 v[52:53], v14 offset:51008
  v_mfma_f32_16x16x32_bf16 a[76:79], v[60:63], a[236:239], a[76:79]
  ds_read_b64_tr_b16 v[54:55], v14 offset:59456
  s_waitcnt lgkmcnt(8)
  v_mfma_f32_16x16x32_bf16 v[136:139], v[32:35], a[224:227], v[136:139]
  ds_read_b64_tr_b16 v[56:57], v2 offset:51040
  v_accvgpr_read_b32 v16, a4
  v_accvgpr_read_b32 v17, a5
  v_mfma_f32_16x16x32_bf16 v[136:139], v[36:39], a[232:235], v[136:139]
  ds_read_b64_tr_b16 v[58:59], v2 offset:59488
  s_add_u32 s63, s62, 3408384
  v_accvgpr_read_b32 v18, a6
  v_accvgpr_read_b32 v19, a7
  v_mfma_f32_16x16x32_bf16 v[168:171], v[32:35], a[228:231], v[168:171]
  ds_read_b64_tr_b16 v[60:61], v14 offset:51040
  v_mul_f32 v128, s58, v128
  v_mul_f32 v129, s58, v129
  v_mul_f32 v130, s58, v130
  v_mfma_f32_16x16x32_bf16 v[168:171], v[36:39], a[236:239], v[168:171]
  ds_read_b64_tr_b16 v[62:63], v14 offset:59488
  v_mul_f32 v131, s58, v131
  v_mul_f32 v16, s58, v16
  s_waitcnt lgkmcnt(8)
  v_mfma_f32_16x16x32_bf16 a[20:23], v[40:43], a[224:227], a[20:23]
  ds_read_b64_tr_b16 v[32:33], v2 offset:51200
  s_add_u32 m0, s31, 86528
  v_mul_f32 v17, s58, v17
  v_mul_f32 v18, s58, v18
  v_mfma_f32_16x16x32_bf16 a[20:23], v[44:47], a[232:235], a[20:23]
  ds_read_b64_tr_b16 v[34:35], v2 offset:59648
  buffer_load_dwordx4 v20, s[8:11], s63 offen  lds
  v_mul_f32 v19, s58, v19
  v_cvt_pk_bf16_f32 v128, v128, v129
  v_mfma_f32_16x16x32_bf16 a[84:87], v[40:43], a[228:231], a[84:87]
  ds_read_b64_tr_b16 v[36:37], v14 offset:51200
  v_cvt_pk_bf16_f32 v129, v130, v131
  v_cvt_pk_bf16_f32 v130, v16, v17
  v_cvt_pk_bf16_f32 v131, v18, v19
  v_mfma_f32_16x16x32_bf16 a[84:87], v[44:47], a[236:239], a[84:87]
  ds_read_b64_tr_b16 v[38:39], v14 offset:59648
  v_accvgpr_read_b32 v10, a68
  v_accvgpr_read_b32 v11, a69
  s_waitcnt lgkmcnt(8)
  v_mfma_f32_16x16x32_bf16 v[140:143], v[48:51], a[224:227], v[140:143]
  ds_read_b64_tr_b16 v[40:41], v2 offset:51232
  s_add_u32 m0, s31, 87584
  v_accvgpr_read_b32 v12, a70
  v_accvgpr_read_b32 v13, a71
  v_mfma_f32_16x16x32_bf16 v[140:143], v[52:55], a[232:235], v[140:143]
  ds_read_b64_tr_b16 v[42:43], v2 offset:59680
  buffer_load_dwordx4 v21, s[8:11], s63 offen  lds
  v_mul_f32 v160, s58, v160
  v_mul_f32 v161, s58, v161
  v_mfma_f32_16x16x32_bf16 v[172:175], v[48:51], a[228:231], v[172:175]
  ds_read_b64_tr_b16 v[44:45], v14 offset:51232
  v_mul_f32 v162, s58, v162
  v_mul_f32 v163, s58, v163
  v_mfma_f32_16x16x32_bf16 v[172:175], v[52:55], a[236:239], v[172:175]
  ds_read_b64_tr_b16 v[46:47], v14 offset:59680
  v_mul_f32 v10, s58, v10
  v_mul_f32 v11, s58, v11
  s_waitcnt lgkmcnt(8)
  v_mfma_f32_16x16x32_bf16 a[28:31], v[56:59], a[224:227], a[28:31]
  ds_read_b64_tr_b16 v[48:49], v2 offset:51264
  v_mul_f32 v12, s58, v12
  v_mul_f32 v13, s58, v13
  v_permlane16_swap_b32 v128, v130
  v_mfma_f32_16x16x32_bf16 a[28:31], v[60:63], a[232:235], a[28:31]
  ds_read_b64_tr_b16 v[50:51], v2 offset:59712
  v_permlane16_swap_b32 v129, v131
  v_cvt_pk_bf16_f32 v160, v160, v161
  v_cvt_pk_bf16_f32 v161, v162, v163
  v_mfma_f32_16x16x32_bf16 a[92:95], v[56:59], a[228:231], a[92:95]
  ds_read_b64_tr_b16 v[52:53], v14 offset:51264
  v_cvt_pk_bf16_f32 v162, v10, v11
  v_cvt_pk_bf16_f32 v163, v12, v13
  v_accvgpr_read_b32 v16, a12
  v_mfma_f32_16x16x32_bf16 a[92:95], v[60:63], a[236:239], a[92:95]
  ds_read_b64_tr_b16 v[54:55], v14 offset:59712
  v_accvgpr_read_b32 v17, a13
  v_accvgpr_read_b32 v18, a14
  s_waitcnt lgkmcnt(8)
  v_mfma_f32_16x16x32_bf16 v[144:147], v[32:35], a[224:227], v[144:147]
  ds_read_b64_tr_b16 v[56:57], v2 offset:51296
  s_add_u32 m0, s31, 88640
  v_accvgpr_read_b32 v19, a15
  v_mul_f32 v132, s58, v132
  v_mfma_f32_16x16x32_bf16 v[144:147], v[36:39], a[232:235], v[144:147]
  ds_read_b64_tr_b16 v[58:59], v2 offset:59744
  buffer_load_dwordx4 v22, s[8:11], s63 offen  lds
  v_mul_f32 v133, s58, v133
  v_mul_f32 v134, s58, v134
  v_mfma_f32_16x16x32_bf16 v[176:179], v[32:35], a[228:231], v[176:179]
  ds_read_b64_tr_b16 v[60:61], v14 offset:51296
  v_mul_f32 v135, s58, v135
  v_mul_f32 v16, s58, v16
  v_mul_f32 v17, s58, v17
  v_mfma_f32_16x16x32_bf16 v[176:179], v[36:39], a[236:239], v[176:179]
  ds_read_b64_tr_b16 v[62:63], v14 offset:59744
  v_mul_f32 v18, s58, v18
  v_mul_f32 v19, s58, v19
  s_waitcnt lgkmcnt(8)
  v_mfma_f32_16x16x32_bf16 a[36:39], v[40:43], a[224:227], a[36:39]
  ds_read_b64_tr_b16 v[32:33], v2 offset:51456
  v_permlane16_swap_b32 v160, v162
  v_permlane16_swap_b32 v161, v163
  v_mfma_f32_16x16x32_bf16 a[36:39], v[44:47], a[232:235], a[36:39]
  ds_read_b64_tr_b16 v[34:35], v2 offset:59904
  v_cvt_pk_bf16_f32 v132, v132, v133
  v_cvt_pk_bf16_f32 v133, v134, v135
  v_cvt_pk_bf16_f32 v134, v16, v17
  v_mfma_f32_16x16x32_bf16 a[100:103], v[40:43], a[228:231], a[100:103]
  ds_read_b64_tr_b16 v[36:37], v14 offset:51456
  v_cvt_pk_bf16_f32 v135, v18, v19
  v_accvgpr_read_b32 v10, a76
  v_accvgpr_read_b32 v11, a77
  v_mfma_f32_16x16x32_bf16 a[100:103], v[44:47], a[236:239], a[100:103]
  ds_read_b64_tr_b16 v[38:39], v14 offset:59904
  v_accvgpr_read_b32 v12, a78
  v_accvgpr_read_b32 v13, a79
  s_waitcnt lgkmcnt(8)
  v_mfma_f32_16x16x32_bf16 v[148:151], v[48:51], a[224:227], v[148:151]
  ds_read_b64_tr_b16 v[40:41], v2 offset:51488
  s_add_u32 m0, s31, 89696
  v_mul_f32 v164, s58, v164
  v_mul_f32 v165, s58, v165
  v_mfma_f32_16x16x32_bf16 v[148:151], v[52:55], a[232:235], v[148:151]
  ds_read_b64_tr_b16 v[42:43], v2 offset:59936
  buffer_load_dwordx4 v23, s[8:11], s63 offen  lds
  v_mul_f32 v166, s58, v166
  v_mul_f32 v167, s58, v167
  v_mfma_f32_16x16x32_bf16 v[180:183], v[48:51], a[228:231], v[180:183]
  ds_read_b64_tr_b16 v[44:45], v14 offset:51488
  v_mul_f32 v10, s58, v10
  v_mul_f32 v11, s58, v11
  v_mul_f32 v12, s58, v12
  v_mfma_f32_16x16x32_bf16 v[180:183], v[52:55], a[236:239], v[180:183]
  ds_read_b64_tr_b16 v[46:47], v14 offset:59936
  v_mul_f32 v13, s58, v13
  v_permlane16_swap_b32 v132, v134
  s_waitcnt lgkmcnt(8)
  v_mfma_f32_16x16x32_bf16 a[44:47], v[56:59], a[224:227], a[44:47]
  ds_read_b64_tr_b16 v[48:49], v2 offset:51520
  v_permlane16_swap_b32 v133, v135
  v_cvt_pk_bf16_f32 v164, v164, v165
  v_cvt_pk_bf16_f32 v165, v166, v167
  v_mfma_f32_16x16x32_bf16 a[44:47], v[60:63], a[232:235], a[44:47]
  ds_read_b64_tr_b16 v[50:51], v2 offset:59968
  v_cvt_pk_bf16_f32 v166, v10, v11
  v_cvt_pk_bf16_f32 v167, v12, v13
  v_accvgpr_read_b32 v16, a20
  v_mfma_f32_16x16x32_bf16 a[108:111], v[56:59], a[228:231], a[108:111]
  ds_read_b64_tr_b16 v[52:53], v14 offset:51520
  v_accvgpr_read_b32 v17, a21
  v_accvgpr_read_b32 v18, a22
  v_mfma_f32_16x16x32_bf16 a[108:111], v[60:63], a[236:239], a[108:111]
  ds_read_b64_tr_b16 v[54:55], v14 offset:59968
  v_accvgpr_read_b32 v19, a23
  v_mul_f32 v136, s58, v136
  s_waitcnt lgkmcnt(8)
  v_mfma_f32_16x16x32_bf16 v[152:155], v[32:35], a[224:227], v[152:155]
  ds_read_b64_tr_b16 v[56:57], v2 offset:51552
  v_mul_f32 v137, s58, v137
  v_mul_f32 v138, s58, v138
  v_mul_f32 v139, s58, v139
  v_mfma_f32_16x16x32_bf16 v[152:155], v[36:39], a[232:235], v[152:155]
  ds_read_b64_tr_b16 v[58:59], v2 offset:60000
  v_mul_f32 v16, s58, v16
  v_mul_f32 v17, s58, v17
  s_waitcnt vmcnt(8)
  v_mfma_f32_16x16x32_bf16 v[184:187], v[32:35], a[228:231], v[184:187]
  ds_read_b64_tr_b16 v[60:61], v14 offset:51552
  v_mul_f32 v18, s58, v18
  v_mul_f32 v19, s58, v19
  s_barrier
  v_mfma_f32_16x16x32_bf16 v[184:187], v[36:39], a[236:239], v[184:187]
  ds_read_b64_tr_b16 v[62:63], v14 offset:60000
  v_permlane16_swap_b32 v164, v166
  v_permlane16_swap_b32 v165, v167
  s_waitcnt lgkmcnt(8)
  v_mfma_f32_16x16x32_bf16 a[52:55], v[40:43], a[224:227], a[52:55]
  ds_read_b64_tr_b16 v[32:33], v2 offset:0
  s_mov_b32 s60, 0
  v_cvt_pk_bf16_f32 v136, v136, v137
  v_cvt_pk_bf16_f32 v137, v138, v139
  v_mfma_f32_16x16x32_bf16 a[52:55], v[44:47], a[232:235], a[52:55]
  ds_read_b64_tr_b16 v[34:35], v2 offset:8448
  s_add_u32 m0, s31, 35840
  v_cvt_pk_bf16_f32 v138, v16, v17
  v_cvt_pk_bf16_f32 v139, v18, v19
  v_mfma_f32_16x16x32_bf16 a[116:119], v[40:43], a[228:231], a[116:119]
  ds_read_b64_tr_b16 v[36:37], v14 offset:0
  buffer_load_dwordx4 v3, s[12:15], s60 offen offset:0 nt lds
  v_accvgpr_read_b32 v10, a84
  v_accvgpr_read_b32 v11, a85
  v_mfma_f32_16x16x32_bf16 a[116:119], v[44:47], a[236:239], a[116:119]
  ds_read_b64_tr_b16 v[38:39], v14 offset:8448
  v_accvgpr_read_b32 v12, a86
  v_accvgpr_read_b32 v13, a87
  s_waitcnt lgkmcnt(8)
  v_mfma_f32_16x16x32_bf16 v[156:159], v[48:51], a[224:227], v[156:159]
  ds_read_b64_tr_b16 v[40:41], v2 offset:32
  v_mul_f32 v168, s58, v168
  v_mul_f32 v169, s58, v169
  v_mfma_f32_16x16x32_bf16 v[156:159], v[52:55], a[232:235], v[156:159]
  ds_read_b64_tr_b16 v[42:43], v2 offset:8480
  v_mul_f32 v170, s58, v170
  v_mul_f32 v171, s58, v171
  v_mul_f32 v10, s58, v10
  v_mfma_f32_16x16x32_bf16 v[188:191], v[48:51], a[228:231], v[188:191]
  ds_read_b64_tr_b16 v[44:45], v14 offset:32
  v_mul_f32 v11, s58, v11
  v_mul_f32 v12, s58, v12
  v_mul_f32 v13, s58, v13
  v_mfma_f32_16x16x32_bf16 v[188:191], v[52:55], a[236:239], v[188:191]
  ds_read_b64_tr_b16 v[46:47], v14 offset:8480
  v_permlane16_swap_b32 v136, v138
  v_permlane16_swap_b32 v137, v139
  s_waitcnt lgkmcnt(8)
  v_mfma_f32_16x16x32_bf16 a[60:63], v[56:59], a[224:227], a[60:63]
  ds_read_b64_tr_b16 v[48:49], v2 offset:64
  s_add_u32 m0, s31, 35872
  v_cvt_pk_bf16_f32 v168, v168, v169
  v_cvt_pk_bf16_f32 v169, v170, v171
  v_mfma_f32_16x16x32_bf16 a[60:63], v[60:63], a[232:235], a[60:63]
  ds_read_b64_tr_b16 v[50:51], v2 offset:8512
  buffer_load_dwordx4 v3, s[12:15], s60 offen offset:1024 nt lds
  v_cvt_pk_bf16_f32 v170, v10, v11
  v_cvt_pk_bf16_f32 v171, v12, v13
  v_mfma_f32_16x16x32_bf16 a[124:127], v[56:59], a[228:231], a[124:127]
  ds_read_b64_tr_b16 v[52:53], v14 offset:64
  v_accvgpr_read_b32 v16, a28
  v_accvgpr_read_b32 v17, a29
  v_accvgpr_read_b32 v18, a30
  v_mfma_f32_16x16x32_bf16 a[124:127], v[60:63], a[236:239], a[124:127]
  ds_read_b64_tr_b16 v[54:55], v14 offset:8512
  v_accvgpr_read_b32 v19, a31
  v_mul_f32 v140, s58, v140
  s_waitcnt lgkmcnt(8)
  v_mfma_f32_16x16x32_bf16 v[192:195], v[32:35], a[208:211], v[192:195]
  ds_read_b64_tr_b16 v[56:57], v2 offset:96
  v_mul_f32 v141, s58, v141
  v_mul_f32 v142, s58, v142
  v_mul_f32 v143, s58, v143
  v_mfma_f32_16x16x32_bf16 v[192:195], v[36:39], a[216:219], v[192:195]
  ds_read_b64_tr_b16 v[58:59], v2 offset:8544
  v_mul_f32 v16, s58, v16
  v_mul_f32 v17, s58, v17
  v_mul_f32 v18, s58, v18
  v_mfma_f32_16x16x32_bf16 v[224:227], v[32:35], a[212:215], v[224:227]
  ds_read_b64_tr_b16 v[60:61], v14 offset:96
  v_mul_f32 v19, s58, v19
  v_permlane16_swap_b32 v168, v170
  v_mfma_f32_16x16x32_bf16 v[224:227], v[36:39], a[220:223], v[224:227]
  ds_read_b64_tr_b16 v[62:63], v14 offset:8544
  v_permlane16_swap_b32 v169, v171
  v_cvt_pk_bf16_f32 v140, v140, v141
  s_waitcnt lgkmcnt(8)
  v_mfma_f32_16x16x32_bf16 v[64:67], v[40:43], a[208:211], v[64:67]
  ds_read_b64_tr_b16 v[32:33], v2 offset:256
  s_add_u32 m0, s31, 35904
  v_cvt_pk_bf16_f32 v141, v142, v143
  v_cvt_pk_bf16_f32 v142, v16, v17
  v_mfma_f32_16x16x32_bf16 v[64:67], v[44:47], a[216:219], v[64:67]
  ds_read_b64_tr_b16 v[34:35], v2 offset:8704
  buffer_load_dwordx4 v3, s[12:15], s60 offen offset:2048 nt lds
  v_cvt_pk_bf16_f32 v143, v18, v19
  v_accvgpr_read_b32 v10, a92
  v_mfma_f32_16x16x32_bf16 v[68:71], v[40:43], a[212:215], v[68:71]
  ds_read_b64_tr_b16 v[36:37], v14 offset:256
  v_accvgpr_read_b32 v11, a93
  v_accvgpr_read_b32 v12, a94
  v_accvgpr_read_b32 v13, a95
  v_mfma_f32_16x16x32_bf16 v[68:71], v[44:47], a[220:223], v[68:71]
  ds_read_b64_tr_b16 v[38:39], v14 offset:8704
  v_mul_f32 v172, s58, v172
  v_mul_f32 v173, s58, v173
  s_waitcnt lgkmcnt(8)
  v_mfma_f32_16x16x32_bf16 v[196:199], v[48:51], a[208:211], v[196:199]
  ds_read_b64_tr_b16 v[40:41], v2 offset:288
  v_mul_f32 v174, s58, v174
  v_mul_f32 v175, s58, v175
  v_mul_f32 v10, s58, v10
  v_mfma_f32_16x16x32_bf16 v[196:199], v[52:55], a[216:219], v[196:199]
  ds_read_b64_tr_b16 v[42:43], v2 offset:8736
  v_mul_f32 v11, s58, v11
  v_mul_f32 v12, s58, v12
  v_mul_f32 v13, s58, v13
  v_mfma_f32_16x16x32_bf16 v[228:231], v[48:51], a[212:215], v[228:231]
  ds_read_b64_tr_b16 v[44:45], v14 offset:288
  v_permlane16_swap_b32 v140, v142
  v_permlane16_swap_b32 v141, v143
  v_cvt_pk_bf16_f32 v172, v172, v173
  v_mfma_f32_16x16x32_bf16 v[228:231], v[52:55], a[220:223], v[228:231]
  ds_read_b64_tr_b16 v[46:47], v14 offset:8736
  v_cvt_pk_bf16_f32 v173, v174, v175
  v_cvt_pk_bf16_f32 v174, v10, v11
  s_waitcnt lgkmcnt(8)
  v_mfma_f32_16x16x32_bf16 v[72:75], v[56:59], a[208:211], v[72:75]
  ds_read_b64_tr_b16 v[48:49], v2 offset:320
  s_add_u32 m0, s31, 35936
  v_cvt_pk_bf16_f32 v175, v12, v13
  v_mfma_f32_16x16x32_bf16 v[72:75], v[60:63], a[216:219], v[72:75]
  ds_read_b64_tr_b16 v[50:51], v2 offset:8768
  buffer_load_dwordx4 v3, s[12:15], s60 offen offset:3072 nt lds
  v_accvgpr_read_b32 v16, a36
  v_accvgpr_read_b32 v17, a37
  v_mfma_f32_16x16x32_bf16 v[76:79], v[56:59], a[212:215], v[76:79]
  ds_read_b64_tr_b16 v[52:53], v14 offset:320
  v_accvgpr_read_b32 v18, a38
  v_accvgpr_read_b32 v19, a39
  v_mul_f32 v144, s58, v144
  v_mfma_f32_16x16x32_bf16 v[76:79], v[60:63], a[220:223], v[76:79]
  ds_read_b64_tr_b16 v[54:55], v14 offset:8768
  v_mul_f32 v145, s58, v145
  v_mul_f32 v146, s58, v146
  s_waitcnt lgkmcnt(8)
  v_mfma_f32_16x16x32_bf16 v[200:203], v[32:35], a[208:211], v[200:203]
  ds_read_b64_tr_b16 v[56:57], v2 offset:352
  v_mul_f32 v147, s58, v147
  v_mul_f32 v16, s58, v16
  v_mul_f32 v17, s58, v17
  v_mfma_f32_16x16x32_bf16 v[200:203], v[36:39], a[216:219], v[200:203]
  ds_read_b64_tr_b16 v[58:59], v2 offset:8800
  s_add_u32 s61, s60, 16384
  v_mul_f32 v18, s58, v18
  v_mul_f32 v19, s58, v19
  v_mfma_f32_16x16x32_bf16 v[232:235], v[32:35], a[212:215], v[232:235]
  ds_read_b64_tr_b16 v[60:61], v14 offset:352
  v_permlane16_swap_b32 v172, v174
  v_permlane16_swap_b32 v173, v175
  v_cvt_pk_bf16_f32 v144, v144, v145
  v_mfma_f32_16x16x32_bf16 v[232:235], v[36:39], a[220:223], v[232:235]
  ds_read_b64_tr_b16 v[62:63], v14 offset:8800
  v_cvt_pk_bf16_f32 v145, v146, v147
  v_cvt_pk_bf16_f32 v146, v16, v17
  s_waitcnt lgkmcnt(8)
  v_mfma_f32_16x16x32_bf16 v[80:83], v[40:43], a[208:211], v[80:83]
  ds_read_b64_tr_b16 v[32:33], v2 offset:512
  s_add_u32 m0, s31, 103424
  v_cvt_pk_bf16_f32 v147, v18, v19
  v_accvgpr_read_b32 v10, a100
  v_mfma_f32_16x16x32_bf16 v[80:83], v[44:47], a[216:219], v[80:83]
  ds_read_b64_tr_b16 v[34:35], v2 offset:8960
  buffer_load_dwordx4 v3, s[12:15], s61 offen offset:0 nt lds
  v_accvgpr_read_b32 v11, a101
  v_accvgpr_read_b32 v12, a102
  v_mfma_f32_16x16x32_bf16 v[84:87], v[40:43], a[212:215], v[84:87]
  ds_read_b64_tr_b16 v[36:37], v14 offset:512
  v_accvgpr_read_b32 v13, a103
  v_mul_f32 v176, s58, v176
  v_mfma_f32_16x16x32_bf16 v[84:87], v[44:47], a[220:223], v[84:87]
  ds_read_b64_tr_b16 v[38:39], v14 offset:8960
  v_mul_f32 v177, s58, v177
  v_mul_f32 v178, s58, v178
  s_waitcnt lgkmcnt(8)
  v_mfma_f32_16x16x32_bf16 v[204:207], v[48:51], a[208:211], v[204:207]
  ds_read_b64_tr_b16 v[40:41], v2 offset:544
  s_add_u32 m0, s31, 103456
  v_mul_f32 v179, s58, v179
  v_mul_f32 v10, s58, v10
  v_mfma_f32_16x16x32_bf16 v[204:207], v[52:55], a[216:219], v[204:207]
  ds_read_b64_tr_b16 v[42:43], v2 offset:8992
  buffer_load_dwordx4 v3, s[12:15], s61 offen offset:1024 nt lds
  v_mul_f32 v11, s58, v11
  v_mul_f32 v12, s58, v12
  v_mfma_f32_16x16x32_bf16 v[236:239], v[48:51], a[212:215], v[236:239]
  ds_read_b64_tr_b16 v[44:45], v14 offset:544
  v_mul_f32 v13, s58, v13
  v_permlane16_swap_b32 v144, v146
  v_permlane16_swap_b32 v145, v147
  v_mfma_f32_16x16x32_bf16 v[236:239], v[52:55], a[220:223], v[236:239]
  ds_read_b64_tr_b16 v[46:47], v14 offset:8992
  v_cvt_pk_bf16_f32 v176, v176, v177
  v_cvt_pk_bf16_f32 v177, v178, v179
  s_waitcnt lgkmcnt(8)
  v_mfma_f32_16x16x32_bf16 v[88:91], v[56:59], a[208:211], v[88:91]
  ds_read_b64_tr_b16 v[48:49], v2 offset:576
  v_cvt_pk_bf16_f32 v178, v10, v11
  v_cvt_pk_bf16_f32 v179, v12, v13
  v_accvgpr_read_b32 v16, a44
  v_mfma_f32_16x16x32_bf16 v[88:91], v[60:63], a[216:219], v[88:91]
  ds_read_b64_tr_b16 v[50:51], v2 offset:9024
  v_accvgpr_read_b32 v17, a45
  v_accvgpr_read_b32 v18, a46
  v_accvgpr_read_b32 v19, a47
  v_mfma_f32_16x16x32_bf16 v[92:95], v[56:59], a[212:215], v[92:95]
  ds_read_b64_tr_b16 v[52:53], v14 offset:576
  v_mul_f32 v148, s58, v148
  v_mul_f32 v149, s58, v149
  v_mul_f32 v150, s58, v150
  v_mfma_f32_16x16x32_bf16 v[92:95], v[60:63], a[220:223], v[92:95]
  ds_read_b64_tr_b16 v[54:55], v14 offset:9024
  v_mul_f32 v151, s58, v151
  v_mul_f32 v16, s58, v16
  s_waitcnt lgkmcnt(8)
  v_mfma_f32_16x16x32_bf16 v[208:211], v[32:35], a[208:211], v[208:211]
  ds_read_b64_tr_b16 v[56:57], v2 offset:608
  s_add_u32 m0, s31, 103488
  v_mul_f32 v17, s58, v17
  v_mfma_f32_16x16x32_bf16 v[208:211], v[36:39], a[216:219], v[208:211]
  ds_read_b64_tr_b16 v[58:59], v2 offset:9056
  buffer_load_dwordx4 v3, s[12:15], s61 offen offset:2048 nt lds
  v_mul_f32 v18, s58, v18
  v_mul_f32 v19, s58, v19
  v_mfma_f32_16x16x32_bf16 v[240:243], v[32:35], a[212:215], v[240:243]
  ds_read_b64_tr_b16 v[60:61], v14 offset:608
  v_permlane16_swap_b32 v176, v178
  v_permlane16_swap_b32 v177, v179
  v_cvt_pk_bf16_f32 v148, v148, v149
  v_mfma_f32_16x16x32_bf16 v[240:243], v[36:39], a[220:223], v[240:243]
  ds_read_b64_tr_b16 v[62:63], v14 offset:9056
  v_cvt_pk_bf16_f32 v149, v150, v151
  v_cvt_pk_bf16_f32 v150, v16, v17
  s_waitcnt lgkmcnt(8)
  v_mfma_f32_16x16x32_bf16 v[96:99], v[40:43], a[208:211], v[96:99]
  ds_read_b64_tr_b16 v[32:33], v2 offset:768
  v_cvt_pk_bf16_f32 v151, v18, v19
  v_accvgpr_read_b32 v10, a108
  v_accvgpr_read_b32 v11, a109
  v_mfma_f32_16x16x32_bf16 v[96:99], v[44:47], a[216:219], v[96:99]
  ds_read_b64_tr_b16 v[34:35], v2 offset:9216
  v_accvgpr_read_b32 v12, a110
  v_accvgpr_read_b32 v13, a111
  v_mul_f32 v180, s58, v180
  v_mfma_f32_16x16x32_bf16 v[100:103], v[40:43], a[212:215], v[100:103]
  ds_read_b64_tr_b16 v[36:37], v14 offset:768
  v_mul_f32 v181, s58, v181
  v_mul_f32 v182, s58, v182
  v_mul_f32 v183, s58, v183
  v_mfma_f32_16x16x32_bf16 v[100:103], v[44:47], a[220:223], v[100:103]
  ds_read_b64_tr_b16 v[38:39], v14 offset:9216
  v_mul_f32 v10, s58, v10
  v_mul_f32 v11, s58, v11
  s_waitcnt lgkmcnt(8)
  v_mfma_f32_16x16x32_bf16 v[212:215], v[48:51], a[208:211], v[212:215]
  ds_read_b64_tr_b16 v[40:41], v2 offset:800
  s_add_u32 m0, s31, 103520
  v_mul_f32 v12, s58, v12
  v_mul_f32 v13, s58, v13
  v_mfma_f32_16x16x32_bf16 v[212:215], v[52:55], a[216:219], v[212:215]
  ds_read_b64_tr_b16 v[42:43], v2 offset:9248
  buffer_load_dwordx4 v3, s[12:15], s61 offen offset:3072 nt lds
  v_permlane16_swap_b32 v148, v150
  v_permlane16_swap_b32 v149, v151
  v_mfma_f32_16x16x32_bf16 v[244:247], v[48:51], a[212:215], v[244:247]
  ds_read_b64_tr_b16 v[44:45], v14 offset:800
  v_cvt_pk_bf16_f32 v180, v180, v181
  v_cvt_pk_bf16_f32 v181, v182, v183
  v_mfma_f32_16x16x32_bf16 v[244:247], v[52:55], a[220:223], v[244:247]
  ds_read_b64_tr_b16 v[46:47], v14 offset:9248
  v_cvt_pk_bf16_f32 v182, v10, v11
  v_cvt_pk_bf16_f32 v183, v12, v13
  s_waitcnt lgkmcnt(8)
  v_mfma_f32_16x16x32_bf16 v[104:107], v[56:59], a[208:211], v[104:107]
  ds_read_b64_tr_b16 v[48:49], v2 offset:832
  v_accvgpr_read_b32 v16, a52
  v_accvgpr_read_b32 v17, a53
  v_accvgpr_read_b32 v18, a54
  v_mfma_f32_16x16x32_bf16 v[104:107], v[60:63], a[216:219], v[104:107]
  ds_read_b64_tr_b16 v[50:51], v2 offset:9280
  v_accvgpr_read_b32 v19, a55
  v_mul_f32 v152, s58, v152
  v_mul_f32 v153, s58, v153
  v_mfma_f32_16x16x32_bf16 v[108:111], v[56:59], a[212:215], v[108:111]
  ds_read_b64_tr_b16 v[52:53], v14 offset:832
  v_mul_f32 v154, s58, v154
  v_mul_f32 v155, s58, v155
  v_mul_f32 v16, s58, v16
  v_mfma_f32_16x16x32_bf16 v[108:111], v[60:63], a[220:223], v[108:111]
  ds_read_b64_tr_b16 v[54:55], v14 offset:9280
  v_mul_f32 v17, s58, v17
  v_mul_f32 v18, s58, v18
  s_waitcnt lgkmcnt(8)
  v_mfma_f32_16x16x32_bf16 v[216:219], v[32:35], a[208:211], v[216:219]
  ds_read_b64_tr_b16 v[56:57], v2 offset:864
  v_mul_f32 v19, s58, v19
  v_permlane16_swap_b32 v180, v182
  v_permlane16_swap_b32 v181, v183
  v_mfma_f32_16x16x32_bf16 v[216:219], v[36:39], a[216:219], v[216:219]
  ds_read_b64_tr_b16 v[58:59], v2 offset:9312
  v_cvt_pk_bf16_f32 v152, v152, v153
  v_cvt_pk_bf16_f32 v153, v154, v155
  s_waitcnt vmcnt(8)
  v_mfma_f32_16x16x32_bf16 v[248:251], v[32:35], a[212:215], v[248:251]
  ds_read_b64_tr_b16 v[60:61], v14 offset:864
  v_cvt_pk_bf16_f32 v154, v16, v17
  v_cvt_pk_bf16_f32 v155, v18, v19
  s_barrier
  v_mfma_f32_16x16x32_bf16 v[248:251], v[36:39], a[220:223], v[248:251]
  ds_read_b64_tr_b16 v[62:63], v14 offset:9312
  v_accvgpr_read_b32 v10, a116
  v_accvgpr_read_b32 v11, a117
  s_waitcnt lgkmcnt(8)
  v_mfma_f32_16x16x32_bf16 v[112:115], v[40:43], a[208:211], v[112:115]
  ds_read_b64_tr_b16 v[32:33], v2 offset:16896
  s_add_u32 m0, s31, 52736
  v_accvgpr_read_b32 v12, a118
  v_mfma_f32_16x16x32_bf16 v[112:115], v[44:47], a[216:219], v[112:115]
  ds_read_b64_tr_b16 v[34:35], v2 offset:25344
  buffer_load_dwordx4 v8, s[16:19], s60 offen offset:0 nt lds
  v_accvgpr_read_b32 v13, a119
  v_mul_f32 v184, s58, v184
  v_mfma_f32_16x16x32_bf16 v[116:119], v[40:43], a[212:215], v[116:119]
  ds_read_b64_tr_b16 v[36:37], v14 offset:16896
  v_mul_f32 v185, s58, v185
  v_mul_f32 v186, s58, v186
  v_mul_f32 v187, s58, v187
  v_mfma_f32_16x16x32_bf16 v[116:119], v[44:47], a[220:223], v[116:119]
  ds_read_b64_tr_b16 v[38:39], v14 offset:25344
  v_mul_f32 v10, s58, v10
  v_mul_f32 v11, s58, v11
  s_waitcnt lgkmcnt(8)
  v_mfma_f32_16x16x32_bf16 v[220:223], v[48:51], a[208:211], v[220:223]
  ds_read_b64_tr_b16 v[40:41], v2 offset:16928
  v_mul_f32 v12, s58, v12
  v_mul_f32 v13, s58, v13
  v_permlane16_swap_b32 v152, v154
  v_mfma_f32_16x16x32_bf16 v[220:223], v[52:55], a[216:219], v[220:223]
  ds_read_b64_tr_b16 v[42:43], v2 offset:25376
  v_permlane16_swap_b32 v153, v155
  v_cvt_pk_bf16_f32 v184, v184, v185
  v_cvt_pk_bf16_f32 v185, v186, v187
  v_mfma_f32_16x16x32_bf16 v[252:255], v[48:51], a[212:215], v[252:255]
  ds_read_b64_tr_b16 v[44:45], v14 offset:16928
  v_cvt_pk_bf16_f32 v186, v10, v11
  v_cvt_pk_bf16_f32 v187, v12, v13
  v_accvgpr_read_b32 v16, a60
  v_mfma_f32_16x16x32_bf16 v[252:255], v[52:55], a[220:223], v[252:255]
  ds_read_b64_tr_b16 v[46:47], v14 offset:25376
  v_accvgpr_read_b32 v17, a61
  v_accvgpr_read_b32 v18, a62
  s_waitcnt lgkmcnt(8)
  v_mfma_f32_16x16x32_bf16 v[120:123], v[56:59], a[208:211], v[120:123]
  ds_read_b64_tr_b16 v[48:49], v2 offset:16960
  s_add_u32 m0, s31, 52768
  v_accvgpr_read_b32 v19, a63
  v_mul_f32 v156, s58, v156
  v_mfma_f32_16x16x32_bf16 v[120:123], v[60:63], a[216:219], v[120:123]
  ds_read_b64_tr_b16 v[50:51], v2 offset:25408
  buffer_load_dwordx4 v8, s[16:19], s60 offen offset:1024 nt lds
  v_mul_f32 v157, s58, v157
  v_mul_f32 v158, s58, v158
  v_mfma_f32_16x16x32_bf16 v[124:127], v[56:59], a[212:215], v[124:127]
  ds_read_b64_tr_b16 v[52:53], v14 offset:16960
  v_mul_f32 v159, s58, v159
  v_mul_f32 v16, s58, v16
  v_mfma_f32_16x16x32_bf16 v[124:127], v[60:63], a[220:223], v[124:127]
  ds_read_b64_tr_b16 v[54:55], v14 offset:25408
  v_mul_f32 v17, s58, v17
  v_mul_f32 v18, s58, v18
  s_waitcnt lgkmcnt(8)
  v_mfma_f32_16x16x32_bf16 v[192:195], v[32:35], a[224:227], v[192:195]
  ds_read_b64_tr_b16 v[56:57], v2 offset:16992
  v_mul_f32 v19, s58, v19
  v_permlane16_swap_b32 v184, v186
  v_permlane16_swap_b32 v185, v187
  v_mfma_f32_16x16x32_bf16 v[192:195], v[36:39], a[232:235], v[192:195]
  ds_read_b64_tr_b16 v[58:59], v2 offset:25440
  v_cvt_pk_bf16_f32 v156, v156, v157
  v_cvt_pk_bf16_f32 v157, v158, v159
  v_cvt_pk_bf16_f32 v158, v16, v17
  v_mfma_f32_16x16x32_bf16 v[224:227], v[32:35], a[228:231], v[224:227]
  ds_read_b64_tr_b16 v[60:61], v14 offset:16992
  v_cvt_pk_bf16_f32 v159, v18, v19
  v_accvgpr_read_b32 v10, a124
  v_accvgpr_read_b32 v11, a125
  v_mfma_f32_16x16x32_bf16 v[224:227], v[36:39], a[236:239], v[224:227]
  ds_read_b64_tr_b16 v[62:63], v14 offset:25440
  v_accvgpr_read_b32 v12, a126
  v_accvgpr_read_b32 v13, a127
  s_waitcnt lgkmcnt(8)
  v_mfma_f32_16x16x32_bf16 v[64:67], v[40:43], a[224:227], v[64:67]
  ds_read_b64_tr_b16 v[32:33], v2 offset:17152
  s_add_u32 m0, s31, 52800
  v_mul_f32 v188, s58, v188
  v_mul_f32 v189, s58, v189
  v_mfma_f32_16x16x32_bf16 v[64:67], v[44:47], a[232:235], v[64:67]
  ds_read_b64_tr_b16 v[34:35], v2 offset:25600
  buffer_load_dwordx4 v8, s[16:19], s60 offen offset:2048 nt lds
  v_mul_f32 v190, s58, v190
  v_mul_f32 v191, s58, v191
  v_mfma_f32_16x16x32_bf16 v[68:71], v[40:43], a[228:231], v[68:71]
  ds_read_b64_tr_b16 v[36:37], v14 offset:17152
  v_mul_f32 v10, s58, v10
  v_mul_f32 v11, s58, v11
  v_mul_f32 v12, s58, v12
  v_mfma_f32_16x16x32_bf16 v[68:71], v[44:47], a[236:239], v[68:71]
  ds_read_b64_tr_b16 v[38:39], v14 offset:25600
  v_mul_f32 v13, s58, v13
  v_permlane16_swap_b32 v156, v158
  s_waitcnt lgkmcnt(8)
  v_mfma_f32_16x16x32_bf16 v[196:199], v[48:51], a[224:227], v[196:199]
  ds_read_b64_tr_b16 v[40:41], v2 offset:17184
  v_permlane16_swap_b32 v157, v159
  v_cvt_pk_bf16_f32 v188, v188, v189
  v_mfma_f32_16x16x32_bf16 v[196:199], v[52:55], a[232:235], v[196:199]
  ds_read_b64_tr_b16 v[42:43], v2 offset:25632
  v_cvt_pk_bf16_f32 v189, v190, v191
  v_cvt_pk_bf16_f32 v190, v10, v11
  v_cvt_pk_bf16_f32 v191, v12, v13
  v_mfma_f32_16x16x32_bf16 v[228:231], v[48:51], a[228:231], v[228:231]
  ds_read_b64_tr_b16 v[44:45], v14 offset:17184
  s_nop 1
  v_permlane16_swap_b32 v188, v190
  v_permlane16_swap_b32 v189, v191
  v_mfma_f32_16x16x32_bf16 v[228:231], v[52:55], a[236:239], v[228:231]
  ds_read_b64_tr_b16 v[46:47], v14 offset:25632
  v_mul_f32 v192, s58, v192
  v_mul_f32 v193, s58, v193
  s_waitcnt lgkmcnt(8)
  v_mfma_f32_16x16x32_bf16 v[72:75], v[56:59], a[224:227], v[72:75]
  ds_read_b64_tr_b16 v[48:49], v2 offset:17216
  s_add_u32 m0, s31, 52832
  v_mul_f32 v194, s58, v194
  v_mul_f32 v195, s58, v195
  v_mfma_f32_16x16x32_bf16 v[72:75], v[60:63], a[232:235], v[72:75]
  ds_read_b64_tr_b16 v[50:51], v2 offset:25664
  buffer_load_dwordx4 v8, s[16:19], s60 offen offset:3072 nt lds
  v_mul_f32 v64, s58, v64
  v_mul_f32 v65, s58, v65
  v_mfma_f32_16x16x32_bf16 v[76:79], v[56:59], a[228:231], v[76:79]
  ds_read_b64_tr_b16 v[52:53], v14 offset:17216
  v_mul_f32 v66, s58, v66
  v_mul_f32 v67, s58, v67
  v_cvt_pk_bf16_f32 v192, v192, v193
  v_mfma_f32_16x16x32_bf16 v[76:79], v[60:63], a[236:239], v[76:79]
  ds_read_b64_tr_b16 v[54:55], v14 offset:25664
  v_cvt_pk_bf16_f32 v193, v194, v195
  v_cvt_pk_bf16_f32 v194, v64, v65
  v_cvt_pk_bf16_f32 v195, v66, v67
  s_waitcnt lgkmcnt(8)
  v_mfma_f32_16x16x32_bf16 v[200:203], v[32:35], a[224:227], v[200:203]
  ds_read_b64_tr_b16 v[56:57], v2 offset:17248
  v_mul_f32 v224, s58, v224
  v_mul_f32 v225, s58, v225
  v_mul_f32 v226, s58, v226
  v_mfma_f32_16x16x32_bf16 v[200:203], v[36:39], a[232:235], v[200:203]
  ds_read_b64_tr_b16 v[58:59], v2 offset:25696
  v_mul_f32 v227, s58, v227
  v_mul_f32 v68, s58, v68
  v_mul_f32 v69, s58, v69
  v_mfma_f32_16x16x32_bf16 v[232:235], v[32:35], a[228:231], v[232:235]
  ds_read_b64_tr_b16 v[60:61], v14 offset:17248
  v_mul_f32 v70, s58, v70
  v_mul_f32 v71, s58, v71
  v_permlane16_swap_b32 v192, v194
  v_mfma_f32_16x16x32_bf16 v[232:235], v[36:39], a[236:239], v[232:235]
  ds_read_b64_tr_b16 v[62:63], v14 offset:25696
  v_permlane16_swap_b32 v193, v195
  v_cvt_pk_bf16_f32 v224, v224, v225
  s_waitcnt lgkmcnt(8)
  v_mfma_f32_16x16x32_bf16 v[80:83], v[40:43], a[224:227], v[80:83]
  ds_read_b64_tr_b16 v[32:33], v2 offset:17408
  s_add_u32 s60, s61, 16384
  v_cvt_pk_bf16_f32 v225, v226, v227
  v_cvt_pk_bf16_f32 v226, v68, v69
  v_cvt_pk_bf16_f32 v227, v70, v71
  v_mfma_f32_16x16x32_bf16 v[80:83], v[44:47], a[232:235], v[80:83]
  ds_read_b64_tr_b16 v[34:35], v2 offset:25856
  s_add_u32 m0, s31, 120320
  v_mul_f32 v196, s58, v196
  v_mul_f32 v197, s58, v197
  v_mfma_f32_16x16x32_bf16 v[84:87], v[40:43], a[228:231], v[84:87]
  ds_read_b64_tr_b16 v[36:37], v14 offset:17408
  buffer_load_dwordx4 v3, s[12:15], s60 offen offset:0 nt lds
  v_mul_f32 v198, s58, v198
  v_mul_f32 v199, s58, v199
  v_mfma_f32_16x16x32_bf16 v[84:87], v[44:47], a[236:239], v[84:87]
  ds_read_b64_tr_b16 v[38:39], v14 offset:25856
  v_mul_f32 v72, s58, v72
  v_mul_f32 v73, s58, v73
  s_waitcnt lgkmcnt(8)
  v_mfma_f32_16x16x32_bf16 v[204:207], v[48:51], a[224:227], v[204:207]
  ds_read_b64_tr_b16 v[40:41], v2 offset:17440
  v_mul_f32 v74, s58, v74
  v_mul_f32 v75, s58, v75
  v_permlane16_swap_b32 v224, v226
  v_mfma_f32_16x16x32_bf16 v[204:207], v[52:55], a[232:235], v[204:207]
  ds_read_b64_tr_b16 v[42:43], v2 offset:25888
  v_permlane16_swap_b32 v225, v227
  v_cvt_pk_bf16_f32 v196, v196, v197
  v_cvt_pk_bf16_f32 v197, v198, v199
  v_cvt_pk_bf16_f32 v198, v72, v73
  v_mfma_f32_16x16x32_bf16 v[236:239], v[48:51], a[228:231], v[236:239]
  ds_read_b64_tr_b16 v[44:45], v14 offset:17440
  v_cvt_pk_bf16_f32 v199, v74, v75
  v_mul_f32 v228, s58, v228
  v_mul_f32 v229, s58, v229
  v_mfma_f32_16x16x32_bf16 v[236:239], v[52:55], a[236:239], v[236:239]
  ds_read_b64_tr_b16 v[46:47], v14 offset:25888
  v_mul_f32 v230, s58, v230
  v_mul_f32 v231, s58, v231
  s_waitcnt lgkmcnt(8)
  v_mfma_f32_16x16x32_bf16 v[88:91], v[56:59], a[224:227], v[88:91]
  ds_read_b64_tr_b16 v[48:49], v2 offset:17472
  s_add_u32 m0, s31, 120352
  v_mul_f32 v76, s58, v76
  v_mul_f32 v77, s58, v77
  v_mfma_f32_16x16x32_bf16 v[88:91], v[60:63], a[232:235], v[88:91]
  ds_read_b64_tr_b16 v[50:51], v2 offset:25920
  buffer_load_dwordx4 v3, s[12:15], s60 offen offset:1024 nt lds
  v_mul_f32 v78, s58, v78
  v_mul_f32 v79, s58, v79
  v_mfma_f32_16x16x32_bf16 v[92:95], v[56:59], a[228:231], v[92:95]
  ds_read_b64_tr_b16 v[52:53], v14 offset:17472
  v_permlane16_swap_b32 v196, v198
  v_permlane16_swap_b32 v197, v199
  v_cvt_pk_bf16_f32 v228, v228, v229
  v_cvt_pk_bf16_f32 v229, v230, v231
  v_mfma_f32_16x16x32_bf16 v[92:95], v[60:63], a[236:239], v[92:95]
  ds_read_b64_tr_b16 v[54:55], v14 offset:25920
  v_cvt_pk_bf16_f32 v230, v76, v77
  v_cvt_pk_bf16_f32 v231, v78, v79
  s_waitcnt lgkmcnt(8)
  v_mfma_f32_16x16x32_bf16 v[208:211], v[32:35], a[224:227], v[208:211]
  ds_read_b64_tr_b16 v[56:57], v2 offset:17504
  v_mul_f32 v200, s58, v200
  v_mul_f32 v201, s58, v201
  v_mul_f32 v202, s58, v202
  v_mfma_f32_16x16x32_bf16 v[208:211], v[36:39], a[232:235], v[208:211]
  ds_read_b64_tr_b16 v[58:59], v2 offset:25952
  v_mul_f32 v203, s58, v203
  v_mul_f32 v80, s58, v80
  v_mul_f32 v81, s58, v81
  v_mfma_f32_16x16x32_bf16 v[240:243], v[32:35], a[228:231], v[240:243]
  ds_read_b64_tr_b16 v[60:61], v14 offset:17504
  v_mul_f32 v82, s58, v82
  v_mul_f32 v83, s58, v83
  v_permlane16_swap_b32 v228, v230
  v_mfma_f32_16x16x32_bf16 v[240:243], v[36:39], a[236:239], v[240:243]
  ds_read_b64_tr_b16 v[62:63], v14 offset:25952
  v_permlane16_swap_b32 v229, v231
  v_cvt_pk_bf16_f32 v200, v200, v201
  s_waitcnt lgkmcnt(8)
  v_mfma_f32_16x16x32_bf16 v[96:99], v[40:43], a[224:227], v[96:99]
  ds_read_b64_tr_b16 v[32:33], v2 offset:17664
  s_add_u32 m0, s31, 120384
  v_cvt_pk_bf16_f32 v201, v202, v203
  v_cvt_pk_bf16_f32 v202, v80, v81
  v_cvt_pk_bf16_f32 v203, v82, v83
  v_mfma_f32_16x16x32_bf16 v[96:99], v[44:47], a[232:235], v[96:99]
  ds_read_b64_tr_b16 v[34:35], v2 offset:26112
  buffer_load_dwordx4 v3, s[12:15], s60 offen offset:2048 nt lds
  v_mul_f32 v232, s58, v232
  v_mul_f32 v233, s58, v233
  v_mfma_f32_16x16x32_bf16 v[100:103], v[40:43], a[228:231], v[100:103]
  ds_read_b64_tr_b16 v[36:37], v14 offset:17664
  v_mul_f32 v234, s58, v234
  v_mul_f32 v235, s58, v235
  v_mul_f32 v84, s58, v84
  v_mfma_f32_16x16x32_bf16 v[100:103], v[44:47], a[236:239], v[100:103]
  ds_read_b64_tr_b16 v[38:39], v14 offset:26112
  v_mul_f32 v85, s58, v85
  v_mul_f32 v86, s58, v86
  s_waitcnt lgkmcnt(8)
  v_mfma_f32_16x16x32_bf16 v[212:215], v[48:51], a[224:227], v[212:215]
  ds_read_b64_tr_b16 v[40:41], v2 offset:17696
  v_mul_f32 v87, s58, v87
  v_permlane16_swap_b32 v200, v202
  v_permlane16_swap_b32 v201, v203
  v_mfma_f32_16x16x32_bf16 v[212:215], v[52:55], a[232:235], v[212:215]
  ds_read_b64_tr_b16 v[42:43], v2 offset:26144
  v_cvt_pk_bf16_f32 v232, v232, v233
  v_cvt_pk_bf16_f32 v233, v234, v235
  v_cvt_pk_bf16_f32 v234, v84, v85
  v_cvt_pk_bf16_f32 v235, v86, v87
  v_mfma_f32_16x16x32_bf16 v[244:247], v[48:51], a[228:231], v[244:247]
  ds_read_b64_tr_b16 v[44:45], v14 offset:17696
  v_mul_f32 v204, s58, v204
  v_mul_f32 v205, s58, v205
  v_mfma_f32_16x16x32_bf16 v[244:247], v[52:55], a[236:239], v[244:247]
  ds_read_b64_tr_b16 v[46:47], v14 offset:26144
  v_mul_f32 v206, s58, v206
  v_mul_f32 v207, s58, v207
  s_waitcnt lgkmcnt(8)
  v_mfma_f32_16x16x32_bf16 v[104:107], v[56:59], a[224:227], v[104:107]
  ds_read_b64_tr_b16 v[48:49], v2 offset:17728
  s_add_u32 m0, s31, 120416
  v_mul_f32 v88, s58, v88
  v_mul_f32 v89, s58, v89
  v_mfma_f32_16x16x32_bf16 v[104:107], v[60:63], a[232:235], v[104:107]
  ds_read_b64_tr_b16 v[50:51], v2 offset:26176
  buffer_load_dwordx4 v3, s[12:15], s60 offen offset:3072 nt lds
  v_mul_f32 v90, s58, v90
  v_mul_f32 v91, s58, v91
  v_mfma_f32_16x16x32_bf16 v[108:111], v[56:59], a[228:231], v[108:111]
  ds_read_b64_tr_b16 v[52:53], v14 offset:17728
  v_permlane16_swap_b32 v232, v234
  v_permlane16_swap_b32 v233, v235
  v_cvt_pk_bf16_f32 v204, v204, v205
  v_mfma_f32_16x16x32_bf16 v[108:111], v[60:63], a[236:239], v[108:111]
  ds_read_b64_tr_b16 v[54:55], v14 offset:26176
  v_cvt_pk_bf16_f32 v205, v206, v207
  v_cvt_pk_bf16_f32 v206, v88, v89
  s_waitcnt lgkmcnt(8)
  v_mfma_f32_16x16x32_bf16 v[216:219], v[32:35], a[224:227], v[216:219]
  ds_read_b64_tr_b16 v[56:57], v2 offset:17760
  v_cvt_pk_bf16_f32 v207, v90, v91
  v_mul_f32 v236, s58, v236
  v_mul_f32 v237, s58, v237
  v_mfma_f32_16x16x32_bf16 v[216:219], v[36:39], a[232:235], v[216:219]
  ds_read_b64_tr_b16 v[58:59], v2 offset:26208
  v_mul_f32 v238, s58, v238
  v_mul_f32 v239, s58, v239
  v_mul_f32 v92, s58, v92
  v_mfma_f32_16x16x32_bf16 v[248:251], v[32:35], a[228:231], v[248:251]
  ds_read_b64_tr_b16 v[60:61], v14 offset:17760
  v_mul_f32 v93, s58, v93
  v_mul_f32 v94, s58, v94
  v_mul_f32 v95, s58, v95
  v_mfma_f32_16x16x32_bf16 v[248:251], v[36:39], a[236:239], v[248:251]
  ds_read_b64_tr_b16 v[62:63], v14 offset:26208
  v_permlane16_swap_b32 v204, v206
  v_permlane16_swap_b32 v205, v207
  s_waitcnt lgkmcnt(8)
  v_mfma_f32_16x16x32_bf16 v[112:115], v[40:43], a[224:227], v[112:115]
  v_cvt_pk_bf16_f32 v236, v236, v237
  v_cvt_pk_bf16_f32 v237, v238, v239
  v_cvt_pk_bf16_f32 v238, v92, v93
  v_cvt_pk_bf16_f32 v239, v94, v95
  v_mfma_f32_16x16x32_bf16 v[112:115], v[44:47], a[232:235], v[112:115]
  v_mul_f32 v208, s58, v208
  v_mul_f32 v209, s58, v209
  s_waitcnt vmcnt(12)
  v_mfma_f32_16x16x32_bf16 v[116:119], v[40:43], a[228:231], v[116:119]
  v_mul_f32 v210, s58, v210
  v_mul_f32 v211, s58, v211
  v_mul_f32 v96, s58, v96
  s_barrier
  v_mfma_f32_16x16x32_bf16 v[116:119], v[44:47], a[236:239], v[116:119]
  v_mul_f32 v97, s58, v97
  v_mul_f32 v98, s58, v98
  s_waitcnt lgkmcnt(4)
  v_mfma_f32_16x16x32_bf16 v[220:223], v[48:51], a[224:227], v[220:223]
  ds_read_b128 v[32:35], v9 offset:33792
  s_add_u32 m0, s31, 2048
  v_mul_f32 v99, s58, v99
  v_permlane16_swap_b32 v236, v238
  v_mfma_f32_16x16x32_bf16 v[220:223], v[52:55], a[232:235], v[220:223]
  ds_read_b128 v[36:39], v9 offset:33856
  buffer_load_dwordx4 v8, s[16:19], s61 offen offset:0 nt lds
  v_permlane16_swap_b32 v237, v239
  v_cvt_pk_bf16_f32 v208, v208, v209
  v_mfma_f32_16x16x32_bf16 v[252:255], v[48:51], a[228:231], v[252:255]
  ds_read_b128 v[40:43], v9 offset:34048
  v_cvt_pk_bf16_f32 v209, v210, v211
  v_cvt_pk_bf16_f32 v210, v96, v97
  v_mfma_f32_16x16x32_bf16 v[252:255], v[52:55], a[236:239], v[252:255]
  ds_read_b128 v[44:47], v9 offset:34112
  v_cvt_pk_bf16_f32 v211, v98, v99
  v_mul_f32 v240, s58, v240
  s_waitcnt lgkmcnt(4)
  v_mfma_f32_16x16x32_bf16 v[120:123], v[56:59], a[224:227], v[120:123]
  v_mul_f32 v241, s58, v241
  v_mul_f32 v242, s58, v242
  v_mul_f32 v243, s58, v243
  v_mul_f32 v100, s58, v100
  v_mfma_f32_16x16x32_bf16 v[120:123], v[60:63], a[232:235], v[120:123]
  v_mul_f32 v101, s58, v101
  v_mul_f32 v102, s58, v102
  v_mul_f32 v103, s58, v103
  v_mfma_f32_16x16x32_bf16 v[124:127], v[56:59], a[228:231], v[124:127]
  v_permlane16_swap_b32 v208, v210
  v_permlane16_swap_b32 v209, v211
  v_cvt_pk_bf16_f32 v240, v240, v241
  v_cvt_pk_bf16_f32 v241, v242, v243
  v_mfma_f32_16x16x32_bf16 v[124:127], v[60:63], a[236:239], v[124:127]
  s_add_u32 m0, s31, 2080
  v_cvt_pk_bf16_f32 v242, v100, v101
  v_cvt_pk_bf16_f32 v243, v102, v103
  s_waitcnt lgkmcnt(0)
  v_mfma_f32_16x16x32_bf16 v[64:67], v[32:35], v[128:131], 0
  ds_read_b128 v[48:51], v9 offset:34304
  buffer_load_dwordx4 v8, s[16:19], s61 offen offset:1024 nt lds
  v_mul_f32 v212, s58, v212
  v_mfma_f32_16x16x32_bf16 v[64:67], v[36:39], v[132:135], v[64:67]
  ds_read_b128 v[52:55], v9 offset:34368
  v_mul_f32 v213, s58, v213
  v_mul_f32 v214, s58, v214
  v_mul_f32 v215, s58, v215
  v_mfma_f32_16x16x32_bf16 v[64:67], v[40:43], v[136:139], v[64:67]
  ds_read_b128 v[56:59], v9 offset:34560
  v_mul_f32 v104, s58, v104
  v_mul_f32 v105, s58, v105
  v_mul_f32 v106, s58, v106
  v_mfma_f32_16x16x32_bf16 v[64:67], v[44:47], v[140:143], v[64:67]
  ds_read_b128 v[60:63], v9 offset:34624
  v_mul_f32 v107, s58, v107
  v_permlane16_swap_b32 v240, v242
  v_permlane16_swap_b32 v241, v243
  v_mfma_f32_16x16x32_bf16 v[72:75], v[32:35], v[160:163], 0
  v_cvt_pk_bf16_f32 v212, v212, v213
  v_cvt_pk_bf16_f32 v213, v214, v215
  v_cvt_pk_bf16_f32 v214, v104, v105
  v_cvt_pk_bf16_f32 v215, v106, v107
  v_mfma_f32_16x16x32_bf16 v[72:75], v[36:39], v[164:167], v[72:75]
  v_mul_f32 v244, s58, v244
  v_mul_f32 v245, s58, v245
  v_mul_f32 v246, s58, v246
  v_mfma_f32_16x16x32_bf16 v[72:75], v[40:43], v[168:171], v[72:75]
  s_add_u32 m0, s31, 2112
  v_mul_f32 v247, s58, v247
  v_mul_f32 v108, s58, v108
  v_mul_f32 v109, s58, v109
  v_mfma_f32_16x16x32_bf16 v[72:75], v[44:47], v[172:175], v[72:75]
  buffer_load_dwordx4 v8, s[16:19], s61 offen offset:2048 nt lds
  v_mul_f32 v110, s58, v110
  v_mul_f32 v111, s58, v111
  s_waitcnt lgkmcnt(0)
  v_mfma_f32_16x16x32_bf16 v[64:67], v[48:51], v[144:147], v[64:67]
  ds_read_b128 v[32:35], v9 offset:42240
  v_permlane16_swap_b32 v212, v214
  v_permlane16_swap_b32 v213, v215
  v_cvt_pk_bf16_f32 v244, v244, v245
  v_mfma_f32_16x16x32_bf16 v[64:67], v[52:55], v[148:151], v[64:67]
  ds_read_b128 v[36:39], v9 offset:42304
  v_cvt_pk_bf16_f32 v245, v246, v247
  v_cvt_pk_bf16_f32 v246, v108, v109
  v_cvt_pk_bf16_f32 v247, v110, v111
  v_mfma_f32_16x16x32_bf16 v[64:67], v[56:59], v[152:155], v[64:67]
  ds_read_b128 v[40:43], v9 offset:42496
  v_mul_f32 v216, s58, v216
  v_mul_f32 v217, s58, v217
  v_mfma_f32_16x16x32_bf16 v[64:67], v[60:63], v[156:159], v[64:67]
  ds_read_b128 v[44:47], v9 offset:42560
  v_mul_f32 v218, s58, v218
  v_mul_f32 v219, s58, v219
  v_mfma_f32_16x16x32_bf16 v[72:75], v[48:51], v[176:179], v[72:75]
  v_mul_f32 v112, s58, v112
  v_mul_f32 v113, s58, v113
  v_mul_f32 v114, s58, v114
  v_mul_f32 v115, s58, v115
  v_mfma_f32_16x16x32_bf16 v[72:75], v[52:55], v[180:183], v[72:75]
  v_permlane16_swap_b32 v244, v246
  v_permlane16_swap_b32 v245, v247
  v_cvt_pk_bf16_f32 v216, v216, v217
  v_mfma_f32_16x16x32_bf16 v[72:75], v[56:59], v[184:187], v[72:75]
  s_add_u32 m0, s31, 2144
  v_cvt_pk_bf16_f32 v217, v218, v219
  v_cvt_pk_bf16_f32 v218, v112, v113
  v_cvt_pk_bf16_f32 v219, v114, v115
  v_mfma_f32_16x16x32_bf16 v[72:75], v[60:63], v[188:191], v[72:75]
  buffer_load_dwordx4 v8, s[16:19], s61 offen offset:3072 nt lds
  v_mul_f32 v248, s58, v248
  s_waitcnt lgkmcnt(0)
  v_mfma_f32_16x16x32_bf16 v[68:71], v[32:35], v[128:131], 0
  ds_read_b128 v[48:51], v9 offset:42752
  v_mul_f32 v249, s58, v249
  v_mul_f32 v250, s58, v250
  v_mfma_f32_16x16x32_bf16 v[68:71], v[36:39], v[132:135], v[68:71]
  ds_read_b128 v[52:55], v9 offset:42816
  v_mul_f32 v251, s58, v251
  v_mul_f32 v116, s58, v116
  v_mul_f32 v117, s58, v117
  v_mfma_f32_16x16x32_bf16 v[68:71], v[40:43], v[136:139], v[68:71]
  ds_read_b128 v[56:59], v9 offset:43008
  v_mul_f32 v118, s58, v118
  v_mul_f32 v119, s58, v119
  v_mfma_f32_16x16x32_bf16 v[68:71], v[44:47], v[140:143], v[68:71]
  ds_read_b128 v[60:63], v9 offset:43072
  v_permlane16_swap_b32 v216, v218
  v_permlane16_swap_b32 v217, v219
  v_cvt_pk_bf16_f32 v248, v248, v249
  v_mfma_f32_16x16x32_bf16 v[76:79], v[32:35], v[160:163], 0
  v_cvt_pk_bf16_f32 v249, v250, v251
  v_cvt_pk_bf16_f32 v250, v116, v117
  v_cvt_pk_bf16_f32 v251, v118, v119
  v_mfma_f32_16x16x32_bf16 v[76:79], v[36:39], v[164:167], v[76:79]
  s_add_u32 s61, s60, 16384
  s_add_u32 m0, s31, 69632
  v_mul_f32 v220, s58, v220
  v_mfma_f32_16x16x32_bf16 v[76:79], v[40:43], v[168:171], v[76:79]
  buffer_load_dwordx4 v3, s[12:15], s61 offen offset:0 nt lds
  v_mul_f32 v221, s58, v221
  v_mul_f32 v222, s58, v222
  v_mul_f32 v223, s58, v223
  v_mfma_f32_16x16x32_bf16 v[76:79], v[44:47], v[172:175], v[76:79]
  v_mul_f32 v120, s58, v120
  v_mul_f32 v121, s58, v121
  v_mul_f32 v122, s58, v122
  s_waitcnt lgkmcnt(0)
  v_mfma_f32_16x16x32_bf16 v[68:71], v[48:51], v[144:147], v[68:71]
  ds_read_b128 v[32:35], v9 offset:33792
  v_mul_f32 v123, s58, v123
  v_permlane16_swap_b32 v248, v250
  v_permlane16_swap_b32 v249, v251
  v_mfma_f32_16x16x32_bf16 v[68:71], v[52:55], v[148:151], v[68:71]
  ds_read_b128 v[36:39], v9 offset:33856
  v_cvt_pk_bf16_f32 v220, v220, v221
  v_cvt_pk_bf16_f32 v221, v222, v223
  v_cvt_pk_bf16_f32 v222, v120, v121
  v_mfma_f32_16x16x32_bf16 v[68:71], v[56:59], v[152:155], v[68:71]
  ds_read_b128 v[40:43], v9 offset:34048
  v_cvt_pk_bf16_f32 v223, v122, v123
  v_mul_f32 v252, s58, v252
  v_mul_f32 v253, s58, v253
  v_mfma_f32_16x16x32_bf16 v[68:71], v[60:63], v[156:159], v[68:71]
  ds_read_b128 v[44:47], v9 offset:34112
  v_mul_f32 v254, s58, v254
  v_mul_f32 v255, s58, v255
  v_mul_f32 v124, s58, v124
  v_mfma_f32_16x16x32_bf16 v[76:79], v[48:51], v[176:179], v[76:79]
  s_add_u32 m0, s31, 69664
  v_mul_f32 v125, s58, v125
  v_mul_f32 v126, s58, v126
  v_mul_f32 v127, s58, v127
  v_mfma_f32_16x16x32_bf16 v[76:79], v[52:55], v[180:183], v[76:79]
  buffer_load_dwordx4 v3, s[12:15], s61 offen offset:1024 nt lds
  v_permlane16_swap_b32 v220, v222
  v_permlane16_swap_b32 v221, v223
  v_cvt_pk_bf16_f32 v252, v252, v253
  v_mfma_f32_16x16x32_bf16 v[76:79], v[56:59], v[184:187], v[76:79]
  v_cvt_pk_bf16_f32 v253, v254, v255
  v_cvt_pk_bf16_f32 v254, v124, v125
  v_cvt_pk_bf16_f32 v255, v126, v127
  s_nop 1
  v_mfma_f32_16x16x32_bf16 v[76:79], v[60:63], v[188:191], v[76:79]
  v_permlane16_swap_b32 v252, v254
  v_permlane16_swap_b32 v253, v255
  s_nop 1
  s_waitcnt lgkmcnt(0)
  v_mfma_f32_16x16x32_bf16 v[80:83], v[32:35], v[192:195], 0
  ds_read_b128 v[48:51], v9 offset:34304
  v_mfma_f32_16x16x32_bf16 v[80:83], v[36:39], v[196:199], v[80:83]
  ds_read_b128 v[52:55], v9 offset:34368
  v_mfma_f32_16x16x32_bf16 v[80:83], v[40:43], v[200:203], v[80:83]
  ds_read_b128 v[56:59], v9 offset:34560
  v_mbcnt_lo_u32_b32 v24, -1, 0
  v_mfma_f32_16x16x32_bf16 v[80:83], v[44:47], v[204:207], v[80:83]
  ds_read_b128 v[60:63], v9 offset:34624
  v_mbcnt_hi_u32_b32 v24, -1, v24
  v_mfma_f32_16x16x32_bf16 v[88:91], v[32:35], v[224:227], 0
  s_add_u32 m0, s31, 69696
  v_lshlrev_b32 v29, 10, v24
  v_max3_f32 v10, v64, v65, v66
  v_mfma_f32_16x16x32_bf16 v[88:91], v[36:39], v[228:231], v[88:91]
  buffer_load_dwordx4 v3, s[12:15], s61 offen offset:2048 nt lds
  s_lshl_b32 s67, s3, 6
  v_max3_f32 v11, v72, v73, v74
  v_mfma_f32_16x16x32_bf16 v[88:91], v[40:43], v[232:235], v[88:91]
  s_add_u32 s67, s67, s28
  s_lshl_b32 s67, s67, 2
  v_max3_f32 v10, v67, v68, v10
  v_mfma_f32_16x16x32_bf16 v[88:91], v[44:47], v[236:239], v[88:91]
  v_mov_b32 v25, 0
  v_max3_f32 v11, v75, v76, v11
  s_waitcnt lgkmcnt(0)
  v_mfma_f32_16x16x32_bf16 v[80:83], v[48:51], v[208:211], v[80:83]
  ds_read_b128 v[32:35], v9 offset:42240
  buffer_store_dword v25, v29, s[40:43], s67 offen sc1
  v_max3_f32 v10, v69, v70, v10
  v_mfma_f32_16x16x32_bf16 v[80:83], v[52:55], v[212:215], v[80:83]
  ds_read_b128 v[36:39], v9 offset:42304
  s_lshl_b32 s38, s29, 2
  v_max3_f32 v11, v77, v78, v11
  v_mfma_f32_16x16x32_bf16 v[80:83], v[56:59], v[216:219], v[80:83]
  ds_read_b128 v[40:43], v9 offset:42496
  s_add_u32 s38, s38, s3
  v_max_f32 v10, v71, v10
  v_mfma_f32_16x16x32_bf16 v[80:83], v[60:63], v[220:223], v[80:83]
  ds_read_b128 v[44:47], v9 offset:42560
  s_add_u32 m0, s31, 69728
  v_max_f32 v11, v79, v11
  v_mfma_f32_16x16x32_bf16 v[88:91], v[48:51], v[240:243], v[88:91]
  buffer_load_dwordx4 v3, s[12:15], s61 offen offset:3072 nt lds
  s_mul_i32 s38, s38, 7168
  v_mov_b32 v30, v10
  v_mfma_f32_16x16x32_bf16 v[88:91], v[52:55], v[244:247], v[88:91]
  s_add_u32 s38, s38, s64
  v_mov_b32 v31, v11
  s_nop 0
  v_mfma_f32_16x16x32_bf16 v[88:91], v[56:59], v[248:251], v[88:91]
  v_permlane32_swap_b32 v10, v30
  v_permlane32_swap_b32 v11, v31
  v_max_f32 v10, v10, v30
  v_mfma_f32_16x16x32_bf16 v[88:91], v[60:63], v[252:255], v[88:91]
  v_max_f32 v11, v11, v31
  v_mov_b32 v30, v10
  s_waitcnt lgkmcnt(0)
  v_mfma_f32_16x16x32_bf16 v[84:87], v[32:35], v[192:195], 0
  ds_read_b128 v[48:51], v9 offset:42752
  v_mov_b32 v31, v11
  s_nop 0
  v_mfma_f32_16x16x32_bf16 v[84:87], v[36:39], v[196:199], v[84:87]
  ds_read_b128 v[52:55], v9 offset:42816
  v_permlane16_swap_b32 v10, v30
  v_permlane16_swap_b32 v11, v31
  v_mfma_f32_16x16x32_bf16 v[84:87], v[40:43], v[200:203], v[84:87]
  ds_read_b128 v[56:59], v9 offset:43008
  v_max_f32 v10, v10, v30
  v_max_f32 v11, v11, v31
  v_mfma_f32_16x16x32_bf16 v[84:87], v[44:47], v[204:207], v[84:87]
  ds_read_b128 v[60:63], v9 offset:43072
  v_sub_f32 v16, 0, v10
  v_sub_f32 v17, 0, v10
  v_mfma_f32_16x16x32_bf16 v[92:95], v[32:35], v[224:227], 0
  v_sub_f32 v18, 0, v10
  v_sub_f32 v19, 0, v10
  v_sub_f32 v20, 0, v11
  v_mfma_f32_16x16x32_bf16 v[92:95], v[36:39], v[228:231], v[92:95]
  v_sub_f32 v21, 0, v11
  v_sub_f32 v22, 0, v11
  s_waitcnt vmcnt(17)
  v_mfma_f32_16x16x32_bf16 v[92:95], v[40:43], v[232:235], v[92:95]
  v_sub_f32 v23, 0, v11
  v_sub_f32 v64, v64, v10
  s_barrier
  v_mfma_f32_16x16x32_bf16 v[92:95], v[44:47], v[236:239], v[92:95]
  v_sub_f32 v65, v65, v10
  v_sub_f32 v66, v66, v10
  s_waitcnt lgkmcnt(0)
  v_mfma_f32_16x16x32_bf16 v[84:87], v[48:51], v[208:211], v[84:87]
  ds_read_b128 v[32:35], v1 offset:33792
  v_sub_f32 v67, v67, v10
  v_sub_f32 v68, v68, v10
  v_mfma_f32_16x16x32_bf16 v[84:87], v[52:55], v[212:215], v[84:87]
  ds_read_b128 v[36:39], v1 offset:33856
  v_sub_f32 v69, v69, v10
  v_sub_f32 v70, v70, v10
  v_mfma_f32_16x16x32_bf16 v[84:87], v[56:59], v[216:219], v[84:87]
  ds_read_b128 v[40:43], v1 offset:34048
  v_sub_f32 v71, v71, v10
  v_sub_f32 v72, v72, v11
  v_mfma_f32_16x16x32_bf16 v[84:87], v[60:63], v[220:223], v[84:87]
  ds_read_b128 v[44:47], v1 offset:34112
  v_sub_f32 v73, v73, v11
  v_sub_f32 v74, v74, v11
  v_mfma_f32_16x16x32_bf16 v[92:95], v[48:51], v[240:243], v[92:95]
  v_sub_f32 v75, v75, v11
  v_sub_f32 v76, v76, v11
  v_sub_f32 v77, v77, v11
  v_mfma_f32_16x16x32_bf16 v[92:95], v[52:55], v[244:247], v[92:95]
  v_sub_f32 v78, v78, v11
  v_sub_f32 v79, v79, v11
  v_mfma_f32_16x16x32_bf16 v[92:95], v[56:59], v[248:251], v[92:95]
  v_mfma_f32_16x16x32_bf16 v[92:95], v[60:63], v[252:255], v[92:95]
  s_waitcnt lgkmcnt(0)
  v_mfma_f32_16x16x32_bf16 v[96:99], v[32:35], v[128:131], v[16:19]
  ds_read_b128 v[48:51], v1 offset:34304
  s_add_u32 m0, s31, 18944
  v_mfma_f32_16x16x32_bf16 v[96:99], v[36:39], v[132:135], v[96:99]
  buffer_load_dwordx4 v8, s[16:19], s60 offen offset:0 nt lds
  v_mfma_f32_16x16x32_bf16 v[96:99], v[40:43], v[136:139], v[96:99]
  ds_read_b128 v[52:55], v1 offset:34368
  v_max3_f32 v12, v80, v81, v82
  v_max3_f32 v13, v88, v89, v90
  v_max3_f32 v12, v83, v84, v12
  v_max3_f32 v13, v91, v92, v13
  v_mfma_f32_16x16x32_bf16 v[96:99], v[44:47], v[140:143], v[96:99]
  v_max3_f32 v12, v85, v86, v12
  v_max3_f32 v13, v93, v94, v13
  v_max_f32 v12, v87, v12
  v_max_f32 v13, v95, v13
  v_mov_b32 v9, v12
  v_mov_b32 v31, v13
  v_mfma_f32_16x16x32_bf16 v[104:107], v[32:35], v[160:163], v[20:23]
  ds_read_b128 v[56:59], v1 offset:34560
  s_nop 0
  v_permlane32_swap_b32 v12, v9
  v_permlane32_swap_b32 v13, v31
  v_max_f32 v12, v12, v9
  v_max_f32 v13, v13, v31
  v_mfma_f32_16x16x32_bf16 v[104:107], v[36:39], v[164:167], v[104:107]
  v_mov_b32 v9, v12
  v_mov_b32 v31, v13
  s_nop 0
  v_permlane16_swap_b32 v12, v9
  v_permlane16_swap_b32 v13, v31
  v_max_f32 v12, v12, v9
  v_mfma_f32_16x16x32_bf16 v[104:107], v[40:43], v[168:171], v[104:107]
  ds_read_b128 v[60:63], v1 offset:34624
  v_max_f32 v13, v13, v31
  v_sub_f32 v24, 0, v12
  v_sub_f32 v25, 0, v12
  v_sub_f32 v26, 0, v12
  v_sub_f32 v27, 0, v12
  v_mfma_f32_16x16x32_bf16 v[104:107], v[44:47], v[172:175], v[104:107]
  v_sub_f32 v28, 0, v13
  v_sub_f32 v29, 0, v13
  v_mfma_f32_16x16x32_bf16 v[112:115], v[32:35], v[192:195], v[24:27]
  v_sub_f32 v30, 0, v13
  v_sub_f32 v31, 0, v13
  v_mfma_f32_16x16x32_bf16 v[112:115], v[36:39], v[196:199], v[112:115]
  v_sub_f32 v80, v80, v12
  v_sub_f32 v81, v81, v12
  v_mfma_f32_16x16x32_bf16 v[112:115], v[40:43], v[200:203], v[112:115]
  s_add_u32 m0, s31, 18976
  v_sub_f32 v82, v82, v12
  v_mfma_f32_16x16x32_bf16 v[112:115], v[44:47], v[204:207], v[112:115]
  buffer_load_dwordx4 v8, s[16:19], s60 offen offset:1024 nt lds
  v_sub_f32 v83, v83, v12
  v_mfma_f32_16x16x32_bf16 v[120:123], v[32:35], v[224:227], v[28:31]
  v_sub_f32 v84, v84, v12
  v_sub_f32 v85, v85, v12
  v_mfma_f32_16x16x32_bf16 v[120:123], v[36:39], v[228:231], v[120:123]
  v_sub_f32 v86, v86, v12
  v_sub_f32 v87, v87, v12
  v_mfma_f32_16x16x32_bf16 v[120:123], v[40:43], v[232:235], v[120:123]
  v_sub_f32 v88, v88, v13
  v_sub_f32 v89, v89, v13
  v_mfma_f32_16x16x32_bf16 v[120:123], v[44:47], v[236:239], v[120:123]
  v_sub_f32 v90, v90, v13
  s_waitcnt lgkmcnt(0)
  v_mfma_f32_16x16x32_bf16 v[96:99], v[48:51], v[144:147], v[96:99]
  ds_read_b128 v[32:35], v1 offset:42240
  v_sub_f32 v91, v91, v13
  v_mfma_f32_16x16x32_bf16 v[96:99], v[52:55], v[148:151], v[96:99]
  v_sub_f32 v92, v92, v13
  v_sub_f32 v93, v93, v13
  v_exp_f32 v64, v64
  v_mfma_f32_16x16x32_bf16 v[96:99], v[56:59], v[152:155], v[96:99]
  ds_read_b128 v[36:39], v1 offset:42304
  v_sub_f32 v94, v94, v13
  v_add_f32 v4, v4, v64
  v_mfma_f32_16x16x32_bf16 v[96:99], v[60:63], v[156:159], v[96:99]
  v_sub_f32 v95, v95, v13
  v_exp_f32 v65, v65
  v_mfma_f32_16x16x32_bf16 v[104:107], v[48:51], v[176:179], v[104:107]
  ds_read_b128 v[40:43], v1 offset:42496
  v_exp_f32 v66, v66
  v_mfma_f32_16x16x32_bf16 v[104:107], v[52:55], v[180:183], v[104:107]
  s_add_u32 m0, s31, 19008
  v_exp_f32 v67, v67
  v_mfma_f32_16x16x32_bf16 v[104:107], v[56:59], v[184:187], v[104:107]
  ds_read_b128 v[44:47], v1 offset:42560
  buffer_load_dwordx4 v8, s[16:19], s60 offen offset:2048 nt lds
  v_add_f32 v4, v4, v65
  v_mfma_f32_16x16x32_bf16 v[104:107], v[60:63], v[188:191], v[104:107]
  v_cvt_pk_bf16_f32 v64, v64, v65
  v_exp_f32 v68, v68
  v_mfma_f32_16x16x32_bf16 v[112:115], v[48:51], v[208:211], v[112:115]
  v_add_f32 v4, v4, v66
  v_exp_f32 v69, v69
  v_mfma_f32_16x16x32_bf16 v[112:115], v[52:55], v[212:215], v[112:115]
  v_add_f32 v4, v4, v67
  v_cvt_pk_bf16_f32 v65, v66, v67
  v_add_f32 v4, v4, v68
  v_mfma_f32_16x16x32_bf16 v[112:115], v[56:59], v[216:219], v[112:115]
  v_exp_f32 v70, v70
  v_add_f32 v4, v4, v69
  v_mfma_f32_16x16x32_bf16 v[112:115], v[60:63], v[220:223], v[112:115]
  v_exp_f32 v71, v71
  v_cvt_pk_bf16_f32 v66, v68, v69
  v_add_f32 v4, v4, v70
  v_mfma_f32_16x16x32_bf16 v[120:123], v[48:51], v[240:243], v[120:123]
  v_exp_f32 v72, v72
  v_add_f32 v4, v4, v71
  v_mfma_f32_16x16x32_bf16 v[120:123], v[52:55], v[244:247], v[120:123]
  v_exp_f32 v73, v73
  v_cvt_pk_bf16_f32 v67, v70, v71
  v_mfma_f32_16x16x32_bf16 v[120:123], v[56:59], v[248:251], v[120:123]
  v_exp_f32 v74, v74
  v_add_f32 v5, v5, v72
  v_mfma_f32_16x16x32_bf16 v[120:123], v[60:63], v[252:255], v[120:123]
  v_exp_f32 v75, v75
  s_waitcnt lgkmcnt(0)
  v_mfma_f32_16x16x32_bf16 v[100:103], v[32:35], v[128:131], v[16:19]
  ds_read_b128 v[48:51], v1 offset:42752
  s_add_u32 m0, s31, 19040
  v_add_f32 v5, v5, v73
  v_mfma_f32_16x16x32_bf16 v[100:103], v[36:39], v[132:135], v[100:103]
  buffer_load_dwordx4 v8, s[16:19], s60 offen offset:3072 nt lds
  v_cvt_pk_bf16_f32 v72, v72, v73
  v_add_f32 v5, v5, v74
  v_mfma_f32_16x16x32_bf16 v[100:103], v[40:43], v[136:139], v[100:103]
  ds_read_b128 v[52:55], v1 offset:42816
  v_exp_f32 v76, v76
  v_mfma_f32_16x16x32_bf16 v[100:103], v[44:47], v[140:143], v[100:103]
  v_exp_f32 v77, v77
  v_add_f32 v5, v5, v75
  v_mfma_f32_16x16x32_bf16 v[108:111], v[32:35], v[160:163], v[20:23]
  ds_read_b128 v[56:59], v1 offset:43008
  v_cvt_pk_bf16_f32 v73, v74, v75
  v_add_f32 v5, v5, v76
  v_mfma_f32_16x16x32_bf16 v[108:111], v[36:39], v[164:167], v[108:111]
  v_exp_f32 v78, v78
  v_exp_f32 v79, v79
  v_mfma_f32_16x16x32_bf16 v[108:111], v[40:43], v[168:171], v[108:111]
  ds_read_b128 v[60:63], v1 offset:43072
  v_add_f32 v5, v5, v77
  v_cvt_pk_bf16_f32 v74, v76, v77
  v_mfma_f32_16x16x32_bf16 v[108:111], v[44:47], v[172:175], v[108:111]
  v_exp_f32 v80, v80
  v_add_f32 v5, v5, v78
  v_mfma_f32_16x16x32_bf16 v[116:119], v[32:35], v[192:195], v[24:27]
  v_exp_f32 v81, v81
  v_add_f32 v5, v5, v79
  v_mfma_f32_16x16x32_bf16 v[116:119], v[36:39], v[196:199], v[116:119]
  v_cvt_pk_bf16_f32 v75, v78, v79
  v_exp_f32 v82, v82
  v_mfma_f32_16x16x32_bf16 v[116:119], v[40:43], v[200:203], v[116:119]
  v_add_f32 v6, v6, v80
  v_exp_f32 v83, v83
  v_mfma_f32_16x16x32_bf16 v[116:119], v[44:47], v[204:207], v[116:119]
  v_add_f32 v6, v6, v81
  v_cvt_pk_bf16_f32 v80, v80, v81
  v_add_f32 v6, v6, v82
  v_mfma_f32_16x16x32_bf16 v[124:127], v[32:35], v[224:227], v[28:31]
  v_exp_f32 v84, v84
  v_add_f32 v6, v6, v83
  v_mfma_f32_16x16x32_bf16 v[124:127], v[36:39], v[228:231], v[124:127]
  v_exp_f32 v85, v85
  s_waitcnt vmcnt(13)
  v_mfma_f32_16x16x32_bf16 v[124:127], v[40:43], v[232:235], v[124:127]
  v_cvt_pk_bf16_f32 v81, v82, v83
  v_add_f32 v6, v6, v84
  s_barrier
  v_mfma_f32_16x16x32_bf16 v[124:127], v[44:47], v[236:239], v[124:127]
  v_exp_f32 v86, v86
  v_add_f32 v6, v6, v85
  s_waitcnt lgkmcnt(0)
  v_mfma_f32_16x16x32_bf16 v[100:103], v[48:51], v[144:147], v[100:103]
  ds_read_b64_tr_b16 v[32:33], v2 offset:50688
  v_exp_f32 v87, v87
  v_mfma_f32_16x16x32_bf16 v[100:103], v[52:55], v[148:151], v[100:103]
  ds_read_b64_tr_b16 v[34:35], v2 offset:59136
  v_cvt_pk_bf16_f32 v82, v84, v85
  v_add_f32 v6, v6, v86
  v_mfma_f32_16x16x32_bf16 v[100:103], v[56:59], v[152:155], v[100:103]
  v_exp_f32 v88, v88
  v_add_f32 v6, v6, v87
  v_mfma_f32_16x16x32_bf16 v[100:103], v[60:63], v[156:159], v[100:103]
  ds_read_b64_tr_b16 v[36:37], v2 offset:50720
  v_exp_f32 v89, v89
  v_mfma_f32_16x16x32_bf16 v[108:111], v[48:51], v[176:179], v[108:111]
  ds_read_b64_tr_b16 v[38:39], v2 offset:59168
  v_cvt_pk_bf16_f32 v83, v86, v87
  v_add_f32 v7, v7, v88
  v_mfma_f32_16x16x32_bf16 v[108:111], v[52:55], v[180:183], v[108:111]
  v_exp_f32 v90, v90
  v_add_f32 v7, v7, v89
  v_mfma_f32_16x16x32_bf16 v[108:111], v[56:59], v[184:187], v[108:111]
  ds_read_b64_tr_b16 v[40:41], v2 offset:50752
  v_exp_f32 v91, v91
  v_mfma_f32_16x16x32_bf16 v[108:111], v[60:63], v[188:191], v[108:111]
  ds_read_b64_tr_b16 v[42:43], v2 offset:59200
  v_cvt_pk_bf16_f32 v88, v88, v89
  v_add_f32 v7, v7, v90
  v_mfma_f32_16x16x32_bf16 v[116:119], v[48:51], v[208:211], v[116:119]
  v_exp_f32 v92, v92
  v_add_f32 v7, v7, v91
  v_mfma_f32_16x16x32_bf16 v[116:119], v[52:55], v[212:215], v[116:119]
  ds_read_b64_tr_b16 v[44:45], v2 offset:50784
  v_exp_f32 v93, v93
  v_cvt_pk_bf16_f32 v89, v90, v91
  v_mfma_f32_16x16x32_bf16 v[116:119], v[56:59], v[216:219], v[116:119]
  ds_read_b64_tr_b16 v[46:47], v2 offset:59232
  v_exp_f32 v94, v94
  v_mfma_f32_16x16x32_bf16 v[116:119], v[60:63], v[220:223], v[116:119]
  v_add_f32 v7, v7, v92
  v_exp_f32 v95, v95
  v_mfma_f32_16x16x32_bf16 v[124:127], v[48:51], v[240:243], v[124:127]
  v_add_f32 v7, v7, v93
  v_cvt_pk_bf16_f32 v90, v92, v93
  v_add_f32 v7, v7, v94
  v_mfma_f32_16x16x32_bf16 v[124:127], v[52:55], v[244:247], v[124:127]
  v_add_f32 v7, v7, v95
  v_cvt_pk_bf16_f32 v91, v94, v95
  v_mfma_f32_16x16x32_bf16 v[124:127], v[56:59], v[248:251], v[124:127]
  v_mfma_f32_16x16x32_bf16 v[124:127], v[60:63], v[252:255], v[124:127]
  s_waitcnt lgkmcnt(4)
  v_mfma_f32_16x16x32_bf16 a[0:3], v[32:35], v[64:67], 0
  ds_read_b64_tr_b16 v[48:49], v2 offset:50944
  s_add_u32 s60, s61, 16384
  v_mfma_f32_16x16x32_bf16 a[64:67], v[32:35], v[72:75], 0
  ds_read_b64_tr_b16 v[50:51], v2 offset:59392
  s_add_u32 m0, s31, 86528
  v_mfma_f32_16x16x32_bf16 a[128:131], v[32:35], v[80:83], 0
  buffer_load_dwordx4 v3, s[12:15], s60 offen offset:0 nt lds
  v_max_f32 v9, v96, v97
  v_mfma_f32_16x16x32_bf16 a[192:195], v[32:35], v[88:91], 0
  v_max3_f32 v9, v98, v99, v9
  v_max3_f32 v9, v104, v105, v9
  v_mfma_f32_16x16x32_bf16 a[4:7], v[36:39], v[64:67], 0
  ds_read_b64_tr_b16 v[52:53], v2 offset:50976
  v_max3_f32 v9, v106, v107, v9
  v_mfma_f32_16x16x32_bf16 a[68:71], v[36:39], v[72:75], 0
  ds_read_b64_tr_b16 v[54:55], v2 offset:59424
  v_max3_f32 v9, v112, v113, v9
  v_mfma_f32_16x16x32_bf16 a[132:135], v[36:39], v[80:83], 0
  v_max3_f32 v9, v114, v115, v9
  v_max3_f32 v9, v120, v121, v9
  v_mfma_f32_16x16x32_bf16 a[196:199], v[36:39], v[88:91], 0
  v_max3_f32 v9, v122, v123, v9
  s_waitcnt lgkmcnt(4)
  v_mfma_f32_16x16x32_bf16 a[8:11], v[40:43], v[64:67], 0
  ds_read_b64_tr_b16 v[56:57], v2 offset:51008
  v_max3_f32 v9, v100, v101, v9
  v_mfma_f32_16x16x32_bf16 a[72:75], v[40:43], v[72:75], 0
  ds_read_b64_tr_b16 v[58:59], v2 offset:59456
  v_max3_f32 v9, v102, v103, v9
  v_mfma_f32_16x16x32_bf16 a[136:139], v[40:43], v[80:83], 0
  v_max3_f32 v9, v108, v109, v9
  v_max3_f32 v9, v110, v111, v9
  v_mfma_f32_16x16x32_bf16 a[200:203], v[40:43], v[88:91], 0
  v_max3_f32 v9, v116, v117, v9
  v_max3_f32 v9, v118, v119, v9
  v_mfma_f32_16x16x32_bf16 a[12:15], v[44:47], v[64:67], 0
  ds_read_b64_tr_b16 v[60:61], v2 offset:51040
  v_max3_f32 v9, v124, v125, v9
  v_mfma_f32_16x16x32_bf16 a[76:79], v[44:47], v[72:75], 0
  ds_read_b64_tr_b16 v[62:63], v2 offset:59488
  s_add_u32 m0, s31, 86560
  v_mfma_f32_16x16x32_bf16 a[140:143], v[44:47], v[80:83], 0
  buffer_load_dwordx4 v3, s[12:15], s60 offen offset:1024 nt lds
  v_max3_f32 v9, v126, v127, v9
  v_mfma_f32_16x16x32_bf16 a[204:207], v[44:47], v[88:91], 0
  v_cmp_lt_f32 vcc, s59, v9
  s_waitcnt lgkmcnt(4)
  v_mfma_f32_16x16x32_bf16 a[16:19], v[48:51], v[64:67], 0
  ds_read_b64_tr_b16 v[32:33], v2 offset:51200
  s_cbranch_vccnz RA_S1
RAr_S1:
  v_mfma_f32_16x16x32_bf16 a[80:83], v[48:51], v[72:75], 0
  ds_read_b64_tr_b16 v[34:35], v2 offset:59648
  v_mfma_f32_16x16x32_bf16 a[144:147], v[48:51], v[80:83], 0
  v_exp_f32 v96, v96
  v_mfma_f32_16x16x32_bf16 a[208:211], v[48:51], v[88:91], 0
  v_exp_f32 v97, v97
  v_mfma_f32_16x16x32_bf16 a[20:23], v[52:55], v[64:67], 0
  ds_read_b64_tr_b16 v[36:37], v2 offset:51232
  v_add_f32 v4, v4, v96
  v_mfma_f32_16x16x32_bf16 a[84:87], v[52:55], v[72:75], 0
  ds_read_b64_tr_b16 v[38:39], v2 offset:59680
  v_add_f32 v4, v4, v97
  v_mfma_f32_16x16x32_bf16 a[148:151], v[52:55], v[80:83], 0
  v_exp_f32 v98, v98
  v_mfma_f32_16x16x32_bf16 a[212:215], v[52:55], v[88:91], 0
  v_cvt_pk_bf16_f32 v96, v96, v97
  s_waitcnt lgkmcnt(4)
  v_mfma_f32_16x16x32_bf16 a[24:27], v[56:59], v[64:67], 0
  ds_read_b64_tr_b16 v[40:41], v2 offset:51264
  v_add_f32 v4, v4, v98
  v_mfma_f32_16x16x32_bf16 a[88:91], v[56:59], v[72:75], 0
  ds_read_b64_tr_b16 v[42:43], v2 offset:59712
  v_mfma_f32_16x16x32_bf16 a[152:155], v[56:59], v[80:83], 0
  s_add_u32 m0, s31, 86592
  v_mfma_f32_16x16x32_bf16 a[216:219], v[56:59], v[88:91], 0
  buffer_load_dwordx4 v3, s[12:15], s60 offen offset:2048 nt lds
  v_mfma_f32_16x16x32_bf16 a[28:31], v[60:63], v[64:67], 0
  ds_read_b64_tr_b16 v[44:45], v2 offset:51296
  v_mfma_f32_16x16x32_bf16 a[92:95], v[60:63], v[72:75], 0
  ds_read_b64_tr_b16 v[46:47], v2 offset:59744
  v_mfma_f32_16x16x32_bf16 a[156:159], v[60:63], v[80:83], 0
  v_exp_f32 v99, v99
  v_mfma_f32_16x16x32_bf16 a[220:223], v[60:63], v[88:91], 0
  v_add_f32 v4, v4, v99
  s_waitcnt lgkmcnt(4)
  v_mfma_f32_16x16x32_bf16 a[32:35], v[32:35], v[64:67], 0
  ds_read_b64_tr_b16 v[48:49], v2 offset:51456
  v_cvt_pk_bf16_f32 v97, v98, v99
  v_mfma_f32_16x16x32_bf16 a[96:99], v[32:35], v[72:75], 0
  ds_read_b64_tr_b16 v[50:51], v2 offset:59904
  v_mfma_f32_16x16x32_bf16 a[160:163], v[32:35], v[80:83], 0
  v_exp_f32 v100, v100
  v_mfma_f32_16x16x32_bf16 a[224:227], v[32:35], v[88:91], 0
  v_exp_f32 v101, v101
  v_mfma_f32_16x16x32_bf16 a[36:39], v[36:39], v[64:67], 0
  ds_read_b64_tr_b16 v[52:53], v2 offset:51488
  v_add_f32 v4, v4, v100
  v_mfma_f32_16x16x32_bf16 a[100:103], v[36:39], v[72:75], 0
  ds_read_b64_tr_b16 v[54:55], v2 offset:59936
  v_add_f32 v4, v4, v101
  v_mfma_f32_16x16x32_bf16 a[164:167], v[36:39], v[80:83], 0
  v_exp_f32 v102, v102
  v_mfma_f32_16x16x32_bf16 a[228:231], v[36:39], v[88:91], 0
  v_cvt_pk_bf16_f32 v98, v100, v101
  s_waitcnt lgkmcnt(4)
  v_mfma_f32_16x16x32_bf16 a[40:43], v[40:43], v[64:67], 0
  ds_read_b64_tr_b16 v[56:57], v2 offset:51520
  s_add_u32 m0, s31, 86624
  v_mfma_f32_16x16x32_bf16 a[104:107], v[40:43], v[72:75], 0
  ds_read_b64_tr_b16 v[58:59], v2 offset:59968
  buffer_load_dwordx4 v3, s[12:15], s60 offen offset:3072 nt lds
  v_mfma_f32_16x16x32_bf16 a[168:171], v[40:43], v[80:83], 0
  v_exp_f32 v103, v103
  v_mfma_f32_16x16x32_bf16 a[232:235], v[40:43], v[88:91], 0
  v_exp_f32 v104, v104
  v_mfma_f32_16x16x32_bf16 a[44:47], v[44:47], v[64:67], 0
  ds_read_b64_tr_b16 v[60:61], v2 offset:51552
  v_add_f32 v4, v4, v102
  v_mfma_f32_16x16x32_bf16 a[108:111], v[44:47], v[72:75], 0
  ds_read_b64_tr_b16 v[62:63], v2 offset:60000
  v_add_f32 v4, v4, v103
  v_mfma_f32_16x16x32_bf16 a[172:175], v[44:47], v[80:83], 0
  v_exp_f32 v105, v105
  v_mfma_f32_16x16x32_bf16 a[236:239], v[44:47], v[88:91], 0
  v_cvt_pk_bf16_f32 v99, v102, v103
  s_waitcnt lgkmcnt(4)
  v_mfma_f32_16x16x32_bf16 a[48:51], v[48:51], v[64:67], 0
  ds_read_b128 v[32:35], v1 offset:50688
  v_add_f32 v5, v5, v104
  v_mfma_f32_16x16x32_bf16 a[112:115], v[48:51], v[72:75], 0
  v_exp_f32 v106, v106
  v_mfma_f32_16x16x32_bf16 a[176:179], v[48:51], v[80:83], 0
  ds_read_b128 v[36:39], v1 offset:50752
  v_add_f32 v5, v5, v105
  v_mfma_f32_16x16x32_bf16 a[240:243], v[48:51], v[88:91], 0
  v_exp_f32 v107, v107
  v_mfma_f32_16x16x32_bf16 a[52:55], v[52:55], v[64:67], 0
  ds_read_b128 v[40:43], v1 offset:50944
  v_cvt_pk_bf16_f32 v104, v104, v105
  v_mfma_f32_16x16x32_bf16 a[116:119], v[52:55], v[72:75], 0
  s_add_u32 m0, s31, 35840
  v_add_f32 v5, v5, v106
  v_mfma_f32_16x16x32_bf16 a[180:183], v[52:55], v[80:83], 0
  ds_read_b128 v[44:47], v1 offset:51008
  buffer_load_dwordx4 v8, s[16:19], s61 offen offset:0 nt lds
  v_mfma_f32_16x16x32_bf16 a[244:247], v[52:55], v[88:91], 0
  v_add_f32 v5, v5, v107
  s_waitcnt lgkmcnt(4)
  v_mfma_f32_16x16x32_bf16 a[56:59], v[56:59], v[64:67], 0
  v_exp_f32 v108, v108
  v_mfma_f32_16x16x32_bf16 a[120:123], v[56:59], v[72:75], 0
  v_exp_f32 v109, v109
  v_mfma_f32_16x16x32_bf16 a[184:187], v[56:59], v[80:83], 0
  v_cvt_pk_bf16_f32 v105, v106, v107
  v_add_f32 v5, v5, v108
  v_mfma_f32_16x16x32_bf16 a[248:251], v[56:59], v[88:91], 0
  v_exp_f32 v110, v110
  v_mfma_f32_16x16x32_bf16 a[60:63], v[60:63], v[64:67], 0
  v_exp_f32 v111, v111
  v_mfma_f32_16x16x32_bf16 a[124:127], v[60:63], v[72:75], 0
  v_add_f32 v5, v5, v109
  v_cvt_pk_bf16_f32 v106, v108, v109
  v_mfma_f32_16x16x32_bf16 a[188:191], v[60:63], v[80:83], 0
  v_exp_f32 v112, v112
  v_mfma_f32_16x16x32_bf16 a[252:255], v[60:63], v[88:91], 0
  s_cbranch_vccnz RB_S1
RBr_S1:
  s_waitcnt lgkmcnt(0)
  v_mfma_f32_16x16x32_bf16 v[64:67], v[32:35], v[128:131], v[16:19]
  ds_read_b128 v[48:51], v1 offset:51200
  v_add_f32 v5, v5, v110
  v_mfma_f32_16x16x32_bf16 v[64:67], v[36:39], v[132:135], v[64:67]
  v_exp_f32 v113, v113
  v_mfma_f32_16x16x32_bf16 v[64:67], v[40:43], v[136:139], v[64:67]
  ds_read_b128 v[52:55], v1 offset:51264
  s_add_u32 m0, s31, 35872
  v_mfma_f32_16x16x32_bf16 v[64:67], v[44:47], v[140:143], v[64:67]
  buffer_load_dwordx4 v8, s[16:19], s61 offen offset:1024 nt lds
  v_add_f32 v5, v5, v111
  v_mfma_f32_16x16x32_bf16 v[72:75], v[32:35], v[160:163], v[20:23]
  ds_read_b128 v[56:59], v1 offset:51456
  v_cvt_pk_bf16_f32 v107, v110, v111
  v_mfma_f32_16x16x32_bf16 v[72:75], v[36:39], v[164:167], v[72:75]
  v_exp_f32 v114, v114
  v_mfma_f32_16x16x32_bf16 v[72:75], v[40:43], v[168:171], v[72:75]
  ds_read_b128 v[60:63], v1 offset:51520
  v_add_f32 v6, v6, v112
  v_mfma_f32_16x16x32_bf16 v[72:75], v[44:47], v[172:175], v[72:75]
  v_exp_f32 v115, v115
  v_mfma_f32_16x16x32_bf16 v[80:83], v[32:35], v[192:195], v[24:27]
  v_add_f32 v6, v6, v113
  v_cvt_pk_bf16_f32 v112, v112, v113
  v_mfma_f32_16x16x32_bf16 v[80:83], v[36:39], v[196:199], v[80:83]
  v_exp_f32 v116, v116
  v_mfma_f32_16x16x32_bf16 v[80:83], v[40:43], v[200:203], v[80:83]
  v_add_f32 v6, v6, v114
  v_add_f32 v6, v6, v115
  v_mfma_f32_16x16x32_bf16 v[80:83], v[44:47], v[204:207], v[80:83]
  v_exp_f32 v117, v117
  v_mfma_f32_16x16x32_bf16 v[88:91], v[32:35], v[224:227], v[28:31]
  v_cvt_pk_bf16_f32 v113, v114, v115
  v_add_f32 v6, v6, v116
  v_mfma_f32_16x16x32_bf16 v[88:91], v[36:39], v[228:231], v[88:91]
  v_exp_f32 v118, v118
  v_mfma_f32_16x16x32_bf16 v[88:91], v[40:43], v[232:235], v[88:91]
  v_exp_f32 v119, v119
  v_mfma_f32_16x16x32_bf16 v[88:91], v[44:47], v[236:239], v[88:91]
  v_add_f32 v6, v6, v117
  s_waitcnt lgkmcnt(0)
  v_mfma_f32_16x16x32_bf16 v[64:67], v[48:51], v[144:147], v[64:67]
  ds_read_b128 v[32:35], v1 offset:59136
  s_add_u32 m0, s31, 35904
  v_mfma_f32_16x16x32_bf16 v[64:67], v[52:55], v[148:151], v[64:67]
  buffer_load_dwordx4 v8, s[16:19], s61 offen offset:2048 nt lds
  v_cvt_pk_bf16_f32 v114, v116, v117
  v_mfma_f32_16x16x32_bf16 v[64:67], v[56:59], v[152:155], v[64:67]
  ds_read_b128 v[36:39], v1 offset:59200
  v_add_f32 v6, v6, v118
  v_mfma_f32_16x16x32_bf16 v[64:67], v[60:63], v[156:159], v[64:67]
  v_exp_f32 v120, v120
  v_mfma_f32_16x16x32_bf16 v[72:75], v[48:51], v[176:179], v[72:75]
  ds_read_b128 v[40:43], v1 offset:59392
  v_add_f32 v6, v6, v119
  v_mfma_f32_16x16x32_bf16 v[72:75], v[52:55], v[180:183], v[72:75]
  v_exp_f32 v121, v121
  v_mfma_f32_16x16x32_bf16 v[72:75], v[56:59], v[184:187], v[72:75]
  ds_read_b128 v[44:47], v1 offset:59456
  v_cvt_pk_bf16_f32 v115, v118, v119
  v_mfma_f32_16x16x32_bf16 v[72:75], v[60:63], v[188:191], v[72:75]
  v_exp_f32 v122, v122
  v_mfma_f32_16x16x32_bf16 v[80:83], v[48:51], v[208:211], v[80:83]
  v_add_f32 v7, v7, v120
  v_add_f32 v7, v7, v121
  v_mfma_f32_16x16x32_bf16 v[80:83], v[52:55], v[212:215], v[80:83]
  v_exp_f32 v123, v123
  v_mfma_f32_16x16x32_bf16 v[80:83], v[56:59], v[216:219], v[80:83]
  v_cvt_pk_bf16_f32 v120, v120, v121
  v_add_f32 v7, v7, v122
  v_mfma_f32_16x16x32_bf16 v[80:83], v[60:63], v[220:223], v[80:83]
  v_exp_f32 v124, v124
  v_mfma_f32_16x16x32_bf16 v[88:91], v[48:51], v[240:243], v[88:91]
  v_exp_f32 v125, v125
  v_mfma_f32_16x16x32_bf16 v[88:91], v[52:55], v[244:247], v[88:91]
  s_add_u32 m0, s31, 35936
  v_add_f32 v7, v7, v123
  v_mfma_f32_16x16x32_bf16 v[88:91], v[56:59], v[248:251], v[88:91]
  buffer_load_dwordx4 v8, s[16:19], s61 offen offset:3072 nt lds
  v_cvt_pk_bf16_f32 v121, v122, v123
  v_mfma_f32_16x16x32_bf16 v[88:91], v[60:63], v[252:255], v[88:91]
  v_add_f32 v7, v7, v124
  s_waitcnt lgkmcnt(0)
  v_mfma_f32_16x16x32_bf16 v[68:71], v[32:35], v[128:131], v[16:19]
  ds_read_b128 v[48:51], v1 offset:59648
  v_add_f32 v7, v7, v125
  v_mfma_f32_16x16x32_bf16 v[68:71], v[36:39], v[132:135], v[68:71]
  v_exp_f32 v126, v126
  v_mfma_f32_16x16x32_bf16 v[68:71], v[40:43], v[136:139], v[68:71]
  ds_read_b128 v[52:55], v1 offset:59712
  v_cvt_pk_bf16_f32 v122, v124, v125
  v_mfma_f32_16x16x32_bf16 v[68:71], v[44:47], v[140:143], v[68:71]
  v_exp_f32 v127, v127
  v_mfma_f32_16x16x32_bf16 v[76:79], v[32:35], v[160:163], v[20:23]
  ds_read_b128 v[56:59], v1 offset:59904
  v_add_f32 v7, v7, v126
  v_mfma_f32_16x16x32_bf16 v[76:79], v[36:39], v[164:167], v[76:79]
  v_add_f32 v7, v7, v127
  v_cvt_pk_bf16_f32 v123, v126, v127
  v_mfma_f32_16x16x32_bf16 v[76:79], v[40:43], v[168:171], v[76:79]
  ds_read_b128 v[60:63], v1 offset:59968
  v_mfma_f32_16x16x32_bf16 v[76:79], v[44:47], v[172:175], v[76:79]
  v_mfma_f32_16x16x32_bf16 v[84:87], v[32:35], v[192:195], v[24:27]
  v_mfma_f32_16x16x32_bf16 v[84:87], v[36:39], v[196:199], v[84:87]
  v_mfma_f32_16x16x32_bf16 v[84:87], v[40:43], v[200:203], v[84:87]
  v_mfma_f32_16x16x32_bf16 v[84:87], v[44:47], v[204:207], v[84:87]
  v_mfma_f32_16x16x32_bf16 v[92:95], v[32:35], v[224:227], v[28:31]
  v_mfma_f32_16x16x32_bf16 v[92:95], v[36:39], v[228:231], v[92:95]
  s_waitcnt vmcnt(12)
  v_mfma_f32_16x16x32_bf16 v[92:95], v[40:43], v[232:235], v[92:95]
  s_barrier
  v_mfma_f32_16x16x32_bf16 v[92:95], v[44:47], v[236:239], v[92:95]
  s_waitcnt lgkmcnt(0)
  v_mfma_f32_16x16x32_bf16 v[68:71], v[48:51], v[144:147], v[68:71]
  ds_read_b64_tr_b16 v[32:33], v2 offset:0
  v_mbcnt_lo_u32_b32 v14, -1, 0
  v_mfma_f32_16x16x32_bf16 v[68:71], v[52:55], v[148:151], v[68:71]
  ds_read_b64_tr_b16 v[34:35], v2 offset:8448
  v_mbcnt_hi_u32_b32 v14, -1, v14
  v_mfma_f32_16x16x32_bf16 v[68:71], v[56:59], v[152:155], v[68:71]
  v_lshlrev_b32 v14, 8, v14
  s_lshl_b32 s39, s3, 8
  v_mfma_f32_16x16x32_bf16 v[68:71], v[60:63], v[156:159], v[68:71]
  ds_read_b64_tr_b16 v[36:37], v2 offset:32
  v_add_u32 v14, s39, v14
  v_mfma_f32_16x16x32_bf16 v[76:79], v[48:51], v[176:179], v[76:79]
  ds_read_b64_tr_b16 v[38:39], v2 offset:8480
  s_lshl_b32 s37, s37, 2
  v_mfma_f32_16x16x32_bf16 v[76:79], v[52:55], v[180:183], v[76:79]
  v_mov_b32 v9, 1
  buffer_atomic_add v9, v14, s[44:47], s37 offen sc1
  v_mfma_f32_16x16x32_bf16 v[76:79], v[56:59], v[184:187], v[76:79]
  ds_read_b64_tr_b16 v[40:41], v2 offset:64
  v_mfma_f32_16x16x32_bf16 v[76:79], v[60:63], v[188:191], v[76:79]
  ds_read_b64_tr_b16 v[42:43], v2 offset:8512
  v_mfma_f32_16x16x32_bf16 v[84:87], v[48:51], v[208:211], v[84:87]
  v_mfma_f32_16x16x32_bf16 v[84:87], v[52:55], v[212:215], v[84:87]
  ds_read_b64_tr_b16 v[44:45], v2 offset:96
  v_mfma_f32_16x16x32_bf16 v[84:87], v[56:59], v[216:219], v[84:87]
  ds_read_b64_tr_b16 v[46:47], v2 offset:8544
  v_mfma_f32_16x16x32_bf16 v[84:87], v[60:63], v[220:223], v[84:87]
  v_mfma_f32_16x16x32_bf16 v[92:95], v[48:51], v[240:243], v[92:95]
  v_mfma_f32_16x16x32_bf16 v[92:95], v[52:55], v[244:247], v[92:95]
  v_mfma_f32_16x16x32_bf16 v[92:95], v[56:59], v[248:251], v[92:95]
  v_mfma_f32_16x16x32_bf16 v[92:95], v[60:63], v[252:255], v[92:95]
  s_mov_b32 s65, 0
.p2align 6
L_loop:
  s_waitcnt lgkmcnt(4)
  v_mfma_f32_16x16x32_bf16 a[0:3], v[32:35], v[96:99], a[0:3]
  ds_read_b64_tr_b16 v[48:49], v2 offset:256
  s_add_u32 s61, s60, 16384
  v_mfma_f32_16x16x32_bf16 a[64:67], v[32:35], v[104:107], a[64:67]
  ds_read_b64_tr_b16 v[50:51], v2 offset:8704
  s_add_u32 m0, s31, 103424
  v_mfma_f32_16x16x32_bf16 a[128:131], v[32:35], v[112:115], a[128:131]
  buffer_load_dwordx4 v3, s[12:15], s61 offen offset:0 nt lds
  v_max_f32 v9, v64, v65
  v_mfma_f32_16x16x32_bf16 a[192:195], v[32:35], v[120:123], a[192:195]
  v_max3_f32 v9, v66, v67, v9
  v_max3_f32 v9, v72, v73, v9
  v_mfma_f32_16x16x32_bf16 a[4:7], v[36:39], v[96:99], a[4:7]
  ds_read_b64_tr_b16 v[52:53], v2 offset:288
  v_max3_f32 v9, v74, v75, v9
  v_mfma_f32_16x16x32_bf16 a[68:71], v[36:39], v[104:107], a[68:71]
  ds_read_b64_tr_b16 v[54:55], v2 offset:8736
  v_max3_f32 v9, v80, v81, v9
  v_mfma_f32_16x16x32_bf16 a[132:135], v[36:39], v[112:115], a[132:135]
  v_max3_f32 v9, v82, v83, v9
  v_max3_f32 v9, v88, v89, v9
  v_mfma_f32_16x16x32_bf16 a[196:199], v[36:39], v[120:123], a[196:199]
  v_max3_f32 v9, v90, v91, v9
  s_waitcnt lgkmcnt(4)
  v_mfma_f32_16x16x32_bf16 a[8:11], v[40:43], v[96:99], a[8:11]
  ds_read_b64_tr_b16 v[56:57], v2 offset:320
  v_max3_f32 v9, v68, v69, v9
  v_mfma_f32_16x16x32_bf16 a[72:75], v[40:43], v[104:107], a[72:75]
  ds_read_b64_tr_b16 v[58:59], v2 offset:8768
  v_max3_f32 v9, v70, v71, v9
  v_mfma_f32_16x16x32_bf16 a[136:139], v[40:43], v[112:115], a[136:139]
  v_max3_f32 v9, v76, v77, v9
  v_max3_f32 v9, v78, v79, v9
  v_mfma_f32_16x16x32_bf16 a[200:203], v[40:43], v[120:123], a[200:203]
  v_max3_f32 v9, v84, v85, v9
  v_max3_f32 v9, v86, v87, v9
  v_mfma_f32_16x16x32_bf16 a[12:15], v[44:47], v[96:99], a[12:15]
  ds_read_b64_tr_b16 v[60:61], v2 offset:352
  v_max3_f32 v9, v92, v93, v9
  v_mfma_f32_16x16x32_bf16 a[76:79], v[44:47], v[104:107], a[76:79]
  ds_read_b64_tr_b16 v[62:63], v2 offset:8800
  s_add_u32 m0, s31, 103456
  v_mfma_f32_16x16x32_bf16 a[140:143], v[44:47], v[112:115], a[140:143]
  buffer_load_dwordx4 v3, s[12:15], s61 offen offset:1024 nt lds
  v_max3_f32 v9, v94, v95, v9
  v_mfma_f32_16x16x32_bf16 a[204:207], v[44:47], v[120:123], a[204:207]
  v_cmp_lt_f32 vcc, s59, v9
  s_waitcnt lgkmcnt(4)
  v_mfma_f32_16x16x32_bf16 a[16:19], v[48:51], v[96:99], a[16:19]
  ds_read_b64_tr_b16 v[32:33], v2 offset:512
  s_cbranch_vccnz RA_L0
RAr_L0:
  v_mfma_f32_16x16x32_bf16 a[80:83], v[48:51], v[104:107], a[80:83]
  ds_read_b64_tr_b16 v[34:35], v2 offset:8960
  v_mfma_f32_16x16x32_bf16 a[144:147], v[48:51], v[112:115], a[144:147]
  v_exp_f32 v64, v64
  v_mfma_f32_16x16x32_bf16 a[208:211], v[48:51], v[120:123], a[208:211]
  v_mfma_f32_16x16x32_bf16 a[20:23], v[52:55], v[96:99], a[20:23]
  ds_read_b64_tr_b16 v[36:37], v2 offset:544
  v_mfma_f32_16x16x32_bf16 a[84:87], v[52:55], v[104:107], a[84:87]
  ds_read_b64_tr_b16 v[38:39], v2 offset:8992
  v_mfma_f32_16x16x32_bf16 a[148:151], v[52:55], v[112:115], a[148:151]
  v_exp_f32 v65, v65
  v_mfma_f32_16x16x32_bf16 a[212:215], v[52:55], v[120:123], a[212:215]
  v_cvt_pk_bf16_f32 v64, v64, v65
  s_waitcnt lgkmcnt(4)
  v_mfma_f32_16x16x32_bf16 a[24:27], v[56:59], v[96:99], a[24:27]
  ds_read_b64_tr_b16 v[40:41], v2 offset:576
  v_dot2c_f32_bf16 v4, s66, v64
  v_mfma_f32_16x16x32_bf16 a[88:91], v[56:59], v[104:107], a[88:91]
  ds_read_b64_tr_b16 v[42:43], v2 offset:9024
  v_mfma_f32_16x16x32_bf16 a[152:155], v[56:59], v[112:115], a[152:155]
  s_add_u32 m0, s31, 103488
  v_mfma_f32_16x16x32_bf16 a[216:219], v[56:59], v[120:123], a[216:219]
  buffer_load_dwordx4 v3, s[12:15], s61 offen offset:2048 nt lds
  v_mfma_f32_16x16x32_bf16 a[28:31], v[60:63], v[96:99], a[28:31]
  ds_read_b64_tr_b16 v[44:45], v2 offset:608
  v_mfma_f32_16x16x32_bf16 a[92:95], v[60:63], v[104:107], a[92:95]
  ds_read_b64_tr_b16 v[46:47], v2 offset:9056
  v_mfma_f32_16x16x32_bf16 a[156:159], v[60:63], v[112:115], a[156:159]
  v_exp_f32 v66, v66
  v_mfma_f32_16x16x32_bf16 a[220:223], v[60:63], v[120:123], a[220:223]
  s_waitcnt lgkmcnt(4)
  v_mfma_f32_16x16x32_bf16 a[32:35], v[32:35], v[96:99], a[32:35]
  ds_read_b64_tr_b16 v[48:49], v2 offset:768
  v_mfma_f32_16x16x32_bf16 a[96:99], v[32:35], v[104:107], a[96:99]
  ds_read_b64_tr_b16 v[50:51], v2 offset:9216
  v_mfma_f32_16x16x32_bf16 a[160:163], v[32:35], v[112:115], a[160:163]
  v_exp_f32 v67, v67
  v_mfma_f32_16x16x32_bf16 a[224:227], v[32:35], v[120:123], a[224:227]
  v_exp_f32 v68, v68
  v_mfma_f32_16x16x32_bf16 a[36:39], v[36:39], v[96:99], a[36:39]
  ds_read_b64_tr_b16 v[52:53], v2 offset:800
  v_cvt_pk_bf16_f32 v65, v66, v67
  v_mfma_f32_16x16x32_bf16 a[100:103], v[36:39], v[104:107], a[100:103]
  ds_read_b64_tr_b16 v[54:55], v2 offset:9248
  v_dot2c_f32_bf16 v4, s66, v65
  v_mfma_f32_16x16x32_bf16 a[164:167], v[36:39], v[112:115], a[164:167]
  v_exp_f32 v69, v69
  v_mfma_f32_16x16x32_bf16 a[228:231], v[36:39], v[120:123], a[228:231]
  v_cvt_pk_bf16_f32 v66, v68, v69
  s_waitcnt lgkmcnt(4)
  v_mfma_f32_16x16x32_bf16 a[40:43], v[40:43], v[96:99], a[40:43]
  ds_read_b64_tr_b16 v[56:57], v2 offset:832
  s_add_u32 m0, s31, 103520
  v_mfma_f32_16x16x32_bf16 a[104:107], v[40:43], v[104:107], a[104:107]
  ds_read_b64_tr_b16 v[58:59], v2 offset:9280
  buffer_load_dwordx4 v3, s[12:15], s61 offen offset:3072 nt lds
  v_mfma_f32_16x16x32_bf16 a[168:171], v[40:43], v[112:115], a[168:171]
  v_exp_f32 v70, v70
  v_mfma_f32_16x16x32_bf16 a[232:235], v[40:43], v[120:123], a[232:235]
  v_exp_f32 v71, v71
  v_mfma_f32_16x16x32_bf16 a[44:47], v[44:47], v[96:99], a[44:47]
  ds_read_b64_tr_b16 v[60:61], v2 offset:864
  v_dot2c_f32_bf16 v4, s66, v66
  v_mfma_f32_16x16x32_bf16 a[108:111], v[44:47], v[104:107], a[108:111]
  ds_read_b64_tr_b16 v[62:63], v2 offset:9312
  v_cvt_pk_bf16_f32 v67, v70, v71
  v_mfma_f32_16x16x32_bf16 a[172:175], v[44:47], v[112:115], a[172:175]
  v_exp_f32 v72, v72
  v_mfma_f32_16x16x32_bf16 a[236:239], v[44:47], v[120:123], a[236:239]
  v_dot2c_f32_bf16 v4, s66, v67
  s_waitcnt lgkmcnt(4)
  v_mfma_f32_16x16x32_bf16 a[48:51], v[48:51], v[96:99], a[48:51]
  ds_read_b128 v[32:35], v1 offset:0
  v_mfma_f32_16x16x32_bf16 a[112:115], v[48:51], v[104:107], a[112:115]
  v_exp_f32 v73, v73
  v_mfma_f32_16x16x32_bf16 a[176:179], v[48:51], v[112:115], a[176:179]
  ds_read_b128 v[36:39], v1 offset:64
  v_cvt_pk_bf16_f32 v72, v72, v73
  v_mfma_f32_16x16x32_bf16 a[240:243], v[48:51], v[120:123], a[240:243]
  v_exp_f32 v74, v74
  v_mfma_f32_16x16x32_bf16 a[52:55], v[52:55], v[96:99], a[52:55]
  ds_read_b128 v[40:43], v1 offset:256
  v_dot2c_f32_bf16 v5, s66, v72
  v_mfma_f32_16x16x32_bf16 a[116:119], v[52:55], v[104:107], a[116:119]
  s_add_u32 m0, s31, 52736
  v_mfma_f32_16x16x32_bf16 a[180:183], v[52:55], v[112:115], a[180:183]
  ds_read_b128 v[44:47], v1 offset:320
  buffer_load_dwordx4 v8, s[16:19], s60 offen offset:0 nt lds
  v_mfma_f32_16x16x32_bf16 a[244:247], v[52:55], v[120:123], a[244:247]
  s_waitcnt lgkmcnt(4)
  v_mfma_f32_16x16x32_bf16 a[56:59], v[56:59], v[96:99], a[56:59]
  v_exp_f32 v75, v75
  v_mfma_f32_16x16x32_bf16 a[120:123], v[56:59], v[104:107], a[120:123]
  v_exp_f32 v76, v76
  v_mfma_f32_16x16x32_bf16 a[184:187], v[56:59], v[112:115], a[184:187]
  v_exp_f32 v77, v77
  v_mfma_f32_16x16x32_bf16 a[248:251], v[56:59], v[120:123], a[248:251]
  v_cvt_pk_bf16_f32 v73, v74, v75
  v_dot2c_f32_bf16 v5, s66, v73
  v_mfma_f32_16x16x32_bf16 a[60:63], v[60:63], v[96:99], a[60:63]
  v_exp_f32 v78, v78
  v_mfma_f32_16x16x32_bf16 a[124:127], v[60:63], v[104:107], a[124:127]
  v_cvt_pk_bf16_f32 v74, v76, v77
  v_dot2c_f32_bf16 v5, s66, v74
  v_mfma_f32_16x16x32_bf16 a[188:191], v[60:63], v[112:115], a[188:191]
  v_mfma_f32_16x16x32_bf16 a[252:255], v[60:63], v[120:123], a[252:255]
  s_cbranch_vccnz RB_L0
RBr_L0:
  s_waitcnt lgkmcnt(0)
  v_mfma_f32_16x16x32_bf16 v[96:99], v[32:35], v[128:131], v[16:19]
  ds_read_b128 v[48:51], v1 offset:512
  v_mfma_f32_16x16x32_bf16 v[96:99], v[36:39], v[132:135], v[96:99]
  v_exp_f32 v79, v79
  v_mfma_f32_16x16x32_bf16 v[96:99], v[40:43], v[136:139], v[96:99]
  ds_read_b128 v[52:55], v1 offset:576
  s_add_u32 m0, s31, 52768
  v_mfma_f32_16x16x32_bf16 v[96:99], v[44:47], v[140:143], v[96:99]
  buffer_load_dwordx4 v8, s[16:19], s60 offen offset:1024 nt lds
  v_cvt_pk_bf16_f32 v75, v78, v79
  v_mfma_f32_16x16x32_bf16 v[104:107], v[32:35], v[160:163], v[20:23]
  ds_read_b128 v[56:59], v1 offset:768
  v_dot2c_f32_bf16 v5, s66, v75
  v_mfma_f32_16x16x32_bf16 v[104:107], v[36:39], v[164:167], v[104:107]
  v_exp_f32 v80, v80
  v_mfma_f32_16x16x32_bf16 v[104:107], v[40:43], v[168:171], v[104:107]
  ds_read_b128 v[60:63], v1 offset:832
  v_mfma_f32_16x16x32_bf16 v[104:107], v[44:47], v[172:175], v[104:107]
  v_exp_f32 v81, v81
  v_mfma_f32_16x16x32_bf16 v[112:115], v[32:35], v[192:195], v[24:27]
  v_exp_f32 v82, v82
  v_mfma_f32_16x16x32_bf16 v[112:115], v[36:39], v[196:199], v[112:115]
  v_cvt_pk_bf16_f32 v80, v80, v81
  v_dot2c_f32_bf16 v6, s66, v80
  v_mfma_f32_16x16x32_bf16 v[112:115], v[40:43], v[200:203], v[112:115]
  v_mfma_f32_16x16x32_bf16 v[112:115], v[44:47], v[204:207], v[112:115]
  v_exp_f32 v83, v83
  v_mfma_f32_16x16x32_bf16 v[120:123], v[32:35], v[224:227], v[28:31]
  v_cvt_pk_bf16_f32 v81, v82, v83
  v_dot2c_f32_bf16 v6, s66, v81
  v_mfma_f32_16x16x32_bf16 v[120:123], v[36:39], v[228:231], v[120:123]
  v_mfma_f32_16x16x32_bf16 v[120:123], v[40:43], v[232:235], v[120:123]
  v_exp_f32 v84, v84
  v_mfma_f32_16x16x32_bf16 v[120:123], v[44:47], v[236:239], v[120:123]
  s_waitcnt lgkmcnt(0)
  v_mfma_f32_16x16x32_bf16 v[96:99], v[48:51], v[144:147], v[96:99]
  ds_read_b128 v[32:35], v1 offset:8448
  s_add_u32 m0, s31, 52800
  v_mfma_f32_16x16x32_bf16 v[96:99], v[52:55], v[148:151], v[96:99]
  buffer_load_dwordx4 v8, s[16:19], s60 offen offset:2048 nt lds
  v_mfma_f32_16x16x32_bf16 v[96:99], v[56:59], v[152:155], v[96:99]
  ds_read_b128 v[36:39], v1 offset:8512
  v_mfma_f32_16x16x32_bf16 v[96:99], v[60:63], v[156:159], v[96:99]
  v_exp_f32 v85, v85
  v_mfma_f32_16x16x32_bf16 v[104:107], v[48:51], v[176:179], v[104:107]
  ds_read_b128 v[40:43], v1 offset:8704
  v_cvt_pk_bf16_f32 v82, v84, v85
  v_mfma_f32_16x16x32_bf16 v[104:107], v[52:55], v[180:183], v[104:107]
  v_exp_f32 v86, v86
  v_mfma_f32_16x16x32_bf16 v[104:107], v[56:59], v[184:187], v[104:107]
  ds_read_b128 v[44:47], v1 offset:8768
  v_dot2c_f32_bf16 v6, s66, v82
  v_mfma_f32_16x16x32_bf16 v[104:107], v[60:63], v[188:191], v[104:107]
  v_mfma_f32_16x16x32_bf16 v[112:115], v[48:51], v[208:211], v[112:115]
  v_exp_f32 v87, v87
  v_mfma_f32_16x16x32_bf16 v[112:115], v[52:55], v[212:215], v[112:115]
  v_cvt_pk_bf16_f32 v83, v86, v87
  v_dot2c_f32_bf16 v6, s66, v83
  v_mfma_f32_16x16x32_bf16 v[112:115], v[56:59], v[216:219], v[112:115]
  v_mfma_f32_16x16x32_bf16 v[112:115], v[60:63], v[220:223], v[112:115]
  v_exp_f32 v88, v88
  v_mfma_f32_16x16x32_bf16 v[120:123], v[48:51], v[240:243], v[120:123]
  v_mfma_f32_16x16x32_bf16 v[120:123], v[52:55], v[244:247], v[120:123]
  s_add_u32 m0, s31, 52832
  v_mfma_f32_16x16x32_bf16 v[120:123], v[56:59], v[248:251], v[120:123]
  buffer_load_dwordx4 v8, s[16:19], s60 offen offset:3072 nt lds
  v_mfma_f32_16x16x32_bf16 v[120:123], v[60:63], v[252:255], v[120:123]
  s_waitcnt lgkmcnt(0)
  v_mfma_f32_16x16x32_bf16 v[100:103], v[32:35], v[128:131], v[16:19]
  ds_read_b128 v[48:51], v1 offset:8960
  v_mfma_f32_16x16x32_bf16 v[100:103], v[36:39], v[132:135], v[100:103]
  v_exp_f32 v89, v89
  v_mfma_f32_16x16x32_bf16 v[100:103], v[40:43], v[136:139], v[100:103]
  ds_read_b128 v[52:55], v1 offset:9024
  v_cvt_pk_bf16_f32 v88, v88, v89
  v_mfma_f32_16x16x32_bf16 v[100:103], v[44:47], v[140:143], v[100:103]
  v_exp_f32 v90, v90
  v_mfma_f32_16x16x32_bf16 v[108:111], v[32:35], v[160:163], v[20:23]
  ds_read_b128 v[56:59], v1 offset:9216
  v_dot2c_f32_bf16 v7, s66, v88
  v_mfma_f32_16x16x32_bf16 v[108:111], v[36:39], v[164:167], v[108:111]
  v_exp_f32 v91, v91
  v_mfma_f32_16x16x32_bf16 v[108:111], v[40:43], v[168:171], v[108:111]
  ds_read_b128 v[60:63], v1 offset:9280
  v_cvt_pk_bf16_f32 v89, v90, v91
  v_mfma_f32_16x16x32_bf16 v[108:111], v[44:47], v[172:175], v[108:111]
  v_exp_f32 v92, v92
  v_mfma_f32_16x16x32_bf16 v[116:119], v[32:35], v[192:195], v[24:27]
  v_dot2c_f32_bf16 v7, s66, v89
  v_mfma_f32_16x16x32_bf16 v[116:119], v[36:39], v[196:199], v[116:119]
  v_mfma_f32_16x16x32_bf16 v[116:119], v[40:43], v[200:203], v[116:119]
  v_exp_f32 v93, v93
  v_mfma_f32_16x16x32_bf16 v[116:119], v[44:47], v[204:207], v[116:119]
  v_cvt_pk_bf16_f32 v90, v92, v93
  v_dot2c_f32_bf16 v7, s66, v90
  v_mfma_f32_16x16x32_bf16 v[124:127], v[32:35], v[224:227], v[28:31]
  v_mfma_f32_16x16x32_bf16 v[124:127], v[36:39], v[228:231], v[124:127]
  s_waitcnt vmcnt(12)
  v_mfma_f32_16x16x32_bf16 v[124:127], v[40:43], v[232:235], v[124:127]
  s_barrier
  v_mfma_f32_16x16x32_bf16 v[124:127], v[44:47], v[236:239], v[124:127]
  s_waitcnt lgkmcnt(0)
  v_mfma_f32_16x16x32_bf16 v[100:103], v[48:51], v[144:147], v[100:103]
  ds_read_b64_tr_b16 v[32:33], v2 offset:16896
  v_mfma_f32_16x16x32_bf16 v[100:103], v[52:55], v[148:151], v[100:103]
  ds_read_b64_tr_b16 v[34:35], v2 offset:25344
  v_mfma_f32_16x16x32_bf16 v[100:103], v[56:59], v[152:155], v[100:103]
  v_exp_f32 v94, v94
  v_mfma_f32_16x16x32_bf16 v[100:103], v[60:63], v[156:159], v[100:103]
  ds_read_b64_tr_b16 v[36:37], v2 offset:16928
  v_mfma_f32_16x16x32_bf16 v[108:111], v[48:51], v[176:179], v[108:111]
  ds_read_b64_tr_b16 v[38:39], v2 offset:25376
  v_mfma_f32_16x16x32_bf16 v[108:111], v[52:55], v[180:183], v[108:111]
  v_exp_f32 v95, v95
  v_mfma_f32_16x16x32_bf16 v[108:111], v[56:59], v[184:187], v[108:111]
  ds_read_b64_tr_b16 v[40:41], v2 offset:16960
  v_cvt_pk_bf16_f32 v91, v94, v95
  v_mfma_f32_16x16x32_bf16 v[108:111], v[60:63], v[188:191], v[108:111]
  ds_read_b64_tr_b16 v[42:43], v2 offset:25408
  v_dot2c_f32_bf16 v7, s66, v91
  v_mfma_f32_16x16x32_bf16 v[116:119], v[48:51], v[208:211], v[116:119]
  v_mfma_f32_16x16x32_bf16 v[116:119], v[52:55], v[212:215], v[116:119]
  ds_read_b64_tr_b16 v[44:45], v2 offset:16992
  v_mfma_f32_16x16x32_bf16 v[116:119], v[56:59], v[216:219], v[116:119]
  ds_read_b64_tr_b16 v[46:47], v2 offset:25440
  v_mfma_f32_16x16x32_bf16 v[116:119], v[60:63], v[220:223], v[116:119]
  v_mfma_f32_16x16x32_bf16 v[124:127], v[48:51], v[240:243], v[124:127]
  v_mfma_f32_16x16x32_bf16 v[124:127], v[52:55], v[244:247], v[124:127]
  v_mfma_f32_16x16x32_bf16 v[124:127], v[56:59], v[248:251], v[124:127]
  v_mfma_f32_16x16x32_bf16 v[124:127], v[60:63], v[252:255], v[124:127]
  s_waitcnt lgkmcnt(4)
  v_mfma_f32_16x16x32_bf16 a[0:3], v[32:35], v[64:67], a[0:3]
  ds_read_b64_tr_b16 v[48:49], v2 offset:17152
  s_add_u32 s60, s61, 16384
  v_mfma_f32_16x16x32_bf16 a[64:67], v[32:35], v[72:75], a[64:67]
  ds_read_b64_tr_b16 v[50:51], v2 offset:25600
  s_add_u32 m0, s31, 120320
  v_mfma_f32_16x16x32_bf16 a[128:131], v[32:35], v[80:83], a[128:131]
  buffer_load_dwordx4 v3, s[12:15], s60 offen offset:0 nt lds
  v_max_f32 v9, v96, v97
  v_mfma_f32_16x16x32_bf16 a[192:195], v[32:35], v[88:91], a[192:195]
  v_max3_f32 v9, v98, v99, v9
  v_max3_f32 v9, v104, v105, v9
  v_mfma_f32_16x16x32_bf16 a[4:7], v[36:39], v[64:67], a[4:7]
  ds_read_b64_tr_b16 v[52:53], v2 offset:17184
  v_max3_f32 v9, v106, v107, v9
  v_mfma_f32_16x16x32_bf16 a[68:71], v[36:39], v[72:75], a[68:71]
  ds_read_b64_tr_b16 v[54:55], v2 offset:25632
  v_max3_f32 v9, v112, v113, v9
  v_mfma_f32_16x16x32_bf16 a[132:135], v[36:39], v[80:83], a[132:135]
  v_max3_f32 v9, v114, v115, v9
  v_max3_f32 v9, v120, v121, v9
  v_mfma_f32_16x16x32_bf16 a[196:199], v[36:39], v[88:91], a[196:199]
  v_max3_f32 v9, v122, v123, v9
  s_waitcnt lgkmcnt(4)
  v_mfma_f32_16x16x32_bf16 a[8:11], v[40:43], v[64:67], a[8:11]
  ds_read_b64_tr_b16 v[56:57], v2 offset:17216
  v_max3_f32 v9, v100, v101, v9
  v_mfma_f32_16x16x32_bf16 a[72:75], v[40:43], v[72:75], a[72:75]
  ds_read_b64_tr_b16 v[58:59], v2 offset:25664
  v_max3_f32 v9, v102, v103, v9
  v_mfma_f32_16x16x32_bf16 a[136:139], v[40:43], v[80:83], a[136:139]
  v_max3_f32 v9, v108, v109, v9
  v_max3_f32 v9, v110, v111, v9
  v_mfma_f32_16x16x32_bf16 a[200:203], v[40:43], v[88:91], a[200:203]
  v_max3_f32 v9, v116, v117, v9
  v_max3_f32 v9, v118, v119, v9
  v_mfma_f32_16x16x32_bf16 a[12:15], v[44:47], v[64:67], a[12:15]
  ds_read_b64_tr_b16 v[60:61], v2 offset:17248
  v_max3_f32 v9, v124, v125, v9
  v_mfma_f32_16x16x32_bf16 a[76:79], v[44:47], v[72:75], a[76:79]
  ds_read_b64_tr_b16 v[62:63], v2 offset:25696
  s_add_u32 m0, s31, 120352
  v_mfma_f32_16x16x32_bf16 a[140:143], v[44:47], v[80:83], a[140:143]
  buffer_load_dwordx4 v3, s[12:15], s60 offen offset:1024 nt lds
  v_max3_f32 v9, v126, v127, v9
  v_mfma_f32_16x16x32_bf16 a[204:207], v[44:47], v[88:91], a[204:207]
  v_cmp_lt_f32 vcc, s59, v9
  s_waitcnt lgkmcnt(4)
  v_mfma_f32_16x16x32_bf16 a[16:19], v[48:51], v[64:67], a[16:19]
  ds_read_b64_tr_b16 v[32:33], v2 offset:17408
  s_cbranch_vccnz RA_L1
RAr_L1:
  v_mfma_f32_16x16x32_bf16 a[80:83], v[48:51], v[72:75], a[80:83]
  ds_read_b64_tr_b16 v[34:35], v2 offset:25856
  v_mfma_f32_16x16x32_bf16 a[144:147], v[48:51], v[80:83], a[144:147]
  v_exp_f32 v96, v96
  v_mfma_f32_16x16x32_bf16 a[208:211], v[48:51], v[88:91], a[208:211]
  v_mfma_f32_16x16x32_bf16 a[20:23], v[52:55], v[64:67], a[20:23]
  ds_read_b64_tr_b16 v[36:37], v2 offset:17440
  v_mfma_f32_16x16x32_bf16 a[84:87], v[52:55], v[72:75], a[84:87]
  ds_read_b64_tr_b16 v[38:39], v2 offset:25888
  v_mfma_f32_16x16x32_bf16 a[148:151], v[52:55], v[80:83], a[148:151]
  v_exp_f32 v97, v97
  v_mfma_f32_16x16x32_bf16 a[212:215], v[52:55], v[88:91], a[212:215]
  v_cvt_pk_bf16_f32 v96, v96, v97
  s_waitcnt lgkmcnt(4)
  v_mfma_f32_16x16x32_bf16 a[24:27], v[56:59], v[64:67], a[24:27]
  ds_read_b64_tr_b16 v[40:41], v2 offset:17472
  v_dot2c_f32_bf16 v4, s66, v96
  v_mfma_f32_16x16x32_bf16 a[88:91], v[56:59], v[72:75], a[88:91]
  ds_read_b64_tr_b16 v[42:43], v2 offset:25920
  v_mfma_f32_16x16x32_bf16 a[152:155], v[56:59], v[80:83], a[152:155]
  s_add_u32 m0, s31, 120384
  v_mfma_f32_16x16x32_bf16 a[216:219], v[56:59], v[88:91], a[216:219]
  buffer_load_dwordx4 v3, s[12:15], s60 offen offset:2048 nt lds
  v_mfma_f32_16x16x32_bf16 a[28:31], v[60:63], v[64:67], a[28:31]
  ds_read_b64_tr_b16 v[44:45], v2 offset:17504
  v_mfma_f32_16x16x32_bf16 a[92:95], v[60:63], v[72:75], a[92:95]
  ds_read_b64_tr_b16 v[46:47], v2 offset:25952
  v_mfma_f32_16x16x32_bf16 a[156:159], v[60:63], v[80:83], a[156:159]
  v_exp_f32 v98, v98
  v_mfma_f32_16x16x32_bf16 a[220:223], v[60:63], v[88:91], a[220:223]
  s_waitcnt lgkmcnt(4)
  v_mfma_f32_16x16x32_bf16 a[32:35], v[32:35], v[64:67], a[32:35]
  ds_read_b64_tr_b16 v[48:49], v2 offset:17664
  v_mfma_f32_16x16x32_bf16 a[96:99], v[32:35], v[72:75], a[96:99]
  ds_read_b64_tr_b16 v[50:51], v2 offset:26112
  v_mfma_f32_16x16x32_bf16 a[160:163], v[32:35], v[80:83], a[160:163]
  v_exp_f32 v99, v99
  v_mfma_f32_16x16x32_bf16 a[224:227], v[32:35], v[88:91], a[224:227]
  v_exp_f32 v100, v100
  v_mfma_f32_16x16x32_bf16 a[36:39], v[36:39], v[64:67], a[36:39]
  ds_read_b64_tr_b16 v[52:53], v2 offset:17696
  v_cvt_pk_bf16_f32 v97, v98, v99
  v_mfma_f32_16x16x32_bf16 a[100:103], v[36:39], v[72:75], a[100:103]
  ds_read_b64_tr_b16 v[54:55], v2 offset:26144
  v_dot2c_f32_bf16 v4, s66, v97
  v_mfma_f32_16x16x32_bf16 a[164:167], v[36:39], v[80:83], a[164:167]
  v_exp_f32 v101, v101
  v_mfma_f32_16x16x32_bf16 a[228:231], v[36:39], v[88:91], a[228:231]
  v_cvt_pk_bf16_f32 v98, v100, v101
  s_waitcnt lgkmcnt(4)
  v_mfma_f32_16x16x32_bf16 a[40:43], v[40:43], v[64:67], a[40:43]
  ds_read_b64_tr_b16 v[56:57], v2 offset:17728
  s_add_u32 m0, s31, 120416
  v_mfma_f32_16x16x32_bf16 a[104:107], v[40:43], v[72:75], a[104:107]
  ds_read_b64_tr_b16 v[58:59], v2 offset:26176
  buffer_load_dwordx4 v3, s[12:15], s60 offen offset:3072 nt lds
  v_mfma_f32_16x16x32_bf16 a[168:171], v[40:43], v[80:83], a[168:171]
  v_exp_f32 v102, v102
  v_mfma_f32_16x16x32_bf16 a[232:235], v[40:43], v[88:91], a[232:235]
  v_exp_f32 v103, v103
  v_mfma_f32_16x16x32_bf16 a[44:47], v[44:47], v[64:67], a[44:47]
  ds_read_b64_tr_b16 v[60:61], v2 offset:17760
  v_dot2c_f32_bf16 v4, s66, v98
  v_mfma_f32_16x16x32_bf16 a[108:111], v[44:47], v[72:75], a[108:111]
  ds_read_b64_tr_b16 v[62:63], v2 offset:26208
  v_cvt_pk_bf16_f32 v99, v102, v103
  v_mfma_f32_16x16x32_bf16 a[172:175], v[44:47], v[80:83], a[172:175]
  v_exp_f32 v104, v104
  v_mfma_f32_16x16x32_bf16 a[236:239], v[44:47], v[88:91], a[236:239]
  v_dot2c_f32_bf16 v4, s66, v99
  s_waitcnt lgkmcnt(4)
  v_mfma_f32_16x16x32_bf16 a[48:51], v[48:51], v[64:67], a[48:51]
  ds_read_b128 v[32:35], v1 offset:16896
  v_mfma_f32_16x16x32_bf16 a[112:115], v[48:51], v[72:75], a[112:115]
  v_exp_f32 v105, v105
  v_mfma_f32_16x16x32_bf16 a[176:179], v[48:51], v[80:83], a[176:179]
  ds_read_b128 v[36:39], v1 offset:16960
  v_cvt_pk_bf16_f32 v104, v104, v105
  v_mfma_f32_16x16x32_bf16 a[240:243], v[48:51], v[88:91], a[240:243]
  v_exp_f32 v106, v106
  v_mfma_f32_16x16x32_bf16 a[52:55], v[52:55], v[64:67], a[52:55]
  ds_read_b128 v[40:43], v1 offset:17152
  v_dot2c_f32_bf16 v5, s66, v104
  v_mfma_f32_16x16x32_bf16 a[116:119], v[52:55], v[72:75], a[116:119]
  s_add_u32 m0, s31, 2048
  v_mfma_f32_16x16x32_bf16 a[180:183], v[52:55], v[80:83], a[180:183]
  ds_read_b128 v[44:47], v1 offset:17216
  buffer_load_dwordx4 v8, s[16:19], s61 offen offset:0 nt lds
  v_mfma_f32_16x16x32_bf16 a[244:247], v[52:55], v[88:91], a[244:247]
  s_waitcnt lgkmcnt(4)
  v_mfma_f32_16x16x32_bf16 a[56:59], v[56:59], v[64:67], a[56:59]
  v_exp_f32 v107, v107
  v_mfma_f32_16x16x32_bf16 a[120:123], v[56:59], v[72:75], a[120:123]
  v_exp_f32 v108, v108
  v_mfma_f32_16x16x32_bf16 a[184:187], v[56:59], v[80:83], a[184:187]
  v_exp_f32 v109, v109
  v_mfma_f32_16x16x32_bf16 a[248:251], v[56:59], v[88:91], a[248:251]
  v_cvt_pk_bf16_f32 v105, v106, v107
  v_dot2c_f32_bf16 v5, s66, v105
  v_mfma_f32_16x16x32_bf16 a[60:63], v[60:63], v[64:67], a[60:63]
  v_exp_f32 v110, v110
  v_mfma_f32_16x16x32_bf16 a[124:127], v[60:63], v[72:75], a[124:127]
  v_cvt_pk_bf16_f32 v106, v108, v109
  v_dot2c_f32_bf16 v5, s66, v106
  v_mfma_f32_16x16x32_bf16 a[188:191], v[60:63], v[80:83], a[188:191]
  v_mfma_f32_16x16x32_bf16 a[252:255], v[60:63], v[88:91], a[252:255]
  s_cbranch_vccnz RB_L1
RBr_L1:
  s_waitcnt lgkmcnt(0)
  v_mfma_f32_16x16x32_bf16 v[64:67], v[32:35], v[128:131], v[16:19]
  ds_read_b128 v[48:51], v1 offset:17408
  v_mfma_f32_16x16x32_bf16 v[64:67], v[36:39], v[132:135], v[64:67]
  v_exp_f32 v111, v111
  v_mfma_f32_16x16x32_bf16 v[64:67], v[40:43], v[136:139], v[64:67]
  ds_read_b128 v[52:55], v1 offset:17472
  s_add_u32 m0, s31, 2080
  v_mfma_f32_16x16x32_bf16 v[64:67], v[44:47], v[140:143], v[64:67]
  buffer_load_dwordx4 v8, s[16:19], s61 offen offset:1024 nt lds
  v_cvt_pk_bf16_f32 v107, v110, v111
  v_mfma_f32_16x16x32_bf16 v[72:75], v[32:35], v[160:163], v[20:23]
  ds_read_b128 v[56:59], v1 offset:17664
  v_dot2c_f32_bf16 v5, s66, v107
  v_mfma_f32_16x16x32_bf16 v[72:75], v[36:39], v[164:167], v[72:75]
  v_exp_f32 v112, v112
  v_mfma_f32_16x16x32_bf16 v[72:75], v[40:43], v[168:171], v[72:75]
  ds_read_b128 v[60:63], v1 offset:17728
  v_mfma_f32_16x16x32_bf16 v[72:75], v[44:47], v[172:175], v[72:75]
  v_exp_f32 v113, v113
  v_mfma_f32_16x16x32_bf16 v[80:83], v[32:35], v[192:195], v[24:27]
  v_exp_f32 v114, v114
  v_mfma_f32_16x16x32_bf16 v[80:83], v[36:39], v[196:199], v[80:83]
  v_cvt_pk_bf16_f32 v112, v112, v113
  v_dot2c_f32_bf16 v6, s66, v112
  v_mfma_f32_16x16x32_bf16 v[80:83], v[40:43], v[200:203], v[80:83]
  v_mfma_f32_16x16x32_bf16 v[80:83], v[44:47], v[204:207], v[80:83]
  v_exp_f32 v115, v115
  v_mfma_f32_16x16x32_bf16 v[88:91], v[32:35], v[224:227], v[28:31]
  v_cvt_pk_bf16_f32 v113, v114, v115
  v_dot2c_f32_bf16 v6, s66, v113
  v_mfma_f32_16x16x32_bf16 v[88:91], v[36:39], v[228:231], v[88:91]
  v_mfma_f32_16x16x32_bf16 v[88:91], v[40:43], v[232:235], v[88:91]
  v_exp_f32 v116, v116
  v_mfma_f32_16x16x32_bf16 v[88:91], v[44:47], v[236:239], v[88:91]
  s_waitcnt lgkmcnt(0)
  v_mfma_f32_16x16x32_bf16 v[64:67], v[48:51], v[144:147], v[64:67]
  ds_read_b128 v[32:35], v1 offset:25344
  s_add_u32 m0, s31, 2112
  v_mfma_f32_16x16x32_bf16 v[64:67], v[52:55], v[148:151], v[64:67]
  buffer_load_dwordx4 v8, s[16:19], s61 offen offset:2048 nt lds
  v_mfma_f32_16x16x32_bf16 v[64:67], v[56:59], v[152:155], v[64:67]
  ds_read_b128 v[36:39], v1 offset:25408
  v_mfma_f32_16x16x32_bf16 v[64:67], v[60:63], v[156:159], v[64:67]
  v_exp_f32 v117, v117
  v_mfma_f32_16x16x32_bf16 v[72:75], v[48:51], v[176:179], v[72:75]
  ds_read_b128 v[40:43], v1 offset:25600
  v_cvt_pk_bf16_f32 v114, v116, v117
  v_mfma_f32_16x16x32_bf16 v[72:75], v[52:55], v[180:183], v[72:75]
  v_exp_f32 v118, v118
  v_mfma_f32_16x16x32_bf16 v[72:75], v[56:59], v[184:187], v[72:75]
  ds_read_b128 v[44:47], v1 offset:25664
  v_dot2c_f32_bf16 v6, s66, v114
  v_mfma_f32_16x16x32_bf16 v[72:75], v[60:63], v[188:191], v[72:75]
  v_mfma_f32_16x16x32_bf16 v[80:83], v[48:51], v[208:211], v[80:83]
  v_exp_f32 v119, v119
  v_mfma_f32_16x16x32_bf16 v[80:83], v[52:55], v[212:215], v[80:83]
  v_cvt_pk_bf16_f32 v115, v118, v119
  v_dot2c_f32_bf16 v6, s66, v115
  v_mfma_f32_16x16x32_bf16 v[80:83], v[56:59], v[216:219], v[80:83]
  v_mfma_f32_16x16x32_bf16 v[80:83], v[60:63], v[220:223], v[80:83]
  v_exp_f32 v120, v120
  v_mfma_f32_16x16x32_bf16 v[88:91], v[48:51], v[240:243], v[88:91]
  v_mfma_f32_16x16x32_bf16 v[88:91], v[52:55], v[244:247], v[88:91]
  s_add_u32 m0, s31, 2144
  v_mfma_f32_16x16x32_bf16 v[88:91], v[56:59], v[248:251], v[88:91]
  buffer_load_dwordx4 v8, s[16:19], s61 offen offset:3072 nt lds
  v_mfma_f32_16x16x32_bf16 v[88:91], v[60:63], v[252:255], v[88:91]
  s_waitcnt lgkmcnt(0)
  v_mfma_f32_16x16x32_bf16 v[68:71], v[32:35], v[128:131], v[16:19]
  ds_read_b128 v[48:51], v1 offset:25856
  v_mfma_f32_16x16x32_bf16 v[68:71], v[36:39], v[132:135], v[68:71]
  v_exp_f32 v121, v121
  v_mfma_f32_16x16x32_bf16 v[68:71], v[40:43], v[136:139], v[68:71]
  ds_read_b128 v[52:55], v1 offset:25920
  v_cvt_pk_bf16_f32 v120, v120, v121
  v_mfma_f32_16x16x32_bf16 v[68:71], v[44:47], v[140:143], v[68:71]
  v_exp_f32 v122, v122
  v_mfma_f32_16x16x32_bf16 v[76:79], v[32:35], v[160:163], v[20:23]
  ds_read_b128 v[56:59], v1 offset:26112
  v_dot2c_f32_bf16 v7, s66, v120
  v_mfma_f32_16x16x32_bf16 v[76:79], v[36:39], v[164:167], v[76:79]
  v_exp_f32 v123, v123
  v_mfma_f32_16x16x32_bf16 v[76:79], v[40:43], v[168:171], v[76:79]
  ds_read_b128 v[60:63], v1 offset:26176
  v_cvt_pk_bf16_f32 v121, v122, v123
  v_mfma_f32_16x16x32_bf16 v[76:79], v[44:47], v[172:175], v[76:79]
  v_exp_f32 v124, v124
  v_mfma_f32_16x16x32_bf16 v[84:87], v[32:35], v[192:195], v[24:27]
  v_dot2c_f32_bf16 v7, s66, v121
  v_mfma_f32_16x16x32_bf16 v[84:87], v[36:39], v[196:199], v[84:87]
  v_mfma_f32_16x16x32_bf16 v[84:87], v[40:43], v[200:203], v[84:87]
  v_exp_f32 v125, v125
  v_mfma_f32_16x16x32_bf16 v[84:87], v[44:47], v[204:207], v[84:87]
  v_cvt_pk_bf16_f32 v122, v124, v125
  v_dot2c_f32_bf16 v7, s66, v122
  v_mfma_f32_16x16x32_bf16 v[92:95], v[32:35], v[224:227], v[28:31]
  v_mfma_f32_16x16x32_bf16 v[92:95], v[36:39], v[228:231], v[92:95]
  s_waitcnt vmcnt(12)
  v_mfma_f32_16x16x32_bf16 v[92:95], v[40:43], v[232:235], v[92:95]
  s_barrier
  v_mfma_f32_16x16x32_bf16 v[92:95], v[44:47], v[236:239], v[92:95]
  s_waitcnt lgkmcnt(0)
  v_mfma_f32_16x16x32_bf16 v[68:71], v[48:51], v[144:147], v[68:71]
  ds_read_b64_tr_b16 v[32:33], v2 offset:33792
  v_mfma_f32_16x16x32_bf16 v[68:71], v[52:55], v[148:151], v[68:71]
  ds_read_b64_tr_b16 v[34:35], v2 offset:42240
  v_mfma_f32_16x16x32_bf16 v[68:71], v[56:59], v[152:155], v[68:71]
  v_exp_f32 v126, v126
  v_mfma_f32_16x16x32_bf16 v[68:71], v[60:63], v[156:159], v[68:71]
  ds_read_b64_tr_b16 v[36:37], v2 offset:33824
  v_mfma_f32_16x16x32_bf16 v[76:79], v[48:51], v[176:179], v[76:79]
  ds_read_b64_tr_b16 v[38:39], v2 offset:42272
  v_mfma_f32_16x16x32_bf16 v[76:79], v[52:55], v[180:183], v[76:79]
  v_exp_f32 v127, v127
  v_mfma_f32_16x16x32_bf16 v[76:79], v[56:59], v[184:187], v[76:79]
  ds_read_b64_tr_b16 v[40:41], v2 offset:33856
  v_cvt_pk_bf16_f32 v123, v126, v127
  v_mfma_f32_16x16x32_bf16 v[76:79], v[60:63], v[188:191], v[76:79]
  ds_read_b64_tr_b16 v[42:43], v2 offset:42304
  v_dot2c_f32_bf16 v7, s66, v123
  v_mfma_f32_16x16x32_bf16 v[84:87], v[48:51], v[208:211], v[84:87]
  v_mfma_f32_16x16x32_bf16 v[84:87], v[52:55], v[212:215], v[84:87]
  ds_read_b64_tr_b16 v[44:45], v2 offset:33888
  v_mfma_f32_16x16x32_bf16 v[84:87], v[56:59], v[216:219], v[84:87]
  ds_read_b64_tr_b16 v[46:47], v2 offset:42336
  v_mfma_f32_16x16x32_bf16 v[84:87], v[60:63], v[220:223], v[84:87]
  v_mfma_f32_16x16x32_bf16 v[92:95], v[48:51], v[240:243], v[92:95]
  v_mfma_f32_16x16x32_bf16 v[92:95], v[52:55], v[244:247], v[92:95]
  v_mfma_f32_16x16x32_bf16 v[92:95], v[56:59], v[248:251], v[92:95]
  v_mfma_f32_16x16x32_bf16 v[92:95], v[60:63], v[252:255], v[92:95]
  s_waitcnt lgkmcnt(4)
  v_mfma_f32_16x16x32_bf16 a[0:3], v[32:35], v[96:99], a[0:3]
  ds_read_b64_tr_b16 v[48:49], v2 offset:34048
  s_add_u32 s61, s60, 16384
  v_mfma_f32_16x16x32_bf16 a[64:67], v[32:35], v[104:107], a[64:67]
  ds_read_b64_tr_b16 v[50:51], v2 offset:42496
  s_add_u32 m0, s31, 69632
  v_mfma_f32_16x16x32_bf16 a[128:131], v[32:35], v[112:115], a[128:131]
  buffer_load_dwordx4 v3, s[12:15], s61 offen offset:0 nt lds
  v_max_f32 v9, v64, v65
  v_mfma_f32_16x16x32_bf16 a[192:195], v[32:35], v[120:123], a[192:195]
  v_max3_f32 v9, v66, v67, v9
  v_max3_f32 v9, v72, v73, v9
  v_mfma_f32_16x16x32_bf16 a[4:7], v[36:39], v[96:99], a[4:7]
  ds_read_b64_tr_b16 v[52:53], v2 offset:34080
  v_max3_f32 v9, v74, v75, v9
  v_mfma_f32_16x16x32_bf16 a[68:71], v[36:39], v[104:107], a[68:71]
  ds_read_b64_tr_b16 v[54:55], v2 offset:42528
  v_max3_f32 v9, v80, v81, v9
  v_mfma_f32_16x16x32_bf16 a[132:135], v[36:39], v[112:115], a[132:135]
  v_max3_f32 v9, v82, v83, v9
  v_max3_f32 v9, v88, v89, v9
  v_mfma_f32_16x16x32_bf16 a[196:199], v[36:39], v[120:123], a[196:199]
  v_max3_f32 v9, v90, v91, v9
  s_waitcnt lgkmcnt(4)
  v_mfma_f32_16x16x32_bf16 a[8:11], v[40:43], v[96:99], a[8:11]
  ds_read_b64_tr_b16 v[56:57], v2 offset:34112
  v_max3_f32 v9, v68, v69, v9
  v_mfma_f32_16x16x32_bf16 a[72:75], v[40:43], v[104:107], a[72:75]
  ds_read_b64_tr_b16 v[58:59], v2 offset:42560
  v_max3_f32 v9, v70, v71, v9
  v_mfma_f32_16x16x32_bf16 a[136:139], v[40:43], v[112:115], a[136:139]
  v_max3_f32 v9, v76, v77, v9
  v_max3_f32 v9, v78, v79, v9
  v_mfma_f32_16x16x32_bf16 a[200:203], v[40:43], v[120:123], a[200:203]
  v_max3_f32 v9, v84, v85, v9
  v_max3_f32 v9, v86, v87, v9
  v_mfma_f32_16x16x32_bf16 a[12:15], v[44:47], v[96:99], a[12:15]
  ds_read_b64_tr_b16 v[60:61], v2 offset:34144
  v_max3_f32 v9, v92, v93, v9
  v_mfma_f32_16x16x32_bf16 a[76:79], v[44:47], v[104:107], a[76:79]
  ds_read_b64_tr_b16 v[62:63], v2 offset:42592
  s_add_u32 m0, s31, 69664
  v_mfma_f32_16x16x32_bf16 a[140:143], v[44:47], v[112:115], a[140:143]
  buffer_load_dwordx4 v3, s[12:15], s61 offen offset:1024 nt lds
  v_max3_f32 v9, v94, v95, v9
  v_mfma_f32_16x16x32_bf16 a[204:207], v[44:47], v[120:123], a[204:207]
  v_cmp_lt_f32 vcc, s59, v9
  s_waitcnt lgkmcnt(4)
  v_mfma_f32_16x16x32_bf16 a[16:19], v[48:51], v[96:99], a[16:19]
  ds_read_b64_tr_b16 v[32:33], v2 offset:34304
  s_cbranch_vccnz RA_L2
RAr_L2:
  v_mfma_f32_16x16x32_bf16 a[80:83], v[48:51], v[104:107], a[80:83]
  ds_read_b64_tr_b16 v[34:35], v2 offset:42752
  v_mfma_f32_16x16x32_bf16 a[144:147], v[48:51], v[112:115], a[144:147]
  v_exp_f32 v64, v64
  v_mfma_f32_16x16x32_bf16 a[208:211], v[48:51], v[120:123], a[208:211]
  v_mfma_f32_16x16x32_bf16 a[20:23], v[52:55], v[96:99], a[20:23]
  ds_read_b64_tr_b16 v[36:37], v2 offset:34336
  v_mfma_f32_16x16x32_bf16 a[84:87], v[52:55], v[104:107], a[84:87]
  ds_read_b64_tr_b16 v[38:39], v2 offset:42784
  v_mfma_f32_16x16x32_bf16 a[148:151], v[52:55], v[112:115], a[148:151]
  v_exp_f32 v65, v65
  v_mfma_f32_16x16x32_bf16 a[212:215], v[52:55], v[120:123], a[212:215]
  v_cvt_pk_bf16_f32 v64, v64, v65
  s_waitcnt lgkmcnt(4)
  v_mfma_f32_16x16x32_bf16 a[24:27], v[56:59], v[96:99], a[24:27]
  ds_read_b64_tr_b16 v[40:41], v2 offset:34368
  v_dot2c_f32_bf16 v4, s66, v64
  v_mfma_f32_16x16x32_bf16 a[88:91], v[56:59], v[104:107], a[88:91]
  ds_read_b64_tr_b16 v[42:43], v2 offset:42816
  v_mfma_f32_16x16x32_bf16 a[152:155], v[56:59], v[112:115], a[152:155]
  s_add_u32 m0, s31, 69696
  v_mfma_f32_16x16x32_bf16 a[216:219], v[56:59], v[120:123], a[216:219]
  buffer_load_dwordx4 v3, s[12:15], s61 offen offset:2048 nt lds
  v_mfma_f32_16x16x32_bf16 a[28:31], v[60:63], v[96:99], a[28:31]
  ds_read_b64_tr_b16 v[44:45], v2 offset:34400
  v_mfma_f32_16x16x32_bf16 a[92:95], v[60:63], v[104:107], a[92:95]
  ds_read_b64_tr_b16 v[46:47], v2 offset:42848
  v_mfma_f32_16x16x32_bf16 a[156:159], v[60:63], v[112:115], a[156:159]
  v_exp_f32 v66, v66
  v_mfma_f32_16x16x32_bf16 a[220:223], v[60:63], v[120:123], a[220:223]
  s_waitcnt lgkmcnt(4)
  v_mfma_f32_16x16x32_bf16 a[32:35], v[32:35], v[96:99], a[32:35]
  ds_read_b64_tr_b16 v[48:49], v2 offset:34560
  v_mfma_f32_16x16x32_bf16 a[96:99], v[32:35], v[104:107], a[96:99]
  ds_read_b64_tr_b16 v[50:51], v2 offset:43008
  v_mfma_f32_16x16x32_bf16 a[160:163], v[32:35], v[112:115], a[160:163]
  v_exp_f32 v67, v67
  v_mfma_f32_16x16x32_bf16 a[224:227], v[32:35], v[120:123], a[224:227]
  v_exp_f32 v68, v68
  v_mfma_f32_16x16x32_bf16 a[36:39], v[36:39], v[96:99], a[36:39]
  ds_read_b64_tr_b16 v[52:53], v2 offset:34592
  v_cvt_pk_bf16_f32 v65, v66, v67
  v_mfma_f32_16x16x32_bf16 a[100:103], v[36:39], v[104:107], a[100:103]
  ds_read_b64_tr_b16 v[54:55], v2 offset:43040
  v_dot2c_f32_bf16 v4, s66, v65
  v_mfma_f32_16x16x32_bf16 a[164:167], v[36:39], v[112:115], a[164:167]
  v_exp_f32 v69, v69
  v_mfma_f32_16x16x32_bf16 a[228:231], v[36:39], v[120:123], a[228:231]
  v_cvt_pk_bf16_f32 v66, v68, v69
  s_waitcnt lgkmcnt(4)
  v_mfma_f32_16x16x32_bf16 a[40:43], v[40:43], v[96:99], a[40:43]
  ds_read_b64_tr_b16 v[56:57], v2 offset:34624
  s_add_u32 m0, s31, 69728
  v_mfma_f32_16x16x32_bf16 a[104:107], v[40:43], v[104:107], a[104:107]
  ds_read_b64_tr_b16 v[58:59], v2 offset:43072
  buffer_load_dwordx4 v3, s[12:15], s61 offen offset:3072 nt lds
  v_mfma_f32_16x16x32_bf16 a[168:171], v[40:43], v[112:115], a[168:171]
  v_exp_f32 v70, v70
  v_mfma_f32_16x16x32_bf16 a[232:235], v[40:43], v[120:123], a[232:235]
  v_exp_f32 v71, v71
  v_mfma_f32_16x16x32_bf16 a[44:47], v[44:47], v[96:99], a[44:47]
  ds_read_b64_tr_b16 v[60:61], v2 offset:34656
  v_dot2c_f32_bf16 v4, s66, v66
  v_mfma_f32_16x16x32_bf16 a[108:111], v[44:47], v[104:107], a[108:111]
  ds_read_b64_tr_b16 v[62:63], v2 offset:43104
  v_cvt_pk_bf16_f32 v67, v70, v71
  v_mfma_f32_16x16x32_bf16 a[172:175], v[44:47], v[112:115], a[172:175]
  v_exp_f32 v72, v72
  v_mfma_f32_16x16x32_bf16 a[236:239], v[44:47], v[120:123], a[236:239]
  v_dot2c_f32_bf16 v4, s66, v67
  s_waitcnt lgkmcnt(4)
  v_mfma_f32_16x16x32_bf16 a[48:51], v[48:51], v[96:99], a[48:51]
  ds_read_b128 v[32:35], v1 offset:33792
  v_mfma_f32_16x16x32_bf16 a[112:115], v[48:51], v[104:107], a[112:115]
  v_exp_f32 v73, v73
  v_mfma_f32_16x16x32_bf16 a[176:179], v[48:51], v[112:115], a[176:179]
  ds_read_b128 v[36:39], v1 offset:33856
  v_cvt_pk_bf16_f32 v72, v72, v73
  v_mfma_f32_16x16x32_bf16 a[240:243], v[48:51], v[120:123], a[240:243]
  v_exp_f32 v74, v74
  v_mfma_f32_16x16x32_bf16 a[52:55], v[52:55], v[96:99], a[52:55]
  ds_read_b128 v[40:43], v1 offset:34048
  v_dot2c_f32_bf16 v5, s66, v72
  v_mfma_f32_16x16x32_bf16 a[116:119], v[52:55], v[104:107], a[116:119]
  s_add_u32 m0, s31, 18944
  v_mfma_f32_16x16x32_bf16 a[180:183], v[52:55], v[112:115], a[180:183]
  ds_read_b128 v[44:47], v1 offset:34112
  buffer_load_dwordx4 v8, s[16:19], s60 offen offset:0 nt lds
  v_mfma_f32_16x16x32_bf16 a[244:247], v[52:55], v[120:123], a[244:247]
  s_waitcnt lgkmcnt(4)
  v_mfma_f32_16x16x32_bf16 a[56:59], v[56:59], v[96:99], a[56:59]
  v_exp_f32 v75, v75
  v_mfma_f32_16x16x32_bf16 a[120:123], v[56:59], v[104:107], a[120:123]
  v_exp_f32 v76, v76
  v_mfma_f32_16x16x32_bf16 a[184:187], v[56:59], v[112:115], a[184:187]
  v_exp_f32 v77, v77
  v_mfma_f32_16x16x32_bf16 a[248:251], v[56:59], v[120:123], a[248:251]
  v_cvt_pk_bf16_f32 v73, v74, v75
  v_dot2c_f32_bf16 v5, s66, v73
  v_mfma_f32_16x16x32_bf16 a[60:63], v[60:63], v[96:99], a[60:63]
  v_exp_f32 v78, v78
  v_mfma_f32_16x16x32_bf16 a[124:127], v[60:63], v[104:107], a[124:127]
  v_cvt_pk_bf16_f32 v74, v76, v77
  v_dot2c_f32_bf16 v5, s66, v74
  v_mfma_f32_16x16x32_bf16 a[188:191], v[60:63], v[112:115], a[188:191]
  v_mfma_f32_16x16x32_bf16 a[252:255], v[60:63], v[120:123], a[252:255]
  s_cbranch_vccnz RB_L2
RBr_L2:
  s_waitcnt lgkmcnt(0)
  v_mfma_f32_16x16x32_bf16 v[96:99], v[32:35], v[128:131], v[16:19]
  ds_read_b128 v[48:51], v1 offset:34304
  v_mfma_f32_16x16x32_bf16 v[96:99], v[36:39], v[132:135], v[96:99]
  v_exp_f32 v79, v79
  v_mfma_f32_16x16x32_bf16 v[96:99], v[40:43], v[136:139], v[96:99]
  ds_read_b128 v[52:55], v1 offset:34368
  s_add_u32 m0, s31, 18976
  v_mfma_f32_16x16x32_bf16 v[96:99], v[44:47], v[140:143], v[96:99]
  buffer_load_dwordx4 v8, s[16:19], s60 offen offset:1024 nt lds
  v_cvt_pk_bf16_f32 v75, v78, v79
  v_mfma_f32_16x16x32_bf16 v[104:107], v[32:35], v[160:163], v[20:23]
  ds_read_b128 v[56:59], v1 offset:34560
  v_dot2c_f32_bf16 v5, s66, v75
  v_mfma_f32_16x16x32_bf16 v[104:107], v[36:39], v[164:167], v[104:107]
  v_exp_f32 v80, v80
  v_mfma_f32_16x16x32_bf16 v[104:107], v[40:43], v[168:171], v[104:107]
  ds_read_b128 v[60:63], v1 offset:34624
  v_mfma_f32_16x16x32_bf16 v[104:107], v[44:47], v[172:175], v[104:107]
  v_exp_f32 v81, v81
  v_mfma_f32_16x16x32_bf16 v[112:115], v[32:35], v[192:195], v[24:27]
  v_exp_f32 v82, v82
  v_mfma_f32_16x16x32_bf16 v[112:115], v[36:39], v[196:199], v[112:115]
  v_cvt_pk_bf16_f32 v80, v80, v81
  v_dot2c_f32_bf16 v6, s66, v80
  v_mfma_f32_16x16x32_bf16 v[112:115], v[40:43], v[200:203], v[112:115]
  v_mfma_f32_16x16x32_bf16 v[112:115], v[44:47], v[204:207], v[112:115]
  v_exp_f32 v83, v83
  v_mfma_f32_16x16x32_bf16 v[120:123], v[32:35], v[224:227], v[28:31]
  v_cvt_pk_bf16_f32 v81, v82, v83
  v_dot2c_f32_bf16 v6, s66, v81
  v_mfma_f32_16x16x32_bf16 v[120:123], v[36:39], v[228:231], v[120:123]
  v_mfma_f32_16x16x32_bf16 v[120:123], v[40:43], v[232:235], v[120:123]
  v_exp_f32 v84, v84
  v_mfma_f32_16x16x32_bf16 v[120:123], v[44:47], v[236:239], v[120:123]
  s_waitcnt lgkmcnt(0)
  v_mfma_f32_16x16x32_bf16 v[96:99], v[48:51], v[144:147], v[96:99]
  ds_read_b128 v[32:35], v1 offset:42240
  s_add_u32 m0, s31, 19008
  v_mfma_f32_16x16x32_bf16 v[96:99], v[52:55], v[148:151], v[96:99]
  buffer_load_dwordx4 v8, s[16:19], s60 offen offset:2048 nt lds
  v_mfma_f32_16x16x32_bf16 v[96:99], v[56:59], v[152:155], v[96:99]
  ds_read_b128 v[36:39], v1 offset:42304
  v_mfma_f32_16x16x32_bf16 v[96:99], v[60:63], v[156:159], v[96:99]
  v_exp_f32 v85, v85
  v_mfma_f32_16x16x32_bf16 v[104:107], v[48:51], v[176:179], v[104:107]
  ds_read_b128 v[40:43], v1 offset:42496
  v_cvt_pk_bf16_f32 v82, v84, v85
  v_mfma_f32_16x16x32_bf16 v[104:107], v[52:55], v[180:183], v[104:107]
  v_exp_f32 v86, v86
  v_mfma_f32_16x16x32_bf16 v[104:107], v[56:59], v[184:187], v[104:107]
  ds_read_b128 v[44:47], v1 offset:42560
  v_dot2c_f32_bf16 v6, s66, v82
  v_mfma_f32_16x16x32_bf16 v[104:107], v[60:63], v[188:191], v[104:107]
  v_mfma_f32_16x16x32_bf16 v[112:115], v[48:51], v[208:211], v[112:115]
  v_exp_f32 v87, v87
  v_mfma_f32_16x16x32_bf16 v[112:115], v[52:55], v[212:215], v[112:115]
  v_cvt_pk_bf16_f32 v83, v86, v87
  v_dot2c_f32_bf16 v6, s66, v83
  v_mfma_f32_16x16x32_bf16 v[112:115], v[56:59], v[216:219], v[112:115]
  v_mfma_f32_16x16x32_bf16 v[112:115], v[60:63], v[220:223], v[112:115]
  v_exp_f32 v88, v88
  v_mfma_f32_16x16x32_bf16 v[120:123], v[48:51], v[240:243], v[120:123]
  v_mfma_f32_16x16x32_bf16 v[120:123], v[52:55], v[244:247], v[120:123]
  s_add_u32 m0, s31, 19040
  v_mfma_f32_16x16x32_bf16 v[120:123], v[56:59], v[248:251], v[120:123]
  buffer_load_dwordx4 v8, s[16:19], s60 offen offset:3072 nt lds
  v_mfma_f32_16x16x32_bf16 v[120:123], v[60:63], v[252:255], v[120:123]
  s_waitcnt lgkmcnt(0)
  v_mfma_f32_16x16x32_bf16 v[100:103], v[32:35], v[128:131], v[16:19]
  ds_read_b128 v[48:51], v1 offset:42752
  v_mfma_f32_16x16x32_bf16 v[100:103], v[36:39], v[132:135], v[100:103]
  v_exp_f32 v89, v89
  v_mfma_f32_16x16x32_bf16 v[100:103], v[40:43], v[136:139], v[100:103]
  ds_read_b128 v[52:55], v1 offset:42816
  v_cvt_pk_bf16_f32 v88, v88, v89
  v_mfma_f32_16x16x32_bf16 v[100:103], v[44:47], v[140:143], v[100:103]
  v_exp_f32 v90, v90
  v_mfma_f32_16x16x32_bf16 v[108:111], v[32:35], v[160:163], v[20:23]
  ds_read_b128 v[56:59], v1 offset:43008
  v_dot2c_f32_bf16 v7, s66, v88
  v_mfma_f32_16x16x32_bf16 v[108:111], v[36:39], v[164:167], v[108:111]
  v_exp_f32 v91, v91
  v_mfma_f32_16x16x32_bf16 v[108:111], v[40:43], v[168:171], v[108:111]
  ds_read_b128 v[60:63], v1 offset:43072
  v_cvt_pk_bf16_f32 v89, v90, v91
  v_mfma_f32_16x16x32_bf16 v[108:111], v[44:47], v[172:175], v[108:111]
  v_exp_f32 v92, v92
  v_mfma_f32_16x16x32_bf16 v[116:119], v[32:35], v[192:195], v[24:27]
  v_dot2c_f32_bf16 v7, s66, v89
  v_mfma_f32_16x16x32_bf16 v[116:119], v[36:39], v[196:199], v[116:119]
  v_mfma_f32_16x16x32_bf16 v[116:119], v[40:43], v[200:203], v[116:119]
  v_exp_f32 v93, v93
  v_mfma_f32_16x16x32_bf16 v[116:119], v[44:47], v[204:207], v[116:119]
  v_cvt_pk_bf16_f32 v90, v92, v93
  v_dot2c_f32_bf16 v7, s66, v90
  v_mfma_f32_16x16x32_bf16 v[124:127], v[32:35], v[224:227], v[28:31]
  v_mfma_f32_16x16x32_bf16 v[124:127], v[36:39], v[228:231], v[124:127]
  s_waitcnt vmcnt(12)
  v_mfma_f32_16x16x32_bf16 v[124:127], v[40:43], v[232:235], v[124:127]
  s_barrier
  v_mfma_f32_16x16x32_bf16 v[124:127], v[44:47], v[236:239], v[124:127]
  s_waitcnt lgkmcnt(0)
  v_mfma_f32_16x16x32_bf16 v[100:103], v[48:51], v[144:147], v[100:103]
  ds_read_b64_tr_b16 v[32:33], v2 offset:50688
  v_mfma_f32_16x16x32_bf16 v[100:103], v[52:55], v[148:151], v[100:103]
  ds_read_b64_tr_b16 v[34:35], v2 offset:59136
  v_mfma_f32_16x16x32_bf16 v[100:103], v[56:59], v[152:155], v[100:103]
  v_exp_f32 v94, v94
  v_mfma_f32_16x16x32_bf16 v[100:103], v[60:63], v[156:159], v[100:103]
  ds_read_b64_tr_b16 v[36:37], v2 offset:50720
  v_mfma_f32_16x16x32_bf16 v[108:111], v[48:51], v[176:179], v[108:111]
  ds_read_b64_tr_b16 v[38:39], v2 offset:59168
  v_mfma_f32_16x16x32_bf16 v[108:111], v[52:55], v[180:183], v[108:111]
  v_exp_f32 v95, v95
  v_mfma_f32_16x16x32_bf16 v[108:111], v[56:59], v[184:187], v[108:111]
  ds_read_b64_tr_b16 v[40:41], v2 offset:50752
  v_cvt_pk_bf16_f32 v91, v94, v95
  v_mfma_f32_16x16x32_bf16 v[108:111], v[60:63], v[188:191], v[108:111]
  ds_read_b64_tr_b16 v[42:43], v2 offset:59200
  v_dot2c_f32_bf16 v7, s66, v91
  v_mfma_f32_16x16x32_bf16 v[116:119], v[48:51], v[208:211], v[116:119]
  v_mfma_f32_16x16x32_bf16 v[116:119], v[52:55], v[212:215], v[116:119]
  ds_read_b64_tr_b16 v[44:45], v2 offset:50784
  v_mfma_f32_16x16x32_bf16 v[116:119], v[56:59], v[216:219], v[116:119]
  ds_read_b64_tr_b16 v[46:47], v2 offset:59232
  v_mfma_f32_16x16x32_bf16 v[116:119], v[60:63], v[220:223], v[116:119]
  v_mfma_f32_16x16x32_bf16 v[124:127], v[48:51], v[240:243], v[124:127]
  v_mfma_f32_16x16x32_bf16 v[124:127], v[52:55], v[244:247], v[124:127]
  v_mfma_f32_16x16x32_bf16 v[124:127], v[56:59], v[248:251], v[124:127]
  v_mfma_f32_16x16x32_bf16 v[124:127], v[60:63], v[252:255], v[124:127]
  s_waitcnt lgkmcnt(4)
  v_mfma_f32_16x16x32_bf16 a[0:3], v[32:35], v[64:67], a[0:3]
  ds_read_b64_tr_b16 v[48:49], v2 offset:50944
  s_add_u32 s60, s61, 16384
  v_mfma_f32_16x16x32_bf16 a[64:67], v[32:35], v[72:75], a[64:67]
  ds_read_b64_tr_b16 v[50:51], v2 offset:59392
  s_add_u32 m0, s31, 86528
  v_mfma_f32_16x16x32_bf16 a[128:131], v[32:35], v[80:83], a[128:131]
  buffer_load_dwordx4 v3, s[12:15], s60 offen offset:0 nt lds
  v_max_f32 v9, v96, v97
  v_mfma_f32_16x16x32_bf16 a[192:195], v[32:35], v[88:91], a[192:195]
  v_max3_f32 v9, v98, v99, v9
  v_max3_f32 v9, v104, v105, v9
  v_mfma_f32_16x16x32_bf16 a[4:7], v[36:39], v[64:67], a[4:7]
  ds_read_b64_tr_b16 v[52:53], v2 offset:50976
  v_max3_f32 v9, v106, v107, v9
  v_mfma_f32_16x16x32_bf16 a[68:71], v[36:39], v[72:75], a[68:71]
  ds_read_b64_tr_b16 v[54:55], v2 offset:59424
  v_max3_f32 v9, v112, v113, v9
  v_mfma_f32_16x16x32_bf16 a[132:135], v[36:39], v[80:83], a[132:135]
  v_max3_f32 v9, v114, v115, v9
  v_max3_f32 v9, v120, v121, v9
  v_mfma_f32_16x16x32_bf16 a[196:199], v[36:39], v[88:91], a[196:199]
  v_max3_f32 v9, v122, v123, v9
  s_waitcnt lgkmcnt(4)
  v_mfma_f32_16x16x32_bf16 a[8:11], v[40:43], v[64:67], a[8:11]
  ds_read_b64_tr_b16 v[56:57], v2 offset:51008
  v_max3_f32 v9, v100, v101, v9
  v_mfma_f32_16x16x32_bf16 a[72:75], v[40:43], v[72:75], a[72:75]
  ds_read_b64_tr_b16 v[58:59], v2 offset:59456
  v_max3_f32 v9, v102, v103, v9
  v_mfma_f32_16x16x32_bf16 a[136:139], v[40:43], v[80:83], a[136:139]
  v_max3_f32 v9, v108, v109, v9
  v_max3_f32 v9, v110, v111, v9
  v_mfma_f32_16x16x32_bf16 a[200:203], v[40:43], v[88:91], a[200:203]
  v_max3_f32 v9, v116, v117, v9
  v_max3_f32 v9, v118, v119, v9
  v_mfma_f32_16x16x32_bf16 a[12:15], v[44:47], v[64:67], a[12:15]
  ds_read_b64_tr_b16 v[60:61], v2 offset:51040
  v_max3_f32 v9, v124, v125, v9
  v_mfma_f32_16x16x32_bf16 a[76:79], v[44:47], v[72:75], a[76:79]
  ds_read_b64_tr_b16 v[62:63], v2 offset:59488
  s_add_u32 m0, s31, 86560
  v_mfma_f32_16x16x32_bf16 a[140:143], v[44:47], v[80:83], a[140:143]
  buffer_load_dwordx4 v3, s[12:15], s60 offen offset:1024 nt lds
  v_max3_f32 v9, v126, v127, v9
  v_mfma_f32_16x16x32_bf16 a[204:207], v[44:47], v[88:91], a[204:207]
  v_cmp_lt_f32 vcc, s59, v9
  s_waitcnt lgkmcnt(4)
  v_mfma_f32_16x16x32_bf16 a[16:19], v[48:51], v[64:67], a[16:19]
  ds_read_b64_tr_b16 v[32:33], v2 offset:51200
  s_cbranch_vccnz RA_L3
RAr_L3:
  v_mfma_f32_16x16x32_bf16 a[80:83], v[48:51], v[72:75], a[80:83]
  ds_read_b64_tr_b16 v[34:35], v2 offset:59648
  v_mfma_f32_16x16x32_bf16 a[144:147], v[48:51], v[80:83], a[144:147]
  v_exp_f32 v96, v96
  v_mfma_f32_16x16x32_bf16 a[208:211], v[48:51], v[88:91], a[208:211]
  v_mfma_f32_16x16x32_bf16 a[20:23], v[52:55], v[64:67], a[20:23]
  ds_read_b64_tr_b16 v[36:37], v2 offset:51232
  v_mfma_f32_16x16x32_bf16 a[84:87], v[52:55], v[72:75], a[84:87]
  ds_read_b64_tr_b16 v[38:39], v2 offset:59680
  v_mfma_f32_16x16x32_bf16 a[148:151], v[52:55], v[80:83], a[148:151]
  v_exp_f32 v97, v97
  v_mfma_f32_16x16x32_bf16 a[212:215], v[52:55], v[88:91], a[212:215]
  v_cvt_pk_bf16_f32 v96, v96, v97
  s_waitcnt lgkmcnt(4)
  v_mfma_f32_16x16x32_bf16 a[24:27], v[56:59], v[64:67], a[24:27]
  ds_read_b64_tr_b16 v[40:41], v2 offset:51264
  v_dot2c_f32_bf16 v4, s66, v96
  v_mfma_f32_16x16x32_bf16 a[88:91], v[56:59], v[72:75], a[88:91]
  ds_read_b64_tr_b16 v[42:43], v2 offset:59712
  v_mfma_f32_16x16x32_bf16 a[152:155], v[56:59], v[80:83], a[152:155]
  s_add_u32 m0, s31, 86592
  v_mfma_f32_16x16x32_bf16 a[216:219], v[56:59], v[88:91], a[216:219]
  buffer_load_dwordx4 v3, s[12:15], s60 offen offset:2048 nt lds
  v_mfma_f32_16x16x32_bf16 a[28:31], v[60:63], v[64:67], a[28:31]
  ds_read_b64_tr_b16 v[44:45], v2 offset:51296
  v_mfma_f32_16x16x32_bf16 a[92:95], v[60:63], v[72:75], a[92:95]
  ds_read_b64_tr_b16 v[46:47], v2 offset:59744
  v_mfma_f32_16x16x32_bf16 a[156:159], v[60:63], v[80:83], a[156:159]
  v_exp_f32 v98, v98
  v_mfma_f32_16x16x32_bf16 a[220:223], v[60:63], v[88:91], a[220:223]
  s_waitcnt lgkmcnt(4)
  v_mfma_f32_16x16x32_bf16 a[32:35], v[32:35], v[64:67], a[32:35]
  ds_read_b64_tr_b16 v[48:49], v2 offset:51456
  v_mfma_f32_16x16x32_bf16 a[96:99], v[32:35], v[72:75], a[96:99]
  ds_read_b64_tr_b16 v[50:51], v2 offset:59904
  v_mfma_f32_16x16x32_bf16 a[160:163], v[32:35], v[80:83], a[160:163]
  v_exp_f32 v99, v99
  v_mfma_f32_16x16x32_bf16 a[224:227], v[32:35], v[88:91], a[224:227]
  v_exp_f32 v100, v100
  v_mfma_f32_16x16x32_bf16 a[36:39], v[36:39], v[64:67], a[36:39]
  ds_read_b64_tr_b16 v[52:53], v2 offset:51488
  v_cvt_pk_bf16_f32 v97, v98, v99
  v_mfma_f32_16x16x32_bf16 a[100:103], v[36:39], v[72:75], a[100:103]
  ds_read_b64_tr_b16 v[54:55], v2 offset:59936
  v_dot2c_f32_bf16 v4, s66, v97
  v_mfma_f32_16x16x32_bf16 a[164:167], v[36:39], v[80:83], a[164:167]
  v_exp_f32 v101, v101
  v_mfma_f32_16x16x32_bf16 a[228:231], v[36:39], v[88:91], a[228:231]
  v_cvt_pk_bf16_f32 v98, v100, v101
  s_waitcnt lgkmcnt(4)
  v_mfma_f32_16x16x32_bf16 a[40:43], v[40:43], v[64:67], a[40:43]
  ds_read_b64_tr_b16 v[56:57], v2 offset:51520
  s_add_u32 m0, s31, 86624
  v_mfma_f32_16x16x32_bf16 a[104:107], v[40:43], v[72:75], a[104:107]
  ds_read_b64_tr_b16 v[58:59], v2 offset:59968
  buffer_load_dwordx4 v3, s[12:15], s60 offen offset:3072 nt lds
  v_mfma_f32_16x16x32_bf16 a[168:171], v[40:43], v[80:83], a[168:171]
  v_exp_f32 v102, v102
  v_mfma_f32_16x16x32_bf16 a[232:235], v[40:43], v[88:91], a[232:235]
  v_exp_f32 v103, v103
  v_mfma_f32_16x16x32_bf16 a[44:47], v[44:47], v[64:67], a[44:47]
  ds_read_b64_tr_b16 v[60:61], v2 offset:51552
  v_dot2c_f32_bf16 v4, s66, v98
  v_mfma_f32_16x16x32_bf16 a[108:111], v[44:47], v[72:75], a[108:111]
  ds_read_b64_tr_b16 v[62:63], v2 offset:60000
  v_cvt_pk_bf16_f32 v99, v102, v103
  v_mfma_f32_16x16x32_bf16 a[172:175], v[44:47], v[80:83], a[172:175]
  v_exp_f32 v104, v104
  v_mfma_f32_16x16x32_bf16 a[236:239], v[44:47], v[88:91], a[236:239]
  v_dot2c_f32_bf16 v4, s66, v99
  s_waitcnt lgkmcnt(4)
  v_mfma_f32_16x16x32_bf16 a[48:51], v[48:51], v[64:67], a[48:51]
  ds_read_b128 v[32:35], v1 offset:50688
  v_mfma_f32_16x16x32_bf16 a[112:115], v[48:51], v[72:75], a[112:115]
  v_exp_f32 v105, v105
  v_mfma_f32_16x16x32_bf16 a[176:179], v[48:51], v[80:83], a[176:179]
  ds_read_b128 v[36:39], v1 offset:50752
  v_cvt_pk_bf16_f32 v104, v104, v105
  v_mfma_f32_16x16x32_bf16 a[240:243], v[48:51], v[88:91], a[240:243]
  v_exp_f32 v106, v106
  v_mfma_f32_16x16x32_bf16 a[52:55], v[52:55], v[64:67], a[52:55]
  ds_read_b128 v[40:43], v1 offset:50944
  v_dot2c_f32_bf16 v5, s66, v104
  v_mfma_f32_16x16x32_bf16 a[116:119], v[52:55], v[72:75], a[116:119]
  s_add_u32 m0, s31, 35840
  v_mfma_f32_16x16x32_bf16 a[180:183], v[52:55], v[80:83], a[180:183]
  ds_read_b128 v[44:47], v1 offset:51008
  buffer_load_dwordx4 v8, s[16:19], s61 offen offset:0 nt lds
  v_mfma_f32_16x16x32_bf16 a[244:247], v[52:55], v[88:91], a[244:247]
  s_waitcnt lgkmcnt(4)
  v_mfma_f32_16x16x32_bf16 a[56:59], v[56:59], v[64:67], a[56:59]
  v_exp_f32 v107, v107
  v_mfma_f32_16x16x32_bf16 a[120:123], v[56:59], v[72:75], a[120:123]
  v_exp_f32 v108, v108
  v_mfma_f32_16x16x32_bf16 a[184:187], v[56:59], v[80:83], a[184:187]
  v_exp_f32 v109, v109
  v_mfma_f32_16x16x32_bf16 a[248:251], v[56:59], v[88:91], a[248:251]
  v_cvt_pk_bf16_f32 v105, v106, v107
  v_dot2c_f32_bf16 v5, s66, v105
  v_mfma_f32_16x16x32_bf16 a[60:63], v[60:63], v[64:67], a[60:63]
  v_exp_f32 v110, v110
  v_mfma_f32_16x16x32_bf16 a[124:127], v[60:63], v[72:75], a[124:127]
  v_cvt_pk_bf16_f32 v106, v108, v109
  v_dot2c_f32_bf16 v5, s66, v106
  v_mfma_f32_16x16x32_bf16 a[188:191], v[60:63], v[80:83], a[188:191]
  v_mfma_f32_16x16x32_bf16 a[252:255], v[60:63], v[88:91], a[252:255]
  s_cbranch_vccnz RB_L3
RBr_L3:
  s_waitcnt lgkmcnt(0)
  v_mfma_f32_16x16x32_bf16 v[64:67], v[32:35], v[128:131], v[16:19]
  ds_read_b128 v[48:51], v1 offset:51200
  v_mfma_f32_16x16x32_bf16 v[64:67], v[36:39], v[132:135], v[64:67]
  v_exp_f32 v111, v111
  v_mfma_f32_16x16x32_bf16 v[64:67], v[40:43], v[136:139], v[64:67]
  ds_read_b128 v[52:55], v1 offset:51264
  s_add_u32 m0, s31, 35872
  v_mfma_f32_16x16x32_bf16 v[64:67], v[44:47], v[140:143], v[64:67]
  buffer_load_dwordx4 v8, s[16:19], s61 offen offset:1024 nt lds
  v_cvt_pk_bf16_f32 v107, v110, v111
  v_mfma_f32_16x16x32_bf16 v[72:75], v[32:35], v[160:163], v[20:23]
  ds_read_b128 v[56:59], v1 offset:51456
  v_dot2c_f32_bf16 v5, s66, v107
  v_mfma_f32_16x16x32_bf16 v[72:75], v[36:39], v[164:167], v[72:75]
  v_exp_f32 v112, v112
  v_mfma_f32_16x16x32_bf16 v[72:75], v[40:43], v[168:171], v[72:75]
  ds_read_b128 v[60:63], v1 offset:51520
  v_mfma_f32_16x16x32_bf16 v[72:75], v[44:47], v[172:175], v[72:75]
  v_exp_f32 v113, v113
  v_mfma_f32_16x16x32_bf16 v[80:83], v[32:35], v[192:195], v[24:27]
  v_exp_f32 v114, v114
  v_mfma_f32_16x16x32_bf16 v[80:83], v[36:39], v[196:199], v[80:83]
  v_cvt_pk_bf16_f32 v112, v112, v113
  v_dot2c_f32_bf16 v6, s66, v112
  v_mfma_f32_16x16x32_bf16 v[80:83], v[40:43], v[200:203], v[80:83]
  v_mfma_f32_16x16x32_bf16 v[80:83], v[44:47], v[204:207], v[80:83]
  v_exp_f32 v115, v115
  v_mfma_f32_16x16x32_bf16 v[88:91], v[32:35], v[224:227], v[28:31]
  v_cvt_pk_bf16_f32 v113, v114, v115
  v_dot2c_f32_bf16 v6, s66, v113
  v_mfma_f32_16x16x32_bf16 v[88:91], v[36:39], v[228:231], v[88:91]
  v_mfma_f32_16x16x32_bf16 v[88:91], v[40:43], v[232:235], v[88:91]
  v_exp_f32 v116, v116
  v_mfma_f32_16x16x32_bf16 v[88:91], v[44:47], v[236:239], v[88:91]
  s_waitcnt lgkmcnt(0)
  v_mfma_f32_16x16x32_bf16 v[64:67], v[48:51], v[144:147], v[64:67]
  ds_read_b128 v[32:35], v1 offset:59136
  s_add_u32 m0, s31, 35904
  v_mfma_f32_16x16x32_bf16 v[64:67], v[52:55], v[148:151], v[64:67]
  buffer_load_dwordx4 v8, s[16:19], s61 offen offset:2048 nt lds
  v_mfma_f32_16x16x32_bf16 v[64:67], v[56:59], v[152:155], v[64:67]
  ds_read_b128 v[36:39], v1 offset:59200
  v_mfma_f32_16x16x32_bf16 v[64:67], v[60:63], v[156:159], v[64:67]
  v_exp_f32 v117, v117
  v_mfma_f32_16x16x32_bf16 v[72:75], v[48:51], v[176:179], v[72:75]
  ds_read_b128 v[40:43], v1 offset:59392
  v_cvt_pk_bf16_f32 v114, v116, v117
  v_mfma_f32_16x16x32_bf16 v[72:75], v[52:55], v[180:183], v[72:75]
  v_exp_f32 v118, v118
  v_mfma_f32_16x16x32_bf16 v[72:75], v[56:59], v[184:187], v[72:75]
  ds_read_b128 v[44:47], v1 offset:59456
  v_dot2c_f32_bf16 v6, s66, v114
  v_mfma_f32_16x16x32_bf16 v[72:75], v[60:63], v[188:191], v[72:75]
  v_mfma_f32_16x16x32_bf16 v[80:83], v[48:51], v[208:211], v[80:83]
  v_exp_f32 v119, v119
  v_mfma_f32_16x16x32_bf16 v[80:83], v[52:55], v[212:215], v[80:83]
  v_cvt_pk_bf16_f32 v115, v118, v119
  v_dot2c_f32_bf16 v6, s66, v115
  v_mfma_f32_16x16x32_bf16 v[80:83], v[56:59], v[216:219], v[80:83]
  v_mfma_f32_16x16x32_bf16 v[80:83], v[60:63], v[220:223], v[80:83]
  v_exp_f32 v120, v120
  v_mfma_f32_16x16x32_bf16 v[88:91], v[48:51], v[240:243], v[88:91]
  v_mfma_f32_16x16x32_bf16 v[88:91], v[52:55], v[244:247], v[88:91]
  s_add_u32 m0, s31, 35936
  v_mfma_f32_16x16x32_bf16 v[88:91], v[56:59], v[248:251], v[88:91]
  buffer_load_dwordx4 v8, s[16:19], s61 offen offset:3072 nt lds
  v_mfma_f32_16x16x32_bf16 v[88:91], v[60:63], v[252:255], v[88:91]
  s_waitcnt lgkmcnt(0)
  v_mfma_f32_16x16x32_bf16 v[68:71], v[32:35], v[128:131], v[16:19]
  ds_read_b128 v[48:51], v1 offset:59648
  v_mfma_f32_16x16x32_bf16 v[68:71], v[36:39], v[132:135], v[68:71]
  v_exp_f32 v121, v121
  v_mfma_f32_16x16x32_bf16 v[68:71], v[40:43], v[136:139], v[68:71]
  ds_read_b128 v[52:55], v1 offset:59712
  v_cvt_pk_bf16_f32 v120, v120, v121
  v_mfma_f32_16x16x32_bf16 v[68:71], v[44:47], v[140:143], v[68:71]
  v_exp_f32 v122, v122
  v_mfma_f32_16x16x32_bf16 v[76:79], v[32:35], v[160:163], v[20:23]
  ds_read_b128 v[56:59], v1 offset:59904
  v_dot2c_f32_bf16 v7, s66, v120
  v_mfma_f32_16x16x32_bf16 v[76:79], v[36:39], v[164:167], v[76:79]
  v_exp_f32 v123, v123
  v_mfma_f32_16x16x32_bf16 v[76:79], v[40:43], v[168:171], v[76:79]
  ds_read_b128 v[60:63], v1 offset:59968
  v_cvt_pk_bf16_f32 v121, v122, v123
  v_mfma_f32_16x16x32_bf16 v[76:79], v[44:47], v[172:175], v[76:79]
  v_exp_f32 v124, v124
  v_mfma_f32_16x16x32_bf16 v[84:87], v[32:35], v[192:195], v[24:27]
  v_dot2c_f32_bf16 v7, s66, v121
  v_mfma_f32_16x16x32_bf16 v[84:87], v[36:39], v[196:199], v[84:87]
  v_mfma_f32_16x16x32_bf16 v[84:87], v[40:43], v[200:203], v[84:87]
  v_exp_f32 v125, v125
  v_mfma_f32_16x16x32_bf16 v[84:87], v[44:47], v[204:207], v[84:87]
  v_cvt_pk_bf16_f32 v122, v124, v125
  v_dot2c_f32_bf16 v7, s66, v122
  v_mfma_f32_16x16x32_bf16 v[92:95], v[32:35], v[224:227], v[28:31]
  v_mfma_f32_16x16x32_bf16 v[92:95], v[36:39], v[228:231], v[92:95]
  s_waitcnt vmcnt(12)
  v_mfma_f32_16x16x32_bf16 v[92:95], v[40:43], v[232:235], v[92:95]
  s_barrier
  v_mfma_f32_16x16x32_bf16 v[92:95], v[44:47], v[236:239], v[92:95]
  s_waitcnt lgkmcnt(0)
  v_mfma_f32_16x16x32_bf16 v[68:71], v[48:51], v[144:147], v[68:71]
  ds_read_b64_tr_b16 v[32:33], v2 offset:0
  v_mfma_f32_16x16x32_bf16 v[68:71], v[52:55], v[148:151], v[68:71]
  ds_read_b64_tr_b16 v[34:35], v2 offset:8448
  v_mfma_f32_16x16x32_bf16 v[68:71], v[56:59], v[152:155], v[68:71]
  v_exp_f32 v126, v126
  v_mfma_f32_16x16x32_bf16 v[68:71], v[60:63], v[156:159], v[68:71]
  ds_read_b64_tr_b16 v[36:37], v2 offset:32
  v_mfma_f32_16x16x32_bf16 v[76:79], v[48:51], v[176:179], v[76:79]
  ds_read_b64_tr_b16 v[38:39], v2 offset:8480
  v_mfma_f32_16x16x32_bf16 v[76:79], v[52:55], v[180:183], v[76:79]
  v_exp_f32 v127, v127
  v_mfma_f32_16x16x32_bf16 v[76:79], v[56:59], v[184:187], v[76:79]
  ds_read_b64_tr_b16 v[40:41], v2 offset:64
  v_cvt_pk_bf16_f32 v123, v126, v127
  v_mfma_f32_16x16x32_bf16 v[76:79], v[60:63], v[188:191], v[76:79]
  ds_read_b64_tr_b16 v[42:43], v2 offset:8512
  v_dot2c_f32_bf16 v7, s66, v123
  v_mfma_f32_16x16x32_bf16 v[84:87], v[48:51], v[208:211], v[84:87]
  v_mfma_f32_16x16x32_bf16 v[84:87], v[52:55], v[212:215], v[84:87]
  ds_read_b64_tr_b16 v[44:45], v2 offset:96
  v_mfma_f32_16x16x32_bf16 v[84:87], v[56:59], v[216:219], v[84:87]
  ds_read_b64_tr_b16 v[46:47], v2 offset:8544
  v_mfma_f32_16x16x32_bf16 v[84:87], v[60:63], v[220:223], v[84:87]
  v_mfma_f32_16x16x32_bf16 v[92:95], v[48:51], v[240:243], v[92:95]
  v_mfma_f32_16x16x32_bf16 v[92:95], v[52:55], v[244:247], v[92:95]
  v_mfma_f32_16x16x32_bf16 v[92:95], v[56:59], v[248:251], v[92:95]
  v_mfma_f32_16x16x32_bf16 v[92:95], v[60:63], v[252:255], v[92:95]
  s_add_u32 s65, s65, 1
  s_cmp_lt_u32 s65, 7
  s_cbranch_scc1 L_loop
  s_waitcnt lgkmcnt(4)
  v_mov_b32 v3, v0
  v_mfma_f32_16x16x32_bf16 a[0:3], v[32:35], v[96:99], a[0:3]
  ds_read_b64_tr_b16 v[48:49], v2 offset:256
  s_add_u32 s63, s64, 0
  v_mfma_f32_16x16x32_bf16 a[64:67], v[32:35], v[104:107], a[64:67]
  ds_read_b64_tr_b16 v[50:51], v2 offset:8704
  s_add_u32 m0, s31, 103424
  v_mfma_f32_16x16x32_bf16 a[128:131], v[32:35], v[112:115], a[128:131]
  buffer_load_dwordx4 v3, s[20:23], s63 offen offset:0  lds
  v_max_f32 v9, v64, v65
  v_mfma_f32_16x16x32_bf16 a[192:195], v[32:35], v[120:123], a[192:195]
  v_max3_f32 v9, v66, v67, v9
  v_max3_f32 v9, v72, v73, v9
  v_mfma_f32_16x16x32_bf16 a[4:7], v[36:39], v[96:99], a[4:7]
  ds_read_b64_tr_b16 v[52:53], v2 offset:288
  v_max3_f32 v9, v74, v75, v9
  v_mfma_f32_16x16x32_bf16 a[68:71], v[36:39], v[104:107], a[68:71]
  ds_read_b64_tr_b16 v[54:55], v2 offset:8736
  s_add_u32 m0, s31, 102688
  v_mfma_f32_16x16x32_bf16 a[132:135], v[36:39], v[112:115], a[132:135]
  buffer_load_dwordx4 v3, s[20:23], s63 offen offset:1792  lds
  v_max3_f32 v9, v80, v81, v9
  v_mfma_f32_16x16x32_bf16 a[196:199], v[36:39], v[120:123], a[196:199]
  v_max3_f32 v9, v82, v83, v9
  s_waitcnt lgkmcnt(4)
  v_mfma_f32_16x16x32_bf16 a[8:11], v[40:43], v[96:99], a[8:11]
  ds_read_b64_tr_b16 v[56:57], v2 offset:320
  v_max3_f32 v9, v88, v89, v9
  v_mfma_f32_16x16x32_bf16 a[72:75], v[40:43], v[104:107], a[72:75]
  ds_read_b64_tr_b16 v[58:59], v2 offset:8768
  v_max3_f32 v9, v90, v91, v9
  v_mfma_f32_16x16x32_bf16 a[136:139], v[40:43], v[112:115], a[136:139]
  s_add_u32 m0, s31, 101952
  v_max3_f32 v9, v68, v69, v9
  v_mfma_f32_16x16x32_bf16 a[200:203], v[40:43], v[120:123], a[200:203]
  buffer_load_dwordx4 v3, s[20:23], s63 offen offset:3584  lds
  v_max3_f32 v9, v70, v71, v9
  v_mfma_f32_16x16x32_bf16 a[12:15], v[44:47], v[96:99], a[12:15]
  ds_read_b64_tr_b16 v[60:61], v2 offset:352
  v_max3_f32 v9, v76, v77, v9
  v_mfma_f32_16x16x32_bf16 a[76:79], v[44:47], v[104:107], a[76:79]
  ds_read_b64_tr_b16 v[62:63], v2 offset:8800
  v_max3_f32 v9, v78, v79, v9
  v_mfma_f32_16x16x32_bf16 a[140:143], v[44:47], v[112:115], a[140:143]
  v_max3_f32 v9, v84, v85, v9
  v_max3_f32 v9, v86, v87, v9
  v_mfma_f32_16x16x32_bf16 a[204:207], v[44:47], v[120:123], a[204:207]
  s_add_u32 s63, s63, 1792
  s_waitcnt lgkmcnt(4)
  v_mfma_f32_16x16x32_bf16 a[16:19], v[48:51], v[96:99], a[16:19]
  ds_read_b64_tr_b16 v[32:33], v2 offset:512
  s_add_u32 m0, s31, 103008
  v_mfma_f32_16x16x32_bf16 a[80:83], v[48:51], v[104:107], a[80:83]
  ds_read_b64_tr_b16 v[34:35], v2 offset:8960
  buffer_load_dwordx4 v3, s[20:23], s63 offen offset:3584  lds
  v_mfma_f32_16x16x32_bf16 a[144:147], v[48:51], v[112:115], a[144:147]
  v_max3_f32 v9, v92, v93, v9
  v_max3_f32 v9, v94, v95, v9
  v_mfma_f32_16x16x32_bf16 a[208:211], v[48:51], v[120:123], a[208:211]
  v_cmp_lt_f32 vcc, s59, v9
  s_cbranch_vccnz RA_S30
RAr_S30:
  v_mfma_f32_16x16x32_bf16 a[20:23], v[52:55], v[96:99], a[20:23]
  ds_read_b64_tr_b16 v[36:37], v2 offset:544
  s_add_u32 s63, s64, 114688
  v_mfma_f32_16x16x32_bf16 a[84:87], v[52:55], v[104:107], a[84:87]
  ds_read_b64_tr_b16 v[38:39], v2 offset:8992
  s_add_u32 m0, s31, 52736
  v_mfma_f32_16x16x32_bf16 a[148:151], v[52:55], v[112:115], a[148:151]
  buffer_load_dwordx4 v3, s[20:23], s63 offen offset:0  lds
  v_mfma_f32_16x16x32_bf16 a[212:215], v[52:55], v[120:123], a[212:215]
  s_waitcnt lgkmcnt(4)
  v_mfma_f32_16x16x32_bf16 a[24:27], v[56:59], v[96:99], a[24:27]
  ds_read_b64_tr_b16 v[40:41], v2 offset:576
  v_mfma_f32_16x16x32_bf16 a[88:91], v[56:59], v[104:107], a[88:91]
  ds_read_b64_tr_b16 v[42:43], v2 offset:9024
  s_add_u32 m0, s31, 52000
  v_mfma_f32_16x16x32_bf16 a[152:155], v[56:59], v[112:115], a[152:155]
  buffer_load_dwordx4 v3, s[20:23], s63 offen offset:1792  lds
  v_mfma_f32_16x16x32_bf16 a[216:219], v[56:59], v[120:123], a[216:219]
  v_exp_f32 v64, v64
  v_mfma_f32_16x16x32_bf16 a[28:31], v[60:63], v[96:99], a[28:31]
  ds_read_b64_tr_b16 v[44:45], v2 offset:608
  v_add_f32 v4, v4, v64
  v_mfma_f32_16x16x32_bf16 a[92:95], v[60:63], v[104:107], a[92:95]
  ds_read_b64_tr_b16 v[46:47], v2 offset:9056
  v_mfma_f32_16x16x32_bf16 a[156:159], v[60:63], v[112:115], a[156:159]
  s_add_u32 m0, s31, 51264
  v_mfma_f32_16x16x32_bf16 a[220:223], v[60:63], v[120:123], a[220:223]
  buffer_load_dwordx4 v3, s[20:23], s63 offen offset:3584  lds
  s_waitcnt lgkmcnt(4)
  v_mfma_f32_16x16x32_bf16 a[32:35], v[32:35], v[96:99], a[32:35]
  ds_read_b64_tr_b16 v[48:49], v2 offset:768
  v_mfma_f32_16x16x32_bf16 a[96:99], v[32:35], v[104:107], a[96:99]
  ds_read_b64_tr_b16 v[50:51], v2 offset:9216
  v_mfma_f32_16x16x32_bf16 a[160:163], v[32:35], v[112:115], a[160:163]
  v_exp_f32 v65, v65
  v_mfma_f32_16x16x32_bf16 a[224:227], v[32:35], v[120:123], a[224:227]
  s_add_u32 s63, s63, 1792
  s_add_u32 m0, s31, 52320
  v_mfma_f32_16x16x32_bf16 a[36:39], v[36:39], v[96:99], a[36:39]
  ds_read_b64_tr_b16 v[52:53], v2 offset:800
  buffer_load_dwordx4 v3, s[20:23], s63 offen offset:3584  lds
  v_mfma_f32_16x16x32_bf16 a[100:103], v[36:39], v[104:107], a[100:103]
  ds_read_b64_tr_b16 v[54:55], v2 offset:9248
  v_mbcnt_lo_u32_b32 v14, -1, 0
  v_mfma_f32_16x16x32_bf16 a[164:167], v[36:39], v[112:115], a[164:167]
  v_mbcnt_hi_u32_b32 v14, -1, v14
  v_lshlrev_b32 v14, 7, v14
  v_mfma_f32_16x16x32_bf16 a[228:231], v[36:39], v[120:123], a[228:231]
  buffer_load_dword v0, v14, s[20:23], s38 offen
  s_waitcnt lgkmcnt(4)
  v_mfma_f32_16x16x32_bf16 a[40:43], v[40:43], v[96:99], a[40:43]
  ds_read_b64_tr_b16 v[56:57], v2 offset:832
  v_add_u32 v14, 67584, v2
  v_mfma_f32_16x16x32_bf16 a[104:107], v[40:43], v[104:107], a[104:107]
  ds_read_b64_tr_b16 v[58:59], v2 offset:9280
  v_add_f32 v4, v4, v65
  v_mfma_f32_16x16x32_bf16 a[168:171], v[40:43], v[112:115], a[168:171]
  v_exp_f32 v66, v66
  v_mfma_f32_16x16x32_bf16 a[232:235], v[40:43], v[120:123], a[232:235]
  v_exp_f32 v67, v67
  v_mfma_f32_16x16x32_bf16 a[44:47], v[44:47], v[96:99], a[44:47]
  ds_read_b64_tr_b16 v[60:61], v2 offset:864
  v_cvt_pk_bf16_f32 v64, v64, v65
  v_mfma_f32_16x16x32_bf16 a[108:111], v[44:47], v[104:107], a[108:111]
  ds_read_b64_tr_b16 v[62:63], v2 offset:9312
  v_add_f32 v4, v4, v66
  v_mfma_f32_16x16x32_bf16 a[172:175], v[44:47], v[112:115], a[172:175]
  v_exp_f32 v68, v68
  v_mfma_f32_16x16x32_bf16 a[236:239], v[44:47], v[120:123], a[236:239]
  v_add_f32 v4, v4, v67
  s_waitcnt lgkmcnt(4)
  v_mfma_f32_16x16x32_bf16 a[48:51], v[48:51], v[96:99], a[48:51]
  ds_read_b128 v[32:35], v1 offset:0
  v_cvt_pk_bf16_f32 v65, v66, v67
  v_mfma_f32_16x16x32_bf16 a[112:115], v[48:51], v[104:107], a[112:115]
  v_exp_f32 v69, v69
  v_mfma_f32_16x16x32_bf16 a[176:179], v[48:51], v[112:115], a[176:179]
  ds_read_b128 v[36:39], v1 offset:64
  v_add_f32 v4, v4, v68
  v_mfma_f32_16x16x32_bf16 a[240:243], v[48:51], v[120:123], a[240:243]
  v_exp_f32 v70, v70
  v_mfma_f32_16x16x32_bf16 a[52:55], v[52:55], v[96:99], a[52:55]
  ds_read_b128 v[40:43], v1 offset:256
  v_add_f32 v4, v4, v69
  v_mfma_f32_16x16x32_bf16 a[116:119], v[52:55], v[104:107], a[116:119]
  v_exp_f32 v71, v71
  v_mfma_f32_16x16x32_bf16 a[180:183], v[52:55], v[112:115], a[180:183]
  ds_read_b128 v[44:47], v1 offset:320
  v_cvt_pk_bf16_f32 v66, v68, v69
  v_mfma_f32_16x16x32_bf16 a[244:247], v[52:55], v[120:123], a[244:247]
  v_add_f32 v4, v4, v70
  s_waitcnt lgkmcnt(4)
  v_mfma_f32_16x16x32_bf16 a[56:59], v[56:59], v[96:99], a[56:59]
  v_exp_f32 v72, v72
  v_mfma_f32_16x16x32_bf16 a[120:123], v[56:59], v[104:107], a[120:123]
  v_exp_f32 v73, v73
  v_mfma_f32_16x16x32_bf16 a[184:187], v[56:59], v[112:115], a[184:187]
  v_add_f32 v4, v4, v71
  v_cvt_pk_bf16_f32 v67, v70, v71
  v_mfma_f32_16x16x32_bf16 a[248:251], v[56:59], v[120:123], a[248:251]
  v_exp_f32 v74, v74
  v_mfma_f32_16x16x32_bf16 a[60:63], v[60:63], v[96:99], a[60:63]
  v_add_f32 v5, v5, v72
  v_add_f32 v5, v5, v73
  v_mfma_f32_16x16x32_bf16 a[124:127], v[60:63], v[104:107], a[124:127]
  v_exp_f32 v75, v75
  v_mfma_f32_16x16x32_bf16 a[188:191], v[60:63], v[112:115], a[188:191]
  v_cvt_pk_bf16_f32 v72, v72, v73
  v_add_f32 v5, v5, v74
  v_mfma_f32_16x16x32_bf16 a[252:255], v[60:63], v[120:123], a[252:255]
  s_cbranch_vccnz RB_S30
RBr_S30:
  s_waitcnt lgkmcnt(0)
  v_mfma_f32_16x16x32_bf16 v[96:99], v[32:35], v[128:131], v[16:19]
  ds_read_b128 v[48:51], v1 offset:512
  v_add_f32 v5, v5, v75
  v_mfma_f32_16x16x32_bf16 v[96:99], v[36:39], v[132:135], v[96:99]
  v_exp_f32 v76, v76
  v_mfma_f32_16x16x32_bf16 v[96:99], v[40:43], v[136:139], v[96:99]
  ds_read_b128 v[52:55], v1 offset:576
  v_cvt_pk_bf16_f32 v73, v74, v75
  v_mfma_f32_16x16x32_bf16 v[96:99], v[44:47], v[140:143], v[96:99]
  v_exp_f32 v77, v77
  v_mfma_f32_16x16x32_bf16 v[104:107], v[32:35], v[160:163], v[20:23]
  ds_read_b128 v[56:59], v1 offset:768
  v_add_f32 v5, v5, v76
  v_mfma_f32_16x16x32_bf16 v[104:107], v[36:39], v[164:167], v[104:107]
  v_exp_f32 v78, v78
  v_mfma_f32_16x16x32_bf16 v[104:107], v[40:43], v[168:171], v[104:107]
  ds_read_b128 v[60:63], v1 offset:832
  v_add_f32 v5, v5, v77
  v_mfma_f32_16x16x32_bf16 v[104:107], v[44:47], v[172:175], v[104:107]
  v_exp_f32 v79, v79
  v_mfma_f32_16x16x32_bf16 v[112:115], v[32:35], v[192:195], v[24:27]
  v_cvt_pk_bf16_f32 v74, v76, v77
  v_add_f32 v5, v5, v78
  v_mfma_f32_16x16x32_bf16 v[112:115], v[36:39], v[196:199], v[112:115]
  v_exp_f32 v80, v80
  v_mfma_f32_16x16x32_bf16 v[112:115], v[40:43], v[200:203], v[112:115]
  v_exp_f32 v81, v81
  v_mfma_f32_16x16x32_bf16 v[112:115], v[44:47], v[204:207], v[112:115]
  v_add_f32 v5, v5, v79
  v_cvt_pk_bf16_f32 v75, v78, v79
  v_mfma_f32_16x16x32_bf16 v[120:123], v[32:35], v[224:227], v[28:31]
  v_exp_f32 v82, v82
  v_mfma_f32_16x16x32_bf16 v[120:123], v[36:39], v[228:231], v[120:123]
  v_add_f32 v6, v6, v80
  v_add_f32 v6, v6, v81
  v_mfma_f32_16x16x32_bf16 v[120:123], v[40:43], v[232:235], v[120:123]
  v_exp_f32 v83, v83
  v_mfma_f32_16x16x32_bf16 v[120:123], v[44:47], v[236:239], v[120:123]
  v_cvt_pk_bf16_f32 v80, v80, v81
  s_waitcnt lgkmcnt(0)
  v_mfma_f32_16x16x32_bf16 v[96:99], v[48:51], v[144:147], v[96:99]
  ds_read_b128 v[32:35], v1 offset:8448
  v_add_f32 v6, v6, v82
  v_mfma_f32_16x16x32_bf16 v[96:99], v[52:55], v[148:151], v[96:99]
  v_exp_f32 v84, v84
  v_mfma_f32_16x16x32_bf16 v[96:99], v[56:59], v[152:155], v[96:99]
  ds_read_b128 v[36:39], v1 offset:8512
  v_add_f32 v6, v6, v83
  v_mfma_f32_16x16x32_bf16 v[96:99], v[60:63], v[156:159], v[96:99]
  v_exp_f32 v85, v85
  v_mfma_f32_16x16x32_bf16 v[104:107], v[48:51], v[176:179], v[104:107]
  ds_read_b128 v[40:43], v1 offset:8704
  v_cvt_pk_bf16_f32 v81, v82, v83
  v_mfma_f32_16x16x32_bf16 v[104:107], v[52:55], v[180:183], v[104:107]
  v_exp_f32 v86, v86
  v_mfma_f32_16x16x32_bf16 v[104:107], v[56:59], v[184:187], v[104:107]
  ds_read_b128 v[44:47], v1 offset:8768
  v_add_f32 v6, v6, v84
  v_mfma_f32_16x16x32_bf16 v[104:107], v[60:63], v[188:191], v[104:107]
  v_exp_f32 v87, v87
  v_mfma_f32_16x16x32_bf16 v[112:115], v[48:51], v[208:211], v[112:115]
  v_add_f32 v6, v6, v85
  v_cvt_pk_bf16_f32 v82, v84, v85
  v_mfma_f32_16x16x32_bf16 v[112:115], v[52:55], v[212:215], v[112:115]
  v_exp_f32 v88, v88
  v_mfma_f32_16x16x32_bf16 v[112:115], v[56:59], v[216:219], v[112:115]
  v_add_f32 v6, v6, v86
  v_add_f32 v6, v6, v87
  v_mfma_f32_16x16x32_bf16 v[112:115], v[60:63], v[220:223], v[112:115]
  v_exp_f32 v89, v89
  v_mfma_f32_16x16x32_bf16 v[120:123], v[48:51], v[240:243], v[120:123]
  v_cvt_pk_bf16_f32 v83, v86, v87
  v_add_f32 v7, v7, v88
  v_mfma_f32_16x16x32_bf16 v[120:123], v[52:55], v[244:247], v[120:123]
  v_exp_f32 v90, v90
  v_mfma_f32_16x16x32_bf16 v[120:123], v[56:59], v[248:251], v[120:123]
  v_exp_f32 v91, v91
  v_mfma_f32_16x16x32_bf16 v[120:123], v[60:63], v[252:255], v[120:123]
  v_add_f32 v7, v7, v89
  s_waitcnt lgkmcnt(0)
  v_mfma_f32_16x16x32_bf16 v[100:103], v[32:35], v[128:131], v[16:19]
  ds_read_b128 v[48:51], v1 offset:8960
  v_cvt_pk_bf16_f32 v88, v88, v89
  v_mfma_f32_16x16x32_bf16 v[100:103], v[36:39], v[132:135], v[100:103]
  v_exp_f32 v92, v92
  v_mfma_f32_16x16x32_bf16 v[100:103], v[40:43], v[136:139], v[100:103]
  ds_read_b128 v[52:55], v1 offset:9024
  v_add_f32 v7, v7, v90
  v_mfma_f32_16x16x32_bf16 v[100:103], v[44:47], v[140:143], v[100:103]
  v_exp_f32 v93, v93
  v_mfma_f32_16x16x32_bf16 v[108:111], v[32:35], v[160:163], v[20:23]
  ds_read_b128 v[56:59], v1 offset:9216
  v_add_f32 v7, v7, v91
  v_mfma_f32_16x16x32_bf16 v[108:111], v[36:39], v[164:167], v[108:111]
  v_cvt_pk_bf16_f32 v89, v90, v91
  v_add_f32 v7, v7, v92
  v_mfma_f32_16x16x32_bf16 v[108:111], v[40:43], v[168:171], v[108:111]
  ds_read_b128 v[60:63], v1 offset:9280
  v_add_f32 v7, v7, v93
  v_mfma_f32_16x16x32_bf16 v[108:111], v[44:47], v[172:175], v[108:111]
  v_exp_f32 v94, v94
  v_mfma_f32_16x16x32_bf16 v[116:119], v[32:35], v[192:195], v[24:27]
  v_exp_f32 v95, v95
  v_mfma_f32_16x16x32_bf16 v[116:119], v[36:39], v[196:199], v[116:119]
  v_cvt_pk_bf16_f32 v90, v92, v93
  v_add_f32 v7, v7, v94
  v_mfma_f32_16x16x32_bf16 v[116:119], v[40:43], v[200:203], v[116:119]
  v_add_f32 v7, v7, v95
  v_cvt_pk_bf16_f32 v91, v94, v95
  v_mfma_f32_16x16x32_bf16 v[116:119], v[44:47], v[204:207], v[116:119]
  v_mfma_f32_16x16x32_bf16 v[124:127], v[32:35], v[224:227], v[28:31]
  v_mfma_f32_16x16x32_bf16 v[124:127], v[36:39], v[228:231], v[124:127]
  s_waitcnt vmcnt(13)
  v_mfma_f32_16x16x32_bf16 v[124:127], v[40:43], v[232:235], v[124:127]
  s_barrier
  v_mfma_f32_16x16x32_bf16 v[124:127], v[44:47], v[236:239], v[124:127]
  s_waitcnt lgkmcnt(0)
  v_mfma_f32_16x16x32_bf16 v[100:103], v[48:51], v[144:147], v[100:103]
  ds_read_b64_tr_b16 v[32:33], v2 offset:16896
  v_mfma_f32_16x16x32_bf16 v[100:103], v[52:55], v[148:151], v[100:103]
  ds_read_b64_tr_b16 v[34:35], v2 offset:25344
  v_mfma_f32_16x16x32_bf16 v[100:103], v[56:59], v[152:155], v[100:103]
  v_mfma_f32_16x16x32_bf16 v[100:103], v[60:63], v[156:159], v[100:103]
  ds_read_b64_tr_b16 v[36:37], v2 offset:16928
  v_mfma_f32_16x16x32_bf16 v[108:111], v[48:51], v[176:179], v[108:111]
  ds_read_b64_tr_b16 v[38:39], v2 offset:25376
  v_mfma_f32_16x16x32_bf16 v[108:111], v[52:55], v[180:183], v[108:111]
  v_mfma_f32_16x16x32_bf16 v[108:111], v[56:59], v[184:187], v[108:111]
  ds_read_b64_tr_b16 v[40:41], v2 offset:16960
  v_mfma_f32_16x16x32_bf16 v[108:111], v[60:63], v[188:191], v[108:111]
  ds_read_b64_tr_b16 v[42:43], v2 offset:25408
  v_mfma_f32_16x16x32_bf16 v[116:119], v[48:51], v[208:211], v[116:119]
  v_mfma_f32_16x16x32_bf16 v[116:119], v[52:55], v[212:215], v[116:119]
  ds_read_b64_tr_b16 v[44:45], v2 offset:16992
  v_mfma_f32_16x16x32_bf16 v[116:119], v[56:59], v[216:219], v[116:119]
  ds_read_b64_tr_b16 v[46:47], v2 offset:25440
  v_mfma_f32_16x16x32_bf16 v[116:119], v[60:63], v[220:223], v[116:119]
  v_mfma_f32_16x16x32_bf16 v[124:127], v[48:51], v[240:243], v[124:127]
  v_mfma_f32_16x16x32_bf16 v[124:127], v[52:55], v[244:247], v[124:127]
  v_mfma_f32_16x16x32_bf16 v[124:127], v[56:59], v[248:251], v[124:127]
  v_mfma_f32_16x16x32_bf16 v[124:127], v[60:63], v[252:255], v[124:127]
  s_waitcnt lgkmcnt(4)
  v_mfma_f32_16x16x32_bf16 a[0:3], v[32:35], v[64:67], a[0:3]
  ds_read_b64_tr_b16 v[48:49], v2 offset:17152
  s_add_u32 s63, s64, 229376
  v_mfma_f32_16x16x32_bf16 a[64:67], v[32:35], v[72:75], a[64:67]
  ds_read_b64_tr_b16 v[50:51], v2 offset:25600
  s_add_u32 m0, s31, 120320
  v_mfma_f32_16x16x32_bf16 a[128:131], v[32:35], v[80:83], a[128:131]
  buffer_load_dwordx4 v3, s[20:23], s63 offen offset:0  lds
  v_max_f32 v9, v96, v97
  v_mfma_f32_16x16x32_bf16 a[192:195], v[32:35], v[88:91], a[192:195]
  v_max3_f32 v9, v98, v99, v9
  v_max3_f32 v9, v104, v105, v9
  v_mfma_f32_16x16x32_bf16 a[4:7], v[36:39], v[64:67], a[4:7]
  ds_read_b64_tr_b16 v[52:53], v2 offset:17184
  v_max3_f32 v9, v106, v107, v9
  v_mfma_f32_16x16x32_bf16 a[68:71], v[36:39], v[72:75], a[68:71]
  ds_read_b64_tr_b16 v[54:55], v2 offset:25632
  s_add_u32 m0, s31, 119584
  v_mfma_f32_16x16x32_bf16 a[132:135], v[36:39], v[80:83], a[132:135]
  buffer_load_dwordx4 v3, s[20:23], s63 offen offset:1792  lds
  v_max3_f32 v9, v112, v113, v9
  v_mfma_f32_16x16x32_bf16 a[196:199], v[36:39], v[88:91], a[196:199]
  v_max3_f32 v9, v114, v115, v9
  s_waitcnt lgkmcnt(4)
  v_mfma_f32_16x16x32_bf16 a[8:11], v[40:43], v[64:67], a[8:11]
  ds_read_b64_tr_b16 v[56:57], v2 offset:17216
  v_max3_f32 v9, v120, v121, v9
  v_mfma_f32_16x16x32_bf16 a[72:75], v[40:43], v[72:75], a[72:75]
  ds_read_b64_tr_b16 v[58:59], v2 offset:25664
  v_max3_f32 v9, v122, v123, v9
  v_mfma_f32_16x16x32_bf16 a[136:139], v[40:43], v[80:83], a[136:139]
  s_add_u32 m0, s31, 118848
  v_max3_f32 v9, v100, v101, v9
  v_mfma_f32_16x16x32_bf16 a[200:203], v[40:43], v[88:91], a[200:203]
  buffer_load_dwordx4 v3, s[20:23], s63 offen offset:3584  lds
  v_max3_f32 v9, v102, v103, v9
  v_mfma_f32_16x16x32_bf16 a[12:15], v[44:47], v[64:67], a[12:15]
  ds_read_b64_tr_b16 v[60:61], v2 offset:17248
  v_max3_f32 v9, v108, v109, v9
  v_mfma_f32_16x16x32_bf16 a[76:79], v[44:47], v[72:75], a[76:79]
  ds_read_b64_tr_b16 v[62:63], v2 offset:25696
  v_max3_f32 v9, v110, v111, v9
  v_mfma_f32_16x16x32_bf16 a[140:143], v[44:47], v[80:83], a[140:143]
  v_max3_f32 v9, v116, v117, v9
  v_max3_f32 v9, v118, v119, v9
  v_mfma_f32_16x16x32_bf16 a[204:207], v[44:47], v[88:91], a[204:207]
  v_max3_f32 v9, v124, v125, v9
  s_waitcnt lgkmcnt(4)
  v_mfma_f32_16x16x32_bf16 a[16:19], v[48:51], v[64:67], a[16:19]
  ds_read_b64_tr_b16 v[32:33], v2 offset:17408
  s_add_u32 s63, s63, 1792
  v_mfma_f32_16x16x32_bf16 a[80:83], v[48:51], v[72:75], a[80:83]
  ds_read_b64_tr_b16 v[34:35], v2 offset:25856
  s_add_u32 m0, s31, 119904
  v_mfma_f32_16x16x32_bf16 a[144:147], v[48:51], v[80:83], a[144:147]
  buffer_load_dwordx4 v3, s[20:23], s63 offen offset:3584  lds
  v_max3_f32 v9, v126, v127, v9
  v_mfma_f32_16x16x32_bf16 a[208:211], v[48:51], v[88:91], a[208:211]
  v_cmp_lt_f32 vcc, s59, v9
  s_cbranch_vccnz RA_S31
RAr_S31:
  v_mfma_f32_16x16x32_bf16 a[20:23], v[52:55], v[64:67], a[20:23]
  ds_read_b64_tr_b16 v[36:37], v2 offset:17440
  v_exp_f32 v96, v96
  v_mfma_f32_16x16x32_bf16 a[84:87], v[52:55], v[72:75], a[84:87]
  ds_read_b64_tr_b16 v[38:39], v2 offset:25888
  s_add_u32 s63, s64, 344064
  v_exp_f32 v97, v97
  v_mfma_f32_16x16x32_bf16 a[148:151], v[52:55], v[80:83], a[148:151]
  s_add_u32 m0, s31, 2048
  v_exp_f32 v98, v98
  v_mfma_f32_16x16x32_bf16 a[212:215], v[52:55], v[88:91], a[212:215]
  buffer_load_dwordx4 v3, s[20:23], s63 offen offset:0  lds
  v_add_f32 v4, v4, v96
  v_add_f32 v4, v4, v97
  s_waitcnt lgkmcnt(4)
  v_mfma_f32_16x16x32_bf16 a[24:27], v[56:59], v[64:67], a[24:27]
  ds_read_b64_tr_b16 v[40:41], v2 offset:17472
  v_exp_f32 v99, v99
  v_cvt_pk_bf16_f32 v96, v96, v97
  v_mfma_f32_16x16x32_bf16 a[88:91], v[56:59], v[72:75], a[88:91]
  ds_read_b64_tr_b16 v[42:43], v2 offset:25920
  v_exp_f32 v100, v100
  v_mfma_f32_16x16x32_bf16 a[152:155], v[56:59], v[80:83], a[152:155]
  s_add_u32 m0, s31, 1312
  v_add_f32 v4, v4, v98
  v_exp_f32 v101, v101
  v_mfma_f32_16x16x32_bf16 a[216:219], v[56:59], v[88:91], a[216:219]
  buffer_load_dwordx4 v3, s[20:23], s63 offen offset:1792  lds
  v_add_f32 v4, v4, v99
  v_cvt_pk_bf16_f32 v97, v98, v99
  v_mfma_f32_16x16x32_bf16 a[28:31], v[60:63], v[64:67], a[28:31]
  ds_read_b64_tr_b16 v[44:45], v2 offset:17504
  v_exp_f32 v102, v102
  v_add_f32 v4, v4, v100
  v_mfma_f32_16x16x32_bf16 a[92:95], v[60:63], v[72:75], a[92:95]
  ds_read_b64_tr_b16 v[46:47], v2 offset:25952
  v_exp_f32 v103, v103
  v_add_f32 v4, v4, v101
  v_mfma_f32_16x16x32_bf16 a[156:159], v[60:63], v[80:83], a[156:159]
  v_cvt_pk_bf16_f32 v98, v100, v101
  v_exp_f32 v104, v104
  v_mfma_f32_16x16x32_bf16 a[220:223], v[60:63], v[88:91], a[220:223]
  v_add_f32 v4, v4, v102
  v_exp_f32 v105, v105
  s_waitcnt lgkmcnt(4)
  v_mfma_f32_16x16x32_bf16 a[32:35], v[32:35], v[64:67], a[32:35]
  ds_read_b64_tr_b16 v[48:49], v2 offset:17664
  s_add_u32 m0, s31, 576
  v_add_f32 v4, v4, v103
  v_mfma_f32_16x16x32_bf16 a[96:99], v[32:35], v[72:75], a[96:99]
  ds_read_b64_tr_b16 v[50:51], v2 offset:26112
  buffer_load_dwordx4 v3, s[20:23], s63 offen offset:3584  lds
  v_cvt_pk_bf16_f32 v99, v102, v103
  v_add_f32 v5, v5, v104
  v_mfma_f32_16x16x32_bf16 a[160:163], v[32:35], v[80:83], a[160:163]
  v_exp_f32 v106, v106
  v_exp_f32 v107, v107
  v_mfma_f32_16x16x32_bf16 a[224:227], v[32:35], v[88:91], a[224:227]
  v_add_f32 v5, v5, v105
  v_cvt_pk_bf16_f32 v104, v104, v105
  v_add_f32 v5, v5, v106
  v_mfma_f32_16x16x32_bf16 a[36:39], v[36:39], v[64:67], a[36:39]
  ds_read_b64_tr_b16 v[52:53], v2 offset:17696
  v_exp_f32 v108, v108
  v_add_f32 v5, v5, v107
  v_mfma_f32_16x16x32_bf16 a[100:103], v[36:39], v[72:75], a[100:103]
  ds_read_b64_tr_b16 v[54:55], v2 offset:26144
  s_add_u32 s63, s63, 1792
  v_cvt_pk_bf16_f32 v105, v106, v107
  v_mfma_f32_16x16x32_bf16 a[164:167], v[36:39], v[80:83], a[164:167]
  s_add_u32 m0, s31, 1632
  v_exp_f32 v109, v109
  v_add_f32 v5, v5, v108
  v_mfma_f32_16x16x32_bf16 a[228:231], v[36:39], v[88:91], a[228:231]
  buffer_load_dwordx4 v3, s[20:23], s63 offen offset:3584  lds
  v_exp_f32 v110, v110
  s_waitcnt lgkmcnt(4)
  v_mfma_f32_16x16x32_bf16 a[40:43], v[40:43], v[64:67], a[40:43]
  ds_read_b64_tr_b16 v[56:57], v2 offset:17728
  v_exp_f32 v111, v111
  v_mfma_f32_16x16x32_bf16 a[104:107], v[40:43], v[72:75], a[104:107]
  ds_read_b64_tr_b16 v[58:59], v2 offset:26176
  v_add_f32 v5, v5, v109
  v_cvt_pk_bf16_f32 v106, v108, v109
  v_add_f32 v5, v5, v110
  v_mfma_f32_16x16x32_bf16 a[168:171], v[40:43], v[80:83], a[168:171]
  v_exp_f32 v112, v112
  v_add_f32 v5, v5, v111
  v_mfma_f32_16x16x32_bf16 a[232:235], v[40:43], v[88:91], a[232:235]
  v_exp_f32 v113, v113
  v_cvt_pk_bf16_f32 v107, v110, v111
  v_add_f32 v6, v6, v112
  v_mfma_f32_16x16x32_bf16 a[44:47], v[44:47], v[64:67], a[44:47]
  ds_read_b64_tr_b16 v[60:61], v2 offset:17760
  v_exp_f32 v114, v114
  v_add_f32 v6, v6, v113
  v_mfma_f32_16x16x32_bf16 a[108:111], v[44:47], v[72:75], a[108:111]
  ds_read_b64_tr_b16 v[62:63], v2 offset:26208
  v_cvt_pk_bf16_f32 v112, v112, v113
  s_waitcnt vmcnt(13)
  v_mfma_f32_16x16x32_bf16 a[172:175], v[44:47], v[80:83], a[172:175]
  v_exp_f32 v115, v115
  v_add_f32 v6, v6, v114
  s_barrier
  v_mfma_f32_16x16x32_bf16 a[236:239], v[44:47], v[88:91], a[236:239]
  v_exp_f32 v116, v116
  s_waitcnt lgkmcnt(4)
  v_mfma_f32_16x16x32_bf16 a[48:51], v[48:51], v[64:67], a[48:51]
  ds_read_b64_tr_b16 v[32:33], v2 offset:33792
  v_exp_f32 v117, v117
  v_add_f32 v6, v6, v115
  v_mfma_f32_16x16x32_bf16 a[112:115], v[48:51], v[72:75], a[112:115]
  ds_read_b64_tr_b16 v[34:35], v2 offset:42240
  v_cvt_pk_bf16_f32 v113, v114, v115
  v_exp_f32 v118, v118
  v_mfma_f32_16x16x32_bf16 a[176:179], v[48:51], v[80:83], a[176:179]
  v_add_f32 v6, v6, v116
  v_exp_f32 v119, v119
  v_mfma_f32_16x16x32_bf16 a[240:243], v[48:51], v[88:91], a[240:243]
  v_add_f32 v6, v6, v117
  v_cvt_pk_bf16_f32 v114, v116, v117
  v_exp_f32 v120, v120
  v_mfma_f32_16x16x32_bf16 a[52:55], v[52:55], v[64:67], a[52:55]
  ds_read_b64_tr_b16 v[36:37], v2 offset:33824
  v_add_f32 v6, v6, v118
  v_add_f32 v6, v6, v119
  v_mfma_f32_16x16x32_bf16 a[116:119], v[52:55], v[72:75], a[116:119]
  ds_read_b64_tr_b16 v[38:39], v2 offset:42272
  v_exp_f32 v121, v121
  v_cvt_pk_bf16_f32 v115, v118, v119
  v_mfma_f32_16x16x32_bf16 a[180:183], v[52:55], v[80:83], a[180:183]
  v_exp_f32 v122, v122
  v_add_f32 v7, v7, v120
  v_add_f32 v7, v7, v121
  v_mfma_f32_16x16x32_bf16 a[244:247], v[52:55], v[88:91], a[244:247]
  v_exp_f32 v123, v123
  s_waitcnt lgkmcnt(4)
  v_mfma_f32_16x16x32_bf16 a[56:59], v[56:59], v[64:67], a[56:59]
  ds_read_b64_tr_b16 v[40:41], v2 offset:33856
  v_cvt_pk_bf16_f32 v120, v120, v121
  v_exp_f32 v124, v124
  v_mfma_f32_16x16x32_bf16 a[120:123], v[56:59], v[72:75], a[120:123]
  ds_read_b64_tr_b16 v[42:43], v2 offset:42304
  v_add_f32 v7, v7, v122
  v_add_f32 v7, v7, v123
  v_mfma_f32_16x16x32_bf16 a[184:187], v[56:59], v[80:83], a[184:187]
  v_exp_f32 v125, v125
  v_cvt_pk_bf16_f32 v121, v122, v123
  v_add_f32 v7, v7, v124
  v_mfma_f32_16x16x32_bf16 a[248:251], v[56:59], v[88:91], a[248:251]
  v_exp_f32 v126, v126
  v_exp_f32 v127, v127
  v_mfma_f32_16x16x32_bf16 a[60:63], v[60:63], v[64:67], a[60:63]
  ds_read_b64_tr_b16 v[44:45], v2 offset:33888
  v_add_f32 v7, v7, v125
  v_cvt_pk_bf16_f32 v122, v124, v125
  v_mfma_f32_16x16x32_bf16 a[124:127], v[60:63], v[72:75], a[124:127]
  ds_read_b64_tr_b16 v[46:47], v2 offset:42336
  v_add_f32 v7, v7, v126
  v_add_f32 v7, v7, v127
  v_cvt_pk_bf16_f32 v123, v126, v127
  v_mfma_f32_16x16x32_bf16 a[188:191], v[60:63], v[80:83], a[188:191]
  v_mfma_f32_16x16x32_bf16 a[252:255], v[60:63], v[88:91], a[252:255]
  s_cbranch_vccnz RB_S31
RBr_S31:
  s_waitcnt lgkmcnt(4)
  v_mfma_f32_16x16x32_bf16 a[0:3], v[32:35], v[96:99], a[0:3]
  ds_read_b64_tr_b16 v[48:49], v2 offset:34048
  s_add_u32 s63, s64, 128
  v_mfma_f32_16x16x32_bf16 a[64:67], v[32:35], v[104:107], a[64:67]
  ds_read_b64_tr_b16 v[50:51], v2 offset:42496
  s_add_u32 m0, s31, 69632
  v_mfma_f32_16x16x32_bf16 a[128:131], v[32:35], v[112:115], a[128:131]
  buffer_load_dwordx4 v3, s[20:23], s63 offen offset:0  lds
  v_mov_b32 v10, v4
  v_mfma_f32_16x16x32_bf16 a[192:195], v[32:35], v[120:123], a[192:195]
  v_mov_b32 v11, v5
  s_nop 0
  v_mfma_f32_16x16x32_bf16 a[4:7], v[36:39], v[96:99], a[4:7]
  ds_read_b64_tr_b16 v[52:53], v2 offset:34080
  v_permlane32_swap_b32 v4, v10
  v_mfma_f32_16x16x32_bf16 a[68:71], v[36:39], v[104:107], a[68:71]
  ds_read_b64_tr_b16 v[54:55], v2 offset:42528
  v_permlane32_swap_b32 v5, v11
  v_mfma_f32_16x16x32_bf16 a[132:135], v[36:39], v[112:115], a[132:135]
  v_add_f32 v4, v4, v10
  v_add_f32 v5, v5, v11
  v_mfma_f32_16x16x32_bf16 a[196:199], v[36:39], v[120:123], a[196:199]
  v_mov_b32 v10, v4
  s_waitcnt lgkmcnt(4)
  v_mfma_f32_16x16x32_bf16 a[8:11], v[40:43], v[96:99], a[8:11]
  ds_read_b64_tr_b16 v[56:57], v2 offset:34112
  v_mov_b32 v11, v5
  v_mfma_f32_16x16x32_bf16 a[72:75], v[40:43], v[104:107], a[72:75]
  ds_read_b64_tr_b16 v[58:59], v2 offset:42560
  s_nop 0
  v_mfma_f32_16x16x32_bf16 a[136:139], v[40:43], v[112:115], a[136:139]
  v_permlane16_swap_b32 v4, v10
  v_permlane16_swap_b32 v5, v11
  v_mfma_f32_16x16x32_bf16 a[200:203], v[40:43], v[120:123], a[200:203]
  s_add_u32 m0, s31, 68896
  v_add_f32 v4, v4, v10
  v_mfma_f32_16x16x32_bf16 a[12:15], v[44:47], v[96:99], a[12:15]
  ds_read_b64_tr_b16 v[60:61], v2 offset:34144
  buffer_load_dwordx4 v3, s[20:23], s63 offen offset:1792  lds
  v_mfma_f32_16x16x32_bf16 a[76:79], v[44:47], v[104:107], a[76:79]
  ds_read_b64_tr_b16 v[62:63], v2 offset:42592
  v_add_f32 v5, v5, v11
  v_mfma_f32_16x16x32_bf16 a[140:143], v[44:47], v[112:115], a[140:143]
  v_rcp_f32 v4, v4
  v_mfma_f32_16x16x32_bf16 a[204:207], v[44:47], v[120:123], a[204:207]
  s_waitcnt lgkmcnt(4)
  v_mfma_f32_16x16x32_bf16 a[16:19], v[48:51], v[96:99], a[16:19]
  ds_read_b64_tr_b16 v[32:33], v2 offset:34304
  v_mfma_f32_16x16x32_bf16 a[80:83], v[48:51], v[104:107], a[80:83]
  ds_read_b64_tr_b16 v[34:35], v2 offset:42752
  v_mfma_f32_16x16x32_bf16 a[144:147], v[48:51], v[112:115], a[144:147]
  v_rcp_f32 v5, v5
  v_mfma_f32_16x16x32_bf16 a[208:211], v[48:51], v[120:123], a[208:211]
  v_accvgpr_read_b32 v16, a0
  v_accvgpr_read_b32 v17, a1
  v_mfma_f32_16x16x32_bf16 a[20:23], v[52:55], v[96:99], a[20:23]
  ds_read_b64_tr_b16 v[36:37], v2 offset:34336
  v_accvgpr_read_b32 v18, a2
  v_accvgpr_read_b32 v19, a3
  v_mfma_f32_16x16x32_bf16 a[84:87], v[52:55], v[104:107], a[84:87]
  ds_read_b64_tr_b16 v[38:39], v2 offset:42784
  v_accvgpr_read_b32 v20, a4
  v_accvgpr_read_b32 v21, a5
  v_mfma_f32_16x16x32_bf16 a[148:151], v[52:55], v[112:115], a[148:151]
  v_accvgpr_read_b32 v22, a6
  v_accvgpr_read_b32 v23, a7
  v_mul_f32 v16, v4, v16
  v_mfma_f32_16x16x32_bf16 a[212:215], v[52:55], v[120:123], a[212:215]
  s_add_u32 m0, s31, 68160
  v_mul_f32 v17, v4, v17
  s_waitcnt lgkmcnt(4)
  v_mfma_f32_16x16x32_bf16 a[24:27], v[56:59], v[96:99], a[24:27]
  ds_read_b64_tr_b16 v[40:41], v2 offset:34368
  buffer_load_dwordx4 v3, s[20:23], s63 offen offset:3584  lds
  v_mfma_f32_16x16x32_bf16 a[88:91], v[56:59], v[104:107], a[88:91]
  ds_read_b64_tr_b16 v[42:43], v2 offset:42816
  v_mul_f32 v18, v4, v18
  v_mul_f32 v19, v4, v19
  v_mfma_f32_16x16x32_bf16 a[152:155], v[56:59], v[112:115], a[152:155]
  v_mul_f32 v20, v4, v20
  v_mul_f32 v21, v4, v21
  v_mul_f32 v22, v4, v22
  v_mfma_f32_16x16x32_bf16 a[216:219], v[56:59], v[120:123], a[216:219]
  v_mul_f32 v23, v4, v23
  v_cvt_pk_bf16_f32 v128, v16, v17
  v_cvt_pk_bf16_f32 v129, v18, v19
  v_mfma_f32_16x16x32_bf16 a[28:31], v[60:63], v[96:99], a[28:31]
  ds_read_b64_tr_b16 v[44:45], v2 offset:34400
  v_cvt_pk_bf16_f32 v130, v20, v21
  v_cvt_pk_bf16_f32 v131, v22, v23
  v_mfma_f32_16x16x32_bf16 a[92:95], v[60:63], v[104:107], a[92:95]
  ds_read_b64_tr_b16 v[46:47], v2 offset:42848
  v_accvgpr_read_b32 v24, a64
  v_mfma_f32_16x16x32_bf16 a[156:159], v[60:63], v[112:115], a[156:159]
  v_accvgpr_read_b32 v25, a65
  v_accvgpr_read_b32 v26, a66
  v_accvgpr_read_b32 v27, a67
  v_mfma_f32_16x16x32_bf16 a[220:223], v[60:63], v[120:123], a[220:223]
  v_accvgpr_read_b32 v28, a68
  v_accvgpr_read_b32 v29, a69
  s_waitcnt lgkmcnt(4)
  v_mfma_f32_16x16x32_bf16 a[32:35], v[32:35], v[96:99], a[32:35]
  ds_read_b64_tr_b16 v[48:49], v2 offset:34560
  v_accvgpr_read_b32 v30, a70
  v_accvgpr_read_b32 v31, a71
  v_mfma_f32_16x16x32_bf16 a[96:99], v[32:35], v[104:107], a[96:99]
  ds_read_b64_tr_b16 v[50:51], v2 offset:43008
  v_mul_f32 v24, v5, v24
  v_mul_f32 v25, v5, v25
  v_mfma_f32_16x16x32_bf16 a[160:163], v[32:35], v[112:115], a[160:163]
  v_mul_f32 v26, v5, v26
  v_mul_f32 v27, v5, v27
  v_mfma_f32_16x16x32_bf16 a[224:227], v[32:35], v[120:123], a[224:227]
  s_add_u32 s63, s63, 1792
  s_add_u32 m0, s31, 69216
  v_mul_f32 v28, v5, v28
  v_mfma_f32_16x16x32_bf16 a[36:39], v[36:39], v[96:99], a[36:39]
  ds_read_b64_tr_b16 v[52:53], v2 offset:34592
  buffer_load_dwordx4 v3, s[20:23], s63 offen offset:3584  lds
  v_mul_f32 v29, v5, v29
  v_mfma_f32_16x16x32_bf16 a[100:103], v[36:39], v[104:107], a[100:103]
  ds_read_b64_tr_b16 v[54:55], v2 offset:43040
  v_mul_f32 v30, v5, v30
  v_mul_f32 v31, v5, v31
  v_mfma_f32_16x16x32_bf16 a[164:167], v[36:39], v[112:115], a[164:167]
  v_cvt_pk_bf16_f32 v132, v24, v25
  v_cvt_pk_bf16_f32 v133, v26, v27
  v_cvt_pk_bf16_f32 v134, v28, v29
  v_mfma_f32_16x16x32_bf16 a[228:231], v[36:39], v[120:123], a[228:231]
  v_cvt_pk_bf16_f32 v135, v30, v31
  s_waitcnt lgkmcnt(4)
  v_mfma_f32_16x16x32_bf16 a[40:43], v[40:43], v[96:99], a[40:43]
  ds_read_b64_tr_b16 v[56:57], v2 offset:34624
  v_accvgpr_read_b32 v16, a8
  v_accvgpr_read_b32 v17, a9
  v_mfma_f32_16x16x32_bf16 a[104:107], v[40:43], v[104:107], a[104:107]
  ds_read_b64_tr_b16 v[58:59], v2 offset:43072
  v_accvgpr_read_b32 v18, a10
  v_accvgpr_read_b32 v19, a11
  v_mfma_f32_16x16x32_bf16 a[168:171], v[40:43], v[112:115], a[168:171]
  v_accvgpr_read_b32 v20, a12
  v_accvgpr_read_b32 v21, a13
  v_accvgpr_read_b32 v22, a14
  v_mfma_f32_16x16x32_bf16 a[232:235], v[40:43], v[120:123], a[232:235]
  v_accvgpr_read_b32 v23, a15
  v_mul_f32 v16, v4, v16
  v_mul_f32 v17, v4, v17
  v_mfma_f32_16x16x32_bf16 a[44:47], v[44:47], v[96:99], a[44:47]
  ds_read_b64_tr_b16 v[60:61], v2 offset:34656
  v_mul_f32 v18, v4, v18
  v_mfma_f32_16x16x32_bf16 a[108:111], v[44:47], v[104:107], a[108:111]
  ds_read_b64_tr_b16 v[62:63], v2 offset:43104
  v_mul_f32 v19, v4, v19
  v_mul_f32 v20, v4, v20
  v_mfma_f32_16x16x32_bf16 a[172:175], v[44:47], v[112:115], a[172:175]
  v_mul_f32 v21, v4, v21
  v_mul_f32 v22, v4, v22
  v_mul_f32 v23, v4, v23
  v_mfma_f32_16x16x32_bf16 a[236:239], v[44:47], v[120:123], a[236:239]
  v_cvt_pk_bf16_f32 v136, v16, v17
  v_cvt_pk_bf16_f32 v137, v18, v19
  s_waitcnt lgkmcnt(4)
  v_mfma_f32_16x16x32_bf16 a[48:51], v[48:51], v[96:99], a[48:51]
  v_cvt_pk_bf16_f32 v138, v20, v21
  v_cvt_pk_bf16_f32 v139, v22, v23
  v_accvgpr_read_b32 v24, a72
  v_mfma_f32_16x16x32_bf16 a[112:115], v[48:51], v[104:107], a[112:115]
  v_accvgpr_read_b32 v25, a73
  s_waitcnt vmcnt(13)
  v_mfma_f32_16x16x32_bf16 a[176:179], v[48:51], v[112:115], a[176:179]
  v_accvgpr_read_b32 v26, a74
  v_accvgpr_read_b32 v27, a75
  s_barrier
  v_mfma_f32_16x16x32_bf16 a[240:243], v[48:51], v[120:123], a[240:243]
  v_accvgpr_read_b32 v28, a76
  v_accvgpr_read_b32 v29, a77
  v_accvgpr_read_b32 v30, a78
  v_mfma_f32_16x16x32_bf16 a[52:55], v[52:55], v[96:99], a[52:55]
  ds_read_b64_tr_b16 v[32:33], v14 offset:33792
  s_add_u32 s63, s64, 114816
  v_accvgpr_read_b32 v31, a79
  v_mfma_f32_16x16x32_bf16 a[116:119], v[52:55], v[104:107], a[116:119]
  ds_read_b64_tr_b16 v[34:35], v14 offset:42240
  s_add_u32 m0, s31, 18944
  v_mul_f32 v24, v5, v24
  v_mfma_f32_16x16x32_bf16 a[180:183], v[52:55], v[112:115], a[180:183]
  ds_read_b64_tr_b16 v[36:37], v14 offset:34048
  buffer_load_dwordx4 v3, s[20:23], s63 offen offset:0  lds
  v_mfma_f32_16x16x32_bf16 a[244:247], v[52:55], v[120:123], a[244:247]
  ds_read_b64_tr_b16 v[38:39], v14 offset:42496
  v_mul_f32 v25, v5, v25
  s_waitcnt lgkmcnt(4)
  v_mfma_f32_16x16x32_bf16 a[56:59], v[56:59], v[96:99], a[56:59]
  ds_read_b64_tr_b16 v[40:41], v14 offset:33824
  v_mul_f32 v26, v5, v26
  v_mul_f32 v27, v5, v27
  v_mfma_f32_16x16x32_bf16 a[120:123], v[56:59], v[104:107], a[120:123]
  ds_read_b64_tr_b16 v[42:43], v14 offset:42272
  s_add_u32 m0, s31, 18208
  v_mul_f32 v28, v5, v28
  v_mfma_f32_16x16x32_bf16 a[184:187], v[56:59], v[112:115], a[184:187]
  ds_read_b64_tr_b16 v[44:45], v14 offset:34080
  buffer_load_dwordx4 v3, s[20:23], s63 offen offset:1792  lds
  v_mul_f32 v29, v5, v29
  v_mfma_f32_16x16x32_bf16 a[248:251], v[56:59], v[120:123], a[248:251]
  ds_read_b64_tr_b16 v[46:47], v14 offset:42528
  v_mul_f32 v30, v5, v30
  v_mfma_f32_16x16x32_bf16 a[60:63], v[60:63], v[96:99], a[60:63]
  ds_read_b64_tr_b16 v[48:49], v14 offset:33856
  v_mul_f32 v31, v5, v31
  v_cvt_pk_bf16_f32 v140, v24, v25
  v_mfma_f32_16x16x32_bf16 a[124:127], v[60:63], v[104:107], a[124:127]
  ds_read_b64_tr_b16 v[50:51], v14 offset:42304
  v_cvt_pk_bf16_f32 v141, v26, v27
  v_cvt_pk_bf16_f32 v142, v28, v29
  v_mfma_f32_16x16x32_bf16 a[188:191], v[60:63], v[112:115], a[188:191]
  ds_read_b64_tr_b16 v[52:53], v14 offset:34112
  v_cvt_pk_bf16_f32 v143, v30, v31
  v_mfma_f32_16x16x32_bf16 a[252:255], v[60:63], v[120:123], a[252:255]
  ds_read_b64_tr_b16 v[54:55], v14 offset:42560
  v_mov_b32 v10, v6
  v_mov_b32 v11, v7
  s_nop 0
  v_permlane32_swap_b32 v6, v10
  v_permlane32_swap_b32 v7, v11
  v_add_f32 v6, v6, v10
  s_waitcnt lgkmcnt(8)
  v_mfma_f32_16x16x32_bf16 v[64:67], v[32:35], v[128:131], 0
  ds_read_b64_tr_b16 v[56:57], v14 offset:33888
  s_add_u32 m0, s31, 17472
  v_add_f32 v7, v7, v11
  v_mov_b32 v10, v6
  v_mov_b32 v11, v7
  s_nop 0
  v_permlane16_swap_b32 v6, v10
  v_permlane16_swap_b32 v7, v11
  v_add_f32 v6, v6, v10
  v_mfma_f32_16x16x32_bf16 v[64:67], v[36:39], v[136:139], v[64:67]
  ds_read_b64_tr_b16 v[58:59], v14 offset:42336
  buffer_load_dwordx4 v3, s[20:23], s63 offen offset:3584  lds
  v_add_f32 v7, v7, v11
  v_rcp_f32 v6, v6
  v_rcp_f32 v7, v7
  v_accvgpr_read_b32 v16, a16
  v_accvgpr_read_b32 v17, a17
  v_mfma_f32_16x16x32_bf16 v[68:71], v[32:35], v[132:135], 0
  ds_read_b64_tr_b16 v[60:61], v14 offset:34144
  v_accvgpr_read_b32 v18, a18
  v_accvgpr_read_b32 v19, a19
  v_accvgpr_read_b32 v20, a20
  v_accvgpr_read_b32 v21, a21
  v_accvgpr_read_b32 v22, a22
  v_accvgpr_read_b32 v23, a23
  v_mul_f32 v16, v4, v16
  v_mul_f32 v17, v4, v17
  v_mfma_f32_16x16x32_bf16 v[68:71], v[36:39], v[140:143], v[68:71]
  ds_read_b64_tr_b16 v[62:63], v14 offset:42592
  v_mul_f32 v18, v4, v18
  v_mul_f32 v19, v4, v19
  v_mul_f32 v20, v4, v20
  v_mul_f32 v21, v4, v21
  v_mul_f32 v22, v4, v22
  v_mul_f32 v23, v4, v23
  v_cvt_pk_bf16_f32 v144, v16, v17
  s_waitcnt lgkmcnt(8)
  v_mfma_f32_16x16x32_bf16 v[72:75], v[40:43], v[128:131], 0
  ds_read_b64_tr_b16 v[32:33], v14 offset:34304
  s_add_u32 s63, s63, 1792
  v_cvt_pk_bf16_f32 v145, v18, v19
  v_cvt_pk_bf16_f32 v146, v20, v21
  v_cvt_pk_bf16_f32 v147, v22, v23
  v_accvgpr_read_b32 v24, a80
  v_accvgpr_read_b32 v25, a81
  v_accvgpr_read_b32 v26, a82
  v_accvgpr_read_b32 v27, a83
  v_mfma_f32_16x16x32_bf16 v[72:75], v[44:47], v[136:139], v[72:75]
  ds_read_b64_tr_b16 v[34:35], v14 offset:42752
  s_add_u32 m0, s31, 18528
  v_accvgpr_read_b32 v28, a84
  v_accvgpr_read_b32 v29, a85
  v_accvgpr_read_b32 v30, a86
  v_accvgpr_read_b32 v31, a87
  v_mul_f32 v24, v5, v24
  v_mul_f32 v25, v5, v25
  v_mul_f32 v26, v5, v26
  v_mfma_f32_16x16x32_bf16 v[76:79], v[40:43], v[132:135], 0
  ds_read_b64_tr_b16 v[36:37], v14 offset:34560
  buffer_load_dwordx4 v3, s[20:23], s63 offen offset:3584  lds
  v_mul_f32 v27, v5, v27
  v_mul_f32 v28, v5, v28
  v_mul_f32 v29, v5, v29
  v_mul_f32 v30, v5, v30
  v_mul_f32 v31, v5, v31
  v_cvt_pk_bf16_f32 v148, v24, v25
  v_cvt_pk_bf16_f32 v149, v26, v27
  v_mfma_f32_16x16x32_bf16 v[76:79], v[44:47], v[140:143], v[76:79]
  ds_read_b64_tr_b16 v[38:39], v14 offset:43008
  v_cvt_pk_bf16_f32 v150, v28, v29
  v_cvt_pk_bf16_f32 v151, v30, v31
  v_accvgpr_read_b32 v16, a24
  v_accvgpr_read_b32 v17, a25
  v_accvgpr_read_b32 v18, a26
  v_accvgpr_read_b32 v19, a27
  v_accvgpr_read_b32 v20, a28
  s_waitcnt lgkmcnt(8)
  v_mfma_f32_16x16x32_bf16 v[80:83], v[48:51], v[128:131], 0
  ds_read_b64_tr_b16 v[40:41], v14 offset:34336
  s_add_u32 s63, s64, 229504
  v_accvgpr_read_b32 v21, a29
  v_accvgpr_read_b32 v22, a30
  v_accvgpr_read_b32 v23, a31
  v_mul_f32 v16, v4, v16
  v_mul_f32 v17, v4, v17
  v_mul_f32 v18, v4, v18
  v_mfma_f32_16x16x32_bf16 v[80:83], v[52:55], v[136:139], v[80:83]
  ds_read_b64_tr_b16 v[42:43], v14 offset:42784
  s_add_u32 m0, s31, 86528
  v_mul_f32 v19, v4, v19
  v_mul_f32 v20, v4, v20
  v_mul_f32 v21, v4, v21
  v_mul_f32 v22, v4, v22
  v_mul_f32 v23, v4, v23
  v_cvt_pk_bf16_f32 v152, v16, v17
  v_cvt_pk_bf16_f32 v153, v18, v19
  v_mfma_f32_16x16x32_bf16 v[84:87], v[48:51], v[132:135], 0
  ds_read_b64_tr_b16 v[44:45], v14 offset:34592
  buffer_load_dwordx4 v3, s[20:23], s63 offen offset:0  lds
  v_cvt_pk_bf16_f32 v154, v20, v21
  v_cvt_pk_bf16_f32 v155, v22, v23
  v_accvgpr_read_b32 v24, a88
  v_accvgpr_read_b32 v25, a89
  v_accvgpr_read_b32 v26, a90
  v_accvgpr_read_b32 v27, a91
  v_accvgpr_read_b32 v28, a92
  v_mfma_f32_16x16x32_bf16 v[84:87], v[52:55], v[140:143], v[84:87]
  ds_read_b64_tr_b16 v[46:47], v14 offset:43040
  v_accvgpr_read_b32 v29, a93
  v_accvgpr_read_b32 v30, a94
  v_accvgpr_read_b32 v31, a95
  v_mul_f32 v24, v5, v24
  v_mul_f32 v25, v5, v25
  v_mul_f32 v26, v5, v26
  v_mul_f32 v27, v5, v27
  s_waitcnt lgkmcnt(8)
  v_mfma_f32_16x16x32_bf16 v[88:91], v[56:59], v[128:131], 0
  ds_read_b64_tr_b16 v[48:49], v14 offset:34368
  v_mul_f32 v28, v5, v28
  v_mul_f32 v29, v5, v29
  v_mul_f32 v30, v5, v30
  v_mul_f32 v31, v5, v31
  v_cvt_pk_bf16_f32 v156, v24, v25
  v_cvt_pk_bf16_f32 v157, v26, v27
  v_cvt_pk_bf16_f32 v158, v28, v29
  v_cvt_pk_bf16_f32 v159, v30, v31
  v_mfma_f32_16x16x32_bf16 v[88:91], v[60:63], v[136:139], v[88:91]
  ds_read_b64_tr_b16 v[50:51], v14 offset:42816
  s_add_u32 m0, s31, 85792
  v_accvgpr_read_b32 v16, a32
  v_accvgpr_read_b32 v17, a33
  v_accvgpr_read_b32 v18, a34
  v_accvgpr_read_b32 v19, a35
  v_accvgpr_read_b32 v20, a36
  v_mfma_f32_16x16x32_bf16 v[92:95], v[56:59], v[132:135], 0
  ds_read_b64_tr_b16 v[52:53], v14 offset:34624
  buffer_load_dwordx4 v3, s[20:23], s63 offen offset:1792  lds
  v_accvgpr_read_b32 v21, a37
  v_accvgpr_read_b32 v22, a38
  v_accvgpr_read_b32 v23, a39
  v_mul_f32 v16, v4, v16
  v_mul_f32 v17, v4, v17
  v_mfma_f32_16x16x32_bf16 v[92:95], v[60:63], v[140:143], v[92:95]
  ds_read_b64_tr_b16 v[54:55], v14 offset:43072
  v_mul_f32 v18, v4, v18
  v_mul_f32 v19, v4, v19
  v_mul_f32 v20, v4, v20
  v_mul_f32 v21, v4, v21
  v_mul_f32 v22, v4, v22
  v_mul_f32 v23, v4, v23
  s_waitcnt lgkmcnt(8)
  v_mfma_f32_16x16x32_bf16 v[64:67], v[32:35], v[144:147], v[64:67]
  ds_read_b64_tr_b16 v[56:57], v14 offset:34400
  v_cvt_pk_bf16_f32 v160, v16, v17
  v_cvt_pk_bf16_f32 v161, v18, v19
  v_cvt_pk_bf16_f32 v162, v20, v21
  v_cvt_pk_bf16_f32 v163, v22, v23
  v_accvgpr_read_b32 v24, a96
  v_accvgpr_read_b32 v25, a97
  v_mfma_f32_16x16x32_bf16 v[64:67], v[36:39], v[152:155], v[64:67]
  ds_read_b64_tr_b16 v[58:59], v14 offset:42848
  v_accvgpr_read_b32 v26, a98
  v_accvgpr_read_b32 v27, a99
  v_accvgpr_read_b32 v28, a100
  v_accvgpr_read_b32 v29, a101
  v_accvgpr_read_b32 v30, a102
  v_accvgpr_read_b32 v31, a103
  v_mul_f32 v24, v5, v24
  v_mfma_f32_16x16x32_bf16 v[68:71], v[32:35], v[148:151], v[68:71]
  ds_read_b64_tr_b16 v[60:61], v14 offset:34656
  v_mul_f32 v25, v5, v25
  v_mul_f32 v26, v5, v26
  v_mul_f32 v27, v5, v27
  v_mul_f32 v28, v5, v28
  v_mul_f32 v29, v5, v29
  v_mul_f32 v30, v5, v30
  v_mfma_f32_16x16x32_bf16 v[68:71], v[36:39], v[156:159], v[68:71]
  ds_read_b64_tr_b16 v[62:63], v14 offset:43104
  v_mul_f32 v31, v5, v31
  v_cvt_pk_bf16_f32 v164, v24, v25
  v_cvt_pk_bf16_f32 v165, v26, v27
  v_cvt_pk_bf16_f32 v166, v28, v29
  v_cvt_pk_bf16_f32 v167, v30, v31
  v_accvgpr_read_b32 v16, a40
  s_waitcnt lgkmcnt(8)
  v_mfma_f32_16x16x32_bf16 v[72:75], v[40:43], v[144:147], v[72:75]
  ds_read_b64_tr_b16 v[32:33], v2 offset:50688
  s_add_u32 m0, s31, 85056
  v_accvgpr_read_b32 v17, a41
  v_accvgpr_read_b32 v18, a42
  v_accvgpr_read_b32 v19, a43
  v_accvgpr_read_b32 v20, a44
  v_accvgpr_read_b32 v21, a45
  v_mfma_f32_16x16x32_bf16 v[72:75], v[44:47], v[152:155], v[72:75]
  ds_read_b64_tr_b16 v[34:35], v2 offset:59136
  buffer_load_dwordx4 v3, s[20:23], s63 offen offset:3584  lds
  v_accvgpr_read_b32 v22, a46
  v_accvgpr_read_b32 v23, a47
  v_mul_f32 v16, v4, v16
  v_mul_f32 v17, v4, v17
  v_mul_f32 v18, v4, v18
  v_mul_f32 v19, v4, v19
  v_mfma_f32_16x16x32_bf16 v[76:79], v[40:43], v[148:151], v[76:79]
  ds_read_b64_tr_b16 v[36:37], v2 offset:50944
  v_mul_f32 v20, v4, v20
  v_mul_f32 v21, v4, v21
  v_mul_f32 v22, v4, v22
  v_mul_f32 v23, v4, v23
  v_cvt_pk_bf16_f32 v168, v16, v17
  v_cvt_pk_bf16_f32 v169, v18, v19
  v_mfma_f32_16x16x32_bf16 v[76:79], v[44:47], v[156:159], v[76:79]
  ds_read_b64_tr_b16 v[38:39], v2 offset:59392
  v_cvt_pk_bf16_f32 v170, v20, v21
  v_cvt_pk_bf16_f32 v171, v22, v23
  v_accvgpr_read_b32 v24, a104
  v_accvgpr_read_b32 v25, a105
  v_accvgpr_read_b32 v26, a106
  s_waitcnt lgkmcnt(8)
  v_mfma_f32_16x16x32_bf16 v[80:83], v[48:51], v[144:147], v[80:83]
  ds_read_b64_tr_b16 v[40:41], v2 offset:50720
  s_add_u32 s63, s63, 1792
  v_accvgpr_read_b32 v27, a107
  v_accvgpr_read_b32 v28, a108
  v_accvgpr_read_b32 v29, a109
  v_accvgpr_read_b32 v30, a110
  v_accvgpr_read_b32 v31, a111
  v_mul_f32 v24, v5, v24
  v_mfma_f32_16x16x32_bf16 v[80:83], v[52:55], v[152:155], v[80:83]
  ds_read_b64_tr_b16 v[42:43], v2 offset:59168
  s_add_u32 m0, s31, 86112
  v_mul_f32 v25, v5, v25
  v_mul_f32 v26, v5, v26
  v_mul_f32 v27, v5, v27
  v_mul_f32 v28, v5, v28
  v_mul_f32 v29, v5, v29
  v_mfma_f32_16x16x32_bf16 v[84:87], v[48:51], v[148:151], v[84:87]
  ds_read_b64_tr_b16 v[44:45], v2 offset:50976
  buffer_load_dwordx4 v3, s[20:23], s63 offen offset:3584  lds
  v_mul_f32 v30, v5, v30
  v_mul_f32 v31, v5, v31
  v_cvt_pk_bf16_f32 v172, v24, v25
  v_cvt_pk_bf16_f32 v173, v26, v27
  v_cvt_pk_bf16_f32 v174, v28, v29
  v_cvt_pk_bf16_f32 v175, v30, v31
  v_mfma_f32_16x16x32_bf16 v[84:87], v[52:55], v[156:159], v[84:87]
  ds_read_b64_tr_b16 v[46:47], v2 offset:59424
  v_accvgpr_read_b32 v16, a48
  v_accvgpr_read_b32 v17, a49
  v_accvgpr_read_b32 v18, a50
  v_accvgpr_read_b32 v19, a51
  v_accvgpr_read_b32 v20, a52
  s_waitcnt lgkmcnt(8)
  v_mfma_f32_16x16x32_bf16 v[88:91], v[56:59], v[144:147], v[88:91]
  ds_read_b64_tr_b16 v[48:49], v2 offset:50752
  v_accvgpr_read_b32 v21, a53
  v_accvgpr_read_b32 v22, a54
  v_accvgpr_read_b32 v23, a55
  v_mul_f32 v16, v4, v16
  v_mul_f32 v17, v4, v17
  v_mul_f32 v18, v4, v18
  v_mfma_f32_16x16x32_bf16 v[88:91], v[60:63], v[152:155], v[88:91]
  ds_read_b64_tr_b16 v[50:51], v2 offset:59200
  v_mul_f32 v19, v4, v19
  v_mul_f32 v20, v4, v20
  v_mul_f32 v21, v4, v21
  v_mul_f32 v22, v4, v22
  v_mul_f32 v23, v4, v23
  v_cvt_pk_bf16_f32 v176, v16, v17
  v_mfma_f32_16x16x32_bf16 v[92:95], v[56:59], v[148:151], v[92:95]
  ds_read_b64_tr_b16 v[52:53], v2 offset:51008
  v_cvt_pk_bf16_f32 v177, v18, v19
  v_cvt_pk_bf16_f32 v178, v20, v21
  v_cvt_pk_bf16_f32 v179, v22, v23
  v_accvgpr_read_b32 v24, a112
  v_accvgpr_read_b32 v25, a113
  v_accvgpr_read_b32 v26, a114
  v_mfma_f32_16x16x32_bf16 v[92:95], v[60:63], v[156:159], v[92:95]
  ds_read_b64_tr_b16 v[54:55], v2 offset:59456
  v_accvgpr_read_b32 v27, a115
  v_accvgpr_read_b32 v28, a116
  v_accvgpr_read_b32 v29, a117
  v_accvgpr_read_b32 v30, a118
  v_accvgpr_read_b32 v31, a119
  s_waitcnt lgkmcnt(8)
  v_mfma_f32_16x16x32_bf16 v[64:67], v[32:35], v[160:163], v[64:67]
  ds_read_b64_tr_b16 v[56:57], v2 offset:50784
  v_mul_f32 v24, v5, v24
  v_mul_f32 v25, v5, v25
  v_mul_f32 v26, v5, v26
  v_mul_f32 v27, v5, v27
  v_mul_f32 v28, v5, v28
  v_mul_f32 v29, v5, v29
  v_mfma_f32_16x16x32_bf16 v[64:67], v[36:39], v[168:171], v[64:67]
  ds_read_b64_tr_b16 v[58:59], v2 offset:59232
  v_mul_f32 v30, v5, v30
  v_mul_f32 v31, v5, v31
  v_cvt_pk_bf16_f32 v180, v24, v25
  v_cvt_pk_bf16_f32 v181, v26, v27
  v_cvt_pk_bf16_f32 v182, v28, v29
  v_cvt_pk_bf16_f32 v183, v30, v31
  v_mfma_f32_16x16x32_bf16 v[68:71], v[32:35], v[164:167], v[68:71]
  ds_read_b64_tr_b16 v[60:61], v2 offset:51040
  v_accvgpr_read_b32 v16, a56
  v_accvgpr_read_b32 v17, a57
  v_accvgpr_read_b32 v18, a58
  v_accvgpr_read_b32 v19, a59
  v_accvgpr_read_b32 v20, a60
  v_accvgpr_read_b32 v21, a61
  v_mfma_f32_16x16x32_bf16 v[68:71], v[36:39], v[172:175], v[68:71]
  ds_read_b64_tr_b16 v[62:63], v2 offset:59488
  v_accvgpr_read_b32 v22, a62
  v_accvgpr_read_b32 v23, a63
  v_mul_f32 v16, v4, v16
  v_mul_f32 v17, v4, v17
  v_mul_f32 v18, v4, v18
  s_waitcnt lgkmcnt(8)
  v_mfma_f32_16x16x32_bf16 v[72:75], v[40:43], v[160:163], v[72:75]
  ds_read_b64_tr_b16 v[32:33], v2 offset:51200
  v_mul_f32 v19, v4, v19
  v_mul_f32 v20, v4, v20
  v_mul_f32 v21, v4, v21
  v_mul_f32 v22, v4, v22
  v_mul_f32 v23, v4, v23
  v_cvt_pk_bf16_f32 v184, v16, v17
  v_mfma_f32_16x16x32_bf16 v[72:75], v[44:47], v[168:171], v[72:75]
  ds_read_b64_tr_b16 v[34:35], v2 offset:59648
  v_cvt_pk_bf16_f32 v185, v18, v19
  v_cvt_pk_bf16_f32 v186, v20, v21
  v_cvt_pk_bf16_f32 v187, v22, v23
  v_accvgpr_read_b32 v24, a120
  v_accvgpr_read_b32 v25, a121
  v_accvgpr_read_b32 v26, a122
  v_mfma_f32_16x16x32_bf16 v[76:79], v[40:43], v[164:167], v[76:79]
  ds_read_b64_tr_b16 v[36:37], v2 offset:51456
  v_accvgpr_read_b32 v27, a123
  v_accvgpr_read_b32 v28, a124
  v_accvgpr_read_b32 v29, a125
  v_accvgpr_read_b32 v30, a126
  v_accvgpr_read_b32 v31, a127
  v_mul_f32 v24, v5, v24
  v_mfma_f32_16x16x32_bf16 v[76:79], v[44:47], v[172:175], v[76:79]
  ds_read_b64_tr_b16 v[38:39], v2 offset:59904
  v_mul_f32 v25, v5, v25
  v_mul_f32 v26, v5, v26
  v_mul_f32 v27, v5, v27
  v_mul_f32 v28, v5, v28
  v_mul_f32 v29, v5, v29
  s_waitcnt lgkmcnt(8)
  v_mfma_f32_16x16x32_bf16 v[80:83], v[48:51], v[160:163], v[80:83]
  ds_read_b64_tr_b16 v[40:41], v2 offset:51232
  v_mul_f32 v30, v5, v30
  v_mul_f32 v31, v5, v31
  v_cvt_pk_bf16_f32 v188, v24, v25
  v_cvt_pk_bf16_f32 v189, v26, v27
  v_cvt_pk_bf16_f32 v190, v28, v29
  v_cvt_pk_bf16_f32 v191, v30, v31
  v_mfma_f32_16x16x32_bf16 v[80:83], v[52:55], v[168:171], v[80:83]
  ds_read_b64_tr_b16 v[42:43], v2 offset:59680
  v_accvgpr_read_b32 v16, a128
  v_accvgpr_read_b32 v17, a129
  v_accvgpr_read_b32 v18, a130
  v_accvgpr_read_b32 v19, a131
  v_accvgpr_read_b32 v20, a132
  v_accvgpr_read_b32 v21, a133
  v_mfma_f32_16x16x32_bf16 v[84:87], v[48:51], v[164:167], v[84:87]
  ds_read_b64_tr_b16 v[44:45], v2 offset:51488
  v_accvgpr_read_b32 v22, a134
  v_accvgpr_read_b32 v23, a135
  v_mul_f32 v16, v6, v16
  v_mul_f32 v17, v6, v17
  v_mul_f32 v18, v6, v18
  v_mul_f32 v19, v6, v19
  v_mfma_f32_16x16x32_bf16 v[84:87], v[52:55], v[172:175], v[84:87]
  ds_read_b64_tr_b16 v[46:47], v2 offset:59936
  v_mul_f32 v20, v6, v20
  v_mul_f32 v21, v6, v21
  v_mul_f32 v22, v6, v22
  v_mul_f32 v23, v6, v23
  v_cvt_pk_bf16_f32 v192, v16, v17
  s_waitcnt lgkmcnt(8)
  v_mfma_f32_16x16x32_bf16 v[88:91], v[56:59], v[160:163], v[88:91]
  ds_read_b64_tr_b16 v[48:49], v2 offset:51264
  v_cvt_pk_bf16_f32 v193, v18, v19
  v_cvt_pk_bf16_f32 v194, v20, v21
  v_cvt_pk_bf16_f32 v195, v22, v23
  v_accvgpr_read_b32 v24, a192
  v_accvgpr_read_b32 v25, a193
  v_accvgpr_read_b32 v26, a194
  v_accvgpr_read_b32 v27, a195
  v_mfma_f32_16x16x32_bf16 v[88:91], v[60:63], v[168:171], v[88:91]
  ds_read_b64_tr_b16 v[50:51], v2 offset:59712
  v_accvgpr_read_b32 v28, a196
  v_accvgpr_read_b32 v29, a197
  v_accvgpr_read_b32 v30, a198
  v_accvgpr_read_b32 v31, a199
  v_mul_f32 v24, v7, v24
  v_mul_f32 v25, v7, v25
  v_mfma_f32_16x16x32_bf16 v[92:95], v[56:59], v[164:167], v[92:95]
  ds_read_b64_tr_b16 v[52:53], v2 offset:51520
  v_mul_f32 v26, v7, v26
  v_mul_f32 v27, v7, v27
  v_mul_f32 v28, v7, v28
  v_mul_f32 v29, v7, v29
  v_mul_f32 v30, v7, v30
  v_mul_f32 v31, v7, v31
  v_mfma_f32_16x16x32_bf16 v[92:95], v[60:63], v[172:175], v[92:95]
  ds_read_b64_tr_b16 v[54:55], v2 offset:59968
  v_cvt_pk_bf16_f32 v196, v24, v25
  v_cvt_pk_bf16_f32 v197, v26, v27
  v_cvt_pk_bf16_f32 v198, v28, v29
  v_cvt_pk_bf16_f32 v199, v30, v31
  v_accvgpr_read_b32 v16, a136
  v_accvgpr_read_b32 v17, a137
  s_waitcnt lgkmcnt(8)
  v_mfma_f32_16x16x32_bf16 v[64:67], v[32:35], v[176:179], v[64:67]
  ds_read_b64_tr_b16 v[56:57], v2 offset:51296
  v_accvgpr_read_b32 v18, a138
  v_accvgpr_read_b32 v19, a139
  v_accvgpr_read_b32 v20, a140
  v_accvgpr_read_b32 v21, a141
  v_accvgpr_read_b32 v22, a142
  v_accvgpr_read_b32 v23, a143
  v_mfma_f32_16x16x32_bf16 v[64:67], v[36:39], v[184:187], v[64:67]
  ds_read_b64_tr_b16 v[58:59], v2 offset:59744
  v_mul_f32 v16, v6, v16
  v_mul_f32 v17, v6, v17
  v_mul_f32 v18, v6, v18
  v_mul_f32 v19, v6, v19
  v_mul_f32 v20, v6, v20
  s_waitcnt vmcnt(12)
  v_mfma_f32_16x16x32_bf16 v[68:71], v[32:35], v[180:183], v[68:71]
  ds_read_b64_tr_b16 v[60:61], v2 offset:51552
  v_mul_f32 v21, v6, v21
  v_mul_f32 v22, v6, v22
  v_mul_f32 v23, v6, v23
  v_cvt_pk_bf16_f32 v200, v16, v17
  v_cvt_pk_bf16_f32 v201, v18, v19
  s_barrier
  v_mfma_f32_16x16x32_bf16 v[68:71], v[36:39], v[188:191], v[68:71]
  ds_read_b64_tr_b16 v[62:63], v2 offset:60000
  v_cvt_pk_bf16_f32 v202, v20, v21
  v_cvt_pk_bf16_f32 v203, v22, v23
  v_accvgpr_read_b32 v24, a200
  v_accvgpr_read_b32 v25, a201
  v_accvgpr_read_b32 v26, a202
  v_accvgpr_read_b32 v27, a203
  s_waitcnt lgkmcnt(8)
  v_mfma_f32_16x16x32_bf16 v[72:75], v[40:43], v[176:179], v[72:75]
  ds_read_b64_tr_b16 v[32:33], v14 offset:50688
  s_add_u32 s63, s64, 344192
  v_accvgpr_read_b32 v28, a204
  v_accvgpr_read_b32 v29, a205
  v_accvgpr_read_b32 v30, a206
  v_accvgpr_read_b32 v31, a207
  v_mul_f32 v24, v7, v24
  v_mfma_f32_16x16x32_bf16 v[72:75], v[44:47], v[184:187], v[72:75]
  ds_read_b64_tr_b16 v[34:35], v14 offset:59136
  s_add_u32 m0, s31, 35840
  v_mul_f32 v25, v7, v25
  v_mul_f32 v26, v7, v26
  v_mul_f32 v27, v7, v27
  v_mul_f32 v28, v7, v28
  v_mul_f32 v29, v7, v29
  v_mfma_f32_16x16x32_bf16 v[76:79], v[40:43], v[180:183], v[76:79]
  ds_read_b64_tr_b16 v[36:37], v14 offset:50944
  buffer_load_dwordx4 v3, s[20:23], s63 offen offset:0  lds
  v_mul_f32 v30, v7, v30
  v_mul_f32 v31, v7, v31
  v_cvt_pk_bf16_f32 v204, v24, v25
  v_cvt_pk_bf16_f32 v205, v26, v27
  v_cvt_pk_bf16_f32 v206, v28, v29
  v_cvt_pk_bf16_f32 v207, v30, v31
  v_mfma_f32_16x16x32_bf16 v[76:79], v[44:47], v[188:191], v[76:79]
  ds_read_b64_tr_b16 v[38:39], v14 offset:59392
  v_accvgpr_read_b32 v16, a144
  v_accvgpr_read_b32 v17, a145
  v_accvgpr_read_b32 v18, a146
  v_accvgpr_read_b32 v19, a147
  v_accvgpr_read_b32 v20, a148
  s_waitcnt lgkmcnt(8)
  v_mfma_f32_16x16x32_bf16 v[80:83], v[48:51], v[176:179], v[80:83]
  ds_read_b64_tr_b16 v[40:41], v14 offset:50720
  v_accvgpr_read_b32 v21, a149
  v_accvgpr_read_b32 v22, a150
  v_accvgpr_read_b32 v23, a151
  v_mul_f32 v16, v6, v16
  v_mul_f32 v17, v6, v17
  v_mul_f32 v18, v6, v18
  v_mfma_f32_16x16x32_bf16 v[80:83], v[52:55], v[184:187], v[80:83]
  ds_read_b64_tr_b16 v[42:43], v14 offset:59168
  v_mul_f32 v19, v6, v19
  v_mul_f32 v20, v6, v20
  v_mul_f32 v21, v6, v21
  v_mul_f32 v22, v6, v22
  v_mul_f32 v23, v6, v23
  v_cvt_pk_bf16_f32 v208, v16, v17
  v_mfma_f32_16x16x32_bf16 v[84:87], v[48:51], v[180:183], v[84:87]
  ds_read_b64_tr_b16 v[44:45], v14 offset:50976
  v_cvt_pk_bf16_f32 v209, v18, v19
  v_cvt_pk_bf16_f32 v210, v20, v21
  v_cvt_pk_bf16_f32 v211, v22, v23
  v_accvgpr_read_b32 v24, a208
  v_accvgpr_read_b32 v25, a209
  v_accvgpr_read_b32 v26, a210
  v_mfma_f32_16x16x32_bf16 v[84:87], v[52:55], v[188:191], v[84:87]
  ds_read_b64_tr_b16 v[46:47], v14 offset:59424
  v_accvgpr_read_b32 v27, a211
  v_accvgpr_read_b32 v28, a212
  v_accvgpr_read_b32 v29, a213
  v_accvgpr_read_b32 v30, a214
  v_accvgpr_read_b32 v31, a215
  s_waitcnt lgkmcnt(8)
  v_mfma_f32_16x16x32_bf16 v[88:91], v[56:59], v[176:179], v[88:91]
  ds_read_b64_tr_b16 v[48:49], v14 offset:50752
  v_mul_f32 v24, v7, v24
  v_mul_f32 v25, v7, v25
  v_mul_f32 v26, v7, v26
  v_mul_f32 v27, v7, v27
  v_mul_f32 v28, v7, v28
  v_mul_f32 v29, v7, v29
  v_mfma_f32_16x16x32_bf16 v[88:91], v[60:63], v[184:187], v[88:91]
  ds_read_b64_tr_b16 v[50:51], v14 offset:59200
  v_mul_f32 v30, v7, v30
  v_mul_f32 v31, v7, v31
  v_cvt_pk_bf16_f32 v212, v24, v25
  v_cvt_pk_bf16_f32 v213, v26, v27
  v_cvt_pk_bf16_f32 v214, v28, v29
  v_cvt_pk_bf16_f32 v215, v30, v31
  v_accvgpr_read_b32 v16, a152
  v_mfma_f32_16x16x32_bf16 v[92:95], v[56:59], v[180:183], v[92:95]
  ds_read_b64_tr_b16 v[52:53], v14 offset:51008
  v_accvgpr_read_b32 v17, a153
  v_accvgpr_read_b32 v18, a154
  v_accvgpr_read_b32 v19, a155
  v_accvgpr_read_b32 v20, a156
  v_accvgpr_read_b32 v21, a157
  v_accvgpr_read_b32 v22, a158
  v_mfma_f32_16x16x32_bf16 v[92:95], v[60:63], v[188:191], v[92:95]
  ds_read_b64_tr_b16 v[54:55], v14 offset:59456
  v_accvgpr_read_b32 v23, a159
  v_mul_f32 v16, v6, v16
  v_mul_f32 v17, v6, v17
  v_mul_f32 v18, v6, v18
  v_mul_f32 v19, v6, v19
  s_waitcnt lgkmcnt(8)
  v_mfma_f32_16x16x32_bf16 v[64:67], v[32:35], v[192:195], v[64:67]
  ds_read_b64_tr_b16 v[56:57], v14 offset:50784
  s_add_u32 m0, s31, 35104
  v_mul_f32 v20, v6, v20
  v_mul_f32 v21, v6, v21
  v_mul_f32 v22, v6, v22
  v_mul_f32 v23, v6, v23
  v_cvt_pk_bf16_f32 v216, v16, v17
  v_mfma_f32_16x16x32_bf16 v[64:67], v[36:39], v[200:203], v[64:67]
  ds_read_b64_tr_b16 v[58:59], v14 offset:59232
  buffer_load_dwordx4 v3, s[20:23], s63 offen offset:1792  lds
  v_cvt_pk_bf16_f32 v217, v18, v19
  v_cvt_pk_bf16_f32 v218, v20, v21
  v_cvt_pk_bf16_f32 v219, v22, v23
  v_accvgpr_read_b32 v24, a216
  v_accvgpr_read_b32 v25, a217
  v_mfma_f32_16x16x32_bf16 v[68:71], v[32:35], v[196:199], v[68:71]
  ds_read_b64_tr_b16 v[60:61], v14 offset:51040
  v_accvgpr_read_b32 v26, a218
  v_accvgpr_read_b32 v27, a219
  v_accvgpr_read_b32 v28, a220
  v_accvgpr_read_b32 v29, a221
  v_accvgpr_read_b32 v30, a222
  v_accvgpr_read_b32 v31, a223
  v_mfma_f32_16x16x32_bf16 v[68:71], v[36:39], v[204:207], v[68:71]
  ds_read_b64_tr_b16 v[62:63], v14 offset:59488
  v_mul_f32 v24, v7, v24
  v_mul_f32 v25, v7, v25
  v_mul_f32 v26, v7, v26
  v_mul_f32 v27, v7, v27
  v_mul_f32 v28, v7, v28
  s_waitcnt lgkmcnt(8)
  v_mfma_f32_16x16x32_bf16 v[72:75], v[40:43], v[192:195], v[72:75]
  ds_read_b64_tr_b16 v[32:33], v14 offset:51200
  v_mul_f32 v29, v7, v29
  v_mul_f32 v30, v7, v30
  v_mul_f32 v31, v7, v31
  v_cvt_pk_bf16_f32 v220, v24, v25
  v_cvt_pk_bf16_f32 v221, v26, v27
  v_cvt_pk_bf16_f32 v222, v28, v29
  v_cvt_pk_bf16_f32 v223, v30, v31
  v_mfma_f32_16x16x32_bf16 v[72:75], v[44:47], v[200:203], v[72:75]
  ds_read_b64_tr_b16 v[34:35], v14 offset:59648
  v_accvgpr_read_b32 v16, a160
  v_accvgpr_read_b32 v17, a161
  v_accvgpr_read_b32 v18, a162
  v_accvgpr_read_b32 v19, a163
  v_accvgpr_read_b32 v20, a164
  v_accvgpr_read_b32 v21, a165
  v_mfma_f32_16x16x32_bf16 v[76:79], v[40:43], v[196:199], v[76:79]
  ds_read_b64_tr_b16 v[36:37], v14 offset:51456
  v_accvgpr_read_b32 v22, a166
  v_accvgpr_read_b32 v23, a167
  v_mul_f32 v16, v6, v16
  v_mul_f32 v17, v6, v17
  v_mul_f32 v18, v6, v18
  v_mul_f32 v19, v6, v19
  v_mfma_f32_16x16x32_bf16 v[76:79], v[44:47], v[204:207], v[76:79]
  ds_read_b64_tr_b16 v[38:39], v14 offset:59904
  v_mul_f32 v20, v6, v20
  v_mul_f32 v21, v6, v21
  v_mul_f32 v22, v6, v22
  v_mul_f32 v23, v6, v23
  v_cvt_pk_bf16_f32 v224, v16, v17
  s_waitcnt lgkmcnt(8)
  v_mfma_f32_16x16x32_bf16 v[80:83], v[48:51], v[192:195], v[80:83]
  ds_read_b64_tr_b16 v[40:41], v14 offset:51232
  s_add_u32 m0, s31, 34368
  v_cvt_pk_bf16_f32 v225, v18, v19
  v_cvt_pk_bf16_f32 v226, v20, v21
  v_cvt_pk_bf16_f32 v227, v22, v23
  v_accvgpr_read_b32 v24, a224
  v_accvgpr_read_b32 v25, a225
  v_mfma_f32_16x16x32_bf16 v[80:83], v[52:55], v[200:203], v[80:83]
  ds_read_b64_tr_b16 v[42:43], v14 offset:59680
  buffer_load_dwordx4 v3, s[20:23], s63 offen offset:3584  lds
  v_accvgpr_read_b32 v26, a226
  v_accvgpr_read_b32 v27, a227
  v_accvgpr_read_b32 v28, a228
  v_accvgpr_read_b32 v29, a229
  v_accvgpr_read_b32 v30, a230
  v_mfma_f32_16x16x32_bf16 v[84:87], v[48:51], v[196:199], v[84:87]
  ds_read_b64_tr_b16 v[44:45], v14 offset:51488
  v_accvgpr_read_b32 v31, a231
  v_mul_f32 v24, v7, v24
  v_mul_f32 v25, v7, v25
  v_mul_f32 v26, v7, v26
  v_mul_f32 v27, v7, v27
  v_mul_f32 v28, v7, v28
  v_mfma_f32_16x16x32_bf16 v[84:87], v[52:55], v[204:207], v[84:87]
  ds_read_b64_tr_b16 v[46:47], v14 offset:59936
  v_mul_f32 v29, v7, v29
  v_mul_f32 v30, v7, v30
  v_mul_f32 v31, v7, v31
  v_cvt_pk_bf16_f32 v228, v24, v25
  v_cvt_pk_bf16_f32 v229, v26, v27
  v_cvt_pk_bf16_f32 v230, v28, v29
  s_waitcnt lgkmcnt(8)
  v_mfma_f32_16x16x32_bf16 v[88:91], v[56:59], v[192:195], v[88:91]
  ds_read_b64_tr_b16 v[48:49], v14 offset:51264
  v_cvt_pk_bf16_f32 v231, v30, v31
  v_accvgpr_read_b32 v16, a168
  v_accvgpr_read_b32 v17, a169
  v_accvgpr_read_b32 v18, a170
  v_accvgpr_read_b32 v19, a171
  v_accvgpr_read_b32 v20, a172
  v_mfma_f32_16x16x32_bf16 v[88:91], v[60:63], v[200:203], v[88:91]
  ds_read_b64_tr_b16 v[50:51], v14 offset:59712
  v_accvgpr_read_b32 v21, a173
  v_accvgpr_read_b32 v22, a174
  v_accvgpr_read_b32 v23, a175
  v_mul_f32 v16, v6, v16
  v_mul_f32 v17, v6, v17
  v_mul_f32 v18, v6, v18
  v_mfma_f32_16x16x32_bf16 v[92:95], v[56:59], v[196:199], v[92:95]
  ds_read_b64_tr_b16 v[52:53], v14 offset:51520
  v_mul_f32 v19, v6, v19
  v_mul_f32 v20, v6, v20
  v_mul_f32 v21, v6, v21
  v_mul_f32 v22, v6, v22
  v_mul_f32 v23, v6, v23
  v_cvt_pk_bf16_f32 v232, v16, v17
  v_mfma_f32_16x16x32_bf16 v[92:95], v[60:63], v[204:207], v[92:95]
  ds_read_b64_tr_b16 v[54:55], v14 offset:59968
  v_cvt_pk_bf16_f32 v233, v18, v19
  v_cvt_pk_bf16_f32 v234, v20, v21
  v_cvt_pk_bf16_f32 v235, v22, v23
  v_accvgpr_read_b32 v24, a232
  v_accvgpr_read_b32 v25, a233
  s_waitcnt lgkmcnt(8)
  v_mfma_f32_16x16x32_bf16 v[64:67], v[32:35], v[208:211], v[64:67]
  ds_read_b64_tr_b16 v[56:57], v14 offset:51296
  v_accvgpr_read_b32 v26, a234
  v_accvgpr_read_b32 v27, a235
  v_accvgpr_read_b32 v28, a236
  v_accvgpr_read_b32 v29, a237
  v_accvgpr_read_b32 v30, a238
  v_accvgpr_read_b32 v31, a239
  v_mfma_f32_16x16x32_bf16 v[64:67], v[36:39], v[216:219], v[64:67]
  ds_read_b64_tr_b16 v[58:59], v14 offset:59744
  v_mul_f32 v24, v7, v24
  v_mul_f32 v25, v7, v25
  v_mul_f32 v26, v7, v26
  v_mul_f32 v27, v7, v27
  v_mul_f32 v28, v7, v28
  v_mul_f32 v29, v7, v29
  v_mfma_f32_16x16x32_bf16 v[68:71], v[32:35], v[212:215], v[68:71]
  ds_read_b64_tr_b16 v[60:61], v14 offset:51552
  s_add_u32 s63, s63, 1792
  v_mul_f32 v30, v7, v30
  v_mul_f32 v31, v7, v31
  v_cvt_pk_bf16_f32 v236, v24, v25
  v_cvt_pk_bf16_f32 v237, v26, v27
  v_cvt_pk_bf16_f32 v238, v28, v29
  v_cvt_pk_bf16_f32 v239, v30, v31
  v_mfma_f32_16x16x32_bf16 v[68:71], v[36:39], v[220:223], v[68:71]
  ds_read_b64_tr_b16 v[62:63], v14 offset:60000
  v_accvgpr_read_b32 v16, a176
  v_accvgpr_read_b32 v17, a177
  v_accvgpr_read_b32 v18, a178
  v_accvgpr_read_b32 v19, a179
  v_accvgpr_read_b32 v20, a180
  s_waitcnt lgkmcnt(8)
  v_mfma_f32_16x16x32_bf16 v[72:75], v[40:43], v[208:211], v[72:75]
  ds_read_b64_tr_b16 v[32:33], v2 offset:0
  s_add_u32 m0, s31, 35424
  v_accvgpr_read_b32 v21, a181
  v_accvgpr_read_b32 v22, a182
  v_accvgpr_read_b32 v23, a183
  v_mul_f32 v16, v6, v16
  v_mul_f32 v17, v6, v17
  v_mfma_f32_16x16x32_bf16 v[72:75], v[44:47], v[216:219], v[72:75]
  ds_read_b64_tr_b16 v[34:35], v2 offset:8448
  buffer_load_dwordx4 v3, s[20:23], s63 offen offset:3584  lds
  v_mul_f32 v18, v6, v18
  v_mul_f32 v19, v6, v19
  v_mul_f32 v20, v6, v20
  v_mul_f32 v21, v6, v21
  v_mul_f32 v22, v6, v22
  v_mfma_f32_16x16x32_bf16 v[76:79], v[40:43], v[212:215], v[76:79]
  ds_read_b64_tr_b16 v[36:37], v2 offset:256
  v_mul_f32 v23, v6, v23
  v_cvt_pk_bf16_f32 v240, v16, v17
  v_cvt_pk_bf16_f32 v241, v18, v19
  v_cvt_pk_bf16_f32 v242, v20, v21
  v_cvt_pk_bf16_f32 v243, v22, v23
  v_accvgpr_read_b32 v24, a240
  v_mfma_f32_16x16x32_bf16 v[76:79], v[44:47], v[220:223], v[76:79]
  ds_read_b64_tr_b16 v[38:39], v2 offset:8704
  v_accvgpr_read_b32 v25, a241
  v_accvgpr_read_b32 v26, a242
  v_accvgpr_read_b32 v27, a243
  v_accvgpr_read_b32 v28, a244
  v_accvgpr_read_b32 v29, a245
  s_waitcnt lgkmcnt(8)
  v_mfma_f32_16x16x32_bf16 v[80:83], v[48:51], v[208:211], v[80:83]
  ds_read_b64_tr_b16 v[40:41], v2 offset:512
  v_accvgpr_read_b32 v30, a246
  v_accvgpr_read_b32 v31, a247
  v_mul_f32 v24, v7, v24
  v_mul_f32 v25, v7, v25
  v_mul_f32 v26, v7, v26
  v_mul_f32 v27, v7, v27
  v_mfma_f32_16x16x32_bf16 v[80:83], v[52:55], v[216:219], v[80:83]
  ds_read_b64_tr_b16 v[42:43], v2 offset:8960
  v_mul_f32 v28, v7, v28
  v_mul_f32 v29, v7, v29
  v_mul_f32 v30, v7, v30
  v_mul_f32 v31, v7, v31
  v_cvt_pk_bf16_f32 v244, v24, v25
  v_cvt_pk_bf16_f32 v245, v26, v27
  v_cvt_pk_bf16_f32 v246, v28, v29
  v_mfma_f32_16x16x32_bf16 v[84:87], v[48:51], v[212:215], v[84:87]
  ds_read_b64_tr_b16 v[44:45], v2 offset:768
  v_cvt_pk_bf16_f32 v247, v30, v31
  v_accvgpr_read_b32 v16, a184
  v_accvgpr_read_b32 v17, a185
  v_accvgpr_read_b32 v18, a186
  v_accvgpr_read_b32 v19, a187
  v_accvgpr_read_b32 v20, a188
  v_mfma_f32_16x16x32_bf16 v[84:87], v[52:55], v[220:223], v[84:87]
  ds_read_b64_tr_b16 v[46:47], v2 offset:9216
  v_accvgpr_read_b32 v21, a189
  v_accvgpr_read_b32 v22, a190
  v_accvgpr_read_b32 v23, a191
  v_mul_f32 v16, v6, v16
  v_mul_f32 v17, v6, v17
  s_waitcnt lgkmcnt(8)
  v_mfma_f32_16x16x32_bf16 v[88:91], v[56:59], v[208:211], v[88:91]
  ds_read_b64_tr_b16 v[48:49], v2 offset:32
  v_mul_f32 v18, v6, v18
  v_mul_f32 v19, v6, v19
  v_mul_f32 v20, v6, v20
  v_mul_f32 v21, v6, v21
  v_mul_f32 v22, v6, v22
  v_mul_f32 v23, v6, v23
  v_mfma_f32_16x16x32_bf16 v[88:91], v[60:63], v[216:219], v[88:91]
  ds_read_b64_tr_b16 v[50:51], v2 offset:8480
  v_cvt_pk_bf16_f32 v248, v16, v17
  v_cvt_pk_bf16_f32 v249, v18, v19
  v_cvt_pk_bf16_f32 v250, v20, v21
  v_cvt_pk_bf16_f32 v251, v22, v23
  v_accvgpr_read_b32 v24, a248
  v_accvgpr_read_b32 v25, a249
  v_mfma_f32_16x16x32_bf16 v[92:95], v[56:59], v[212:215], v[92:95]
  ds_read_b64_tr_b16 v[52:53], v2 offset:288
  v_accvgpr_read_b32 v26, a250
  v_accvgpr_read_b32 v27, a251
  v_accvgpr_read_b32 v28, a252
  v_accvgpr_read_b32 v29, a253
  v_accvgpr_read_b32 v30, a254
  v_accvgpr_read_b32 v31, a255
  v_mfma_f32_16x16x32_bf16 v[92:95], v[60:63], v[220:223], v[92:95]
  ds_read_b64_tr_b16 v[54:55], v2 offset:8736
  v_mul_f32 v24, v7, v24
  v_mul_f32 v25, v7, v25
  v_mul_f32 v26, v7, v26
  v_mul_f32 v27, v7, v27
  v_mul_f32 v28, v7, v28
  s_waitcnt lgkmcnt(8)
  v_mfma_f32_16x16x32_bf16 v[64:67], v[32:35], v[224:227], v[64:67]
  ds_read_b64_tr_b16 v[56:57], v2 offset:544
  v_mul_f32 v29, v7, v29
  v_mul_f32 v30, v7, v30
  v_mul_f32 v31, v7, v31
  v_cvt_pk_bf16_f32 v252, v24, v25
  v_cvt_pk_bf16_f32 v253, v26, v27
  v_cvt_pk_bf16_f32 v254, v28, v29
  v_cvt_pk_bf16_f32 v255, v30, v31
  v_mfma_f32_16x16x32_bf16 v[64:67], v[36:39], v[232:235], v[64:67]
  ds_read_b64_tr_b16 v[58:59], v2 offset:8992
  v_mfma_f32_16x16x32_bf16 v[68:71], v[32:35], v[228:231], v[68:71]
  ds_read_b64_tr_b16 v[60:61], v2 offset:800
  v_mbcnt_lo_u32_b32 v10, -1, 0
  v_mfma_f32_16x16x32_bf16 v[68:71], v[36:39], v[236:239], v[68:71]
  ds_read_b64_tr_b16 v[62:63], v2 offset:9248
  s_waitcnt lgkmcnt(8)
  v_mfma_f32_16x16x32_bf16 v[64:67], v[40:43], v[240:243], v[64:67]
  ds_read_b64_tr_b16 v[32:33], v2 offset:64
  v_mbcnt_hi_u32_b32 v10, -1, v10
  v_mfma_f32_16x16x32_bf16 v[64:67], v[44:47], v[248:251], v[64:67]
  ds_read_b64_tr_b16 v[34:35], v2 offset:8512
  s_mul_i32 s38, s28, 114688
  v_mfma_f32_16x16x32_bf16 v[68:71], v[40:43], v[244:247], v[68:71]
  ds_read_b64_tr_b16 v[36:37], v2 offset:320
  s_mul_i32 s39, s3, 28672
  v_mfma_f32_16x16x32_bf16 v[68:71], v[44:47], v[252:255], v[68:71]
  ds_read_b64_tr_b16 v[38:39], v2 offset:8768
  s_waitcnt lgkmcnt(8)
  v_mfma_f32_16x16x32_bf16 v[72:75], v[48:51], v[224:227], v[72:75]
  ds_read_b64_tr_b16 v[40:41], v2 offset:576
  s_add_u32 s38, s38, s39
  v_mfma_f32_16x16x32_bf16 v[72:75], v[52:55], v[232:235], v[72:75]
  ds_read_b64_tr_b16 v[42:43], v2 offset:9024
  v_lshlrev_b32 v11, 4, v10
  v_mfma_f32_16x16x32_bf16 v[76:79], v[48:51], v[228:231], v[76:79]
  ds_read_b64_tr_b16 v[44:45], v2 offset:832
  v_add_u32 v1, s38, v11
  v_mfma_f32_16x16x32_bf16 v[76:79], v[52:55], v[236:239], v[76:79]
  ds_read_b64_tr_b16 v[46:47], v2 offset:9280
  s_waitcnt lgkmcnt(8)
  v_mfma_f32_16x16x32_bf16 v[72:75], v[56:59], v[240:243], v[72:75]
  ds_read_b64_tr_b16 v[48:49], v2 offset:96
  v_mfma_f32_16x16x32_bf16 v[72:75], v[60:63], v[248:251], v[72:75]
  ds_read_b64_tr_b16 v[50:51], v2 offset:8544
  v_mfma_f32_16x16x32_bf16 v[76:79], v[56:59], v[244:247], v[76:79]
  ds_read_b64_tr_b16 v[52:53], v2 offset:352
  v_mfma_f32_16x16x32_bf16 v[76:79], v[60:63], v[252:255], v[76:79]
  ds_read_b64_tr_b16 v[54:55], v2 offset:8800
  s_waitcnt lgkmcnt(8)
  v_mfma_f32_16x16x32_bf16 v[80:83], v[32:35], v[224:227], v[80:83]
  ds_read_b64_tr_b16 v[56:57], v2 offset:608
  s_mul_i32 s38, s28, 14336
  v_mfma_f32_16x16x32_bf16 v[80:83], v[36:39], v[232:235], v[80:83]
  ds_read_b64_tr_b16 v[58:59], v2 offset:9056
  s_waitcnt vmcnt(8)
  v_mfma_f32_16x16x32_bf16 v[84:87], v[32:35], v[228:231], v[84:87]
  ds_read_b64_tr_b16 v[60:61], v2 offset:864
  s_barrier
  v_mfma_f32_16x16x32_bf16 v[84:87], v[36:39], v[236:239], v[84:87]
  ds_read_b64_tr_b16 v[62:63], v2 offset:9312
  v_cvt_pk_bf16_f32 v64, v64, v65
  s_waitcnt lgkmcnt(8)
  v_mfma_f32_16x16x32_bf16 v[80:83], v[40:43], v[240:243], v[80:83]
  ds_read_b64_tr_b16 v[32:33], v14 offset:0
  s_add_u32 s63, s64, 256
  v_cvt_pk_bf16_f32 v65, v66, v67
  v_mfma_f32_16x16x32_bf16 v[80:83], v[44:47], v[248:251], v[80:83]
  ds_read_b64_tr_b16 v[34:35], v14 offset:8448
  s_add_u32 m0, s31, 103424
  v_cvt_pk_bf16_f32 v66, v72, v73
  v_mfma_f32_16x16x32_bf16 v[84:87], v[40:43], v[244:247], v[84:87]
  ds_read_b64_tr_b16 v[36:37], v14 offset:256
  buffer_load_dwordx4 v3, s[20:23], s63 offen offset:0  lds
  v_mfma_f32_16x16x32_bf16 v[84:87], v[44:47], v[252:255], v[84:87]
  ds_read_b64_tr_b16 v[38:39], v14 offset:8704
  v_cvt_pk_bf16_f32 v67, v74, v75
  s_waitcnt lgkmcnt(8)
  v_mfma_f32_16x16x32_bf16 v[88:91], v[48:51], v[224:227], v[88:91]
  ds_read_b64_tr_b16 v[40:41], v14 offset:32
  s_lshl_b32 s39, s3, 10
  s_mov_b32 s60, 0
  v_mfma_f32_16x16x32_bf16 v[88:91], v[52:55], v[232:235], v[88:91]
  ds_read_b64_tr_b16 v[42:43], v14 offset:8480
  s_add_u32 m0, s31, 102688
  buffer_store_dwordx4 v[64:67], v1, s[24:27], s60 offen offset:0 sc1
  v_mfma_f32_16x16x32_bf16 v[92:95], v[48:51], v[228:231], v[92:95]
  ds_read_b64_tr_b16 v[44:45], v14 offset:288
  buffer_load_dwordx4 v3, s[20:23], s63 offen offset:1792  lds
  v_mfma_f32_16x16x32_bf16 v[92:95], v[52:55], v[236:239], v[92:95]
  ds_read_b64_tr_b16 v[46:47], v14 offset:8736
  s_waitcnt lgkmcnt(8)
  v_mfma_f32_16x16x32_bf16 v[88:91], v[56:59], v[240:243], v[88:91]
  ds_read_b64_tr_b16 v[48:49], v14 offset:64
  s_add_u32 s38, s38, s39
  v_mfma_f32_16x16x32_bf16 v[88:91], v[60:63], v[248:251], v[88:91]
  ds_read_b64_tr_b16 v[50:51], v14 offset:8512
  v_add_u32 v11, s38, v11
  v_mfma_f32_16x16x32_bf16 v[92:95], v[56:59], v[244:247], v[92:95]
  ds_read_b64_tr_b16 v[52:53], v14 offset:320
  s_lshr_b32 s39, s3, 1
  v_mfma_f32_16x16x32_bf16 v[92:95], v[60:63], v[252:255], v[92:95]
  ds_read_b64_tr_b16 v[54:55], v14 offset:8768
  s_waitcnt lgkmcnt(8)
  v_mfma_f32_16x16x32_bf16 v[96:99], v[32:35], v[128:131], 0
  ds_read_b64_tr_b16 v[56:57], v14 offset:96
  s_add_u32 m0, s31, 101952
  v_mfma_f32_16x16x32_bf16 v[96:99], v[36:39], v[136:139], v[96:99]
  ds_read_b64_tr_b16 v[58:59], v14 offset:8544
  buffer_load_dwordx4 v3, s[20:23], s63 offen offset:3584  lds
  v_mfma_f32_16x16x32_bf16 v[100:103], v[32:35], v[132:135], 0
  ds_read_b64_tr_b16 v[60:61], v14 offset:352
  s_lshl_b32 s39, s39, 30
  v_mfma_f32_16x16x32_bf16 v[100:103], v[36:39], v[140:143], v[100:103]
  ds_read_b64_tr_b16 v[62:63], v14 offset:8800
  v_cvt_pk_bf16_f32 v68, v68, v69
  s_waitcnt lgkmcnt(8)
  v_mfma_f32_16x16x32_bf16 v[104:107], v[40:43], v[128:131], 0
  ds_read_b64_tr_b16 v[32:33], v14 offset:512
  s_add_u32 s63, s63, 1792
  v_cvt_pk_bf16_f32 v69, v70, v71
  v_mfma_f32_16x16x32_bf16 v[104:107], v[44:47], v[136:139], v[104:107]
  ds_read_b64_tr_b16 v[34:35], v14 offset:8960
  s_add_u32 m0, s31, 103008
  v_cvt_pk_bf16_f32 v70, v76, v77
  v_mfma_f32_16x16x32_bf16 v[108:111], v[40:43], v[132:135], 0
  ds_read_b64_tr_b16 v[36:37], v14 offset:768
  buffer_load_dwordx4 v3, s[20:23], s63 offen offset:3584  lds
  v_mfma_f32_16x16x32_bf16 v[108:111], v[44:47], v[140:143], v[108:111]
  ds_read_b64_tr_b16 v[38:39], v14 offset:9216
  v_cvt_pk_bf16_f32 v71, v78, v79
  s_waitcnt lgkmcnt(8)
  v_mfma_f32_16x16x32_bf16 v[112:115], v[48:51], v[128:131], 0
  ds_read_b64_tr_b16 v[40:41], v14 offset:544
  s_add_u32 s63, s64, 114944
  s_mov_b32 s61, 14336
  v_mfma_f32_16x16x32_bf16 v[112:115], v[52:55], v[136:139], v[112:115]
  ds_read_b64_tr_b16 v[42:43], v14 offset:8992
  s_add_u32 m0, s31, 52736
  buffer_store_dwordx4 v[68:71], v1, s[24:27], s61 offen offset:0 sc1
  v_mfma_f32_16x16x32_bf16 v[116:119], v[48:51], v[132:135], 0
  ds_read_b64_tr_b16 v[44:45], v14 offset:800
  buffer_load_dwordx4 v3, s[20:23], s63 offen offset:0  lds
  v_mfma_f32_16x16x32_bf16 v[116:119], v[52:55], v[140:143], v[116:119]
  ds_read_b64_tr_b16 v[46:47], v14 offset:9248
  s_waitcnt lgkmcnt(8)
  v_mfma_f32_16x16x32_bf16 v[120:123], v[56:59], v[128:131], 0
  ds_read_b64_tr_b16 v[48:49], v14 offset:576
  v_add_u32 v12, s39, v11
  v_mfma_f32_16x16x32_bf16 v[120:123], v[60:63], v[136:139], v[120:123]
  ds_read_b64_tr_b16 v[50:51], v14 offset:9024
  s_add_u32 m0, s31, 52000
  v_mfma_f32_16x16x32_bf16 v[124:127], v[56:59], v[132:135], 0
  ds_read_b64_tr_b16 v[52:53], v14 offset:832
  buffer_load_dwordx4 v3, s[20:23], s63 offen offset:1792  lds
  v_mfma_f32_16x16x32_bf16 v[124:127], v[60:63], v[140:143], v[124:127]
  ds_read_b64_tr_b16 v[54:55], v14 offset:9280
  s_waitcnt lgkmcnt(8)
  v_mfma_f32_16x16x32_bf16 v[96:99], v[32:35], v[144:147], v[96:99]
  ds_read_b64_tr_b16 v[56:57], v14 offset:608
  s_lshl_b32 s38, s29, 3
  v_mfma_f32_16x16x32_bf16 v[96:99], v[36:39], v[152:155], v[96:99]
  ds_read_b64_tr_b16 v[58:59], v14 offset:9056
  s_add_u32 s38, s38, s28
  v_mfma_f32_16x16x32_bf16 v[100:103], v[32:35], v[148:151], v[100:103]
  ds_read_b64_tr_b16 v[60:61], v14 offset:864
  s_mul_i32 s38, s38, 28672
  v_mfma_f32_16x16x32_bf16 v[100:103], v[36:39], v[156:159], v[100:103]
  ds_read_b64_tr_b16 v[62:63], v14 offset:9312
  v_cvt_pk_bf16_f32 v80, v80, v81
  s_waitcnt lgkmcnt(8)
  v_mfma_f32_16x16x32_bf16 v[104:107], v[40:43], v[144:147], v[104:107]
  ds_read_b64_tr_b16 v[32:33], v2 offset:16896
  s_add_u32 m0, s31, 51264
  v_mfma_f32_16x16x32_bf16 v[104:107], v[44:47], v[152:155], v[104:107]
  ds_read_b64_tr_b16 v[34:35], v2 offset:25344
  buffer_load_dwordx4 v3, s[20:23], s63 offen offset:3584  lds
  v_cvt_pk_bf16_f32 v81, v82, v83
  v_mfma_f32_16x16x32_bf16 v[108:111], v[40:43], v[148:151], v[108:111]
  ds_read_b64_tr_b16 v[36:37], v2 offset:17152
  s_mul_i32 s65, s30, 896
  v_cvt_pk_bf16_f32 v82, v88, v89
  v_mfma_f32_16x16x32_bf16 v[108:111], v[44:47], v[156:159], v[108:111]
  ds_read_b64_tr_b16 v[38:39], v2 offset:25600
  s_waitcnt lgkmcnt(8)
  v_mfma_f32_16x16x32_bf16 v[112:115], v[48:51], v[144:147], v[112:115]
  ds_read_b64_tr_b16 v[40:41], v2 offset:16928
  s_add_u32 s63, s63, 1792
  v_cvt_pk_bf16_f32 v83, v90, v91
  v_mfma_f32_16x16x32_bf16 v[112:115], v[52:55], v[152:155], v[112:115]
  ds_read_b64_tr_b16 v[42:43], v2 offset:25376
  s_add_u32 m0, s31, 52320
  buffer_store_dwordx4 v[80:83], v1, s[24:27], s60 offen offset:1024 sc1
  v_mfma_f32_16x16x32_bf16 v[116:119], v[48:51], v[148:151], v[116:119]
  ds_read_b64_tr_b16 v[44:45], v2 offset:17184
  buffer_load_dwordx4 v3, s[20:23], s63 offen offset:3584  lds
  v_mfma_f32_16x16x32_bf16 v[116:119], v[52:55], v[156:159], v[116:119]
  ds_read_b64_tr_b16 v[46:47], v2 offset:25632
  s_waitcnt lgkmcnt(8)
  v_mfma_f32_16x16x32_bf16 v[120:123], v[56:59], v[144:147], v[120:123]
  ds_read_b64_tr_b16 v[48:49], v2 offset:16960
  s_add_u32 s38, s38, s65
  v_mfma_f32_16x16x32_bf16 v[120:123], v[60:63], v[152:155], v[120:123]
  ds_read_b64_tr_b16 v[50:51], v2 offset:25408
  s_lshl_b32 s65, s3, 6
  v_mfma_f32_16x16x32_bf16 v[124:127], v[56:59], v[148:151], v[124:127]
  ds_read_b64_tr_b16 v[52:53], v2 offset:17216
  s_add_u32 s38, s38, s65
  v_mfma_f32_16x16x32_bf16 v[124:127], v[60:63], v[156:159], v[124:127]
  ds_read_b64_tr_b16 v[54:55], v2 offset:25664
  s_waitcnt lgkmcnt(8)
  v_mfma_f32_16x16x32_bf16 v[96:99], v[32:35], v[160:163], v[96:99]
  ds_read_b64_tr_b16 v[56:57], v2 offset:16992
  v_and_b32 v13, 15, v10
  v_mfma_f32_16x16x32_bf16 v[96:99], v[36:39], v[168:171], v[96:99]
  ds_read_b64_tr_b16 v[58:59], v2 offset:25440
  v_mul_u32_u24 v13, 1792, v13
  v_mfma_f32_16x16x32_bf16 v[100:103], v[32:35], v[164:167], v[100:103]
  ds_read_b64_tr_b16 v[60:61], v2 offset:17248
  v_add_u32 v13, s38, v13
  v_mfma_f32_16x16x32_bf16 v[100:103], v[36:39], v[172:175], v[100:103]
  ds_read_b64_tr_b16 v[62:63], v2 offset:25696
  v_cvt_pk_bf16_f32 v84, v84, v85
  s_waitcnt lgkmcnt(8)
  v_mfma_f32_16x16x32_bf16 v[104:107], v[40:43], v[160:163], v[104:107]
  ds_read_b64_tr_b16 v[32:33], v2 offset:17408
  v_bfe_u32 v9, v10, 4, 1
  v_mfma_f32_16x16x32_bf16 v[104:107], v[44:47], v[168:171], v[104:107]
  ds_read_b64_tr_b16 v[34:35], v2 offset:25856
  v_lshl_add_u32 v13, v9, 5, v13
  v_cvt_pk_bf16_f32 v85, v86, v87
  v_mfma_f32_16x16x32_bf16 v[108:111], v[40:43], v[164:167], v[108:111]
  ds_read_b64_tr_b16 v[36:37], v2 offset:17664
  v_lshrrev_b32 v9, 5, v10
  v_cvt_pk_bf16_f32 v86, v92, v93
  v_mfma_f32_16x16x32_bf16 v[108:111], v[44:47], v[172:175], v[108:111]
  ds_read_b64_tr_b16 v[38:39], v2 offset:26112
  s_waitcnt lgkmcnt(8)
  v_mfma_f32_16x16x32_bf16 v[112:115], v[48:51], v[160:163], v[112:115]
  ds_read_b64_tr_b16 v[40:41], v2 offset:17440
  v_lshl_add_u32 v13, v9, 4, v13
  v_cvt_pk_bf16_f32 v87, v94, v95
  v_mfma_f32_16x16x32_bf16 v[112:115], v[52:55], v[168:171], v[112:115]
  ds_read_b64_tr_b16 v[42:43], v2 offset:25888
  v_add_u32 v9, s39, v13
  buffer_store_dwordx4 v[84:87], v1, s[24:27], s61 offen offset:1024 sc1
  v_mfma_f32_16x16x32_bf16 v[116:119], v[48:51], v[164:167], v[116:119]
  ds_read_b64_tr_b16 v[44:45], v2 offset:17696
  v_lshlrev_b32 v15, 10, v10
  v_mfma_f32_16x16x32_bf16 v[116:119], v[52:55], v[172:175], v[116:119]
  ds_read_b64_tr_b16 v[46:47], v2 offset:26144
  s_waitcnt lgkmcnt(8)
  v_mfma_f32_16x16x32_bf16 v[120:123], v[56:59], v[160:163], v[120:123]
  ds_read_b64_tr_b16 v[48:49], v2 offset:17472
  s_lshr_b32 s38, s28, 1
  v_mfma_f32_16x16x32_bf16 v[120:123], v[60:63], v[168:171], v[120:123]
  ds_read_b64_tr_b16 v[50:51], v2 offset:25920
  s_lshl_b32 s38, s38, 8
  v_mfma_f32_16x16x32_bf16 v[124:127], v[56:59], v[164:167], v[124:127]
  ds_read_b64_tr_b16 v[52:53], v2 offset:17728
  v_and_b32 v10, 7, v10
  v_mfma_f32_16x16x32_bf16 v[124:127], v[60:63], v[172:175], v[124:127]
  ds_read_b64_tr_b16 v[54:55], v2 offset:26176
  s_waitcnt lgkmcnt(8)
  v_mfma_f32_16x16x32_bf16 v[96:99], v[32:35], v[176:179], v[96:99]
  ds_read_b64_tr_b16 v[56:57], v2 offset:17504
  v_lshlrev_b32 v10, 2, v10
  v_mfma_f32_16x16x32_bf16 v[96:99], v[36:39], v[184:187], v[96:99]
  ds_read_b64_tr_b16 v[58:59], v2 offset:25952
  s_waitcnt vmcnt(12)
  v_mfma_f32_16x16x32_bf16 v[100:103], v[32:35], v[180:183], v[100:103]
  ds_read_b64_tr_b16 v[60:61], v2 offset:17760
  s_barrier
  v_mfma_f32_16x16x32_bf16 v[100:103], v[36:39], v[188:191], v[100:103]
  ds_read_b64_tr_b16 v[62:63], v2 offset:26208
  s_waitcnt lgkmcnt(8)
  v_mfma_f32_16x16x32_bf16 v[104:107], v[40:43], v[176:179], v[104:107]
  ds_read_b64_tr_b16 v[32:33], v14 offset:16896
  s_add_u32 s63, s64, 229632
  v_mfma_f32_16x16x32_bf16 v[104:107], v[44:47], v[184:187], v[104:107]
  ds_read_b64_tr_b16 v[34:35], v14 offset:25344
  s_add_u32 m0, s31, 120320
  v_mfma_f32_16x16x32_bf16 v[108:111], v[40:43], v[180:183], v[108:111]
  ds_read_b64_tr_b16 v[36:37], v14 offset:17152
  buffer_load_dwordx4 v3, s[20:23], s63 offen offset:0  lds
  v_mfma_f32_16x16x32_bf16 v[108:111], v[44:47], v[188:191], v[108:111]
  ds_read_b64_tr_b16 v[38:39], v14 offset:25600
  s_waitcnt lgkmcnt(8)
  v_mfma_f32_16x16x32_bf16 v[112:115], v[48:51], v[176:179], v[112:115]
  ds_read_b64_tr_b16 v[40:41], v14 offset:16928
  v_add_u32 v10, s38, v10
  v_mfma_f32_16x16x32_bf16 v[112:115], v[52:55], v[184:187], v[112:115]
  ds_read_b64_tr_b16 v[42:43], v14 offset:25376
  s_add_u32 m0, s31, 119584
  v_mfma_f32_16x16x32_bf16 v[116:119], v[48:51], v[180:183], v[116:119]
  ds_read_b64_tr_b16 v[44:45], v14 offset:17184
  buffer_load_dwordx4 v3, s[20:23], s63 offen offset:1792  lds
  v_mfma_f32_16x16x32_bf16 v[116:119], v[52:55], v[188:191], v[116:119]
  ds_read_b64_tr_b16 v[46:47], v14 offset:25632
  s_waitcnt lgkmcnt(8)
  v_mfma_f32_16x16x32_bf16 v[120:123], v[56:59], v[176:179], v[120:123]
  ds_read_b64_tr_b16 v[48:49], v14 offset:16960
  s_mov_b32 s5, 114688
  v_mfma_f32_16x16x32_bf16 v[120:123], v[60:63], v[184:187], v[120:123]
  ds_read_b64_tr_b16 v[50:51], v14 offset:25408
  s_mov_b32 s6, 229376
  v_mfma_f32_16x16x32_bf16 v[124:127], v[56:59], v[180:183], v[124:127]
  ds_read_b64_tr_b16 v[52:53], v14 offset:17216
  s_mov_b32 s7, 344064
  v_mfma_f32_16x16x32_bf16 v[124:127], v[60:63], v[188:191], v[124:127]
  ds_read_b64_tr_b16 v[54:55], v14 offset:25664
  s_waitcnt lgkmcnt(8)
  v_mfma_f32_16x16x32_bf16 v[96:99], v[32:35], v[192:195], v[96:99]
  ds_read_b64_tr_b16 v[56:57], v14 offset:16992
  s_add_u32 m0, s31, 118848
  v_mfma_f32_16x16x32_bf16 v[96:99], v[36:39], v[200:203], v[96:99]
  ds_read_b64_tr_b16 v[58:59], v14 offset:25440
  buffer_load_dwordx4 v3, s[20:23], s63 offen offset:3584  lds
  v_mfma_f32_16x16x32_bf16 v[100:103], v[32:35], v[196:199], v[100:103]
  ds_read_b64_tr_b16 v[60:61], v14 offset:17248
  s_mov_b32 s8, 458752
  v_mfma_f32_16x16x32_bf16 v[100:103], v[36:39], v[204:207], v[100:103]
  ds_read_b64_tr_b16 v[62:63], v14 offset:25696
  s_waitcnt lgkmcnt(8)
  v_mfma_f32_16x16x32_bf16 v[104:107], v[40:43], v[192:195], v[104:107]
  ds_read_b64_tr_b16 v[32:33], v14 offset:17408
  s_add_u32 s63, s63, 1792
  v_mfma_f32_16x16x32_bf16 v[104:107], v[44:47], v[200:203], v[104:107]
  ds_read_b64_tr_b16 v[34:35], v14 offset:25856
  s_add_u32 m0, s31, 119904
  v_mfma_f32_16x16x32_bf16 v[108:111], v[40:43], v[196:199], v[108:111]
  ds_read_b64_tr_b16 v[36:37], v14 offset:17664
  buffer_load_dwordx4 v3, s[20:23], s63 offen offset:3584  lds
  v_mfma_f32_16x16x32_bf16 v[108:111], v[44:47], v[204:207], v[108:111]
  ds_read_b64_tr_b16 v[38:39], v14 offset:26112
  s_waitcnt lgkmcnt(8)
  v_mfma_f32_16x16x32_bf16 v[112:115], v[48:51], v[192:195], v[112:115]
  ds_read_b64_tr_b16 v[40:41], v14 offset:17440
  s_add_u32 s63, s64, 344320
  v_mfma_f32_16x16x32_bf16 v[112:115], v[52:55], v[200:203], v[112:115]
  ds_read_b64_tr_b16 v[42:43], v14 offset:25888
  s_add_u32 m0, s31, 2048
  v_mfma_f32_16x16x32_bf16 v[116:119], v[48:51], v[196:199], v[116:119]
  ds_read_b64_tr_b16 v[44:45], v14 offset:17696
  buffer_load_dwordx4 v3, s[20:23], s63 offen offset:0  lds
  v_mfma_f32_16x16x32_bf16 v[116:119], v[52:55], v[204:207], v[116:119]
  ds_read_b64_tr_b16 v[46:47], v14 offset:26144
  s_waitcnt lgkmcnt(8)
  v_mfma_f32_16x16x32_bf16 v[120:123], v[56:59], v[192:195], v[120:123]
  ds_read_b64_tr_b16 v[48:49], v14 offset:17472
  s_mov_b32 s9, 573440
  v_mfma_f32_16x16x32_bf16 v[120:123], v[60:63], v[200:203], v[120:123]
  ds_read_b64_tr_b16 v[50:51], v14 offset:25920
  s_add_u32 m0, s31, 1312
  v_mfma_f32_16x16x32_bf16 v[124:127], v[56:59], v[196:199], v[124:127]
  ds_read_b64_tr_b16 v[52:53], v14 offset:17728
  buffer_load_dwordx4 v3, s[20:23], s63 offen offset:1792  lds
  v_mfma_f32_16x16x32_bf16 v[124:127], v[60:63], v[204:207], v[124:127]
  ds_read_b64_tr_b16 v[54:55], v14 offset:26176
  s_waitcnt lgkmcnt(8)
  v_mfma_f32_16x16x32_bf16 v[96:99], v[32:35], v[208:211], v[96:99]
  ds_read_b64_tr_b16 v[56:57], v14 offset:17504
  s_mov_b32 s10, 688128
  v_mfma_f32_16x16x32_bf16 v[96:99], v[36:39], v[216:219], v[96:99]
  ds_read_b64_tr_b16 v[58:59], v14 offset:25952
  s_mov_b32 s11, 802816
  v_mfma_f32_16x16x32_bf16 v[100:103], v[32:35], v[212:215], v[100:103]
  ds_read_b64_tr_b16 v[60:61], v14 offset:17760
  v_mfma_f32_16x16x32_bf16 v[100:103], v[36:39], v[220:223], v[100:103]
  ds_read_b64_tr_b16 v[62:63], v14 offset:26208
  s_waitcnt lgkmcnt(8)
  v_mfma_f32_16x16x32_bf16 v[104:107], v[40:43], v[208:211], v[104:107]
  ds_read_b64_tr_b16 v[32:33], v2 offset:33792
  s_add_u32 m0, s31, 576
  v_mfma_f32_16x16x32_bf16 v[104:107], v[44:47], v[216:219], v[104:107]
  ds_read_b64_tr_b16 v[34:35], v2 offset:42240
  buffer_load_dwordx4 v3, s[20:23], s63 offen offset:3584  lds
  v_mfma_f32_16x16x32_bf16 v[108:111], v[40:43], v[212:215], v[108:111]
  ds_read_b64_tr_b16 v[36:37], v2 offset:34048
  v_mfma_f32_16x16x32_bf16 v[108:111], v[44:47], v[220:223], v[108:111]
  ds_read_b64_tr_b16 v[38:39], v2 offset:42496
  s_waitcnt lgkmcnt(8)
  v_mfma_f32_16x16x32_bf16 v[112:115], v[48:51], v[208:211], v[112:115]
  ds_read_b64_tr_b16 v[40:41], v2 offset:34304
  s_add_u32 s63, s63, 1792
  v_mfma_f32_16x16x32_bf16 v[112:115], v[52:55], v[216:219], v[112:115]
  ds_read_b64_tr_b16 v[42:43], v2 offset:42752
  s_add_u32 m0, s31, 1632
  v_mfma_f32_16x16x32_bf16 v[116:119], v[48:51], v[212:215], v[116:119]
  ds_read_b64_tr_b16 v[44:45], v2 offset:34560
  buffer_load_dwordx4 v3, s[20:23], s63 offen offset:3584  lds
  v_mfma_f32_16x16x32_bf16 v[116:119], v[52:55], v[220:223], v[116:119]
  ds_read_b64_tr_b16 v[46:47], v2 offset:43008
  s_waitcnt lgkmcnt(8)
  v_mfma_f32_16x16x32_bf16 v[120:123], v[56:59], v[208:211], v[120:123]
  ds_read_b64_tr_b16 v[48:49], v2 offset:33824
  v_mfma_f32_16x16x32_bf16 v[120:123], v[60:63], v[216:219], v[120:123]
  ds_read_b64_tr_b16 v[50:51], v2 offset:42272
  v_mfma_f32_16x16x32_bf16 v[124:127], v[56:59], v[212:215], v[124:127]
  ds_read_b64_tr_b16 v[52:53], v2 offset:34080
  v_mfma_f32_16x16x32_bf16 v[124:127], v[60:63], v[220:223], v[124:127]
  ds_read_b64_tr_b16 v[54:55], v2 offset:42528
  s_waitcnt lgkmcnt(8)
  v_mfma_f32_16x16x32_bf16 v[96:99], v[32:35], v[224:227], v[96:99]
  ds_read_b64_tr_b16 v[56:57], v2 offset:34336
  v_mfma_f32_16x16x32_bf16 v[96:99], v[36:39], v[232:235], v[96:99]
  ds_read_b64_tr_b16 v[58:59], v2 offset:42784
  v_mfma_f32_16x16x32_bf16 v[100:103], v[32:35], v[228:231], v[100:103]
  ds_read_b64_tr_b16 v[60:61], v2 offset:34592
  v_mfma_f32_16x16x32_bf16 v[100:103], v[36:39], v[236:239], v[100:103]
  ds_read_b64_tr_b16 v[62:63], v2 offset:43040
  s_waitcnt lgkmcnt(8)
  v_mfma_f32_16x16x32_bf16 v[96:99], v[40:43], v[240:243], v[96:99]
  ds_read_b64_tr_b16 v[32:33], v2 offset:33856
  v_mfma_f32_16x16x32_bf16 v[96:99], v[44:47], v[248:251], v[96:99]
  ds_read_b64_tr_b16 v[34:35], v2 offset:42304
  v_mfma_f32_16x16x32_bf16 v[100:103], v[40:43], v[244:247], v[100:103]
  ds_read_b64_tr_b16 v[36:37], v2 offset:34112
  v_mfma_f32_16x16x32_bf16 v[100:103], v[44:47], v[252:255], v[100:103]
  ds_read_b64_tr_b16 v[38:39], v2 offset:42560
  s_waitcnt lgkmcnt(8)
  v_mfma_f32_16x16x32_bf16 v[104:107], v[48:51], v[224:227], v[104:107]
  ds_read_b64_tr_b16 v[40:41], v2 offset:34368
  v_mfma_f32_16x16x32_bf16 v[104:107], v[52:55], v[232:235], v[104:107]
  ds_read_b64_tr_b16 v[42:43], v2 offset:42816
  v_mfma_f32_16x16x32_bf16 v[108:111], v[48:51], v[228:231], v[108:111]
  ds_read_b64_tr_b16 v[44:45], v2 offset:34624
  v_mfma_f32_16x16x32_bf16 v[108:111], v[52:55], v[236:239], v[108:111]
  ds_read_b64_tr_b16 v[46:47], v2 offset:43072
  s_waitcnt lgkmcnt(8)
  v_mfma_f32_16x16x32_bf16 v[104:107], v[56:59], v[240:243], v[104:107]
  ds_read_b64_tr_b16 v[48:49], v2 offset:33888
  v_mfma_f32_16x16x32_bf16 v[104:107], v[60:63], v[248:251], v[104:107]
  ds_read_b64_tr_b16 v[50:51], v2 offset:42336
  v_mfma_f32_16x16x32_bf16 v[108:111], v[56:59], v[244:247], v[108:111]
  ds_read_b64_tr_b16 v[52:53], v2 offset:34144
  v_mfma_f32_16x16x32_bf16 v[108:111], v[60:63], v[252:255], v[108:111]
  ds_read_b64_tr_b16 v[54:55], v2 offset:42592
  s_waitcnt lgkmcnt(8)
  v_mfma_f32_16x16x32_bf16 v[112:115], v[32:35], v[224:227], v[112:115]
  ds_read_b64_tr_b16 v[56:57], v2 offset:34400
  v_mfma_f32_16x16x32_bf16 v[112:115], v[36:39], v[232:235], v[112:115]
  ds_read_b64_tr_b16 v[58:59], v2 offset:42848
  s_waitcnt vmcnt(9)
  v_mfma_f32_16x16x32_bf16 v[116:119], v[32:35], v[228:231], v[116:119]
  ds_read_b64_tr_b16 v[60:61], v2 offset:34656
  s_barrier
  v_mfma_f32_16x16x32_bf16 v[116:119], v[36:39], v[236:239], v[116:119]
  ds_read_b64_tr_b16 v[62:63], v2 offset:43104
  v_cvt_pk_bf16_f32 v96, v96, v97
  s_waitcnt lgkmcnt(8)
  v_mfma_f32_16x16x32_bf16 v[112:115], v[40:43], v[240:243], v[112:115]
  ds_read_b64_tr_b16 v[32:33], v14 offset:33792
  s_add_u32 s63, s64, 384
  v_mfma_f32_16x16x32_bf16 v[112:115], v[44:47], v[248:251], v[112:115]
  ds_read_b64_tr_b16 v[34:35], v14 offset:42240
  s_add_u32 m0, s31, 69632
  v_cvt_pk_bf16_f32 v97, v98, v99
  v_mfma_f32_16x16x32_bf16 v[116:119], v[40:43], v[244:247], v[116:119]
  ds_read_b64_tr_b16 v[36:37], v14 offset:34048
  buffer_load_dwordx4 v3, s[20:23], s63 offen offset:0  lds
  v_mfma_f32_16x16x32_bf16 v[116:119], v[44:47], v[252:255], v[116:119]
  ds_read_b64_tr_b16 v[38:39], v14 offset:42496
  v_cvt_pk_bf16_f32 v98, v104, v105
  s_waitcnt lgkmcnt(8)
  v_mfma_f32_16x16x32_bf16 v[120:123], v[48:51], v[224:227], v[120:123]
  ds_read_b64_tr_b16 v[40:41], v14 offset:33824
  v_cvt_pk_bf16_f32 v99, v106, v107
  v_mfma_f32_16x16x32_bf16 v[120:123], v[52:55], v[232:235], v[120:123]
  ds_read_b64_tr_b16 v[42:43], v14 offset:42272
  s_add_u32 m0, s31, 68896
  buffer_store_dwordx4 v[96:99], v1, s[24:27], s60 offen offset:2048 sc1
  v_mfma_f32_16x16x32_bf16 v[124:127], v[48:51], v[228:231], v[124:127]
  ds_read_b64_tr_b16 v[44:45], v14 offset:34080
  buffer_load_dwordx4 v3, s[20:23], s63 offen offset:1792  lds
  v_mfma_f32_16x16x32_bf16 v[124:127], v[52:55], v[236:239], v[124:127]
  ds_read_b64_tr_b16 v[46:47], v14 offset:42528
  s_waitcnt lgkmcnt(8)
  v_mfma_f32_16x16x32_bf16 v[120:123], v[56:59], v[240:243], v[120:123]
  ds_read_b64_tr_b16 v[48:49], v14 offset:33856
  v_mfma_f32_16x16x32_bf16 v[120:123], v[60:63], v[248:251], v[120:123]
  ds_read_b64_tr_b16 v[50:51], v14 offset:42304
  v_mfma_f32_16x16x32_bf16 v[124:127], v[56:59], v[244:247], v[124:127]
  ds_read_b64_tr_b16 v[52:53], v14 offset:34112
  v_mfma_f32_16x16x32_bf16 v[124:127], v[60:63], v[252:255], v[124:127]
  ds_read_b64_tr_b16 v[54:55], v14 offset:42560
  s_waitcnt lgkmcnt(8)
  v_mfma_f32_16x16x32_bf16 v[64:67], v[32:35], v[128:131], 0
  ds_read_b64_tr_b16 v[56:57], v14 offset:33888
  s_add_u32 m0, s31, 68160
  v_mfma_f32_16x16x32_bf16 v[64:67], v[36:39], v[136:139], v[64:67]
  ds_read_b64_tr_b16 v[58:59], v14 offset:42336
  buffer_load_dwordx4 v3, s[20:23], s63 offen offset:3584  lds
  v_mfma_f32_16x16x32_bf16 v[68:71], v[32:35], v[132:135], 0
  ds_read_b64_tr_b16 v[60:61], v14 offset:34144
  v_cvt_pk_bf16_f32 v100, v100, v101
  v_mfma_f32_16x16x32_bf16 v[68:71], v[36:39], v[140:143], v[68:71]
  ds_read_b64_tr_b16 v[62:63], v14 offset:42592
  v_cvt_pk_bf16_f32 v101, v102, v103
  s_waitcnt lgkmcnt(8)
  v_mfma_f32_16x16x32_bf16 v[72:75], v[40:43], v[128:131], 0
  ds_read_b64_tr_b16 v[32:33], v14 offset:34304
  s_add_u32 s63, s63, 1792
  buffer_load_dword v5, off, s[44:47], s37 sc1
  v_mfma_f32_16x16x32_bf16 v[72:75], v[44:47], v[136:139], v[72:75]
  ds_read_b64_tr_b16 v[34:35], v14 offset:42752
  s_add_u32 m0, s31, 69216
  v_cvt_pk_bf16_f32 v102, v108, v109
  v_mfma_f32_16x16x32_bf16 v[76:79], v[40:43], v[132:135], 0
  ds_read_b64_tr_b16 v[36:37], v14 offset:34560
  buffer_load_dwordx4 v3, s[20:23], s63 offen offset:3584  lds
  v_mfma_f32_16x16x32_bf16 v[76:79], v[44:47], v[140:143], v[76:79]
  ds_read_b64_tr_b16 v[38:39], v14 offset:43008
  v_cvt_pk_bf16_f32 v103, v110, v111
  s_waitcnt lgkmcnt(8)
  v_mfma_f32_16x16x32_bf16 v[80:83], v[48:51], v[128:131], 0
  ds_read_b64_tr_b16 v[40:41], v14 offset:34336
  s_add_u32 s63, s64, 115072
  v_mfma_f32_16x16x32_bf16 v[80:83], v[52:55], v[136:139], v[80:83]
  ds_read_b64_tr_b16 v[42:43], v14 offset:42784
  s_add_u32 m0, s31, 18944
  buffer_store_dwordx4 v[100:103], v1, s[24:27], s61 offen offset:2048 sc1
  v_mfma_f32_16x16x32_bf16 v[84:87], v[48:51], v[132:135], 0
  ds_read_b64_tr_b16 v[44:45], v14 offset:34592
  buffer_load_dwordx4 v3, s[20:23], s63 offen offset:0  lds
  v_mfma_f32_16x16x32_bf16 v[84:87], v[52:55], v[140:143], v[84:87]
  ds_read_b64_tr_b16 v[46:47], v14 offset:43040
  s_waitcnt lgkmcnt(8)
  v_mfma_f32_16x16x32_bf16 v[88:91], v[56:59], v[128:131], 0
  ds_read_b64_tr_b16 v[48:49], v14 offset:34368
  v_mfma_f32_16x16x32_bf16 v[88:91], v[60:63], v[136:139], v[88:91]
  ds_read_b64_tr_b16 v[50:51], v14 offset:42816
  s_add_u32 m0, s31, 18208
  v_mfma_f32_16x16x32_bf16 v[92:95], v[56:59], v[132:135], 0
  ds_read_b64_tr_b16 v[52:53], v14 offset:34624
  buffer_load_dwordx4 v3, s[20:23], s63 offen offset:1792  lds
  v_mfma_f32_16x16x32_bf16 v[92:95], v[60:63], v[140:143], v[92:95]
  ds_read_b64_tr_b16 v[54:55], v14 offset:43072
  s_waitcnt lgkmcnt(8)
  v_mfma_f32_16x16x32_bf16 v[64:67], v[32:35], v[144:147], v[64:67]
  ds_read_b64_tr_b16 v[56:57], v14 offset:34400
  v_mfma_f32_16x16x32_bf16 v[64:67], v[36:39], v[152:155], v[64:67]
  ds_read_b64_tr_b16 v[58:59], v14 offset:42848
  v_mfma_f32_16x16x32_bf16 v[68:71], v[32:35], v[148:151], v[68:71]
  ds_read_b64_tr_b16 v[60:61], v14 offset:34656
  v_cvt_pk_bf16_f32 v112, v112, v113
  v_mfma_f32_16x16x32_bf16 v[68:71], v[36:39], v[156:159], v[68:71]
  ds_read_b64_tr_b16 v[62:63], v14 offset:43104
  s_waitcnt lgkmcnt(8)
  v_mfma_f32_16x16x32_bf16 v[72:75], v[40:43], v[144:147], v[72:75]
  ds_read_b64_tr_b16 v[32:33], v2 offset:50688
  s_add_u32 m0, s31, 17472
  v_cvt_pk_bf16_f32 v113, v114, v115
  v_mfma_f32_16x16x32_bf16 v[72:75], v[44:47], v[152:155], v[72:75]
  ds_read_b64_tr_b16 v[34:35], v2 offset:59136
  buffer_load_dwordx4 v3, s[20:23], s63 offen offset:3584  lds
  v_mfma_f32_16x16x32_bf16 v[76:79], v[40:43], v[148:151], v[76:79]
  ds_read_b64_tr_b16 v[36:37], v2 offset:50944
  v_cvt_pk_bf16_f32 v114, v120, v121
  v_mfma_f32_16x16x32_bf16 v[76:79], v[44:47], v[156:159], v[76:79]
  ds_read_b64_tr_b16 v[38:39], v2 offset:59392
  v_cvt_pk_bf16_f32 v115, v122, v123
  s_waitcnt lgkmcnt(8)
  v_mfma_f32_16x16x32_bf16 v[80:83], v[48:51], v[144:147], v[80:83]
  ds_read_b64_tr_b16 v[40:41], v2 offset:50720
  s_add_u32 s63, s63, 1792
  v_mfma_f32_16x16x32_bf16 v[80:83], v[52:55], v[152:155], v[80:83]
  ds_read_b64_tr_b16 v[42:43], v2 offset:59168
  s_add_u32 m0, s31, 18528
  buffer_store_dwordx4 v[112:115], v1, s[24:27], s60 offen offset:3072 sc1
  v_mfma_f32_16x16x32_bf16 v[84:87], v[48:51], v[148:151], v[84:87]
  ds_read_b64_tr_b16 v[44:45], v2 offset:50976
  buffer_load_dwordx4 v3, s[20:23], s63 offen offset:3584  lds
  v_mfma_f32_16x16x32_bf16 v[84:87], v[52:55], v[156:159], v[84:87]
  ds_read_b64_tr_b16 v[46:47], v2 offset:59424
  s_waitcnt lgkmcnt(8)
  v_mfma_f32_16x16x32_bf16 v[88:91], v[56:59], v[144:147], v[88:91]
  ds_read_b64_tr_b16 v[48:49], v2 offset:50752
  v_mfma_f32_16x16x32_bf16 v[88:91], v[60:63], v[152:155], v[88:91]
  ds_read_b64_tr_b16 v[50:51], v2 offset:59200
  v_mfma_f32_16x16x32_bf16 v[92:95], v[56:59], v[148:151], v[92:95]
  ds_read_b64_tr_b16 v[52:53], v2 offset:51008
  v_mfma_f32_16x16x32_bf16 v[92:95], v[60:63], v[156:159], v[92:95]
  ds_read_b64_tr_b16 v[54:55], v2 offset:59456
  s_waitcnt lgkmcnt(8)
  v_mfma_f32_16x16x32_bf16 v[64:67], v[32:35], v[160:163], v[64:67]
  ds_read_b64_tr_b16 v[56:57], v2 offset:50784
  v_mfma_f32_16x16x32_bf16 v[64:67], v[36:39], v[168:171], v[64:67]
  ds_read_b64_tr_b16 v[58:59], v2 offset:59232
  v_mfma_f32_16x16x32_bf16 v[68:71], v[32:35], v[164:167], v[68:71]
  ds_read_b64_tr_b16 v[60:61], v2 offset:51040
  v_cvt_pk_bf16_f32 v116, v116, v117
  v_mfma_f32_16x16x32_bf16 v[68:71], v[36:39], v[172:175], v[68:71]
  ds_read_b64_tr_b16 v[62:63], v2 offset:59488
  s_waitcnt lgkmcnt(8)
  v_mfma_f32_16x16x32_bf16 v[72:75], v[40:43], v[160:163], v[72:75]
  ds_read_b64_tr_b16 v[32:33], v2 offset:51200
  v_cvt_pk_bf16_f32 v117, v118, v119
  v_mfma_f32_16x16x32_bf16 v[72:75], v[44:47], v[168:171], v[72:75]
  ds_read_b64_tr_b16 v[34:35], v2 offset:59648
  v_cvt_pk_bf16_f32 v118, v124, v125
  v_mfma_f32_16x16x32_bf16 v[76:79], v[40:43], v[164:167], v[76:79]
  ds_read_b64_tr_b16 v[36:37], v2 offset:51456
  v_cvt_pk_bf16_f32 v119, v126, v127
  v_mfma_f32_16x16x32_bf16 v[76:79], v[44:47], v[172:175], v[76:79]
  ds_read_b64_tr_b16 v[38:39], v2 offset:59904
  s_waitcnt lgkmcnt(8)
  v_mfma_f32_16x16x32_bf16 v[80:83], v[48:51], v[160:163], v[80:83]
  ds_read_b64_tr_b16 v[40:41], v2 offset:51232
  buffer_store_dwordx4 v[116:119], v1, s[24:27], s61 offen offset:3072 sc1
  v_mfma_f32_16x16x32_bf16 v[80:83], v[52:55], v[168:171], v[80:83]
  ds_read_b64_tr_b16 v[42:43], v2 offset:59680
  v_mfma_f32_16x16x32_bf16 v[84:87], v[48:51], v[164:167], v[84:87]
  ds_read_b64_tr_b16 v[44:45], v2 offset:51488
  v_mfma_f32_16x16x32_bf16 v[84:87], v[52:55], v[172:175], v[84:87]
  ds_read_b64_tr_b16 v[46:47], v2 offset:59936
  s_waitcnt lgkmcnt(8)
  v_mfma_f32_16x16x32_bf16 v[88:91], v[56:59], v[160:163], v[88:91]
  ds_read_b64_tr_b16 v[48:49], v2 offset:51264
  v_mfma_f32_16x16x32_bf16 v[88:91], v[60:63], v[168:171], v[88:91]
  ds_read_b64_tr_b16 v[50:51], v2 offset:59712
  v_mfma_f32_16x16x32_bf16 v[92:95], v[56:59], v[164:167], v[92:95]
  ds_read_b64_tr_b16 v[52:53], v2 offset:51520
  v_mfma_f32_16x16x32_bf16 v[92:95], v[60:63], v[172:175], v[92:95]
  ds_read_b64_tr_b16 v[54:55], v2 offset:59968
  s_waitcnt lgkmcnt(8)
  v_mfma_f32_16x16x32_bf16 v[64:67], v[32:35], v[176:179], v[64:67]
  ds_read_b64_tr_b16 v[56:57], v2 offset:51296
  v_mfma_f32_16x16x32_bf16 v[64:67], v[36:39], v[184:187], v[64:67]
  ds_read_b64_tr_b16 v[58:59], v2 offset:59744
  s_waitcnt vmcnt(13)
  v_mfma_f32_16x16x32_bf16 v[68:71], v[32:35], v[180:183], v[68:71]
  ds_read_b64_tr_b16 v[60:61], v2 offset:51552
  s_barrier
  v_mfma_f32_16x16x32_bf16 v[68:71], v[36:39], v[188:191], v[68:71]
  ds_read_b64_tr_b16 v[62:63], v2 offset:60000
  s_waitcnt lgkmcnt(8)
  v_mfma_f32_16x16x32_bf16 v[72:75], v[40:43], v[176:179], v[72:75]
  ds_read_b64_tr_b16 v[32:33], v14 offset:50688
  s_add_u32 s63, s64, 229760
  v_mfma_f32_16x16x32_bf16 v[72:75], v[44:47], v[184:187], v[72:75]
  ds_read_b64_tr_b16 v[34:35], v14 offset:59136
  s_add_u32 m0, s31, 86528
  v_mfma_f32_16x16x32_bf16 v[76:79], v[40:43], v[180:183], v[76:79]
  ds_read_b64_tr_b16 v[36:37], v14 offset:50944
  buffer_load_dwordx4 v3, s[20:23], s63 offen offset:0  lds
  v_mfma_f32_16x16x32_bf16 v[76:79], v[44:47], v[188:191], v[76:79]
  ds_read_b64_tr_b16 v[38:39], v14 offset:59392
  s_waitcnt lgkmcnt(8)
  v_mfma_f32_16x16x32_bf16 v[80:83], v[48:51], v[176:179], v[80:83]
  ds_read_b64_tr_b16 v[40:41], v14 offset:50720
  v_mfma_f32_16x16x32_bf16 v[80:83], v[52:55], v[184:187], v[80:83]
  ds_read_b64_tr_b16 v[42:43], v14 offset:59168
  s_add_u32 m0, s31, 85792
  v_mfma_f32_16x16x32_bf16 v[84:87], v[48:51], v[180:183], v[84:87]
  ds_read_b64_tr_b16 v[44:45], v14 offset:50976
  buffer_load_dwordx4 v3, s[20:23], s63 offen offset:1792  lds
  v_mfma_f32_16x16x32_bf16 v[84:87], v[52:55], v[188:191], v[84:87]
  ds_read_b64_tr_b16 v[46:47], v14 offset:59424
  s_waitcnt lgkmcnt(8)
  v_mfma_f32_16x16x32_bf16 v[88:91], v[56:59], v[176:179], v[88:91]
  ds_read_b64_tr_b16 v[48:49], v14 offset:50752
  v_mfma_f32_16x16x32_bf16 v[88:91], v[60:63], v[184:187], v[88:91]
  ds_read_b64_tr_b16 v[50:51], v14 offset:59200
  v_mfma_f32_16x16x32_bf16 v[92:95], v[56:59], v[180:183], v[92:95]
  ds_read_b64_tr_b16 v[52:53], v14 offset:51008
  v_mfma_f32_16x16x32_bf16 v[92:95], v[60:63], v[188:191], v[92:95]
  ds_read_b64_tr_b16 v[54:55], v14 offset:59456
  s_waitcnt lgkmcnt(8)
  v_mfma_f32_16x16x32_bf16 v[64:67], v[32:35], v[192:195], v[64:67]
  ds_read_b64_tr_b16 v[56:57], v14 offset:50784
  s_add_u32 m0, s31, 85056
  v_mfma_f32_16x16x32_bf16 v[64:67], v[36:39], v[200:203], v[64:67]
  ds_read_b64_tr_b16 v[58:59], v14 offset:59232
  buffer_load_dwordx4 v3, s[20:23], s63 offen offset:3584  lds
  v_mfma_f32_16x16x32_bf16 v[68:71], v[32:35], v[196:199], v[68:71]
  ds_read_b64_tr_b16 v[60:61], v14 offset:51040
  v_mfma_f32_16x16x32_bf16 v[68:71], v[36:39], v[204:207], v[68:71]
  ds_read_b64_tr_b16 v[62:63], v14 offset:59488
  s_waitcnt lgkmcnt(8)
  v_mfma_f32_16x16x32_bf16 v[72:75], v[40:43], v[192:195], v[72:75]
  ds_read_b64_tr_b16 v[32:33], v14 offset:51200
  s_add_u32 s63, s63, 1792
  v_mfma_f32_16x16x32_bf16 v[72:75], v[44:47], v[200:203], v[72:75]
  ds_read_b64_tr_b16 v[34:35], v14 offset:59648
  s_add_u32 m0, s31, 86112
  v_mfma_f32_16x16x32_bf16 v[76:79], v[40:43], v[196:199], v[76:79]
  ds_read_b64_tr_b16 v[36:37], v14 offset:51456
  buffer_load_dwordx4 v3, s[20:23], s63 offen offset:3584  lds
  v_mfma_f32_16x16x32_bf16 v[76:79], v[44:47], v[204:207], v[76:79]
  ds_read_b64_tr_b16 v[38:39], v14 offset:59904
  s_waitcnt lgkmcnt(8)
  v_mfma_f32_16x16x32_bf16 v[80:83], v[48:51], v[192:195], v[80:83]
  ds_read_b64_tr_b16 v[40:41], v14 offset:51232
  s_add_u32 s63, s64, 344448
  v_mfma_f32_16x16x32_bf16 v[80:83], v[52:55], v[200:203], v[80:83]
  ds_read_b64_tr_b16 v[42:43], v14 offset:59680
  s_add_u32 m0, s31, 35840
  v_mfma_f32_16x16x32_bf16 v[84:87], v[48:51], v[196:199], v[84:87]
  ds_read_b64_tr_b16 v[44:45], v14 offset:51488
  buffer_load_dwordx4 v3, s[20:23], s63 offen offset:0  lds
  v_mfma_f32_16x16x32_bf16 v[84:87], v[52:55], v[204:207], v[84:87]
  ds_read_b64_tr_b16 v[46:47], v14 offset:59936
  s_waitcnt lgkmcnt(8)
  v_mfma_f32_16x16x32_bf16 v[88:91], v[56:59], v[192:195], v[88:91]
  ds_read_b64_tr_b16 v[48:49], v14 offset:51264
  v_mfma_f32_16x16x32_bf16 v[88:91], v[60:63], v[200:203], v[88:91]
  ds_read_b64_tr_b16 v[50:51], v14 offset:59712
  s_add_u32 m0, s31, 35104
  v_mfma_f32_16x16x32_bf16 v[92:95], v[56:59], v[196:199], v[92:95]
  ds_read_b64_tr_b16 v[52:53], v14 offset:51520
  buffer_load_dwordx4 v3, s[20:23], s63 offen offset:1792  lds
  v_mfma_f32_16x16x32_bf16 v[92:95], v[60:63], v[204:207], v[92:95]
  ds_read_b64_tr_b16 v[54:55], v14 offset:59968
  s_waitcnt lgkmcnt(8)
  v_mfma_f32_16x16x32_bf16 v[64:67], v[32:35], v[208:211], v[64:67]
  ds_read_b64_tr_b16 v[56:57], v14 offset:51296
  v_mfma_f32_16x16x32_bf16 v[64:67], v[36:39], v[216:219], v[64:67]
  ds_read_b64_tr_b16 v[58:59], v14 offset:59744
  v_mfma_f32_16x16x32_bf16 v[68:71], v[32:35], v[212:215], v[68:71]
  ds_read_b64_tr_b16 v[60:61], v14 offset:51552
  v_mfma_f32_16x16x32_bf16 v[68:71], v[36:39], v[220:223], v[68:71]
  ds_read_b64_tr_b16 v[62:63], v14 offset:60000
  s_waitcnt lgkmcnt(8)
  v_mfma_f32_16x16x32_bf16 v[72:75], v[40:43], v[208:211], v[72:75]
  ds_read_b64_tr_b16 v[32:33], v2 offset:0
  s_add_u32 m0, s31, 34368
  v_mfma_f32_16x16x32_bf16 v[72:75], v[44:47], v[216:219], v[72:75]
  ds_read_b64_tr_b16 v[34:35], v2 offset:8448
  buffer_load_dwordx4 v3, s[20:23], s63 offen offset:3584  lds
  v_mfma_f32_16x16x32_bf16 v[76:79], v[40:43], v[212:215], v[76:79]
  ds_read_b64_tr_b16 v[36:37], v2 offset:256
  v_mfma_f32_16x16x32_bf16 v[76:79], v[44:47], v[220:223], v[76:79]
  ds_read_b64_tr_b16 v[38:39], v2 offset:8704
  s_waitcnt lgkmcnt(8)
  v_mfma_f32_16x16x32_bf16 v[80:83], v[48:51], v[208:211], v[80:83]
  ds_read_b64_tr_b16 v[40:41], v2 offset:512
  s_add_u32 s63, s63, 1792
  v_mfma_f32_16x16x32_bf16 v[80:83], v[52:55], v[216:219], v[80:83]
  ds_read_b64_tr_b16 v[42:43], v2 offset:8960
  s_add_u32 m0, s31, 35424
  v_mfma_f32_16x16x32_bf16 v[84:87], v[48:51], v[212:215], v[84:87]
  ds_read_b64_tr_b16 v[44:45], v2 offset:768
  buffer_load_dwordx4 v3, s[20:23], s63 offen offset:3584  lds
  v_mfma_f32_16x16x32_bf16 v[84:87], v[52:55], v[220:223], v[84:87]
  ds_read_b64_tr_b16 v[46:47], v2 offset:9216
  s_waitcnt lgkmcnt(8)
  v_mfma_f32_16x16x32_bf16 v[88:91], v[56:59], v[208:211], v[88:91]
  ds_read_b64_tr_b16 v[48:49], v2 offset:32
  v_mfma_f32_16x16x32_bf16 v[88:91], v[60:63], v[216:219], v[88:91]
  ds_read_b64_tr_b16 v[50:51], v2 offset:8480
  v_mfma_f32_16x16x32_bf16 v[92:95], v[56:59], v[212:215], v[92:95]
  ds_read_b64_tr_b16 v[52:53], v2 offset:288
  v_mfma_f32_16x16x32_bf16 v[92:95], v[60:63], v[220:223], v[92:95]
  ds_read_b64_tr_b16 v[54:55], v2 offset:8736
  s_waitcnt lgkmcnt(8)
  v_mfma_f32_16x16x32_bf16 v[64:67], v[32:35], v[224:227], v[64:67]
  ds_read_b64_tr_b16 v[56:57], v2 offset:544
  v_mfma_f32_16x16x32_bf16 v[64:67], v[36:39], v[232:235], v[64:67]
  ds_read_b64_tr_b16 v[58:59], v2 offset:8992
  v_mfma_f32_16x16x32_bf16 v[68:71], v[32:35], v[228:231], v[68:71]
  ds_read_b64_tr_b16 v[60:61], v2 offset:800
  v_mfma_f32_16x16x32_bf16 v[68:71], v[36:39], v[236:239], v[68:71]
  ds_read_b64_tr_b16 v[62:63], v2 offset:9248
  s_waitcnt lgkmcnt(8)
  v_mfma_f32_16x16x32_bf16 v[64:67], v[40:43], v[240:243], v[64:67]
  ds_read_b64_tr_b16 v[32:33], v2 offset:64
  v_mfma_f32_16x16x32_bf16 v[64:67], v[44:47], v[248:251], v[64:67]
  ds_read_b64_tr_b16 v[34:35], v2 offset:8512
  v_mfma_f32_16x16x32_bf16 v[68:71], v[40:43], v[244:247], v[68:71]
  ds_read_b64_tr_b16 v[36:37], v2 offset:320
  v_mfma_f32_16x16x32_bf16 v[68:71], v[44:47], v[252:255], v[68:71]
  ds_read_b64_tr_b16 v[38:39], v2 offset:8768
  s_waitcnt lgkmcnt(8)
  v_mfma_f32_16x16x32_bf16 v[72:75], v[48:51], v[224:227], v[72:75]
  ds_read_b64_tr_b16 v[40:41], v2 offset:576
  s_waitcnt vmcnt(16)
  v_cmp_gt_u32 vcc, 8, v5
  v_mfma_f32_16x16x32_bf16 v[72:75], v[52:55], v[232:235], v[72:75]
  ds_read_b64_tr_b16 v[42:43], v2 offset:9024
  s_cbranch_vccnz SPS
SPSr:
  v_mfma_f32_16x16x32_bf16 v[76:79], v[48:51], v[228:231], v[76:79]
  ds_read_b64_tr_b16 v[44:45], v2 offset:832
  v_mfma_f32_16x16x32_bf16 v[76:79], v[52:55], v[236:239], v[76:79]
  ds_read_b64_tr_b16 v[46:47], v2 offset:9280
  s_waitcnt lgkmcnt(8)
  v_mfma_f32_16x16x32_bf16 v[72:75], v[56:59], v[240:243], v[72:75]
  ds_read_b64_tr_b16 v[48:49], v2 offset:96
  v_mfma_f32_16x16x32_bf16 v[72:75], v[60:63], v[248:251], v[72:75]
  ds_read_b64_tr_b16 v[50:51], v2 offset:8544
  v_mfma_f32_16x16x32_bf16 v[76:79], v[56:59], v[244:247], v[76:79]
  ds_read_b64_tr_b16 v[52:53], v2 offset:352
  v_mfma_f32_16x16x32_bf16 v[76:79], v[60:63], v[252:255], v[76:79]
  ds_read_b64_tr_b16 v[54:55], v2 offset:8800
  s_waitcnt lgkmcnt(8)
  v_mfma_f32_16x16x32_bf16 v[80:83], v[32:35], v[224:227], v[80:83]
  ds_read_b64_tr_b16 v[56:57], v2 offset:608
  v_mfma_f32_16x16x32_bf16 v[80:83], v[36:39], v[232:235], v[80:83]
  ds_read_b64_tr_b16 v[58:59], v2 offset:9056
  s_waitcnt vmcnt(9)
  v_mfma_f32_16x16x32_bf16 v[84:87], v[32:35], v[228:231], v[84:87]
  ds_read_b64_tr_b16 v[60:61], v2 offset:864
  s_barrier
  v_mfma_f32_16x16x32_bf16 v[84:87], v[36:39], v[236:239], v[84:87]
  ds_read_b64_tr_b16 v[62:63], v2 offset:9312
  v_cvt_pk_bf16_f32 v64, v64, v65
  s_waitcnt lgkmcnt(8)
  v_mfma_f32_16x16x32_bf16 v[80:83], v[40:43], v[240:243], v[80:83]
  ds_read_b64_tr_b16 v[32:33], v14 offset:0
  s_add_u32 s63, s64, 512
  v_mfma_f32_16x16x32_bf16 v[80:83], v[44:47], v[248:251], v[80:83]
  ds_read_b64_tr_b16 v[34:35], v14 offset:8448
  s_add_u32 m0, s31, 103424
  v_cvt_pk_bf16_f32 v65, v66, v67
  v_mfma_f32_16x16x32_bf16 v[84:87], v[40:43], v[244:247], v[84:87]
  ds_read_b64_tr_b16 v[36:37], v14 offset:256
  buffer_load_dwordx4 v3, s[20:23], s63 offen offset:0  lds
  v_cvt_pk_bf16_f32 v66, v72, v73
  v_mfma_f32_16x16x32_bf16 v[84:87], v[44:47], v[252:255], v[84:87]
  ds_read_b64_tr_b16 v[38:39], v14 offset:8704
  s_waitcnt lgkmcnt(8)
  v_mfma_f32_16x16x32_bf16 v[88:91], v[48:51], v[224:227], v[88:91]
  ds_read_b64_tr_b16 v[40:41], v14 offset:32
  v_cvt_pk_bf16_f32 v67, v74, v75
  s_mov_b32 s60, 4096
  v_mfma_f32_16x16x32_bf16 v[88:91], v[52:55], v[232:235], v[88:91]
  ds_read_b64_tr_b16 v[42:43], v14 offset:8480
  s_add_u32 m0, s31, 102688
  buffer_store_dwordx4 v[64:67], v1, s[24:27], s60 offen offset:0 sc1
  v_mfma_f32_16x16x32_bf16 v[92:95], v[48:51], v[228:231], v[92:95]
  ds_read_b64_tr_b16 v[44:45], v14 offset:288
  buffer_load_dwordx4 v3, s[20:23], s63 offen offset:1792  lds
  s_waitcnt vmcnt(11)
  v_mfma_f32_16x16x32_bf16 v[92:95], v[52:55], v[236:239], v[92:95]
  ds_read_b64_tr_b16 v[46:47], v14 offset:8736
  v_mov_b32 v4, 1
  s_waitcnt lgkmcnt(8)
  v_mfma_f32_16x16x32_bf16 v[88:91], v[56:59], v[240:243], v[88:91]
  ds_read_b64_tr_b16 v[48:49], v14 offset:64
  buffer_store_dword v4, v15, s[40:43], s67 offen sc1
  v_mfma_f32_16x16x32_bf16 v[88:91], v[60:63], v[248:251], v[88:91]
  ds_read_b64_tr_b16 v[50:51], v14 offset:8512
  v_mfma_f32_16x16x32_bf16 v[92:95], v[56:59], v[244:247], v[92:95]
  ds_read_b64_tr_b16 v[52:53], v14 offset:320
  v_mfma_f32_16x16x32_bf16 v[92:95], v[60:63], v[252:255], v[92:95]
  ds_read_b64_tr_b16 v[54:55], v14 offset:8768
  s_waitcnt lgkmcnt(8)
  v_mfma_f32_16x16x32_bf16 v[96:99], v[32:35], v[128:131], 0
  ds_read_b64_tr_b16 v[56:57], v14 offset:96
  s_add_u32 m0, s31, 101952
  v_mfma_f32_16x16x32_bf16 v[96:99], v[36:39], v[136:139], v[96:99]
  ds_read_b64_tr_b16 v[58:59], v14 offset:8544
  buffer_load_dwordx4 v3, s[20:23], s63 offen offset:3584  lds
  v_mfma_f32_16x16x32_bf16 v[100:103], v[32:35], v[132:135], 0
  ds_read_b64_tr_b16 v[60:61], v14 offset:352
  v_cvt_pk_bf16_f32 v68, v68, v69
  v_mfma_f32_16x16x32_bf16 v[100:103], v[36:39], v[140:143], v[100:103]
  ds_read_b64_tr_b16 v[62:63], v14 offset:8800
  v_cvt_pk_bf16_f32 v69, v70, v71
  s_waitcnt lgkmcnt(8)
  v_mfma_f32_16x16x32_bf16 v[104:107], v[40:43], v[128:131], 0
  ds_read_b64_tr_b16 v[32:33], v14 offset:512
  s_add_u32 s63, s63, 1792
  v_mfma_f32_16x16x32_bf16 v[104:107], v[44:47], v[136:139], v[104:107]
  ds_read_b64_tr_b16 v[34:35], v14 offset:8960
  s_add_u32 m0, s31, 103008
  v_cvt_pk_bf16_f32 v70, v76, v77
  v_mfma_f32_16x16x32_bf16 v[108:111], v[40:43], v[132:135], 0
  ds_read_b64_tr_b16 v[36:37], v14 offset:768
  buffer_load_dwordx4 v3, s[20:23], s63 offen offset:3584  lds
  v_cvt_pk_bf16_f32 v71, v78, v79
  v_mfma_f32_16x16x32_bf16 v[108:111], v[44:47], v[140:143], v[108:111]
  ds_read_b64_tr_b16 v[38:39], v14 offset:9216
  s_waitcnt lgkmcnt(8)
  v_mfma_f32_16x16x32_bf16 v[112:115], v[48:51], v[128:131], 0
  ds_read_b64_tr_b16 v[40:41], v14 offset:544
  s_add_u32 s63, s64, 115200
  s_mov_b32 s61, 18432
  v_mfma_f32_16x16x32_bf16 v[112:115], v[52:55], v[136:139], v[112:115]
  ds_read_b64_tr_b16 v[42:43], v14 offset:8992
  s_add_u32 m0, s31, 52736
  buffer_store_dwordx4 v[68:71], v1, s[24:27], s61 offen offset:0 sc1
  v_mfma_f32_16x16x32_bf16 v[116:119], v[48:51], v[132:135], 0
  ds_read_b64_tr_b16 v[44:45], v14 offset:800
  buffer_load_dwordx4 v3, s[20:23], s63 offen offset:0  lds
  v_mfma_f32_16x16x32_bf16 v[116:119], v[52:55], v[140:143], v[116:119]
  ds_read_b64_tr_b16 v[46:47], v14 offset:9248
  s_waitcnt lgkmcnt(8)
  v_mfma_f32_16x16x32_bf16 v[120:123], v[56:59], v[128:131], 0
  ds_read_b64_tr_b16 v[48:49], v14 offset:576
  v_mfma_f32_16x16x32_bf16 v[120:123], v[60:63], v[136:139], v[120:123]
  ds_read_b64_tr_b16 v[50:51], v14 offset:9024
  s_add_u32 m0, s31, 52000
  v_mfma_f32_16x16x32_bf16 v[124:127], v[56:59], v[132:135], 0
  ds_read_b64_tr_b16 v[52:53], v14 offset:832
  buffer_load_dwordx4 v3, s[20:23], s63 offen offset:1792  lds
  v_mfma_f32_16x16x32_bf16 v[124:127], v[60:63], v[140:143], v[124:127]
  ds_read_b64_tr_b16 v[54:55], v14 offset:9280
  s_waitcnt lgkmcnt(8)
  v_mfma_f32_16x16x32_bf16 v[96:99], v[32:35], v[144:147], v[96:99]
  ds_read_b64_tr_b16 v[56:57], v14 offset:608
  v_mfma_f32_16x16x32_bf16 v[96:99], v[36:39], v[152:155], v[96:99]
  ds_read_b64_tr_b16 v[58:59], v14 offset:9056
  v_mfma_f32_16x16x32_bf16 v[100:103], v[32:35], v[148:151], v[100:103]
  ds_read_b64_tr_b16 v[60:61], v14 offset:864
  v_cvt_pk_bf16_f32 v80, v80, v81
  v_mfma_f32_16x16x32_bf16 v[100:103], v[36:39], v[156:159], v[100:103]
  ds_read_b64_tr_b16 v[62:63], v14 offset:9312
  s_waitcnt lgkmcnt(8)
  v_mfma_f32_16x16x32_bf16 v[104:107], v[40:43], v[144:147], v[104:107]
  ds_read_b64_tr_b16 v[32:33], v2 offset:16896
  s_add_u32 m0, s31, 51264
  v_cvt_pk_bf16_f32 v81, v82, v83
  v_mfma_f32_16x16x32_bf16 v[104:107], v[44:47], v[152:155], v[104:107]
  ds_read_b64_tr_b16 v[34:35], v2 offset:25344
  buffer_load_dwordx4 v3, s[20:23], s63 offen offset:3584  lds
  v_mfma_f32_16x16x32_bf16 v[108:111], v[40:43], v[148:151], v[108:111]
  ds_read_b64_tr_b16 v[36:37], v2 offset:17152
  v_cvt_pk_bf16_f32 v82, v88, v89
  v_mfma_f32_16x16x32_bf16 v[108:111], v[44:47], v[156:159], v[108:111]
  ds_read_b64_tr_b16 v[38:39], v2 offset:25600
  v_cvt_pk_bf16_f32 v83, v90, v91
  s_waitcnt lgkmcnt(8)
  v_mfma_f32_16x16x32_bf16 v[112:115], v[48:51], v[144:147], v[112:115]
  ds_read_b64_tr_b16 v[40:41], v2 offset:16928
  s_add_u32 s63, s63, 1792
  v_mfma_f32_16x16x32_bf16 v[112:115], v[52:55], v[152:155], v[112:115]
  ds_read_b64_tr_b16 v[42:43], v2 offset:25376
  s_add_u32 m0, s31, 52320
  buffer_store_dwordx4 v[80:83], v1, s[24:27], s60 offen offset:1024 sc1
  v_mfma_f32_16x16x32_bf16 v[116:119], v[48:51], v[148:151], v[116:119]
  ds_read_b64_tr_b16 v[44:45], v2 offset:17184
  buffer_load_dwordx4 v3, s[20:23], s63 offen offset:3584  lds
  v_mfma_f32_16x16x32_bf16 v[116:119], v[52:55], v[156:159], v[116:119]
  ds_read_b64_tr_b16 v[46:47], v2 offset:25632
  s_waitcnt lgkmcnt(8)
  v_mfma_f32_16x16x32_bf16 v[120:123], v[56:59], v[144:147], v[120:123]
  ds_read_b64_tr_b16 v[48:49], v2 offset:16960
  v_mfma_f32_16x16x32_bf16 v[120:123], v[60:63], v[152:155], v[120:123]
  ds_read_b64_tr_b16 v[50:51], v2 offset:25408
  v_mfma_f32_16x16x32_bf16 v[124:127], v[56:59], v[148:151], v[124:127]
  ds_read_b64_tr_b16 v[52:53], v2 offset:17216
  v_mfma_f32_16x16x32_bf16 v[124:127], v[60:63], v[156:159], v[124:127]
  ds_read_b64_tr_b16 v[54:55], v2 offset:25664
  s_waitcnt lgkmcnt(8)
  v_mfma_f32_16x16x32_bf16 v[96:99], v[32:35], v[160:163], v[96:99]
  ds_read_b64_tr_b16 v[56:57], v2 offset:16992
  v_mfma_f32_16x16x32_bf16 v[96:99], v[36:39], v[168:171], v[96:99]
  ds_read_b64_tr_b16 v[58:59], v2 offset:25440
  v_mfma_f32_16x16x32_bf16 v[100:103], v[32:35], v[164:167], v[100:103]
  ds_read_b64_tr_b16 v[60:61], v2 offset:17248
  v_cvt_pk_bf16_f32 v84, v84, v85
  v_mfma_f32_16x16x32_bf16 v[100:103], v[36:39], v[172:175], v[100:103]
  ds_read_b64_tr_b16 v[62:63], v2 offset:25696
  s_waitcnt lgkmcnt(8)
  v_mfma_f32_16x16x32_bf16 v[104:107], v[40:43], v[160:163], v[104:107]
  ds_read_b64_tr_b16 v[32:33], v2 offset:17408
  v_cvt_pk_bf16_f32 v85, v86, v87
  v_mfma_f32_16x16x32_bf16 v[104:107], v[44:47], v[168:171], v[104:107]
  ds_read_b64_tr_b16 v[34:35], v2 offset:25856
  v_cvt_pk_bf16_f32 v86, v92, v93
  v_mfma_f32_16x16x32_bf16 v[108:111], v[40:43], v[164:167], v[108:111]
  ds_read_b64_tr_b16 v[36:37], v2 offset:17664
  v_cvt_pk_bf16_f32 v87, v94, v95
  v_mfma_f32_16x16x32_bf16 v[108:111], v[44:47], v[172:175], v[108:111]
  ds_read_b64_tr_b16 v[38:39], v2 offset:26112
  s_waitcnt lgkmcnt(8)
  v_mfma_f32_16x16x32_bf16 v[112:115], v[48:51], v[160:163], v[112:115]
  ds_read_b64_tr_b16 v[40:41], v2 offset:17440
  buffer_store_dwordx4 v[84:87], v1, s[24:27], s61 offen offset:1024 sc1
  v_mfma_f32_16x16x32_bf16 v[112:115], v[52:55], v[168:171], v[112:115]
  ds_read_b64_tr_b16 v[42:43], v2 offset:25888
  v_mfma_f32_16x16x32_bf16 v[116:119], v[48:51], v[164:167], v[116:119]
  ds_read_b64_tr_b16 v[44:45], v2 offset:17696
  v_mfma_f32_16x16x32_bf16 v[116:119], v[52:55], v[172:175], v[116:119]
  ds_read_b64_tr_b16 v[46:47], v2 offset:26144
  s_waitcnt lgkmcnt(8)
  v_mfma_f32_16x16x32_bf16 v[120:123], v[56:59], v[160:163], v[120:123]
  ds_read_b64_tr_b16 v[48:49], v2 offset:17472
  v_mfma_f32_16x16x32_bf16 v[120:123], v[60:63], v[168:171], v[120:123]
  ds_read_b64_tr_b16 v[50:51], v2 offset:25920
  v_mfma_f32_16x16x32_bf16 v[124:127], v[56:59], v[164:167], v[124:127]
  ds_read_b64_tr_b16 v[52:53], v2 offset:17728
  v_mfma_f32_16x16x32_bf16 v[124:127], v[60:63], v[172:175], v[124:127]
  ds_read_b64_tr_b16 v[54:55], v2 offset:26176
  s_waitcnt lgkmcnt(8)
  v_mfma_f32_16x16x32_bf16 v[96:99], v[32:35], v[176:179], v[96:99]
  ds_read_b64_tr_b16 v[56:57], v2 offset:17504
  v_mfma_f32_16x16x32_bf16 v[96:99], v[36:39], v[184:187], v[96:99]
  ds_read_b64_tr_b16 v[58:59], v2 offset:25952
  s_waitcnt vmcnt(13)
  v_mfma_f32_16x16x32_bf16 v[100:103], v[32:35], v[180:183], v[100:103]
  ds_read_b64_tr_b16 v[60:61], v2 offset:17760
  s_barrier
  v_mfma_f32_16x16x32_bf16 v[100:103], v[36:39], v[188:191], v[100:103]
  ds_read_b64_tr_b16 v[62:63], v2 offset:26208
  s_waitcnt lgkmcnt(8)
  v_mfma_f32_16x16x32_bf16 v[104:107], v[40:43], v[176:179], v[104:107]
  ds_read_b64_tr_b16 v[32:33], v14 offset:16896
  s_add_u32 s63, s64, 229888
  v_mfma_f32_16x16x32_bf16 v[104:107], v[44:47], v[184:187], v[104:107]
  ds_read_b64_tr_b16 v[34:35], v14 offset:25344
  s_add_u32 m0, s31, 120320
  v_mfma_f32_16x16x32_bf16 v[108:111], v[40:43], v[180:183], v[108:111]
  ds_read_b64_tr_b16 v[36:37], v14 offset:17152
  buffer_load_dwordx4 v3, s[20:23], s63 offen offset:0  lds
  v_mfma_f32_16x16x32_bf16 v[108:111], v[44:47], v[188:191], v[108:111]
  ds_read_b64_tr_b16 v[38:39], v14 offset:25600
  s_waitcnt lgkmcnt(8)
  v_mfma_f32_16x16x32_bf16 v[112:115], v[48:51], v[176:179], v[112:115]
  ds_read_b64_tr_b16 v[40:41], v14 offset:16928
  v_mfma_f32_16x16x32_bf16 v[112:115], v[52:55], v[184:187], v[112:115]
  ds_read_b64_tr_b16 v[42:43], v14 offset:25376
  s_add_u32 m0, s31, 119584
  v_mfma_f32_16x16x32_bf16 v[116:119], v[48:51], v[180:183], v[116:119]
  ds_read_b64_tr_b16 v[44:45], v14 offset:17184
  buffer_load_dwordx4 v3, s[20:23], s63 offen offset:1792  lds
  v_mfma_f32_16x16x32_bf16 v[116:119], v[52:55], v[188:191], v[116:119]
  ds_read_b64_tr_b16 v[46:47], v14 offset:25632
  s_waitcnt lgkmcnt(8)
  v_mfma_f32_16x16x32_bf16 v[120:123], v[56:59], v[176:179], v[120:123]
  ds_read_b64_tr_b16 v[48:49], v14 offset:16960
  v_mfma_f32_16x16x32_bf16 v[120:123], v[60:63], v[184:187], v[120:123]
  ds_read_b64_tr_b16 v[50:51], v14 offset:25408
  v_mfma_f32_16x16x32_bf16 v[124:127], v[56:59], v[180:183], v[124:127]
  ds_read_b64_tr_b16 v[52:53], v14 offset:17216
  v_mfma_f32_16x16x32_bf16 v[124:127], v[60:63], v[188:191], v[124:127]
  ds_read_b64_tr_b16 v[54:55], v14 offset:25664
  s_waitcnt lgkmcnt(8)
  v_mfma_f32_16x16x32_bf16 v[96:99], v[32:35], v[192:195], v[96:99]
  ds_read_b64_tr_b16 v[56:57], v14 offset:16992
  s_add_u32 m0, s31, 118848
  v_mfma_f32_16x16x32_bf16 v[96:99], v[36:39], v[200:203], v[96:99]
  ds_read_b64_tr_b16 v[58:59], v14 offset:25440
  buffer_load_dwordx4 v3, s[20:23], s63 offen offset:3584  lds
  v_mfma_f32_16x16x32_bf16 v[100:103], v[32:35], v[196:199], v[100:103]
  ds_read_b64_tr_b16 v[60:61], v14 offset:17248
  buffer_load_dword v5, v10, s[40:43], 0 offen sc1
  v_mfma_f32_16x16x32_bf16 v[100:103], v[36:39], v[204:207], v[100:103]
  ds_read_b64_tr_b16 v[62:63], v14 offset:25696
  s_waitcnt lgkmcnt(8)
  v_mfma_f32_16x16x32_bf16 v[104:107], v[40:43], v[192:195], v[104:107]
  ds_read_b64_tr_b16 v[32:33], v14 offset:17408
  s_add_u32 s63, s63, 1792
  v_mfma_f32_16x16x32_bf16 v[104:107], v[44:47], v[200:203], v[104:107]
  ds_read_b64_tr_b16 v[34:35], v14 offset:25856
  s_add_u32 m0, s31, 119904
  v_mfma_f32_16x16x32_bf16 v[108:111], v[40:43], v[196:199], v[108:111]
  ds_read_b64_tr_b16 v[36:37], v14 offset:17664
  buffer_load_dwordx4 v3, s[20:23], s63 offen offset:3584  lds
  v_mfma_f32_16x16x32_bf16 v[108:111], v[44:47], v[204:207], v[108:111]
  ds_read_b64_tr_b16 v[38:39], v14 offset:26112
  s_waitcnt lgkmcnt(8)
  v_mfma_f32_16x16x32_bf16 v[112:115], v[48:51], v[192:195], v[112:115]
  ds_read_b64_tr_b16 v[40:41], v14 offset:17440
  s_add_u32 s63, s64, 344576
  v_mfma_f32_16x16x32_bf16 v[112:115], v[52:55], v[200:203], v[112:115]
  ds_read_b64_tr_b16 v[42:43], v14 offset:25888
  s_add_u32 m0, s31, 2048
  v_mfma_f32_16x16x32_bf16 v[116:119], v[48:51], v[196:199], v[116:119]
  ds_read_b64_tr_b16 v[44:45], v14 offset:17696
  buffer_load_dwordx4 v3, s[20:23], s63 offen offset:0  lds
  v_mfma_f32_16x16x32_bf16 v[116:119], v[52:55], v[204:207], v[116:119]
  ds_read_b64_tr_b16 v[46:47], v14 offset:26144
  s_waitcnt lgkmcnt(8)
  v_mfma_f32_16x16x32_bf16 v[120:123], v[56:59], v[192:195], v[120:123]
  ds_read_b64_tr_b16 v[48:49], v14 offset:17472
  v_mfma_f32_16x16x32_bf16 v[120:123], v[60:63], v[200:203], v[120:123]
  ds_read_b64_tr_b16 v[50:51], v14 offset:25920
  s_add_u32 m0, s31, 1312
  v_mfma_f32_16x16x32_bf16 v[124:127], v[56:59], v[196:199], v[124:127]
  ds_read_b64_tr_b16 v[52:53], v14 offset:17728
  buffer_load_dwordx4 v3, s[20:23], s63 offen offset:1792  lds
  v_mfma_f32_16x16x32_bf16 v[124:127], v[60:63], v[204:207], v[124:127]
  ds_read_b64_tr_b16 v[54:55], v14 offset:26176
  s_waitcnt lgkmcnt(8)
  v_mfma_f32_16x16x32_bf16 v[96:99], v[32:35], v[208:211], v[96:99]
  ds_read_b64_tr_b16 v[56:57], v14 offset:17504
  v_mfma_f32_16x16x32_bf16 v[96:99], v[36:39], v[216:219], v[96:99]
  ds_read_b64_tr_b16 v[58:59], v14 offset:25952
  v_mfma_f32_16x16x32_bf16 v[100:103], v[32:35], v[212:215], v[100:103]
  ds_read_b64_tr_b16 v[60:61], v14 offset:17760
  v_mfma_f32_16x16x32_bf16 v[100:103], v[36:39], v[220:223], v[100:103]
  ds_read_b64_tr_b16 v[62:63], v14 offset:26208
  s_waitcnt lgkmcnt(8)
  v_mfma_f32_16x16x32_bf16 v[104:107], v[40:43], v[208:211], v[104:107]
  ds_read_b64_tr_b16 v[32:33], v2 offset:33792
  s_add_u32 m0, s31, 576
  v_mfma_f32_16x16x32_bf16 v[104:107], v[44:47], v[216:219], v[104:107]
  ds_read_b64_tr_b16 v[34:35], v2 offset:42240
  buffer_load_dwordx4 v3, s[20:23], s63 offen offset:3584  lds
  v_mfma_f32_16x16x32_bf16 v[108:111], v[40:43], v[212:215], v[108:111]
  ds_read_b64_tr_b16 v[36:37], v2 offset:34048
  v_mfma_f32_16x16x32_bf16 v[108:111], v[44:47], v[220:223], v[108:111]
  ds_read_b64_tr_b16 v[38:39], v2 offset:42496
  s_waitcnt lgkmcnt(8)
  v_mfma_f32_16x16x32_bf16 v[112:115], v[48:51], v[208:211], v[112:115]
  ds_read_b64_tr_b16 v[40:41], v2 offset:34304
  s_add_u32 s63, s63, 1792
  v_mfma_f32_16x16x32_bf16 v[112:115], v[52:55], v[216:219], v[112:115]
  ds_read_b64_tr_b16 v[42:43], v2 offset:42752
  s_add_u32 m0, s31, 1632
  v_mfma_f32_16x16x32_bf16 v[116:119], v[48:51], v[212:215], v[116:119]
  ds_read_b64_tr_b16 v[44:45], v2 offset:34560
  buffer_load_dwordx4 v3, s[20:23], s63 offen offset:3584  lds
  v_mfma_f32_16x16x32_bf16 v[116:119], v[52:55], v[220:223], v[116:119]
  ds_read_b64_tr_b16 v[46:47], v2 offset:43008
  s_waitcnt lgkmcnt(8)
  v_mfma_f32_16x16x32_bf16 v[120:123], v[56:59], v[208:211], v[120:123]
  ds_read_b64_tr_b16 v[48:49], v2 offset:33824
  v_mfma_f32_16x16x32_bf16 v[120:123], v[60:63], v[216:219], v[120:123]
  ds_read_b64_tr_b16 v[50:51], v2 offset:42272
  v_mfma_f32_16x16x32_bf16 v[124:127], v[56:59], v[212:215], v[124:127]
  ds_read_b64_tr_b16 v[52:53], v2 offset:34080
  v_mfma_f32_16x16x32_bf16 v[124:127], v[60:63], v[220:223], v[124:127]
  ds_read_b64_tr_b16 v[54:55], v2 offset:42528
  s_waitcnt lgkmcnt(8)
  v_mfma_f32_16x16x32_bf16 v[96:99], v[32:35], v[224:227], v[96:99]
  ds_read_b64_tr_b16 v[56:57], v2 offset:34336
  v_mfma_f32_16x16x32_bf16 v[96:99], v[36:39], v[232:235], v[96:99]
  ds_read_b64_tr_b16 v[58:59], v2 offset:42784
  v_mfma_f32_16x16x32_bf16 v[100:103], v[32:35], v[228:231], v[100:103]
  ds_read_b64_tr_b16 v[60:61], v2 offset:34592
  v_mfma_f32_16x16x32_bf16 v[100:103], v[36:39], v[236:239], v[100:103]
  ds_read_b64_tr_b16 v[62:63], v2 offset:43040
  s_waitcnt lgkmcnt(8)
  v_mfma_f32_16x16x32_bf16 v[96:99], v[40:43], v[240:243], v[96:99]
  ds_read_b64_tr_b16 v[32:33], v2 offset:33856
  v_mfma_f32_16x16x32_bf16 v[96:99], v[44:47], v[248:251], v[96:99]
  ds_read_b64_tr_b16 v[34:35], v2 offset:42304
  v_mfma_f32_16x16x32_bf16 v[100:103], v[40:43], v[244:247], v[100:103]
  ds_read_b64_tr_b16 v[36:37], v2 offset:34112
  v_mfma_f32_16x16x32_bf16 v[100:103], v[44:47], v[252:255], v[100:103]
  ds_read_b64_tr_b16 v[38:39], v2 offset:42560
  s_waitcnt lgkmcnt(8)
  v_mfma_f32_16x16x32_bf16 v[104:107], v[48:51], v[224:227], v[104:107]
  ds_read_b64_tr_b16 v[40:41], v2 offset:34368
  v_mfma_f32_16x16x32_bf16 v[104:107], v[52:55], v[232:235], v[104:107]
  ds_read_b64_tr_b16 v[42:43], v2 offset:42816
  v_mfma_f32_16x16x32_bf16 v[108:111], v[48:51], v[228:231], v[108:111]
  ds_read_b64_tr_b16 v[44:45], v2 offset:34624
  v_mfma_f32_16x16x32_bf16 v[108:111], v[52:55], v[236:239], v[108:111]
  ds_read_b64_tr_b16 v[46:47], v2 offset:43072
  s_waitcnt lgkmcnt(8)
  v_mfma_f32_16x16x32_bf16 v[104:107], v[56:59], v[240:243], v[104:107]
  ds_read_b64_tr_b16 v[48:49], v2 offset:33888
  v_mfma_f32_16x16x32_bf16 v[104:107], v[60:63], v[248:251], v[104:107]
  ds_read_b64_tr_b16 v[50:51], v2 offset:42336
  v_mfma_f32_16x16x32_bf16 v[108:111], v[56:59], v[244:247], v[108:111]
  ds_read_b64_tr_b16 v[52:53], v2 offset:34144
  v_mfma_f32_16x16x32_bf16 v[108:111], v[60:63], v[252:255], v[108:111]
  ds_read_b64_tr_b16 v[54:55], v2 offset:42592
  s_waitcnt lgkmcnt(8)
  v_mfma_f32_16x16x32_bf16 v[112:115], v[32:35], v[224:227], v[112:115]
  ds_read_b64_tr_b16 v[56:57], v2 offset:34400
  v_mfma_f32_16x16x32_bf16 v[112:115], v[36:39], v[232:235], v[112:115]
  ds_read_b64_tr_b16 v[58:59], v2 offset:42848
  s_waitcnt vmcnt(10)
  v_mfma_f32_16x16x32_bf16 v[116:119], v[32:35], v[228:231], v[116:119]
  ds_read_b64_tr_b16 v[60:61], v2 offset:34656
  s_barrier
  v_mfma_f32_16x16x32_bf16 v[116:119], v[36:39], v[236:239], v[116:119]
  ds_read_b64_tr_b16 v[62:63], v2 offset:43104
  v_cvt_pk_bf16_f32 v96, v96, v97
  s_waitcnt lgkmcnt(8)
  v_mfma_f32_16x16x32_bf16 v[112:115], v[40:43], v[240:243], v[112:115]
  ds_read_b64_tr_b16 v[32:33], v14 offset:33792
  s_add_u32 s63, s64, 640
  v_mfma_f32_16x16x32_bf16 v[112:115], v[44:47], v[248:251], v[112:115]
  ds_read_b64_tr_b16 v[34:35], v14 offset:42240
  s_add_u32 m0, s31, 69632
  v_cvt_pk_bf16_f32 v97, v98, v99
  v_mfma_f32_16x16x32_bf16 v[116:119], v[40:43], v[244:247], v[116:119]
  ds_read_b64_tr_b16 v[36:37], v14 offset:34048
  buffer_load_dwordx4 v3, s[20:23], s63 offen offset:0  lds
  v_mfma_f32_16x16x32_bf16 v[116:119], v[44:47], v[252:255], v[116:119]
  ds_read_b64_tr_b16 v[38:39], v14 offset:42496
  v_cvt_pk_bf16_f32 v98, v104, v105
  s_waitcnt lgkmcnt(8)
  v_mfma_f32_16x16x32_bf16 v[120:123], v[48:51], v[224:227], v[120:123]
  ds_read_b64_tr_b16 v[40:41], v14 offset:33824
  v_cvt_pk_bf16_f32 v99, v106, v107
  v_mfma_f32_16x16x32_bf16 v[120:123], v[52:55], v[232:235], v[120:123]
  ds_read_b64_tr_b16 v[42:43], v14 offset:42272
  s_add_u32 m0, s31, 68896
  buffer_store_dwordx4 v[96:99], v1, s[24:27], s60 offen offset:2048 sc1
  v_mfma_f32_16x16x32_bf16 v[124:127], v[48:51], v[228:231], v[124:127]
  ds_read_b64_tr_b16 v[44:45], v14 offset:34080
  buffer_load_dwordx4 v3, s[20:23], s63 offen offset:1792  lds
  v_mfma_f32_16x16x32_bf16 v[124:127], v[52:55], v[236:239], v[124:127]
  ds_read_b64_tr_b16 v[46:47], v14 offset:42528
  s_waitcnt lgkmcnt(8)
  v_mfma_f32_16x16x32_bf16 v[120:123], v[56:59], v[240:243], v[120:123]
  ds_read_b64_tr_b16 v[48:49], v14 offset:33856
  v_mfma_f32_16x16x32_bf16 v[120:123], v[60:63], v[248:251], v[120:123]
  ds_read_b64_tr_b16 v[50:51], v14 offset:42304
  v_mfma_f32_16x16x32_bf16 v[124:127], v[56:59], v[244:247], v[124:127]
  ds_read_b64_tr_b16 v[52:53], v14 offset:34112
  v_mfma_f32_16x16x32_bf16 v[124:127], v[60:63], v[252:255], v[124:127]
  ds_read_b64_tr_b16 v[54:55], v14 offset:42560
  s_waitcnt lgkmcnt(8)
  v_mfma_f32_16x16x32_bf16 v[64:67], v[32:35], v[128:131], 0
  ds_read_b64_tr_b16 v[56:57], v14 offset:33888
  s_add_u32 m0, s31, 68160
  v_mfma_f32_16x16x32_bf16 v[64:67], v[36:39], v[136:139], v[64:67]
  ds_read_b64_tr_b16 v[58:59], v14 offset:42336
  buffer_load_dwordx4 v3, s[20:23], s63 offen offset:3584  lds
  v_mfma_f32_16x16x32_bf16 v[68:71], v[32:35], v[132:135], 0
  ds_read_b64_tr_b16 v[60:61], v14 offset:34144
  v_cvt_pk_bf16_f32 v100, v100, v101
  v_mfma_f32_16x16x32_bf16 v[68:71], v[36:39], v[140:143], v[68:71]
  ds_read_b64_tr_b16 v[62:63], v14 offset:42592
  v_cvt_pk_bf16_f32 v101, v102, v103
  s_waitcnt lgkmcnt(8)
  v_mfma_f32_16x16x32_bf16 v[72:75], v[40:43], v[128:131], 0
  ds_read_b64_tr_b16 v[32:33], v14 offset:34304
  s_add_u32 s63, s63, 1792
  v_mfma_f32_16x16x32_bf16 v[72:75], v[44:47], v[136:139], v[72:75]
  ds_read_b64_tr_b16 v[34:35], v14 offset:42752
  s_add_u32 m0, s31, 69216
  v_cvt_pk_bf16_f32 v102, v108, v109
  v_mfma_f32_16x16x32_bf16 v[76:79], v[40:43], v[132:135], 0
  ds_read_b64_tr_b16 v[36:37], v14 offset:34560
  buffer_load_dwordx4 v3, s[20:23], s63 offen offset:3584  lds
  v_mfma_f32_16x16x32_bf16 v[76:79], v[44:47], v[140:143], v[76:79]
  ds_read_b64_tr_b16 v[38:39], v14 offset:43008
  v_cvt_pk_bf16_f32 v103, v110, v111
  s_waitcnt lgkmcnt(8)
  v_mfma_f32_16x16x32_bf16 v[80:83], v[48:51], v[128:131], 0
  ds_read_b64_tr_b16 v[40:41], v14 offset:34336
  s_add_u32 s63, s64, 115328
  s_waitcnt vmcnt(10)
  v_mfma_f32_16x16x32_bf16 v[80:83], v[52:55], v[136:139], v[80:83]
  ds_read_b64_tr_b16 v[42:43], v14 offset:42784
  s_add_u32 m0, s31, 18944
  buffer_store_dwordx4 v[100:103], v1, s[24:27], s61 offen offset:2048 sc1
  v_mfma_f32_16x16x32_bf16 v[84:87], v[48:51], v[132:135], 0
  ds_read_b64_tr_b16 v[44:45], v14 offset:34592
  buffer_load_dwordx4 v3, s[20:23], s63 offen offset:0  lds
  v_cmp_gt_u32 vcc, 1, v5
  v_mfma_f32_16x16x32_bf16 v[84:87], v[52:55], v[140:143], v[84:87]
  ds_read_b64_tr_b16 v[46:47], v14 offset:43040
  s_cbranch_vccnz SP0
SP0r:
  s_waitcnt lgkmcnt(8)
  v_mfma_f32_16x16x32_bf16 v[88:91], v[56:59], v[128:131], 0
  ds_read_b64_tr_b16 v[48:49], v14 offset:34368
  v_mfma_f32_16x16x32_bf16 v[88:91], v[60:63], v[136:139], v[88:91]
  ds_read_b64_tr_b16 v[50:51], v14 offset:42816
  s_add_u32 m0, s31, 18208
  v_mfma_f32_16x16x32_bf16 v[92:95], v[56:59], v[132:135], 0
  ds_read_b64_tr_b16 v[52:53], v14 offset:34624
  buffer_load_dwordx4 v3, s[20:23], s63 offen offset:1792  lds
  v_mfma_f32_16x16x32_bf16 v[92:95], v[60:63], v[140:143], v[92:95]
  ds_read_b64_tr_b16 v[54:55], v14 offset:43072
  s_waitcnt lgkmcnt(8)
  v_mfma_f32_16x16x32_bf16 v[64:67], v[32:35], v[144:147], v[64:67]
  ds_read_b64_tr_b16 v[56:57], v14 offset:34400
  v_mfma_f32_16x16x32_bf16 v[64:67], v[36:39], v[152:155], v[64:67]
  ds_read_b64_tr_b16 v[58:59], v14 offset:42848
  buffer_load_dwordx4 a[0:3], v11, s[24:27], 0 offen sc1
  v_mfma_f32_16x16x32_bf16 v[68:71], v[32:35], v[148:151], v[68:71]
  ds_read_b64_tr_b16 v[60:61], v14 offset:34656
  v_cvt_pk_bf16_f32 v112, v112, v113
  v_mfma_f32_16x16x32_bf16 v[68:71], v[36:39], v[156:159], v[68:71]
  ds_read_b64_tr_b16 v[62:63], v14 offset:43104
  s_waitcnt lgkmcnt(8)
  v_mfma_f32_16x16x32_bf16 v[72:75], v[40:43], v[144:147], v[72:75]
  ds_read_b64_tr_b16 v[32:33], v2 offset:50688
  s_add_u32 m0, s31, 17472
  v_cvt_pk_bf16_f32 v113, v114, v115
  v_mfma_f32_16x16x32_bf16 v[72:75], v[44:47], v[152:155], v[72:75]
  ds_read_b64_tr_b16 v[34:35], v2 offset:59136
  buffer_load_dwordx4 v3, s[20:23], s63 offen offset:3584  lds
  v_mfma_f32_16x16x32_bf16 v[76:79], v[40:43], v[148:151], v[76:79]
  ds_read_b64_tr_b16 v[36:37], v2 offset:50944
  v_cvt_pk_bf16_f32 v114, v120, v121
  v_mfma_f32_16x16x32_bf16 v[76:79], v[44:47], v[156:159], v[76:79]
  ds_read_b64_tr_b16 v[38:39], v2 offset:59392
  v_cvt_pk_bf16_f32 v115, v122, v123
  s_waitcnt lgkmcnt(8)
  v_mfma_f32_16x16x32_bf16 v[80:83], v[48:51], v[144:147], v[80:83]
  ds_read_b64_tr_b16 v[40:41], v2 offset:50720
  s_add_u32 s63, s63, 1792
  v_mfma_f32_16x16x32_bf16 v[80:83], v[52:55], v[152:155], v[80:83]
  ds_read_b64_tr_b16 v[42:43], v2 offset:59168
  s_add_u32 m0, s31, 18528
  buffer_store_dwordx4 v[112:115], v1, s[24:27], s60 offen offset:3072 sc1
  v_mfma_f32_16x16x32_bf16 v[84:87], v[48:51], v[148:151], v[84:87]
  ds_read_b64_tr_b16 v[44:45], v2 offset:50976
  buffer_load_dwordx4 v3, s[20:23], s63 offen offset:3584  lds
  v_mfma_f32_16x16x32_bf16 v[84:87], v[52:55], v[156:159], v[84:87]
  ds_read_b64_tr_b16 v[46:47], v2 offset:59424
  s_waitcnt lgkmcnt(8)
  v_mfma_f32_16x16x32_bf16 v[88:91], v[56:59], v[144:147], v[88:91]
  ds_read_b64_tr_b16 v[48:49], v2 offset:50752
  buffer_load_dwordx4 a[4:7], v11, s[24:27], s5 offen sc1
  v_mfma_f32_16x16x32_bf16 v[88:91], v[60:63], v[152:155], v[88:91]
  ds_read_b64_tr_b16 v[50:51], v2 offset:59200
  v_mfma_f32_16x16x32_bf16 v[92:95], v[56:59], v[148:151], v[92:95]
  ds_read_b64_tr_b16 v[52:53], v2 offset:51008
  v_mfma_f32_16x16x32_bf16 v[92:95], v[60:63], v[156:159], v[92:95]
  ds_read_b64_tr_b16 v[54:55], v2 offset:59456
  s_waitcnt lgkmcnt(8)
  v_mfma_f32_16x16x32_bf16 v[64:67], v[32:35], v[160:163], v[64:67]
  ds_read_b64_tr_b16 v[56:57], v2 offset:50784
  v_mfma_f32_16x16x32_bf16 v[64:67], v[36:39], v[168:171], v[64:67]
  ds_read_b64_tr_b16 v[58:59], v2 offset:59232
  v_mfma_f32_16x16x32_bf16 v[68:71], v[32:35], v[164:167], v[68:71]
  ds_read_b64_tr_b16 v[60:61], v2 offset:51040
  v_cvt_pk_bf16_f32 v116, v116, v117
  v_mfma_f32_16x16x32_bf16 v[68:71], v[36:39], v[172:175], v[68:71]
  ds_read_b64_tr_b16 v[62:63], v2 offset:59488
  s_waitcnt lgkmcnt(8)
  v_mfma_f32_16x16x32_bf16 v[72:75], v[40:43], v[160:163], v[72:75]
  ds_read_b64_tr_b16 v[32:33], v2 offset:51200
  v_cvt_pk_bf16_f32 v117, v118, v119
  v_mfma_f32_16x16x32_bf16 v[72:75], v[44:47], v[168:171], v[72:75]
  ds_read_b64_tr_b16 v[34:35], v2 offset:59648
  v_cvt_pk_bf16_f32 v118, v124, v125
  v_mfma_f32_16x16x32_bf16 v[76:79], v[40:43], v[164:167], v[76:79]
  ds_read_b64_tr_b16 v[36:37], v2 offset:51456
  v_cvt_pk_bf16_f32 v119, v126, v127
  v_mfma_f32_16x16x32_bf16 v[76:79], v[44:47], v[172:175], v[76:79]
  ds_read_b64_tr_b16 v[38:39], v2 offset:59904
  s_waitcnt lgkmcnt(8)
  v_mfma_f32_16x16x32_bf16 v[80:83], v[48:51], v[160:163], v[80:83]
  ds_read_b64_tr_b16 v[40:41], v2 offset:51232
  buffer_store_dwordx4 v[116:119], v1, s[24:27], s61 offen offset:3072 sc1
  v_mfma_f32_16x16x32_bf16 v[80:83], v[52:55], v[168:171], v[80:83]
  ds_read_b64_tr_b16 v[42:43], v2 offset:59680
  buffer_load_dwordx4 a[8:11], v11, s[24:27], s6 offen sc1
  v_mfma_f32_16x16x32_bf16 v[84:87], v[48:51], v[164:167], v[84:87]
  ds_read_b64_tr_b16 v[44:45], v2 offset:51488
  v_mfma_f32_16x16x32_bf16 v[84:87], v[52:55], v[172:175], v[84:87]
  ds_read_b64_tr_b16 v[46:47], v2 offset:59936
  s_waitcnt lgkmcnt(8)
  v_mfma_f32_16x16x32_bf16 v[88:91], v[56:59], v[160:163], v[88:91]
  ds_read_b64_tr_b16 v[48:49], v2 offset:51264
  v_mfma_f32_16x16x32_bf16 v[88:91], v[60:63], v[168:171], v[88:91]
  ds_read_b64_tr_b16 v[50:51], v2 offset:59712
  v_mfma_f32_16x16x32_bf16 v[92:95], v[56:59], v[164:167], v[92:95]
  ds_read_b64_tr_b16 v[52:53], v2 offset:51520
  v_mfma_f32_16x16x32_bf16 v[92:95], v[60:63], v[172:175], v[92:95]
  ds_read_b64_tr_b16 v[54:55], v2 offset:59968
  s_waitcnt lgkmcnt(8)
  v_mfma_f32_16x16x32_bf16 v[64:67], v[32:35], v[176:179], v[64:67]
  ds_read_b64_tr_b16 v[56:57], v2 offset:51296
  buffer_load_dwordx4 a[12:15], v11, s[24:27], s7 offen sc1
  v_mfma_f32_16x16x32_bf16 v[64:67], v[36:39], v[184:187], v[64:67]
  ds_read_b64_tr_b16 v[58:59], v2 offset:59744
  s_waitcnt vmcnt(16)
  v_mfma_f32_16x16x32_bf16 v[68:71], v[32:35], v[180:183], v[68:71]
  ds_read_b64_tr_b16 v[60:61], v2 offset:51552
  s_barrier
  v_mfma_f32_16x16x32_bf16 v[68:71], v[36:39], v[188:191], v[68:71]
  ds_read_b64_tr_b16 v[62:63], v2 offset:60000
  s_waitcnt lgkmcnt(8)
  v_mfma_f32_16x16x32_bf16 v[72:75], v[40:43], v[176:179], v[72:75]
  ds_read_b64_tr_b16 v[32:33], v14 offset:50688
  s_add_u32 s63, s64, 230016
  v_mfma_f32_16x16x32_bf16 v[72:75], v[44:47], v[184:187], v[72:75]
  ds_read_b64_tr_b16 v[34:35], v14 offset:59136
  s_add_u32 m0, s31, 86528
  v_mfma_f32_16x16x32_bf16 v[76:79], v[40:43], v[180:183], v[76:79]
  ds_read_b64_tr_b16 v[36:37], v14 offset:50944
  buffer_load_dwordx4 v3, s[20:23], s63 offen offset:0  lds
  v_mfma_f32_16x16x32_bf16 v[76:79], v[44:47], v[188:191], v[76:79]
  ds_read_b64_tr_b16 v[38:39], v14 offset:59392
  s_waitcnt lgkmcnt(8)
  v_mfma_f32_16x16x32_bf16 v[80:83], v[48:51], v[176:179], v[80:83]
  ds_read_b64_tr_b16 v[40:41], v14 offset:50720
  buffer_load_dwordx4 a[16:19], v11, s[24:27], s8 offen sc1
  v_mfma_f32_16x16x32_bf16 v[80:83], v[52:55], v[184:187], v[80:83]
  ds_read_b64_tr_b16 v[42:43], v14 offset:59168
  s_add_u32 m0, s31, 85792
  v_mfma_f32_16x16x32_bf16 v[84:87], v[48:51], v[180:183], v[84:87]
  ds_read_b64_tr_b16 v[44:45], v14 offset:50976
  buffer_load_dwordx4 v3, s[20:23], s63 offen offset:1792  lds
  v_mfma_f32_16x16x32_bf16 v[84:87], v[52:55], v[188:191], v[84:87]
  ds_read_b64_tr_b16 v[46:47], v14 offset:59424
  s_waitcnt lgkmcnt(8)
  v_mfma_f32_16x16x32_bf16 v[88:91], v[56:59], v[176:179], v[88:91]
  ds_read_b64_tr_b16 v[48:49], v14 offset:50752
  v_mfma_f32_16x16x32_bf16 v[88:91], v[60:63], v[184:187], v[88:91]
  ds_read_b64_tr_b16 v[50:51], v14 offset:59200
  v_mfma_f32_16x16x32_bf16 v[92:95], v[56:59], v[180:183], v[92:95]
  ds_read_b64_tr_b16 v[52:53], v14 offset:51008
  buffer_load_dwordx4 a[20:23], v11, s[24:27], s9 offen sc1
  v_mfma_f32_16x16x32_bf16 v[92:95], v[60:63], v[188:191], v[92:95]
  ds_read_b64_tr_b16 v[54:55], v14 offset:59456
  s_waitcnt lgkmcnt(8)
  v_mfma_f32_16x16x32_bf16 v[64:67], v[32:35], v[192:195], v[64:67]
  ds_read_b64_tr_b16 v[56:57], v14 offset:50784
  s_add_u32 m0, s31, 85056
  v_mfma_f32_16x16x32_bf16 v[64:67], v[36:39], v[200:203], v[64:67]
  ds_read_b64_tr_b16 v[58:59], v14 offset:59232
  buffer_load_dwordx4 v3, s[20:23], s63 offen offset:3584  lds
  v_mfma_f32_16x16x32_bf16 v[68:71], v[32:35], v[196:199], v[68:71]
  ds_read_b64_tr_b16 v[60:61], v14 offset:51040
  v_mfma_f32_16x16x32_bf16 v[68:71], v[36:39], v[204:207], v[68:71]
  ds_read_b64_tr_b16 v[62:63], v14 offset:59488
  s_waitcnt lgkmcnt(8)
  v_mfma_f32_16x16x32_bf16 v[72:75], v[40:43], v[192:195], v[72:75]
  ds_read_b64_tr_b16 v[32:33], v14 offset:51200
  s_add_u32 s63, s63, 1792
  v_mfma_f32_16x16x32_bf16 v[72:75], v[44:47], v[200:203], v[72:75]
  ds_read_b64_tr_b16 v[34:35], v14 offset:59648
  s_add_u32 m0, s31, 86112
  v_mfma_f32_16x16x32_bf16 v[76:79], v[40:43], v[196:199], v[76:79]
  ds_read_b64_tr_b16 v[36:37], v14 offset:51456
  buffer_load_dwordx4 v3, s[20:23], s63 offen offset:3584  lds
  v_mfma_f32_16x16x32_bf16 v[76:79], v[44:47], v[204:207], v[76:79]
  ds_read_b64_tr_b16 v[38:39], v14 offset:59904
  s_waitcnt lgkmcnt(8)
  v_mfma_f32_16x16x32_bf16 v[80:83], v[48:51], v[192:195], v[80:83]
  ds_read_b64_tr_b16 v[40:41], v14 offset:51232
  s_add_u32 s63, s64, 344704
  v_mfma_f32_16x16x32_bf16 v[80:83], v[52:55], v[200:203], v[80:83]
  ds_read_b64_tr_b16 v[42:43], v14 offset:59680
  s_add_u32 m0, s31, 35840
  v_mfma_f32_16x16x32_bf16 v[84:87], v[48:51], v[196:199], v[84:87]
  ds_read_b64_tr_b16 v[44:45], v14 offset:51488
  buffer_load_dwordx4 v3, s[20:23], s63 offen offset:0  lds
  v_mfma_f32_16x16x32_bf16 v[84:87], v[52:55], v[204:207], v[84:87]
  ds_read_b64_tr_b16 v[46:47], v14 offset:59936
  s_waitcnt lgkmcnt(8)
  v_mfma_f32_16x16x32_bf16 v[88:91], v[56:59], v[192:195], v[88:91]
  ds_read_b64_tr_b16 v[48:49], v14 offset:51264
  buffer_load_dwordx4 a[24:27], v11, s[24:27], s10 offen sc1
  v_mfma_f32_16x16x32_bf16 v[88:91], v[60:63], v[200:203], v[88:91]
  ds_read_b64_tr_b16 v[50:51], v14 offset:59712
  s_add_u32 m0, s31, 35104
  v_mfma_f32_16x16x32_bf16 v[92:95], v[56:59], v[196:199], v[92:95]
  ds_read_b64_tr_b16 v[52:53], v14 offset:51520
  buffer_load_dwordx4 v3, s[20:23], s63 offen offset:1792  lds
  v_mfma_f32_16x16x32_bf16 v[92:95], v[60:63], v[204:207], v[92:95]
  ds_read_b64_tr_b16 v[54:55], v14 offset:59968
  s_waitcnt lgkmcnt(8)
  v_mfma_f32_16x16x32_bf16 v[64:67], v[32:35], v[208:211], v[64:67]
  ds_read_b64_tr_b16 v[56:57], v14 offset:51296
  v_mfma_f32_16x16x32_bf16 v[64:67], v[36:39], v[216:219], v[64:67]
  ds_read_b64_tr_b16 v[58:59], v14 offset:59744
  v_mfma_f32_16x16x32_bf16 v[68:71], v[32:35], v[212:215], v[68:71]
  ds_read_b64_tr_b16 v[60:61], v14 offset:51552
  buffer_load_dwordx4 a[28:31], v11, s[24:27], s11 offen sc1
  v_mfma_f32_16x16x32_bf16 v[68:71], v[36:39], v[220:223], v[68:71]
  ds_read_b64_tr_b16 v[62:63], v14 offset:60000
  s_waitcnt lgkmcnt(8)
  v_mfma_f32_16x16x32_bf16 v[72:75], v[40:43], v[208:211], v[72:75]
  ds_read_b64_tr_b16 v[32:33], v2 offset:0
  s_add_u32 m0, s31, 34368
  v_mfma_f32_16x16x32_bf16 v[72:75], v[44:47], v[216:219], v[72:75]
  ds_read_b64_tr_b16 v[34:35], v2 offset:8448
  buffer_load_dwordx4 v3, s[20:23], s63 offen offset:3584  lds
  v_mfma_f32_16x16x32_bf16 v[76:79], v[40:43], v[212:215], v[76:79]
  ds_read_b64_tr_b16 v[36:37], v2 offset:256
  v_mfma_f32_16x16x32_bf16 v[76:79], v[44:47], v[220:223], v[76:79]
  ds_read_b64_tr_b16 v[38:39], v2 offset:8704
  s_waitcnt lgkmcnt(8)
  v_mfma_f32_16x16x32_bf16 v[80:83], v[48:51], v[208:211], v[80:83]
  ds_read_b64_tr_b16 v[40:41], v2 offset:512
  s_add_u32 s63, s63, 1792
  v_mfma_f32_16x16x32_bf16 v[80:83], v[52:55], v[216:219], v[80:83]
  ds_read_b64_tr_b16 v[42:43], v2 offset:8960
  s_add_u32 m0, s31, 35424
  v_mfma_f32_16x16x32_bf16 v[84:87], v[48:51], v[212:215], v[84:87]
  ds_read_b64_tr_b16 v[44:45], v2 offset:768
  buffer_load_dwordx4 v3, s[20:23], s63 offen offset:3584  lds
  v_mfma_f32_16x16x32_bf16 v[84:87], v[52:55], v[220:223], v[84:87]
  ds_read_b64_tr_b16 v[46:47], v2 offset:9216
  s_waitcnt lgkmcnt(8)
  v_mfma_f32_16x16x32_bf16 v[88:91], v[56:59], v[208:211], v[88:91]
  ds_read_b64_tr_b16 v[48:49], v2 offset:32
  v_add_u32 v11, 4096, v11
  v_mfma_f32_16x16x32_bf16 v[88:91], v[60:63], v[216:219], v[88:91]
  ds_read_b64_tr_b16 v[50:51], v2 offset:8480
  v_mfma_f32_16x16x32_bf16 v[92:95], v[56:59], v[212:215], v[92:95]
  ds_read_b64_tr_b16 v[52:53], v2 offset:288
  v_mfma_f32_16x16x32_bf16 v[92:95], v[60:63], v[220:223], v[92:95]
  ds_read_b64_tr_b16 v[54:55], v2 offset:8736
  s_waitcnt lgkmcnt(8)
  v_mfma_f32_16x16x32_bf16 v[64:67], v[32:35], v[224:227], v[64:67]
  ds_read_b64_tr_b16 v[56:57], v2 offset:544
  v_mfma_f32_16x16x32_bf16 v[64:67], v[36:39], v[232:235], v[64:67]
  ds_read_b64_tr_b16 v[58:59], v2 offset:8992
  v_mfma_f32_16x16x32_bf16 v[68:71], v[32:35], v[228:231], v[68:71]
  ds_read_b64_tr_b16 v[60:61], v2 offset:800
  v_mfma_f32_16x16x32_bf16 v[68:71], v[36:39], v[236:239], v[68:71]
  ds_read_b64_tr_b16 v[62:63], v2 offset:9248
  s_waitcnt lgkmcnt(8)
  v_mfma_f32_16x16x32_bf16 v[64:67], v[40:43], v[240:243], v[64:67]
  ds_read_b64_tr_b16 v[32:33], v2 offset:64
  v_mfma_f32_16x16x32_bf16 v[64:67], v[44:47], v[248:251], v[64:67]
  ds_read_b64_tr_b16 v[34:35], v2 offset:8512
  v_mfma_f32_16x16x32_bf16 v[68:71], v[40:43], v[244:247], v[68:71]
  ds_read_b64_tr_b16 v[36:37], v2 offset:320
  v_mfma_f32_16x16x32_bf16 v[68:71], v[44:47], v[252:255], v[68:71]
  ds_read_b64_tr_b16 v[38:39], v2 offset:8768
  s_waitcnt lgkmcnt(8)
  v_mfma_f32_16x16x32_bf16 v[72:75], v[48:51], v[224:227], v[72:75]
  ds_read_b64_tr_b16 v[40:41], v2 offset:576
  v_mfma_f32_16x16x32_bf16 v[72:75], v[52:55], v[232:235], v[72:75]
  ds_read_b64_tr_b16 v[42:43], v2 offset:9024
  v_mfma_f32_16x16x32_bf16 v[76:79], v[48:51], v[228:231], v[76:79]
  ds_read_b64_tr_b16 v[44:45], v2 offset:832
  v_mfma_f32_16x16x32_bf16 v[76:79], v[52:55], v[236:239], v[76:79]
  ds_read_b64_tr_b16 v[46:47], v2 offset:9280
  s_waitcnt lgkmcnt(8)
  v_mfma_f32_16x16x32_bf16 v[72:75], v[56:59], v[240:243], v[72:75]
  ds_read_b64_tr_b16 v[48:49], v2 offset:96
  v_mfma_f32_16x16x32_bf16 v[72:75], v[60:63], v[248:251], v[72:75]
  ds_read_b64_tr_b16 v[50:51], v2 offset:8544
  v_mfma_f32_16x16x32_bf16 v[76:79], v[56:59], v[244:247], v[76:79]
  ds_read_b64_tr_b16 v[52:53], v2 offset:352
  v_mfma_f32_16x16x32_bf16 v[76:79], v[60:63], v[252:255], v[76:79]
  ds_read_b64_tr_b16 v[54:55], v2 offset:8800
  s_waitcnt lgkmcnt(8)
  v_mfma_f32_16x16x32_bf16 v[80:83], v[32:35], v[224:227], v[80:83]
  ds_read_b64_tr_b16 v[56:57], v2 offset:608
  v_mfma_f32_16x16x32_bf16 v[80:83], v[36:39], v[232:235], v[80:83]
  ds_read_b64_tr_b16 v[58:59], v2 offset:9056
  s_waitcnt vmcnt(16)
  v_mfma_f32_16x16x32_bf16 v[84:87], v[32:35], v[228:231], v[84:87]
  ds_read_b64_tr_b16 v[60:61], v2 offset:864
  s_barrier
  v_mfma_f32_16x16x32_bf16 v[84:87], v[36:39], v[236:239], v[84:87]
  ds_read_b64_tr_b16 v[62:63], v2 offset:9312
  v_cvt_pk_bf16_f32 v64, v64, v65
  s_waitcnt lgkmcnt(8)
  v_mfma_f32_16x16x32_bf16 v[80:83], v[40:43], v[240:243], v[80:83]
  ds_read_b64_tr_b16 v[32:33], v14 offset:0
  s_add_u32 s63, s64, 768
  v_mfma_f32_16x16x32_bf16 v[80:83], v[44:47], v[248:251], v[80:83]
  ds_read_b64_tr_b16 v[34:35], v14 offset:8448
  s_add_u32 m0, s31, 103424
  v_cvt_pk_bf16_f32 v65, v66, v67
  v_mfma_f32_16x16x32_bf16 v[84:87], v[40:43], v[244:247], v[84:87]
  ds_read_b64_tr_b16 v[36:37], v14 offset:256
  buffer_load_dwordx4 v3, s[20:23], s63 offen offset:0  lds
  v_cvt_pk_bf16_f32 v66, v72, v73
  v_mfma_f32_16x16x32_bf16 v[84:87], v[44:47], v[252:255], v[84:87]
  ds_read_b64_tr_b16 v[38:39], v14 offset:8704
  s_waitcnt lgkmcnt(8)
  v_mfma_f32_16x16x32_bf16 v[88:91], v[48:51], v[224:227], v[88:91]
  ds_read_b64_tr_b16 v[40:41], v14 offset:32
  v_cvt_pk_bf16_f32 v67, v74, v75
  s_mov_b32 s60, 8192
  v_mfma_f32_16x16x32_bf16 v[88:91], v[52:55], v[232:235], v[88:91]
  ds_read_b64_tr_b16 v[42:43], v14 offset:8480
  s_add_u32 m0, s31, 102688
  buffer_store_dwordx4 v[64:67], v1, s[24:27], s60 offen offset:0 sc1
  v_mfma_f32_16x16x32_bf16 v[92:95], v[48:51], v[228:231], v[92:95]
  ds_read_b64_tr_b16 v[44:45], v14 offset:288
  buffer_load_dwordx4 v3, s[20:23], s63 offen offset:1792  lds
  s_waitcnt vmcnt(17)
  v_mfma_f32_16x16x32_bf16 v[92:95], v[52:55], v[236:239], v[92:95]
  ds_read_b64_tr_b16 v[46:47], v14 offset:8736
  v_mov_b32 v4, 2
  s_waitcnt lgkmcnt(8)
  v_mfma_f32_16x16x32_bf16 v[88:91], v[56:59], v[240:243], v[88:91]
  ds_read_b64_tr_b16 v[48:49], v14 offset:64
  buffer_store_dword v4, v15, s[40:43], s67 offen sc1
  v_mfma_f32_16x16x32_bf16 v[88:91], v[60:63], v[248:251], v[88:91]
  ds_read_b64_tr_b16 v[50:51], v14 offset:8512
  v_mfma_f32_16x16x32_bf16 v[92:95], v[56:59], v[244:247], v[92:95]
  ds_read_b64_tr_b16 v[52:53], v14 offset:320
  v_mfma_f32_16x16x32_bf16 v[92:95], v[60:63], v[252:255], v[92:95]
  ds_read_b64_tr_b16 v[54:55], v14 offset:8768
  s_waitcnt lgkmcnt(8)
  v_mfma_f32_16x16x32_bf16 v[96:99], v[32:35], v[128:131], 0
  ds_read_b64_tr_b16 v[56:57], v14 offset:96
  s_add_u32 m0, s31, 101952
  v_mfma_f32_16x16x32_bf16 v[96:99], v[36:39], v[136:139], v[96:99]
  ds_read_b64_tr_b16 v[58:59], v14 offset:8544
  buffer_load_dwordx4 v3, s[20:23], s63 offen offset:3584  lds
  v_mfma_f32_16x16x32_bf16 v[100:103], v[32:35], v[132:135], 0
  ds_read_b64_tr_b16 v[60:61], v14 offset:352
  v_cvt_pk_bf16_f32 v68, v68, v69
  v_mfma_f32_16x16x32_bf16 v[100:103], v[36:39], v[140:143], v[100:103]
  ds_read_b64_tr_b16 v[62:63], v14 offset:8800
  v_cvt_pk_bf16_f32 v69, v70, v71
  s_waitcnt lgkmcnt(8)
  v_mfma_f32_16x16x32_bf16 v[104:107], v[40:43], v[128:131], 0
  ds_read_b64_tr_b16 v[32:33], v14 offset:512
  s_add_u32 s63, s63, 1792
  v_mfma_f32_16x16x32_bf16 v[104:107], v[44:47], v[136:139], v[104:107]
  ds_read_b64_tr_b16 v[34:35], v14 offset:8960
  s_add_u32 m0, s31, 103008
  v_cvt_pk_bf16_f32 v70, v76, v77
  v_mfma_f32_16x16x32_bf16 v[108:111], v[40:43], v[132:135], 0
  ds_read_b64_tr_b16 v[36:37], v14 offset:768
  buffer_load_dwordx4 v3, s[20:23], s63 offen offset:3584  lds
  v_cvt_pk_bf16_f32 v71, v78, v79
  v_mfma_f32_16x16x32_bf16 v[108:111], v[44:47], v[140:143], v[108:111]
  ds_read_b64_tr_b16 v[38:39], v14 offset:9216
  s_waitcnt lgkmcnt(8)
  v_mfma_f32_16x16x32_bf16 v[112:115], v[48:51], v[128:131], 0
  ds_read_b64_tr_b16 v[40:41], v14 offset:544
  s_add_u32 s63, s64, 115456
  s_mov_b32 s61, 22528
  v_mfma_f32_16x16x32_bf16 v[112:115], v[52:55], v[136:139], v[112:115]
  ds_read_b64_tr_b16 v[42:43], v14 offset:8992
  s_add_u32 m0, s31, 52736
  buffer_store_dwordx4 v[68:71], v1, s[24:27], s61 offen offset:0 sc1
  v_mfma_f32_16x16x32_bf16 v[116:119], v[48:51], v[132:135], 0
  ds_read_b64_tr_b16 v[44:45], v14 offset:800
  buffer_load_dwordx4 v3, s[20:23], s63 offen offset:0  lds
  v_mfma_f32_16x16x32_bf16 v[116:119], v[52:55], v[140:143], v[116:119]
  ds_read_b64_tr_b16 v[46:47], v14 offset:9248
  s_waitcnt lgkmcnt(8)
  v_mfma_f32_16x16x32_bf16 v[120:123], v[56:59], v[128:131], 0
  ds_read_b64_tr_b16 v[48:49], v14 offset:576
  v_mfma_f32_16x16x32_bf16 v[120:123], v[60:63], v[136:139], v[120:123]
  ds_read_b64_tr_b16 v[50:51], v14 offset:9024
  s_add_u32 m0, s31, 52000
  v_mfma_f32_16x16x32_bf16 v[124:127], v[56:59], v[132:135], 0
  ds_read_b64_tr_b16 v[52:53], v14 offset:832
  buffer_load_dwordx4 v3, s[20:23], s63 offen offset:1792  lds
  v_mfma_f32_16x16x32_bf16 v[124:127], v[60:63], v[140:143], v[124:127]
  ds_read_b64_tr_b16 v[54:55], v14 offset:9280
  s_waitcnt lgkmcnt(8)
  v_mfma_f32_16x16x32_bf16 v[96:99], v[32:35], v[144:147], v[96:99]
  ds_read_b64_tr_b16 v[56:57], v14 offset:608
  v_mfma_f32_16x16x32_bf16 v[96:99], v[36:39], v[152:155], v[96:99]
  ds_read_b64_tr_b16 v[58:59], v14 offset:9056
  v_mfma_f32_16x16x32_bf16 v[100:103], v[32:35], v[148:151], v[100:103]
  ds_read_b64_tr_b16 v[60:61], v14 offset:864
  v_cvt_pk_bf16_f32 v80, v80, v81
  v_mfma_f32_16x16x32_bf16 v[100:103], v[36:39], v[156:159], v[100:103]
  ds_read_b64_tr_b16 v[62:63], v14 offset:9312
  s_waitcnt lgkmcnt(8)
  v_mfma_f32_16x16x32_bf16 v[104:107], v[40:43], v[144:147], v[104:107]
  ds_read_b64_tr_b16 v[32:33], v2 offset:16896
  s_add_u32 m0, s31, 51264
  v_cvt_pk_bf16_f32 v81, v82, v83
  v_mfma_f32_16x16x32_bf16 v[104:107], v[44:47], v[152:155], v[104:107]
  ds_read_b64_tr_b16 v[34:35], v2 offset:25344
  buffer_load_dwordx4 v3, s[20:23], s63 offen offset:3584  lds
  v_mfma_f32_16x16x32_bf16 v[108:111], v[40:43], v[148:151], v[108:111]
  ds_read_b64_tr_b16 v[36:37], v2 offset:17152
  v_cvt_pk_bf16_f32 v82, v88, v89
  v_mfma_f32_16x16x32_bf16 v[108:111], v[44:47], v[156:159], v[108:111]
  ds_read_b64_tr_b16 v[38:39], v2 offset:25600
  v_cvt_pk_bf16_f32 v83, v90, v91
  s_waitcnt lgkmcnt(8)
  v_mfma_f32_16x16x32_bf16 v[112:115], v[48:51], v[144:147], v[112:115]
  ds_read_b64_tr_b16 v[40:41], v2 offset:16928
  s_add_u32 s63, s63, 1792
  v_mfma_f32_16x16x32_bf16 v[112:115], v[52:55], v[152:155], v[112:115]
  ds_read_b64_tr_b16 v[42:43], v2 offset:25376
  s_add_u32 m0, s31, 52320
  buffer_store_dwordx4 v[80:83], v1, s[24:27], s60 offen offset:1024 sc1
  v_mfma_f32_16x16x32_bf16 v[116:119], v[48:51], v[148:151], v[116:119]
  ds_read_b64_tr_b16 v[44:45], v2 offset:17184
  buffer_load_dwordx4 v3, s[20:23], s63 offen offset:3584  lds
  v_mfma_f32_16x16x32_bf16 v[116:119], v[52:55], v[156:159], v[116:119]
  ds_read_b64_tr_b16 v[46:47], v2 offset:25632
  s_waitcnt lgkmcnt(8)
  v_mfma_f32_16x16x32_bf16 v[120:123], v[56:59], v[144:147], v[120:123]
  ds_read_b64_tr_b16 v[48:49], v2 offset:16960
  v_mfma_f32_16x16x32_bf16 v[120:123], v[60:63], v[152:155], v[120:123]
  ds_read_b64_tr_b16 v[50:51], v2 offset:25408
  v_mfma_f32_16x16x32_bf16 v[124:127], v[56:59], v[148:151], v[124:127]
  ds_read_b64_tr_b16 v[52:53], v2 offset:17216
  v_mfma_f32_16x16x32_bf16 v[124:127], v[60:63], v[156:159], v[124:127]
  ds_read_b64_tr_b16 v[54:55], v2 offset:25664
  s_waitcnt lgkmcnt(8)
  v_mfma_f32_16x16x32_bf16 v[96:99], v[32:35], v[160:163], v[96:99]
  ds_read_b64_tr_b16 v[56:57], v2 offset:16992
  v_mfma_f32_16x16x32_bf16 v[96:99], v[36:39], v[168:171], v[96:99]
  ds_read_b64_tr_b16 v[58:59], v2 offset:25440
  v_mfma_f32_16x16x32_bf16 v[100:103], v[32:35], v[164:167], v[100:103]
  ds_read_b64_tr_b16 v[60:61], v2 offset:17248
  v_cvt_pk_bf16_f32 v84, v84, v85
  v_mfma_f32_16x16x32_bf16 v[100:103], v[36:39], v[172:175], v[100:103]
  ds_read_b64_tr_b16 v[62:63], v2 offset:25696
  s_waitcnt lgkmcnt(8)
  v_mfma_f32_16x16x32_bf16 v[104:107], v[40:43], v[160:163], v[104:107]
  ds_read_b64_tr_b16 v[32:33], v2 offset:17408
  v_cvt_pk_bf16_f32 v85, v86, v87
  v_mfma_f32_16x16x32_bf16 v[104:107], v[44:47], v[168:171], v[104:107]
  ds_read_b64_tr_b16 v[34:35], v2 offset:25856
  v_cvt_pk_bf16_f32 v86, v92, v93
  v_mfma_f32_16x16x32_bf16 v[108:111], v[40:43], v[164:167], v[108:111]
  ds_read_b64_tr_b16 v[36:37], v2 offset:17664
  v_cvt_pk_bf16_f32 v87, v94, v95
  v_mfma_f32_16x16x32_bf16 v[108:111], v[44:47], v[172:175], v[108:111]
  ds_read_b64_tr_b16 v[38:39], v2 offset:26112
  s_waitcnt lgkmcnt(8)
  v_mfma_f32_16x16x32_bf16 v[112:115], v[48:51], v[160:163], v[112:115]
  ds_read_b64_tr_b16 v[40:41], v2 offset:17440
  buffer_store_dwordx4 v[84:87], v1, s[24:27], s61 offen offset:1024 sc1
  v_mfma_f32_16x16x32_bf16 v[112:115], v[52:55], v[168:171], v[112:115]
  ds_read_b64_tr_b16 v[42:43], v2 offset:25888
  v_mfma_f32_16x16x32_bf16 v[116:119], v[48:51], v[164:167], v[116:119]
  ds_read_b64_tr_b16 v[44:45], v2 offset:17696
  v_mfma_f32_16x16x32_bf16 v[116:119], v[52:55], v[172:175], v[116:119]
  ds_read_b64_tr_b16 v[46:47], v2 offset:26144
  s_waitcnt lgkmcnt(8)
  v_mfma_f32_16x16x32_bf16 v[120:123], v[56:59], v[160:163], v[120:123]
  ds_read_b64_tr_b16 v[48:49], v2 offset:17472
  v_mfma_f32_16x16x32_bf16 v[120:123], v[60:63], v[168:171], v[120:123]
  ds_read_b64_tr_b16 v[50:51], v2 offset:25920
  v_mfma_f32_16x16x32_bf16 v[124:127], v[56:59], v[164:167], v[124:127]
  ds_read_b64_tr_b16 v[52:53], v2 offset:17728
  v_mfma_f32_16x16x32_bf16 v[124:127], v[60:63], v[172:175], v[124:127]
  ds_read_b64_tr_b16 v[54:55], v2 offset:26176
  s_waitcnt lgkmcnt(8)
  v_mfma_f32_16x16x32_bf16 v[96:99], v[32:35], v[176:179], v[96:99]
  ds_read_b64_tr_b16 v[56:57], v2 offset:17504
  v_mfma_f32_16x16x32_bf16 v[96:99], v[36:39], v[184:187], v[96:99]
  ds_read_b64_tr_b16 v[58:59], v2 offset:25952
  s_waitcnt vmcnt(13)
  v_mfma_f32_16x16x32_bf16 v[100:103], v[32:35], v[180:183], v[100:103]
  ds_read_b64_tr_b16 v[60:61], v2 offset:17760
  s_barrier
  v_mfma_f32_16x16x32_bf16 v[100:103], v[36:39], v[188:191], v[100:103]
  ds_read_b64_tr_b16 v[62:63], v2 offset:26208
  s_waitcnt lgkmcnt(8)
  v_mfma_f32_16x16x32_bf16 v[104:107], v[40:43], v[176:179], v[104:107]
  ds_read_b64_tr_b16 v[32:33], v14 offset:16896
  s_add_u32 s63, s64, 230144
  v_mfma_f32_16x16x32_bf16 v[104:107], v[44:47], v[184:187], v[104:107]
  ds_read_b64_tr_b16 v[34:35], v14 offset:25344
  s_add_u32 m0, s31, 120320
  v_mfma_f32_16x16x32_bf16 v[108:111], v[40:43], v[180:183], v[108:111]
  ds_read_b64_tr_b16 v[36:37], v14 offset:17152
  buffer_load_dwordx4 v3, s[20:23], s63 offen offset:0  lds
  v_mfma_f32_16x16x32_bf16 v[108:111], v[44:47], v[188:191], v[108:111]
  ds_read_b64_tr_b16 v[38:39], v14 offset:25600
  s_waitcnt lgkmcnt(8)
  v_mfma_f32_16x16x32_bf16 v[112:115], v[48:51], v[176:179], v[112:115]
  ds_read_b64_tr_b16 v[40:41], v14 offset:16928
  v_mfma_f32_16x16x32_bf16 v[112:115], v[52:55], v[184:187], v[112:115]
  ds_read_b64_tr_b16 v[42:43], v14 offset:25376
  s_add_u32 m0, s31, 119584
  v_mfma_f32_16x16x32_bf16 v[116:119], v[48:51], v[180:183], v[116:119]
  ds_read_b64_tr_b16 v[44:45], v14 offset:17184
  buffer_load_dwordx4 v3, s[20:23], s63 offen offset:1792  lds
  v_mfma_f32_16x16x32_bf16 v[116:119], v[52:55], v[188:191], v[116:119]
  ds_read_b64_tr_b16 v[46:47], v14 offset:25632
  s_waitcnt lgkmcnt(8)
  v_mfma_f32_16x16x32_bf16 v[120:123], v[56:59], v[176:179], v[120:123]
  ds_read_b64_tr_b16 v[48:49], v14 offset:16960
  v_mfma_f32_16x16x32_bf16 v[120:123], v[60:63], v[184:187], v[120:123]
  ds_read_b64_tr_b16 v[50:51], v14 offset:25408
  v_mfma_f32_16x16x32_bf16 v[124:127], v[56:59], v[180:183], v[124:127]
  ds_read_b64_tr_b16 v[52:53], v14 offset:17216
  v_mfma_f32_16x16x32_bf16 v[124:127], v[60:63], v[188:191], v[124:127]
  ds_read_b64_tr_b16 v[54:55], v14 offset:25664
  s_waitcnt lgkmcnt(8)
  v_mfma_f32_16x16x32_bf16 v[96:99], v[32:35], v[192:195], v[96:99]
  ds_read_b64_tr_b16 v[56:57], v14 offset:16992
  s_add_u32 m0, s31, 118848
  v_mfma_f32_16x16x32_bf16 v[96:99], v[36:39], v[200:203], v[96:99]
  ds_read_b64_tr_b16 v[58:59], v14 offset:25440
  buffer_load_dwordx4 v3, s[20:23], s63 offen offset:3584  lds
  v_mfma_f32_16x16x32_bf16 v[100:103], v[32:35], v[196:199], v[100:103]
  ds_read_b64_tr_b16 v[60:61], v14 offset:17248
  buffer_load_dword v5, v10, s[40:43], 0 offen sc1
  v_mfma_f32_16x16x32_bf16 v[100:103], v[36:39], v[204:207], v[100:103]
  ds_read_b64_tr_b16 v[62:63], v14 offset:25696
  s_waitcnt lgkmcnt(8)
  v_mfma_f32_16x16x32_bf16 v[104:107], v[40:43], v[192:195], v[104:107]
  ds_read_b64_tr_b16 v[32:33], v14 offset:17408
  s_add_u32 s63, s63, 1792
  v_mfma_f32_16x16x32_bf16 v[104:107], v[44:47], v[200:203], v[104:107]
  ds_read_b64_tr_b16 v[34:35], v14 offset:25856
  s_add_u32 m0, s31, 119904
  v_mfma_f32_16x16x32_bf16 v[108:111], v[40:43], v[196:199], v[108:111]
  ds_read_b64_tr_b16 v[36:37], v14 offset:17664
  buffer_load_dwordx4 v3, s[20:23], s63 offen offset:3584  lds
  v_mfma_f32_16x16x32_bf16 v[108:111], v[44:47], v[204:207], v[108:111]
  ds_read_b64_tr_b16 v[38:39], v14 offset:26112
  s_waitcnt lgkmcnt(8)
  v_mfma_f32_16x16x32_bf16 v[112:115], v[48:51], v[192:195], v[112:115]
  ds_read_b64_tr_b16 v[40:41], v14 offset:17440
  s_add_u32 s63, s64, 344832
  v_mfma_f32_16x16x32_bf16 v[112:115], v[52:55], v[200:203], v[112:115]
  ds_read_b64_tr_b16 v[42:43], v14 offset:25888
  s_add_u32 m0, s31, 2048
  v_mfma_f32_16x16x32_bf16 v[116:119], v[48:51], v[196:199], v[116:119]
  ds_read_b64_tr_b16 v[44:45], v14 offset:17696
  buffer_load_dwordx4 v3, s[20:23], s63 offen offset:0  lds
  v_mfma_f32_16x16x32_bf16 v[116:119], v[52:55], v[204:207], v[116:119]
  ds_read_b64_tr_b16 v[46:47], v14 offset:26144
  s_waitcnt lgkmcnt(8)
  v_mfma_f32_16x16x32_bf16 v[120:123], v[56:59], v[192:195], v[120:123]
  ds_read_b64_tr_b16 v[48:49], v14 offset:17472
  v_mfma_f32_16x16x32_bf16 v[120:123], v[60:63], v[200:203], v[120:123]
  ds_read_b64_tr_b16 v[50:51], v14 offset:25920
  s_add_u32 m0, s31, 1312
  v_mfma_f32_16x16x32_bf16 v[124:127], v[56:59], v[196:199], v[124:127]
  ds_read_b64_tr_b16 v[52:53], v14 offset:17728
  buffer_load_dwordx4 v3, s[20:23], s63 offen offset:1792  lds
  v_mfma_f32_16x16x32_bf16 v[124:127], v[60:63], v[204:207], v[124:127]
  ds_read_b64_tr_b16 v[54:55], v14 offset:26176
  s_waitcnt lgkmcnt(8)
  v_mfma_f32_16x16x32_bf16 v[96:99], v[32:35], v[208:211], v[96:99]
  ds_read_b64_tr_b16 v[56:57], v14 offset:17504
  v_mfma_f32_16x16x32_bf16 v[96:99], v[36:39], v[216:219], v[96:99]
  ds_read_b64_tr_b16 v[58:59], v14 offset:25952
  v_mfma_f32_16x16x32_bf16 v[100:103], v[32:35], v[212:215], v[100:103]
  ds_read_b64_tr_b16 v[60:61], v14 offset:17760
  v_mfma_f32_16x16x32_bf16 v[100:103], v[36:39], v[220:223], v[100:103]
  ds_read_b64_tr_b16 v[62:63], v14 offset:26208
  s_waitcnt lgkmcnt(8)
  v_mfma_f32_16x16x32_bf16 v[104:107], v[40:43], v[208:211], v[104:107]
  ds_read_b64_tr_b16 v[32:33], v2 offset:33792
  s_add_u32 m0, s31, 576
  v_mfma_f32_16x16x32_bf16 v[104:107], v[44:47], v[216:219], v[104:107]
  ds_read_b64_tr_b16 v[34:35], v2 offset:42240
  buffer_load_dwordx4 v3, s[20:23], s63 offen offset:3584  lds
  v_mfma_f32_16x16x32_bf16 v[108:111], v[40:43], v[212:215], v[108:111]
  ds_read_b64_tr_b16 v[36:37], v2 offset:34048
  v_mfma_f32_16x16x32_bf16 v[108:111], v[44:47], v[220:223], v[108:111]
  ds_read_b64_tr_b16 v[38:39], v2 offset:42496
  s_waitcnt lgkmcnt(8)
  v_mfma_f32_16x16x32_bf16 v[112:115], v[48:51], v[208:211], v[112:115]
  ds_read_b64_tr_b16 v[40:41], v2 offset:34304
  s_add_u32 s63, s63, 1792
  v_mfma_f32_16x16x32_bf16 v[112:115], v[52:55], v[216:219], v[112:115]
  ds_read_b64_tr_b16 v[42:43], v2 offset:42752
  s_add_u32 m0, s31, 1632
  v_mfma_f32_16x16x32_bf16 v[116:119], v[48:51], v[212:215], v[116:119]
  ds_read_b64_tr_b16 v[44:45], v2 offset:34560
  buffer_load_dwordx4 v3, s[20:23], s63 offen offset:3584  lds
  v_mfma_f32_16x16x32_bf16 v[116:119], v[52:55], v[220:223], v[116:119]
  ds_read_b64_tr_b16 v[46:47], v2 offset:43008
  s_waitcnt lgkmcnt(8)
  v_mfma_f32_16x16x32_bf16 v[120:123], v[56:59], v[208:211], v[120:123]
  ds_read_b64_tr_b16 v[48:49], v2 offset:33824
  v_mfma_f32_16x16x32_bf16 v[120:123], v[60:63], v[216:219], v[120:123]
  ds_read_b64_tr_b16 v[50:51], v2 offset:42272
  v_mfma_f32_16x16x32_bf16 v[124:127], v[56:59], v[212:215], v[124:127]
  ds_read_b64_tr_b16 v[52:53], v2 offset:34080
  v_mfma_f32_16x16x32_bf16 v[124:127], v[60:63], v[220:223], v[124:127]
  ds_read_b64_tr_b16 v[54:55], v2 offset:42528
  s_waitcnt lgkmcnt(8)
  v_mfma_f32_16x16x32_bf16 v[96:99], v[32:35], v[224:227], v[96:99]
  ds_read_b64_tr_b16 v[56:57], v2 offset:34336
  v_mfma_f32_16x16x32_bf16 v[96:99], v[36:39], v[232:235], v[96:99]
  ds_read_b64_tr_b16 v[58:59], v2 offset:42784
  v_mfma_f32_16x16x32_bf16 v[100:103], v[32:35], v[228:231], v[100:103]
  ds_read_b64_tr_b16 v[60:61], v2 offset:34592
  v_mfma_f32_16x16x32_bf16 v[100:103], v[36:39], v[236:239], v[100:103]
  ds_read_b64_tr_b16 v[62:63], v2 offset:43040
  s_waitcnt lgkmcnt(8)
  v_mfma_f32_16x16x32_bf16 v[96:99], v[40:43], v[240:243], v[96:99]
  ds_read_b64_tr_b16 v[32:33], v2 offset:33856
  v_mfma_f32_16x16x32_bf16 v[96:99], v[44:47], v[248:251], v[96:99]
  ds_read_b64_tr_b16 v[34:35], v2 offset:42304
  v_mfma_f32_16x16x32_bf16 v[100:103], v[40:43], v[244:247], v[100:103]
  ds_read_b64_tr_b16 v[36:37], v2 offset:34112
  v_mfma_f32_16x16x32_bf16 v[100:103], v[44:47], v[252:255], v[100:103]
  ds_read_b64_tr_b16 v[38:39], v2 offset:42560
  s_waitcnt lgkmcnt(8)
  v_mfma_f32_16x16x32_bf16 v[104:107], v[48:51], v[224:227], v[104:107]
  ds_read_b64_tr_b16 v[40:41], v2 offset:34368
  v_mfma_f32_16x16x32_bf16 v[104:107], v[52:55], v[232:235], v[104:107]
  ds_read_b64_tr_b16 v[42:43], v2 offset:42816
  v_mfma_f32_16x16x32_bf16 v[108:111], v[48:51], v[228:231], v[108:111]
  ds_read_b64_tr_b16 v[44:45], v2 offset:34624
  v_mfma_f32_16x16x32_bf16 v[108:111], v[52:55], v[236:239], v[108:111]
  ds_read_b64_tr_b16 v[46:47], v2 offset:43072
  s_waitcnt lgkmcnt(8)
  v_mfma_f32_16x16x32_bf16 v[104:107], v[56:59], v[240:243], v[104:107]
  ds_read_b64_tr_b16 v[48:49], v2 offset:33888
  v_mfma_f32_16x16x32_bf16 v[104:107], v[60:63], v[248:251], v[104:107]
  ds_read_b64_tr_b16 v[50:51], v2 offset:42336
  v_mfma_f32_16x16x32_bf16 v[108:111], v[56:59], v[244:247], v[108:111]
  ds_read_b64_tr_b16 v[52:53], v2 offset:34144
  v_mfma_f32_16x16x32_bf16 v[108:111], v[60:63], v[252:255], v[108:111]
  ds_read_b64_tr_b16 v[54:55], v2 offset:42592
  s_waitcnt lgkmcnt(8)
  v_mfma_f32_16x16x32_bf16 v[112:115], v[32:35], v[224:227], v[112:115]
  ds_read_b64_tr_b16 v[56:57], v2 offset:34400
  v_mfma_f32_16x16x32_bf16 v[112:115], v[36:39], v[232:235], v[112:115]
  ds_read_b64_tr_b16 v[58:59], v2 offset:42848
  s_waitcnt vmcnt(10)
  v_mfma_f32_16x16x32_bf16 v[116:119], v[32:35], v[228:231], v[116:119]
  ds_read_b64_tr_b16 v[60:61], v2 offset:34656
  s_barrier
  v_mfma_f32_16x16x32_bf16 v[116:119], v[36:39], v[236:239], v[116:119]
  ds_read_b64_tr_b16 v[62:63], v2 offset:43104
  s_waitcnt lgkmcnt(8)
  v_mfma_f32_16x16x32_bf16 v[112:115], v[40:43], v[240:243], v[112:115]
  ds_read_b64_tr_b16 v[32:33], v14 offset:33792
  v_cvt_pk_bf16_f32 v96, v96, v97
  v_mfma_f32_16x16x32_bf16 v[112:115], v[44:47], v[248:251], v[112:115]
  ds_read_b64_tr_b16 v[34:35], v14 offset:42240
  v_cvt_pk_bf16_f32 v97, v98, v99
  v_mfma_f32_16x16x32_bf16 v[116:119], v[40:43], v[244:247], v[116:119]
  ds_read_b64_tr_b16 v[36:37], v14 offset:34048
  v_cvt_pk_bf16_f32 v98, v104, v105
  v_mfma_f32_16x16x32_bf16 v[116:119], v[44:47], v[252:255], v[116:119]
  ds_read_b64_tr_b16 v[38:39], v14 offset:42496
  s_waitcnt lgkmcnt(8)
  v_mfma_f32_16x16x32_bf16 v[120:123], v[48:51], v[224:227], v[120:123]
  ds_read_b64_tr_b16 v[40:41], v14 offset:33824
  v_cvt_pk_bf16_f32 v99, v106, v107
  v_mfma_f32_16x16x32_bf16 v[120:123], v[52:55], v[232:235], v[120:123]
  ds_read_b64_tr_b16 v[42:43], v14 offset:42272
  buffer_store_dwordx4 v[96:99], v1, s[24:27], s60 offen offset:2048 sc1
  v_mfma_f32_16x16x32_bf16 v[124:127], v[48:51], v[228:231], v[124:127]
  ds_read_b64_tr_b16 v[44:45], v14 offset:34080
  v_mfma_f32_16x16x32_bf16 v[124:127], v[52:55], v[236:239], v[124:127]
  ds_read_b64_tr_b16 v[46:47], v14 offset:42528
  s_waitcnt lgkmcnt(8)
  v_mfma_f32_16x16x32_bf16 v[120:123], v[56:59], v[240:243], v[120:123]
  ds_read_b64_tr_b16 v[48:49], v14 offset:33856
  v_mfma_f32_16x16x32_bf16 v[120:123], v[60:63], v[248:251], v[120:123]
  ds_read_b64_tr_b16 v[50:51], v14 offset:42304
  v_mfma_f32_16x16x32_bf16 v[124:127], v[56:59], v[244:247], v[124:127]
  ds_read_b64_tr_b16 v[52:53], v14 offset:34112
  v_mfma_f32_16x16x32_bf16 v[124:127], v[60:63], v[252:255], v[124:127]
  ds_read_b64_tr_b16 v[54:55], v14 offset:42560
  s_waitcnt lgkmcnt(8)
  v_mfma_f32_16x16x32_bf16 v[64:67], v[32:35], v[128:131], 0
  ds_read_b64_tr_b16 v[56:57], v14 offset:33888
  v_mfma_f32_16x16x32_bf16 v[64:67], v[36:39], v[136:139], v[64:67]
  ds_read_b64_tr_b16 v[58:59], v14 offset:42336
  v_mfma_f32_16x16x32_bf16 v[68:71], v[32:35], v[132:135], 0
  ds_read_b64_tr_b16 v[60:61], v14 offset:34144
  v_cvt_pk_bf16_f32 v100, v100, v101
  v_mfma_f32_16x16x32_bf16 v[68:71], v[36:39], v[140:143], v[68:71]
  ds_read_b64_tr_b16 v[62:63], v14 offset:42592
  s_waitcnt lgkmcnt(8)
  v_mfma_f32_16x16x32_bf16 v[72:75], v[40:43], v[128:131], 0
  ds_read_b64_tr_b16 v[32:33], v14 offset:34304
  v_cvt_pk_bf16_f32 v101, v102, v103
  v_mfma_f32_16x16x32_bf16 v[72:75], v[44:47], v[136:139], v[72:75]
  ds_read_b64_tr_b16 v[34:35], v14 offset:42752
  v_cvt_pk_bf16_f32 v102, v108, v109
  v_mfma_f32_16x16x32_bf16 v[76:79], v[40:43], v[132:135], 0
  ds_read_b64_tr_b16 v[36:37], v14 offset:34560
  v_cvt_pk_bf16_f32 v103, v110, v111
  v_mfma_f32_16x16x32_bf16 v[76:79], v[44:47], v[140:143], v[76:79]
  ds_read_b64_tr_b16 v[38:39], v14 offset:43008
  s_waitcnt lgkmcnt(8)
  v_mfma_f32_16x16x32_bf16 v[80:83], v[48:51], v[128:131], 0
  ds_read_b64_tr_b16 v[40:41], v14 offset:34336
  buffer_store_dwordx4 v[100:103], v1, s[24:27], s61 offen offset:2048 sc1
  s_waitcnt vmcnt(7)
  v_mfma_f32_16x16x32_bf16 v[80:83], v[52:55], v[136:139], v[80:83]
  ds_read_b64_tr_b16 v[42:43], v14 offset:42784
  v_cmp_gt_u32 vcc, 2, v5
  s_cbranch_vccnz SP1
SP1r:
  v_mfma_f32_16x16x32_bf16 v[84:87], v[48:51], v[132:135], 0
  ds_read_b64_tr_b16 v[44:45], v14 offset:34592
  v_mfma_f32_16x16x32_bf16 v[84:87], v[52:55], v[140:143], v[84:87]
  ds_read_b64_tr_b16 v[46:47], v14 offset:43040
  s_waitcnt lgkmcnt(8)
  v_mfma_f32_16x16x32_bf16 v[88:91], v[56:59], v[128:131], 0
  ds_read_b64_tr_b16 v[48:49], v14 offset:34368
  v_mfma_f32_16x16x32_bf16 v[88:91], v[60:63], v[136:139], v[88:91]
  ds_read_b64_tr_b16 v[50:51], v14 offset:42816
  v_mfma_f32_16x16x32_bf16 v[92:95], v[56:59], v[132:135], 0
  ds_read_b64_tr_b16 v[52:53], v14 offset:34624
  v_mfma_f32_16x16x32_bf16 v[92:95], v[60:63], v[140:143], v[92:95]
  ds_read_b64_tr_b16 v[54:55], v14 offset:43072
  s_waitcnt lgkmcnt(8)
  v_mfma_f32_16x16x32_bf16 v[64:67], v[32:35], v[144:147], v[64:67]
  ds_read_b64_tr_b16 v[56:57], v14 offset:34400
  buffer_load_dwordx4 a[32:35], v11, s[24:27], 0 offen sc1
  v_mfma_f32_16x16x32_bf16 v[64:67], v[36:39], v[152:155], v[64:67]
  ds_read_b64_tr_b16 v[58:59], v14 offset:42848
  v_mfma_f32_16x16x32_bf16 v[68:71], v[32:35], v[148:151], v[68:71]
  ds_read_b64_tr_b16 v[60:61], v14 offset:34656
  v_cvt_pk_bf16_f32 v112, v112, v113
  v_mfma_f32_16x16x32_bf16 v[68:71], v[36:39], v[156:159], v[68:71]
  ds_read_b64_tr_b16 v[62:63], v14 offset:43104
  s_waitcnt lgkmcnt(8)
  v_mfma_f32_16x16x32_bf16 v[72:75], v[40:43], v[144:147], v[72:75]
  ds_read_b64_tr_b16 v[32:33], v2 offset:50688
  v_cvt_pk_bf16_f32 v113, v114, v115
  v_mfma_f32_16x16x32_bf16 v[72:75], v[44:47], v[152:155], v[72:75]
  ds_read_b64_tr_b16 v[34:35], v2 offset:59136
  v_cvt_pk_bf16_f32 v114, v120, v121
  v_mfma_f32_16x16x32_bf16 v[76:79], v[40:43], v[148:151], v[76:79]
  ds_read_b64_tr_b16 v[36:37], v2 offset:50944
  v_cvt_pk_bf16_f32 v115, v122, v123
  v_mfma_f32_16x16x32_bf16 v[76:79], v[44:47], v[156:159], v[76:79]
  ds_read_b64_tr_b16 v[38:39], v2 offset:59392
  s_waitcnt lgkmcnt(8)
  v_mfma_f32_16x16x32_bf16 v[80:83], v[48:51], v[144:147], v[80:83]
  ds_read_b64_tr_b16 v[40:41], v2 offset:50720
  buffer_store_dwordx4 v[112:115], v1, s[24:27], s60 offen offset:3072 sc1
  v_mfma_f32_16x16x32_bf16 v[80:83], v[52:55], v[152:155], v[80:83]
  ds_read_b64_tr_b16 v[42:43], v2 offset:59168
  buffer_load_dwordx4 a[36:39], v11, s[24:27], s5 offen sc1
  v_mfma_f32_16x16x32_bf16 v[84:87], v[48:51], v[148:151], v[84:87]
  ds_read_b64_tr_b16 v[44:45], v2 offset:50976
  v_mfma_f32_16x16x32_bf16 v[84:87], v[52:55], v[156:159], v[84:87]
  ds_read_b64_tr_b16 v[46:47], v2 offset:59424
  s_waitcnt lgkmcnt(8)
  v_mfma_f32_16x16x32_bf16 v[88:91], v[56:59], v[144:147], v[88:91]
  ds_read_b64_tr_b16 v[48:49], v2 offset:50752
  v_mfma_f32_16x16x32_bf16 v[88:91], v[60:63], v[152:155], v[88:91]
  ds_read_b64_tr_b16 v[50:51], v2 offset:59200
  v_mfma_f32_16x16x32_bf16 v[92:95], v[56:59], v[148:151], v[92:95]
  ds_read_b64_tr_b16 v[52:53], v2 offset:51008
  v_mfma_f32_16x16x32_bf16 v[92:95], v[60:63], v[156:159], v[92:95]
  ds_read_b64_tr_b16 v[54:55], v2 offset:59456
  s_waitcnt lgkmcnt(8)
  v_mfma_f32_16x16x32_bf16 v[64:67], v[32:35], v[160:163], v[64:67]
  ds_read_b64_tr_b16 v[56:57], v2 offset:50784
  buffer_load_dwordx4 a[40:43], v11, s[24:27], s6 offen sc1
  v_mfma_f32_16x16x32_bf16 v[64:67], v[36:39], v[168:171], v[64:67]
  ds_read_b64_tr_b16 v[58:59], v2 offset:59232
  v_mfma_f32_16x16x32_bf16 v[68:71], v[32:35], v[164:167], v[68:71]
  ds_read_b64_tr_b16 v[60:61], v2 offset:51040
  v_cvt_pk_bf16_f32 v116, v116, v117
  v_mfma_f32_16x16x32_bf16 v[68:71], v[36:39], v[172:175], v[68:71]
  ds_read_b64_tr_b16 v[62:63], v2 offset:59488
  s_waitcnt lgkmcnt(8)
  v_mfma_f32_16x16x32_bf16 v[72:75], v[40:43], v[160:163], v[72:75]
  ds_read_b64_tr_b16 v[32:33], v2 offset:51200
  v_cvt_pk_bf16_f32 v117, v118, v119
  v_mfma_f32_16x16x32_bf16 v[72:75], v[44:47], v[168:171], v[72:75]
  ds_read_b64_tr_b16 v[34:35], v2 offset:59648
  v_cvt_pk_bf16_f32 v118, v124, v125
  v_mfma_f32_16x16x32_bf16 v[76:79], v[40:43], v[164:167], v[76:79]
  ds_read_b64_tr_b16 v[36:37], v2 offset:51456
  v_cvt_pk_bf16_f32 v119, v126, v127
  v_mfma_f32_16x16x32_bf16 v[76:79], v[44:47], v[172:175], v[76:79]
  ds_read_b64_tr_b16 v[38:39], v2 offset:59904
  s_waitcnt lgkmcnt(8)
  v_mfma_f32_16x16x32_bf16 v[80:83], v[48:51], v[160:163], v[80:83]
  ds_read_b64_tr_b16 v[40:41], v2 offset:51232
  buffer_store_dwordx4 v[116:119], v1, s[24:27], s61 offen offset:3072 sc1
  v_mfma_f32_16x16x32_bf16 v[80:83], v[52:55], v[168:171], v[80:83]
  ds_read_b64_tr_b16 v[42:43], v2 offset:59680
  buffer_load_dwordx4 a[44:47], v11, s[24:27], s7 offen sc1
  v_mfma_f32_16x16x32_bf16 v[84:87], v[48:51], v[164:167], v[84:87]
  ds_read_b64_tr_b16 v[44:45], v2 offset:51488
  v_mfma_f32_16x16x32_bf16 v[84:87], v[52:55], v[172:175], v[84:87]
  ds_read_b64_tr_b16 v[46:47], v2 offset:59936
  s_waitcnt lgkmcnt(8)
  v_mfma_f32_16x16x32_bf16 v[88:91], v[56:59], v[160:163], v[88:91]
  ds_read_b64_tr_b16 v[48:49], v2 offset:51264
  v_mfma_f32_16x16x32_bf16 v[88:91], v[60:63], v[168:171], v[88:91]
  ds_read_b64_tr_b16 v[50:51], v2 offset:59712
  v_mfma_f32_16x16x32_bf16 v[92:95], v[56:59], v[164:167], v[92:95]
  ds_read_b64_tr_b16 v[52:53], v2 offset:51520
  v_mfma_f32_16x16x32_bf16 v[92:95], v[60:63], v[172:175], v[92:95]
  ds_read_b64_tr_b16 v[54:55], v2 offset:59968
  s_waitcnt lgkmcnt(8)
  v_mfma_f32_16x16x32_bf16 v[64:67], v[32:35], v[176:179], v[64:67]
  ds_read_b64_tr_b16 v[56:57], v2 offset:51296
  buffer_load_dwordx4 a[48:51], v11, s[24:27], s8 offen sc1
  v_mfma_f32_16x16x32_bf16 v[64:67], v[36:39], v[184:187], v[64:67]
  ds_read_b64_tr_b16 v[58:59], v2 offset:59744
  s_waitcnt vmcnt(9)
  v_mfma_f32_16x16x32_bf16 v[68:71], v[32:35], v[180:183], v[68:71]
  ds_read_b64_tr_b16 v[60:61], v2 offset:51552
  s_barrier
  v_mfma_f32_16x16x32_bf16 v[68:71], v[36:39], v[188:191], v[68:71]
  ds_read_b64_tr_b16 v[62:63], v2 offset:60000
  s_waitcnt lgkmcnt(8)
  v_mfma_f32_16x16x32_bf16 v[72:75], v[40:43], v[176:179], v[72:75]
  ds_read_b64_tr_b16 v[32:33], v14 offset:50688
  v_mfma_f32_16x16x32_bf16 v[72:75], v[44:47], v[184:187], v[72:75]
  ds_read_b64_tr_b16 v[34:35], v14 offset:59136
  v_mfma_f32_16x16x32_bf16 v[76:79], v[40:43], v[180:183], v[76:79]
  ds_read_b64_tr_b16 v[36:37], v14 offset:50944
  buffer_load_dwordx4 a[52:55], v11, s[24:27], s9 offen sc1
  v_mfma_f32_16x16x32_bf16 v[76:79], v[44:47], v[188:191], v[76:79]
  ds_read_b64_tr_b16 v[38:39], v14 offset:59392
  s_waitcnt lgkmcnt(8)
  v_mfma_f32_16x16x32_bf16 v[80:83], v[48:51], v[176:179], v[80:83]
  ds_read_b64_tr_b16 v[40:41], v14 offset:50720
  v_mfma_f32_16x16x32_bf16 v[80:83], v[52:55], v[184:187], v[80:83]
  ds_read_b64_tr_b16 v[42:43], v14 offset:59168
  v_mfma_f32_16x16x32_bf16 v[84:87], v[48:51], v[180:183], v[84:87]
  ds_read_b64_tr_b16 v[44:45], v14 offset:50976
  v_mfma_f32_16x16x32_bf16 v[84:87], v[52:55], v[188:191], v[84:87]
  ds_read_b64_tr_b16 v[46:47], v14 offset:59424
  s_waitcnt lgkmcnt(8)
  v_mfma_f32_16x16x32_bf16 v[88:91], v[56:59], v[176:179], v[88:91]
  ds_read_b64_tr_b16 v[48:49], v14 offset:50752
  buffer_load_dwordx4 a[56:59], v11, s[24:27], s10 offen sc1
  v_mfma_f32_16x16x32_bf16 v[88:91], v[60:63], v[184:187], v[88:91]
  ds_read_b64_tr_b16 v[50:51], v14 offset:59200
  v_mfma_f32_16x16x32_bf16 v[92:95], v[56:59], v[180:183], v[92:95]
  ds_read_b64_tr_b16 v[52:53], v14 offset:51008
  v_mfma_f32_16x16x32_bf16 v[92:95], v[60:63], v[188:191], v[92:95]
  ds_read_b64_tr_b16 v[54:55], v14 offset:59456
  s_waitcnt lgkmcnt(8)
  v_mfma_f32_16x16x32_bf16 v[64:67], v[32:35], v[192:195], v[64:67]
  ds_read_b64_tr_b16 v[56:57], v14 offset:50784
  v_mfma_f32_16x16x32_bf16 v[64:67], v[36:39], v[200:203], v[64:67]
  ds_read_b64_tr_b16 v[58:59], v14 offset:59232
  v_mfma_f32_16x16x32_bf16 v[68:71], v[32:35], v[196:199], v[68:71]
  ds_read_b64_tr_b16 v[60:61], v14 offset:51040
  buffer_load_dwordx4 a[60:63], v11, s[24:27], s11 offen sc1
  v_mfma_f32_16x16x32_bf16 v[68:71], v[36:39], v[204:207], v[68:71]
  ds_read_b64_tr_b16 v[62:63], v14 offset:59488
  s_waitcnt lgkmcnt(8)
  v_mfma_f32_16x16x32_bf16 v[72:75], v[40:43], v[192:195], v[72:75]
  ds_read_b64_tr_b16 v[32:33], v14 offset:51200
  v_mfma_f32_16x16x32_bf16 v[72:75], v[44:47], v[200:203], v[72:75]
  ds_read_b64_tr_b16 v[34:35], v14 offset:59648
  v_mfma_f32_16x16x32_bf16 v[76:79], v[40:43], v[196:199], v[76:79]
  ds_read_b64_tr_b16 v[36:37], v14 offset:51456
  v_mfma_f32_16x16x32_bf16 v[76:79], v[44:47], v[204:207], v[76:79]
  ds_read_b64_tr_b16 v[38:39], v14 offset:59904
  s_waitcnt lgkmcnt(8)
  v_mfma_f32_16x16x32_bf16 v[80:83], v[48:51], v[192:195], v[80:83]
  ds_read_b64_tr_b16 v[40:41], v14 offset:51232
  v_add_u32 v11, 4096, v11
  v_mfma_f32_16x16x32_bf16 v[80:83], v[52:55], v[200:203], v[80:83]
  ds_read_b64_tr_b16 v[42:43], v14 offset:59680
  v_mfma_f32_16x16x32_bf16 v[84:87], v[48:51], v[196:199], v[84:87]
  ds_read_b64_tr_b16 v[44:45], v14 offset:51488
  v_mfma_f32_16x16x32_bf16 v[84:87], v[52:55], v[204:207], v[84:87]
  ds_read_b64_tr_b16 v[46:47], v14 offset:59936
  s_waitcnt lgkmcnt(8)
  v_mfma_f32_16x16x32_bf16 v[88:91], v[56:59], v[192:195], v[88:91]
  ds_read_b64_tr_b16 v[48:49], v14 offset:51264
  v_mfma_f32_16x16x32_bf16 v[88:91], v[60:63], v[200:203], v[88:91]
  ds_read_b64_tr_b16 v[50:51], v14 offset:59712
  v_mfma_f32_16x16x32_bf16 v[92:95], v[56:59], v[196:199], v[92:95]
  ds_read_b64_tr_b16 v[52:53], v14 offset:51520
  v_mfma_f32_16x16x32_bf16 v[92:95], v[60:63], v[204:207], v[92:95]
  ds_read_b64_tr_b16 v[54:55], v14 offset:59968
  s_waitcnt lgkmcnt(8)
  v_mfma_f32_16x16x32_bf16 v[64:67], v[32:35], v[208:211], v[64:67]
  ds_read_b64_tr_b16 v[56:57], v14 offset:51296
  v_mfma_f32_16x16x32_bf16 v[64:67], v[36:39], v[216:219], v[64:67]
  ds_read_b64_tr_b16 v[58:59], v14 offset:59744
  v_mfma_f32_16x16x32_bf16 v[68:71], v[32:35], v[212:215], v[68:71]
  ds_read_b64_tr_b16 v[60:61], v14 offset:51552
  v_mfma_f32_16x16x32_bf16 v[68:71], v[36:39], v[220:223], v[68:71]
  ds_read_b64_tr_b16 v[62:63], v14 offset:60000
  s_waitcnt lgkmcnt(8)
  v_mfma_f32_16x16x32_bf16 v[72:75], v[40:43], v[208:211], v[72:75]
  ds_read_b64_tr_b16 v[32:33], v2 offset:0
  v_mfma_f32_16x16x32_bf16 v[72:75], v[44:47], v[216:219], v[72:75]
  ds_read_b64_tr_b16 v[34:35], v2 offset:8448
  v_mfma_f32_16x16x32_bf16 v[76:79], v[40:43], v[212:215], v[76:79]
  ds_read_b64_tr_b16 v[36:37], v2 offset:256
  v_mfma_f32_16x16x32_bf16 v[76:79], v[44:47], v[220:223], v[76:79]
  ds_read_b64_tr_b16 v[38:39], v2 offset:8704
  s_waitcnt lgkmcnt(8)
  v_mfma_f32_16x16x32_bf16 v[80:83], v[48:51], v[208:211], v[80:83]
  ds_read_b64_tr_b16 v[40:41], v2 offset:512
  v_mfma_f32_16x16x32_bf16 v[80:83], v[52:55], v[216:219], v[80:83]
  ds_read_b64_tr_b16 v[42:43], v2 offset:8960
  v_mfma_f32_16x16x32_bf16 v[84:87], v[48:51], v[212:215], v[84:87]
  ds_read_b64_tr_b16 v[44:45], v2 offset:768
  v_mfma_f32_16x16x32_bf16 v[84:87], v[52:55], v[220:223], v[84:87]
  ds_read_b64_tr_b16 v[46:47], v2 offset:9216
  s_waitcnt lgkmcnt(8)
  v_mfma_f32_16x16x32_bf16 v[88:91], v[56:59], v[208:211], v[88:91]
  ds_read_b64_tr_b16 v[48:49], v2 offset:32
  v_mfma_f32_16x16x32_bf16 v[88:91], v[60:63], v[216:219], v[88:91]
  ds_read_b64_tr_b16 v[50:51], v2 offset:8480
  v_mfma_f32_16x16x32_bf16 v[92:95], v[56:59], v[212:215], v[92:95]
  ds_read_b64_tr_b16 v[52:53], v2 offset:288
  v_mfma_f32_16x16x32_bf16 v[92:95], v[60:63], v[220:223], v[92:95]
  ds_read_b64_tr_b16 v[54:55], v2 offset:8736
  s_waitcnt lgkmcnt(8)
  v_mfma_f32_16x16x32_bf16 v[64:67], v[32:35], v[224:227], v[64:67]
  ds_read_b64_tr_b16 v[56:57], v2 offset:544
  v_mfma_f32_16x16x32_bf16 v[64:67], v[36:39], v[232:235], v[64:67]
  ds_read_b64_tr_b16 v[58:59], v2 offset:8992
  v_mfma_f32_16x16x32_bf16 v[68:71], v[32:35], v[228:231], v[68:71]
  ds_read_b64_tr_b16 v[60:61], v2 offset:800
  v_mfma_f32_16x16x32_bf16 v[68:71], v[36:39], v[236:239], v[68:71]
  ds_read_b64_tr_b16 v[62:63], v2 offset:9248
  s_waitcnt lgkmcnt(8)
  v_mfma_f32_16x16x32_bf16 v[64:67], v[40:43], v[240:243], v[64:67]
  ds_read_b64_tr_b16 v[32:33], v2 offset:64
  v_mfma_f32_16x16x32_bf16 v[64:67], v[44:47], v[248:251], v[64:67]
  ds_read_b64_tr_b16 v[34:35], v2 offset:8512
  v_mfma_f32_16x16x32_bf16 v[68:71], v[40:43], v[244:247], v[68:71]
  ds_read_b64_tr_b16 v[36:37], v2 offset:320
  v_mfma_f32_16x16x32_bf16 v[68:71], v[44:47], v[252:255], v[68:71]
  ds_read_b64_tr_b16 v[38:39], v2 offset:8768
  s_waitcnt lgkmcnt(8)
  v_mfma_f32_16x16x32_bf16 v[72:75], v[48:51], v[224:227], v[72:75]
  ds_read_b64_tr_b16 v[40:41], v2 offset:576
  v_mfma_f32_16x16x32_bf16 v[72:75], v[52:55], v[232:235], v[72:75]
  ds_read_b64_tr_b16 v[42:43], v2 offset:9024
  v_mfma_f32_16x16x32_bf16 v[76:79], v[48:51], v[228:231], v[76:79]
  ds_read_b64_tr_b16 v[44:45], v2 offset:832
  v_mfma_f32_16x16x32_bf16 v[76:79], v[52:55], v[236:239], v[76:79]
  ds_read_b64_tr_b16 v[46:47], v2 offset:9280
  s_waitcnt lgkmcnt(8)
  v_mfma_f32_16x16x32_bf16 v[72:75], v[56:59], v[240:243], v[72:75]
  ds_read_b64_tr_b16 v[48:49], v2 offset:96
  v_mfma_f32_16x16x32_bf16 v[72:75], v[60:63], v[248:251], v[72:75]
  ds_read_b64_tr_b16 v[50:51], v2 offset:8544
  v_mfma_f32_16x16x32_bf16 v[76:79], v[56:59], v[244:247], v[76:79]
  ds_read_b64_tr_b16 v[52:53], v2 offset:352
  v_mfma_f32_16x16x32_bf16 v[76:79], v[60:63], v[252:255], v[76:79]
  ds_read_b64_tr_b16 v[54:55], v2 offset:8800
  s_waitcnt lgkmcnt(8)
  v_mfma_f32_16x16x32_bf16 v[80:83], v[32:35], v[224:227], v[80:83]
  ds_read_b64_tr_b16 v[56:57], v2 offset:608
  v_mfma_f32_16x16x32_bf16 v[80:83], v[36:39], v[232:235], v[80:83]
  ds_read_b64_tr_b16 v[58:59], v2 offset:9056
  v_mfma_f32_16x16x32_bf16 v[84:87], v[32:35], v[228:231], v[84:87]
  ds_read_b64_tr_b16 v[60:61], v2 offset:864
  v_cvt_pk_bf16_f32 v64, v64, v65
  v_mfma_f32_16x16x32_bf16 v[84:87], v[36:39], v[236:239], v[84:87]
  ds_read_b64_tr_b16 v[62:63], v2 offset:9312
  s_waitcnt lgkmcnt(8)
  v_mfma_f32_16x16x32_bf16 v[80:83], v[40:43], v[240:243], v[80:83]
  v_cvt_pk_bf16_f32 v65, v66, v67
  v_cvt_pk_bf16_f32 v66, v72, v73
  v_mfma_f32_16x16x32_bf16 v[80:83], v[44:47], v[248:251], v[80:83]
  v_cvt_pk_bf16_f32 v67, v74, v75
  s_mov_b32 s60, 12288
  v_mfma_f32_16x16x32_bf16 v[84:87], v[40:43], v[244:247], v[84:87]
  buffer_store_dwordx4 v[64:67], v1, s[24:27], s60 offen offset:0 sc1
  v_mfma_f32_16x16x32_bf16 v[84:87], v[44:47], v[252:255], v[84:87]
  s_waitcnt lgkmcnt(4)
  v_mfma_f32_16x16x32_bf16 v[88:91], v[48:51], v[224:227], v[88:91]
  v_mfma_f32_16x16x32_bf16 v[88:91], v[52:55], v[232:235], v[88:91]
  v_mfma_f32_16x16x32_bf16 v[92:95], v[48:51], v[228:231], v[92:95]
  v_mfma_f32_16x16x32_bf16 v[92:95], v[52:55], v[236:239], v[92:95]
  s_waitcnt lgkmcnt(0)
  v_mfma_f32_16x16x32_bf16 v[88:91], v[56:59], v[240:243], v[88:91]
  v_mfma_f32_16x16x32_bf16 v[88:91], v[60:63], v[248:251], v[88:91]
  v_mfma_f32_16x16x32_bf16 v[92:95], v[56:59], v[244:247], v[92:95]
  v_mfma_f32_16x16x32_bf16 v[92:95], v[60:63], v[252:255], v[92:95]
  v_cvt_pk_bf16_f32 v68, v68, v69
  v_cvt_pk_bf16_f32 v69, v70, v71
  v_cvt_pk_bf16_f32 v70, v76, v77
  v_cvt_pk_bf16_f32 v71, v78, v79
  s_mov_b32 s61, 26624
  buffer_store_dwordx4 v[68:71], v1, s[24:27], s61 offen offset:0 sc1
  s_nop 4
  v_cvt_pk_bf16_f32 v80, v80, v81
  v_cvt_pk_bf16_f32 v81, v82, v83
  v_cvt_pk_bf16_f32 v82, v88, v89
  v_cvt_pk_bf16_f32 v83, v90, v91
  buffer_store_dwordx4 v[80:83], v1, s[24:27], s60 offen offset:1024 sc1
  v_cvt_pk_bf16_f32 v84, v84, v85
  v_cvt_pk_bf16_f32 v85, v86, v87
  v_cvt_pk_bf16_f32 v86, v92, v93
  v_cvt_pk_bf16_f32 v87, v94, v95
  buffer_store_dwordx4 v[84:87], v1, s[24:27], s61 offen offset:1024 sc1
  s_waitcnt vmcnt(9)
  v_mov_b32 v4, 3
  buffer_store_dword v4, v15, s[40:43], s67 offen sc1
  v_add_u32 v12, 12288, v12
  v_accvgpr_read_b32 v40, a0
  v_lshlrev_b32 v192, 16, v40
  v_and_b32 v193, 0xffff0000, v40
  v_accvgpr_read_b32 v41, a1
  v_lshlrev_b32 v194, 16, v41
  v_and_b32 v195, 0xffff0000, v41
  v_accvgpr_read_b32 v42, a2
  v_lshlrev_b32 v196, 16, v42
  v_and_b32 v197, 0xffff0000, v42
  v_accvgpr_read_b32 v43, a3
  v_lshlrev_b32 v198, 16, v43
  v_and_b32 v199, 0xffff0000, v43
  v_accvgpr_read_b32 v40, a4
  v_lshlrev_b32 v32, 16, v40
  v_and_b32 v33, 0xffff0000, v40
  v_accvgpr_read_b32 v41, a5
  v_lshlrev_b32 v34, 16, v41
  v_and_b32 v35, 0xffff0000, v41
  v_accvgpr_read_b32 v42, a6
  v_lshlrev_b32 v36, 16, v42
  v_and_b32 v37, 0xffff0000, v42
  v_accvgpr_read_b32 v43, a7
  v_lshlrev_b32 v38, 16, v43
  v_and_b32 v39, 0xffff0000, v43
  v_pk_add_f32 v[192:193], v[192:193], v[32:33]
  v_pk_add_f32 v[194:195], v[194:195], v[34:35]
  v_pk_add_f32 v[196:197], v[196:197], v[36:37]
  v_pk_add_f32 v[198:199], v[198:199], v[38:39]
  v_accvgpr_read_b32 v40, a8
  v_lshlrev_b32 v32, 16, v40
  v_and_b32 v33, 0xffff0000, v40
  v_accvgpr_read_b32 v41, a9
  v_lshlrev_b32 v34, 16, v41
  v_and_b32 v35, 0xffff0000, v41
  v_accvgpr_read_b32 v42, a10
  v_lshlrev_b32 v36, 16, v42
  v_and_b32 v37, 0xffff0000, v42
  v_accvgpr_read_b32 v43, a11
  v_lshlrev_b32 v38, 16, v43
  v_and_b32 v39, 0xffff0000, v43
  v_pk_add_f32 v[192:193], v[192:193], v[32:33]
  v_pk_add_f32 v[194:195], v[194:195], v[34:35]
  v_pk_add_f32 v[196:197], v[196:197], v[36:37]
  v_pk_add_f32 v[198:199], v[198:199], v[38:39]
  v_accvgpr_read_b32 v40, a12
  v_lshlrev_b32 v32, 16, v40
  v_and_b32 v33, 0xffff0000, v40
  v_accvgpr_read_b32 v41, a13
  v_lshlrev_b32 v34, 16, v41
  v_and_b32 v35, 0xffff0000, v41
  v_accvgpr_read_b32 v42, a14
  v_lshlrev_b32 v36, 16, v42
  v_and_b32 v37, 0xffff0000, v42
  v_accvgpr_read_b32 v43, a15
  v_lshlrev_b32 v38, 16, v43
  v_and_b32 v39, 0xffff0000, v43
  v_pk_add_f32 v[192:193], v[192:193], v[32:33]
  v_pk_add_f32 v[194:195], v[194:195], v[34:35]
  v_pk_add_f32 v[196:197], v[196:197], v[36:37]
  v_pk_add_f32 v[198:199], v[198:199], v[38:39]
  v_accvgpr_read_b32 v40, a16
  v_lshlrev_b32 v32, 16, v40
  v_and_b32 v33, 0xffff0000, v40
  v_accvgpr_read_b32 v41, a17
  v_lshlrev_b32 v34, 16, v41
  v_and_b32 v35, 0xffff0000, v41
  v_accvgpr_read_b32 v42, a18
  v_lshlrev_b32 v36, 16, v42
  v_and_b32 v37, 0xffff0000, v42
  v_accvgpr_read_b32 v43, a19
  v_lshlrev_b32 v38, 16, v43
  v_and_b32 v39, 0xffff0000, v43
  v_pk_add_f32 v[192:193], v[192:193], v[32:33]
  v_pk_add_f32 v[194:195], v[194:195], v[34:35]
  v_pk_add_f32 v[196:197], v[196:197], v[36:37]
  v_pk_add_f32 v[198:199], v[198:199], v[38:39]
  v_accvgpr_read_b32 v40, a20
  v_lshlrev_b32 v32, 16, v40
  v_and_b32 v33, 0xffff0000, v40
  v_accvgpr_read_b32 v41, a21
  v_lshlrev_b32 v34, 16, v41
  v_and_b32 v35, 0xffff0000, v41
  v_accvgpr_read_b32 v42, a22
  v_lshlrev_b32 v36, 16, v42
  v_and_b32 v37, 0xffff0000, v42
  v_accvgpr_read_b32 v43, a23
  v_lshlrev_b32 v38, 16, v43
  v_and_b32 v39, 0xffff0000, v43
  v_pk_add_f32 v[192:193], v[192:193], v[32:33]
  v_pk_add_f32 v[194:195], v[194:195], v[34:35]
  v_pk_add_f32 v[196:197], v[196:197], v[36:37]
  v_pk_add_f32 v[198:199], v[198:199], v[38:39]
  v_accvgpr_read_b32 v40, a24
  v_lshlrev_b32 v32, 16, v40
  v_and_b32 v33, 0xffff0000, v40
  v_accvgpr_read_b32 v41, a25
  v_lshlrev_b32 v34, 16, v41
  v_and_b32 v35, 0xffff0000, v41
  v_accvgpr_read_b32 v42, a26
  v_lshlrev_b32 v36, 16, v42
  v_and_b32 v37, 0xffff0000, v42
  v_accvgpr_read_b32 v43, a27
  v_lshlrev_b32 v38, 16, v43
  v_and_b32 v39, 0xffff0000, v43
  v_pk_add_f32 v[192:193], v[192:193], v[32:33]
  v_pk_add_f32 v[194:195], v[194:195], v[34:35]
  v_pk_add_f32 v[196:197], v[196:197], v[36:37]
  v_pk_add_f32 v[198:199], v[198:199], v[38:39]
  v_accvgpr_read_b32 v40, a28
  v_lshlrev_b32 v32, 16, v40
  v_and_b32 v33, 0xffff0000, v40
  v_accvgpr_read_b32 v41, a29
  v_lshlrev_b32 v34, 16, v41
  v_and_b32 v35, 0xffff0000, v41
  v_accvgpr_read_b32 v42, a30
  v_lshlrev_b32 v36, 16, v42
  v_and_b32 v37, 0xffff0000, v42
  v_accvgpr_read_b32 v43, a31
  v_lshlrev_b32 v38, 16, v43
  v_and_b32 v39, 0xffff0000, v43
  v_pk_add_f32 v[192:193], v[192:193], v[32:33]
  v_pk_add_f32 v[194:195], v[194:195], v[34:35]
  v_pk_add_f32 v[196:197], v[196:197], v[36:37]
  v_pk_add_f32 v[198:199], v[198:199], v[38:39]
  v_cvt_pk_bf16_f32 v200, v192, v193
  v_cvt_pk_bf16_f32 v201, v194, v195
  v_cvt_pk_bf16_f32 v202, v196, v197
  v_cvt_pk_bf16_f32 v203, v198, v199
  s_nop 1
  v_permlane16_swap_b32 v200, v202
  v_permlane16_swap_b32 v201, v203
  buffer_store_dwordx4 v[200:203], v13, s[48:51], 0 offen offset:0 sc1
  s_waitcnt vmcnt(2)
  v_mov_b32 v4, 4
  buffer_store_dword v4, v15, s[40:43], s67 offen sc1
FLAGGED:
  s_mov_b32 s32, 0
SP2_l:
  buffer_load_dword v5, v10, s[40:43], 0 offen sc1
  s_waitcnt vmcnt(0)
  v_cmp_gt_u32 vcc, 3, v5
  s_cbranch_vccz SP2r
  s_add_u32 s32, s32, 1
  s_cmp_lt_u32 s32, 0x200000
  s_cbranch_scc1 SP2_l
SP2r:
  buffer_load_dwordx4 v[128:131], v11, s[24:27], 0 offen sc1
  buffer_load_dwordx4 v[132:135], v11, s[24:27], s5 offen sc1
  buffer_load_dwordx4 v[136:139], v11, s[24:27], s6 offen sc1
  buffer_load_dwordx4 v[140:143], v11, s[24:27], s7 offen sc1
  buffer_load_dwordx4 v[144:147], v11, s[24:27], s8 offen sc1
  buffer_load_dwordx4 v[148:151], v11, s[24:27], s9 offen sc1
  buffer_load_dwordx4 v[152:155], v11, s[24:27], s10 offen sc1
  buffer_load_dwordx4 v[156:159], v11, s[24:27], s11 offen sc1
  buffer_load_dword v5, v10, s[40:43], 0 offen sc1
  v_accvgpr_read_b32 v40, a32
  v_lshlrev_b32 v208, 16, v40
  v_and_b32 v209, 0xffff0000, v40
  v_accvgpr_read_b32 v41, a33
  v_lshlrev_b32 v210, 16, v41
  v_and_b32 v211, 0xffff0000, v41
  v_accvgpr_read_b32 v42, a34
  v_lshlrev_b32 v212, 16, v42
  v_and_b32 v213, 0xffff0000, v42
  v_accvgpr_read_b32 v43, a35
  v_lshlrev_b32 v214, 16, v43
  v_and_b32 v215, 0xffff0000, v43
  v_accvgpr_read_b32 v40, a36
  v_lshlrev_b32 v32, 16, v40
  v_and_b32 v33, 0xffff0000, v40
  v_accvgpr_read_b32 v41, a37
  v_lshlrev_b32 v34, 16, v41
  v_and_b32 v35, 0xffff0000, v41
  v_accvgpr_read_b32 v42, a38
  v_lshlrev_b32 v36, 16, v42
  v_and_b32 v37, 0xffff0000, v42
  v_accvgpr_read_b32 v43, a39
  v_lshlrev_b32 v38, 16, v43
  v_and_b32 v39, 0xffff0000, v43
  v_pk_add_f32 v[208:209], v[208:209], v[32:33]
  v_pk_add_f32 v[210:211], v[210:211], v[34:35]
  v_pk_add_f32 v[212:213], v[212:213], v[36:37]
  v_pk_add_f32 v[214:215], v[214:215], v[38:39]
  v_accvgpr_read_b32 v40, a40
  v_lshlrev_b32 v32, 16, v40
  v_and_b32 v33, 0xffff0000, v40
  v_accvgpr_read_b32 v41, a41
  v_lshlrev_b32 v34, 16, v41
  v_and_b32 v35, 0xffff0000, v41
  v_accvgpr_read_b32 v42, a42
  v_lshlrev_b32 v36, 16, v42
  v_and_b32 v37, 0xffff0000, v42
  v_accvgpr_read_b32 v43, a43
  v_lshlrev_b32 v38, 16, v43
  v_and_b32 v39, 0xffff0000, v43
  v_pk_add_f32 v[208:209], v[208:209], v[32:33]
  v_pk_add_f32 v[210:211], v[210:211], v[34:35]
  v_pk_add_f32 v[212:213], v[212:213], v[36:37]
  v_pk_add_f32 v[214:215], v[214:215], v[38:39]
  v_accvgpr_read_b32 v40, a44
  v_lshlrev_b32 v32, 16, v40
  v_and_b32 v33, 0xffff0000, v40
  v_accvgpr_read_b32 v41, a45
  v_lshlrev_b32 v34, 16, v41
  v_and_b32 v35, 0xffff0000, v41
  v_accvgpr_read_b32 v42, a46
  v_lshlrev_b32 v36, 16, v42
  v_and_b32 v37, 0xffff0000, v42
  v_accvgpr_read_b32 v43, a47
  v_lshlrev_b32 v38, 16, v43
  v_and_b32 v39, 0xffff0000, v43
  v_pk_add_f32 v[208:209], v[208:209], v[32:33]
  v_pk_add_f32 v[210:211], v[210:211], v[34:35]
  v_pk_add_f32 v[212:213], v[212:213], v[36:37]
  v_pk_add_f32 v[214:215], v[214:215], v[38:39]
  v_accvgpr_read_b32 v40, a48
  v_lshlrev_b32 v32, 16, v40
  v_and_b32 v33, 0xffff0000, v40
  v_accvgpr_read_b32 v41, a49
  v_lshlrev_b32 v34, 16, v41
  v_and_b32 v35, 0xffff0000, v41
  v_accvgpr_read_b32 v42, a50
  v_lshlrev_b32 v36, 16, v42
  v_and_b32 v37, 0xffff0000, v42
  v_accvgpr_read_b32 v43, a51
  v_lshlrev_b32 v38, 16, v43
  v_and_b32 v39, 0xffff0000, v43
  v_pk_add_f32 v[208:209], v[208:209], v[32:33]
  v_pk_add_f32 v[210:211], v[210:211], v[34:35]
  v_pk_add_f32 v[212:213], v[212:213], v[36:37]
  v_pk_add_f32 v[214:215], v[214:215], v[38:39]
  v_accvgpr_read_b32 v40, a52
  v_lshlrev_b32 v32, 16, v40
  v_and_b32 v33, 0xffff0000, v40
  v_accvgpr_read_b32 v41, a53
  v_lshlrev_b32 v34, 16, v41
  v_and_b32 v35, 0xffff0000, v41
  v_accvgpr_read_b32 v42, a54
  v_lshlrev_b32 v36, 16, v42
  v_and_b32 v37, 0xffff0000, v42
  v_accvgpr_read_b32 v43, a55
  v_lshlrev_b32 v38, 16, v43
  v_and_b32 v39, 0xffff0000, v43
  v_pk_add_f32 v[208:209], v[208:209], v[32:33]
  v_pk_add_f32 v[210:211], v[210:211], v[34:35]
  v_pk_add_f32 v[212:213], v[212:213], v[36:37]
  v_pk_add_f32 v[214:215], v[214:215], v[38:39]
  v_accvgpr_read_b32 v40, a56
  v_lshlrev_b32 v32, 16, v40
  v_and_b32 v33, 0xffff0000, v40
  v_accvgpr_read_b32 v41, a57
  v_lshlrev_b32 v34, 16, v41
  v_and_b32 v35, 0xffff0000, v41
  v_accvgpr_read_b32 v42, a58
  v_lshlrev_b32 v36, 16, v42
  v_and_b32 v37, 0xffff0000, v42
  v_accvgpr_read_b32 v43, a59
  v_lshlrev_b32 v38, 16, v43
  v_and_b32 v39, 0xffff0000, v43
  v_pk_add_f32 v[208:209], v[208:209], v[32:33]
  v_pk_add_f32 v[210:211], v[210:211], v[34:35]
  v_pk_add_f32 v[212:213], v[212:213], v[36:37]
  v_pk_add_f32 v[214:215], v[214:215], v[38:39]
  v_accvgpr_read_b32 v40, a60
  v_lshlrev_b32 v32, 16, v40
  v_and_b32 v33, 0xffff0000, v40
  v_accvgpr_read_b32 v41, a61
  v_lshlrev_b32 v34, 16, v41
  v_and_b32 v35, 0xffff0000, v41
  v_accvgpr_read_b32 v42, a62
  v_lshlrev_b32 v36, 16, v42
  v_and_b32 v37, 0xffff0000, v42
  v_accvgpr_read_b32 v43, a63
  v_lshlrev_b32 v38, 16, v43
  v_and_b32 v39, 0xffff0000, v43
  v_pk_add_f32 v[208:209], v[208:209], v[32:33]
  v_pk_add_f32 v[210:211], v[210:211], v[34:35]
  v_pk_add_f32 v[212:213], v[212:213], v[36:37]
  v_pk_add_f32 v[214:215], v[214:215], v[38:39]
  v_cvt_pk_bf16_f32 v216, v208, v209
  v_cvt_pk_bf16_f32 v217, v210, v211
  v_cvt_pk_bf16_f32 v218, v212, v213
  v_cvt_pk_bf16_f32 v219, v214, v215
  s_nop 1
  v_permlane16_swap_b32 v216, v218
  v_permlane16_swap_b32 v217, v219
  buffer_store_dwordx4 v[216:219], v13, s[48:51], 0 offen offset:256 sc1
  s_waitcnt vmcnt(1)
  v_cmp_gt_u32 vcc, 4, v5
  s_cbranch_vccz SP3r
  s_mov_b32 s32, 0
SP3_l:
  buffer_load_dword v5, v10, s[40:43], 0 offen sc1
  s_waitcnt vmcnt(0)
  v_cmp_gt_u32 vcc, 4, v5
  s_cbranch_vccz SP3r
  s_add_u32 s32, s32, 1
  s_cmp_lt_u32 s32, 0x200000
  s_cbranch_scc1 SP3_l
SP3r:
  buffer_load_dwordx4 v[160:163], v12, s[24:27], 0 offen sc1
  buffer_load_dwordx4 v[164:167], v12, s[24:27], s5 offen sc1
  buffer_load_dwordx4 v[168:171], v12, s[24:27], s6 offen sc1
  buffer_load_dwordx4 v[172:175], v12, s[24:27], s7 offen sc1
  buffer_load_dwordx4 v[176:179], v12, s[24:27], s8 offen sc1
  buffer_load_dwordx4 v[180:183], v12, s[24:27], s9 offen sc1
  buffer_load_dwordx4 v[184:187], v12, s[24:27], s10 offen sc1
  buffer_load_dwordx4 v[188:191], v12, s[24:27], s11 offen sc1
POLLD:
  v_lshlrev_b32 v224, 16, v128
  v_and_b32 v225, 0xffff0000, v128
  v_lshlrev_b32 v226, 16, v129
  v_and_b32 v227, 0xffff0000, v129
  v_lshlrev_b32 v228, 16, v130
  v_and_b32 v229, 0xffff0000, v130
  v_lshlrev_b32 v230, 16, v131
  v_and_b32 v231, 0xffff0000, v131
  v_lshlrev_b32 v32, 16, v132
  v_and_b32 v33, 0xffff0000, v132
  v_lshlrev_b32 v34, 16, v133
  v_and_b32 v35, 0xffff0000, v133
  v_lshlrev_b32 v36, 16, v134
  v_and_b32 v37, 0xffff0000, v134
  v_lshlrev_b32 v38, 16, v135
  v_and_b32 v39, 0xffff0000, v135
  v_pk_add_f32 v[224:225], v[224:225], v[32:33]
  v_pk_add_f32 v[226:227], v[226:227], v[34:35]
  v_pk_add_f32 v[228:229], v[228:229], v[36:37]
  v_pk_add_f32 v[230:231], v[230:231], v[38:39]
  v_lshlrev_b32 v32, 16, v136
  v_and_b32 v33, 0xffff0000, v136
  v_lshlrev_b32 v34, 16, v137
  v_and_b32 v35, 0xffff0000, v137
  v_lshlrev_b32 v36, 16, v138
  v_and_b32 v37, 0xffff0000, v138
  v_lshlrev_b32 v38, 16, v139
  v_and_b32 v39, 0xffff0000, v139
  v_pk_add_f32 v[224:225], v[224:225], v[32:33]
  v_pk_add_f32 v[226:227], v[226:227], v[34:35]
  v_pk_add_f32 v[228:229], v[228:229], v[36:37]
  v_pk_add_f32 v[230:231], v[230:231], v[38:39]
  v_lshlrev_b32 v32, 16, v140
  v_and_b32 v33, 0xffff0000, v140
  v_lshlrev_b32 v34, 16, v141
  v_and_b32 v35, 0xffff0000, v141
  v_lshlrev_b32 v36, 16, v142
  v_and_b32 v37, 0xffff0000, v142
  v_lshlrev_b32 v38, 16, v143
  v_and_b32 v39, 0xffff0000, v143
  v_pk_add_f32 v[224:225], v[224:225], v[32:33]
  v_pk_add_f32 v[226:227], v[226:227], v[34:35]
  v_pk_add_f32 v[228:229], v[228:229], v[36:37]
  v_pk_add_f32 v[230:231], v[230:231], v[38:39]
  v_lshlrev_b32 v32, 16, v144
  v_and_b32 v33, 0xffff0000, v144
  v_lshlrev_b32 v34, 16, v145
  v_and_b32 v35, 0xffff0000, v145
  v_lshlrev_b32 v36, 16, v146
  v_and_b32 v37, 0xffff0000, v146
  v_lshlrev_b32 v38, 16, v147
  v_and_b32 v39, 0xffff0000, v147
  v_pk_add_f32 v[224:225], v[224:225], v[32:33]
  v_pk_add_f32 v[226:227], v[226:227], v[34:35]
  v_pk_add_f32 v[228:229], v[228:229], v[36:37]
  v_pk_add_f32 v[230:231], v[230:231], v[38:39]
  v_lshlrev_b32 v32, 16, v148
  v_and_b32 v33, 0xffff0000, v148
  v_lshlrev_b32 v34, 16, v149
  v_and_b32 v35, 0xffff0000, v149
  v_lshlrev_b32 v36, 16, v150
  v_and_b32 v37, 0xffff0000, v150
  v_lshlrev_b32 v38, 16, v151
  v_and_b32 v39, 0xffff0000, v151
  v_pk_add_f32 v[224:225], v[224:225], v[32:33]
  v_pk_add_f32 v[226:227], v[226:227], v[34:35]
  v_pk_add_f32 v[228:229], v[228:229], v[36:37]
  v_pk_add_f32 v[230:231], v[230:231], v[38:39]
  v_lshlrev_b32 v32, 16, v152
  v_and_b32 v33, 0xffff0000, v152
  v_lshlrev_b32 v34, 16, v153
  v_and_b32 v35, 0xffff0000, v153
  v_lshlrev_b32 v36, 16, v154
  v_and_b32 v37, 0xffff0000, v154
  v_lshlrev_b32 v38, 16, v155
  v_and_b32 v39, 0xffff0000, v155
  v_pk_add_f32 v[224:225], v[224:225], v[32:33]
  v_pk_add_f32 v[226:227], v[226:227], v[34:35]
  v_pk_add_f32 v[228:229], v[228:229], v[36:37]
  v_pk_add_f32 v[230:231], v[230:231], v[38:39]
  v_lshlrev_b32 v32, 16, v156
  v_and_b32 v33, 0xffff0000, v156
  v_lshlrev_b32 v34, 16, v157
  v_and_b32 v35, 0xffff0000, v157
  v_lshlrev_b32 v36, 16, v158
  v_and_b32 v37, 0xffff0000, v158
  v_lshlrev_b32 v38, 16, v159
  v_and_b32 v39, 0xffff0000, v159
  v_pk_add_f32 v[224:225], v[224:225], v[32:33]
  v_pk_add_f32 v[226:227], v[226:227], v[34:35]
  v_pk_add_f32 v[228:229], v[228:229], v[36:37]
  v_pk_add_f32 v[230:231], v[230:231], v[38:39]
  v_cvt_pk_bf16_f32 v232, v224, v225
  v_cvt_pk_bf16_f32 v233, v226, v227
  v_cvt_pk_bf16_f32 v234, v228, v229
  v_cvt_pk_bf16_f32 v235, v230, v231
  s_nop 1
  v_permlane16_swap_b32 v232, v234
  v_permlane16_swap_b32 v233, v235
  buffer_store_dwordx4 v[232:235], v13, s[48:51], 0 offen offset:512 sc1
  s_waitcnt vmcnt(8)
  v_lshlrev_b32 v240, 16, v160
  v_and_b32 v241, 0xffff0000, v160
  v_lshlrev_b32 v242, 16, v161
  v_and_b32 v243, 0xffff0000, v161
  v_lshlrev_b32 v244, 16, v162
  v_and_b32 v245, 0xffff0000, v162
  v_lshlrev_b32 v246, 16, v163
  v_and_b32 v247, 0xffff0000, v163
  s_waitcnt vmcnt(7)
  v_lshlrev_b32 v32, 16, v164
  v_and_b32 v33, 0xffff0000, v164
  v_lshlrev_b32 v34, 16, v165
  v_and_b32 v35, 0xffff0000, v165
  v_lshlrev_b32 v36, 16, v166
  v_and_b32 v37, 0xffff0000, v166
  v_lshlrev_b32 v38, 16, v167
  v_and_b32 v39, 0xffff0000, v167
  v_pk_add_f32 v[240:241], v[240:241], v[32:33]
  v_pk_add_f32 v[242:243], v[242:243], v[34:35]
  v_pk_add_f32 v[244:245], v[244:245], v[36:37]
  v_pk_add_f32 v[246:247], v[246:247], v[38:39]
  s_waitcnt vmcnt(6)
  v_lshlrev_b32 v32, 16, v168
  v_and_b32 v33, 0xffff0000, v168
  v_lshlrev_b32 v34, 16, v169
  v_and_b32 v35, 0xffff0000, v169
  v_lshlrev_b32 v36, 16, v170
  v_and_b32 v37, 0xffff0000, v170
  v_lshlrev_b32 v38, 16, v171
  v_and_b32 v39, 0xffff0000, v171
  v_pk_add_f32 v[240:241], v[240:241], v[32:33]
  v_pk_add_f32 v[242:243], v[242:243], v[34:35]
  v_pk_add_f32 v[244:245], v[244:245], v[36:37]
  v_pk_add_f32 v[246:247], v[246:247], v[38:39]
  s_waitcnt vmcnt(5)
  v_lshlrev_b32 v32, 16, v172
  v_and_b32 v33, 0xffff0000, v172
  v_lshlrev_b32 v34, 16, v173
  v_and_b32 v35, 0xffff0000, v173
  v_lshlrev_b32 v36, 16, v174
  v_and_b32 v37, 0xffff0000, v174
  v_lshlrev_b32 v38, 16, v175
  v_and_b32 v39, 0xffff0000, v175
  v_pk_add_f32 v[240:241], v[240:241], v[32:33]
  v_pk_add_f32 v[242:243], v[242:243], v[34:35]
  v_pk_add_f32 v[244:245], v[244:245], v[36:37]
  v_pk_add_f32 v[246:247], v[246:247], v[38:39]
  s_waitcnt vmcnt(4)
  v_lshlrev_b32 v32, 16, v176
  v_and_b32 v33, 0xffff0000, v176
  v_lshlrev_b32 v34, 16, v177
  v_and_b32 v35, 0xffff0000, v177
  v_lshlrev_b32 v36, 16, v178
  v_and_b32 v37, 0xffff0000, v178
  v_lshlrev_b32 v38, 16, v179
  v_and_b32 v39, 0xffff0000, v179
  v_pk_add_f32 v[240:241], v[240:241], v[32:33]
  v_pk_add_f32 v[242:243], v[242:243], v[34:35]
  v_pk_add_f32 v[244:245], v[244:245], v[36:37]
  v_pk_add_f32 v[246:247], v[246:247], v[38:39]
  s_waitcnt vmcnt(3)
  v_lshlrev_b32 v32, 16, v180
  v_and_b32 v33, 0xffff0000, v180
  v_lshlrev_b32 v34, 16, v181
  v_and_b32 v35, 0xffff0000, v181
  v_lshlrev_b32 v36, 16, v182
  v_and_b32 v37, 0xffff0000, v182
  v_lshlrev_b32 v38, 16, v183
  v_and_b32 v39, 0xffff0000, v183
  v_pk_add_f32 v[240:241], v[240:241], v[32:33]
  v_pk_add_f32 v[242:243], v[242:243], v[34:35]
  v_pk_add_f32 v[244:245], v[244:245], v[36:37]
  v_pk_add_f32 v[246:247], v[246:247], v[38:39]
  s_waitcnt vmcnt(2)
  v_lshlrev_b32 v32, 16, v184
  v_and_b32 v33, 0xffff0000, v184
  v_lshlrev_b32 v34, 16, v185
  v_and_b32 v35, 0xffff0000, v185
  v_lshlrev_b32 v36, 16, v186
  v_and_b32 v37, 0xffff0000, v186
  v_lshlrev_b32 v38, 16, v187
  v_and_b32 v39, 0xffff0000, v187
  v_pk_add_f32 v[240:241], v[240:241], v[32:33]
  v_pk_add_f32 v[242:243], v[242:243], v[34:35]
  v_pk_add_f32 v[244:245], v[244:245], v[36:37]
  v_pk_add_f32 v[246:247], v[246:247], v[38:39]
  s_waitcnt vmcnt(1)
  v_lshlrev_b32 v32, 16, v188
  v_and_b32 v33, 0xffff0000, v188
  v_lshlrev_b32 v34, 16, v189
  v_and_b32 v35, 0xffff0000, v189
  v_lshlrev_b32 v36, 16, v190
  v_and_b32 v37, 0xffff0000, v190
  v_lshlrev_b32 v38, 16, v191
  v_and_b32 v39, 0xffff0000, v191
  v_pk_add_f32 v[240:241], v[240:241], v[32:33]
  v_pk_add_f32 v[242:243], v[242:243], v[34:35]
  v_pk_add_f32 v[244:245], v[244:245], v[36:37]
  v_pk_add_f32 v[246:247], v[246:247], v[38:39]
  v_cvt_pk_bf16_f32 v248, v240, v241
  v_cvt_pk_bf16_f32 v249, v242, v243
  v_cvt_pk_bf16_f32 v250, v244, v245
  v_cvt_pk_bf16_f32 v251, v246, v247
  s_nop 1
  v_permlane16_swap_b32 v248, v250
  v_permlane16_swap_b32 v249, v251
  buffer_store_dwordx4 v[248:251], v9, s[48:51], 0 offen offset:768 sc1
L_end:
  s_endpgm
SPS:
  s_mov_b32 s32, 0
SPS_l:
  s_sleep 8
  buffer_load_dword v5, off, s[44:47], s37 sc1
  s_waitcnt vmcnt(0)
  v_cmp_gt_u32 vcc, 8, v5
  s_cbranch_vccz SPSr
  s_add_u32 s32, s32, 1
  s_cmp_lt_u32 s32, 0x200000
  s_cbranch_scc1 SPS_l
  s_branch SPSr
SP0:
  s_mov_b32 s32, 0
SP0_l:
  s_sleep 8
  buffer_load_dword v5, v10, s[40:43], 0 offen sc1
  s_waitcnt vmcnt(0)
  v_cmp_gt_u32 vcc, 1, v5
  s_cbranch_vccz SP0r
  s_add_u32 s32, s32, 1
  s_cmp_lt_u32 s32, 0x200000
  s_cbranch_scc1 SP0_l
  s_branch SP0r
SP1:
  s_mov_b32 s32, 0
SP1_l:
  s_sleep 8
  buffer_load_dword v5, v10, s[40:43], 0 offen sc1
  s_waitcnt vmcnt(0)
  v_cmp_gt_u32 vcc, 2, v5
  s_cbranch_vccz SP1r
  s_add_u32 s32, s32, 1
  s_cmp_lt_u32 s32, 0x200000
  s_cbranch_scc1 SP1_l
  s_branch SP1r
L_codeend:
RA_S1:
  v_max3_f32 v10, v96, v97, v98
  v_max3_f32 v10, v99, v100, v10
  v_max3_f32 v10, v101, v102, v10
  v_max_f32 v10, v103, v10
  v_mov_b32 v9, v10
  s_nop 1
  v_permlane32_swap_b32 v10, v9
  v_max_f32 v10, v10, v9
  v_mov_b32 v9, v10
  s_nop 1
  v_permlane16_swap_b32 v10, v9
  v_max_f32 v10, v10, v9
  v_max_f32 v10, 0, v10
  v_sub_f32 v96, v96, v10
  v_sub_f32 v97, v97, v10
  v_sub_f32 v98, v98, v10
  v_sub_f32 v99, v99, v10
  v_sub_f32 v100, v100, v10
  v_sub_f32 v101, v101, v10
  v_sub_f32 v102, v102, v10
  v_sub_f32 v103, v103, v10
  v_sub_f32 v16, v16, v10
  v_sub_f32 v17, v17, v10
  v_sub_f32 v18, v18, v10
  v_sub_f32 v19, v19, v10
  v_sub_f32 v10, 0, v10
  v_exp_f32 v10, v10
  s_nop 0
  v_mul_f32 v4, v4, v10
  v_max3_f32 v11, v104, v105, v106
  v_max3_f32 v11, v107, v108, v11
  v_max3_f32 v11, v109, v110, v11
  v_max_f32 v11, v111, v11
  v_mov_b32 v9, v11
  s_nop 1
  v_permlane32_swap_b32 v11, v9
  v_max_f32 v11, v11, v9
  v_mov_b32 v9, v11
  s_nop 1
  v_permlane16_swap_b32 v11, v9
  v_max_f32 v11, v11, v9
  v_max_f32 v11, 0, v11
  v_sub_f32 v104, v104, v11
  v_sub_f32 v105, v105, v11
  v_sub_f32 v106, v106, v11
  v_sub_f32 v107, v107, v11
  v_sub_f32 v108, v108, v11
  v_sub_f32 v109, v109, v11
  v_sub_f32 v110, v110, v11
  v_sub_f32 v111, v111, v11
  v_sub_f32 v20, v20, v11
  v_sub_f32 v21, v21, v11
  v_sub_f32 v22, v22, v11
  v_sub_f32 v23, v23, v11
  v_sub_f32 v11, 0, v11
  v_exp_f32 v11, v11
  s_nop 0
  v_mul_f32 v5, v5, v11
  v_max3_f32 v12, v112, v113, v114
  v_max3_f32 v12, v115, v116, v12
  v_max3_f32 v12, v117, v118, v12
  v_max_f32 v12, v119, v12
  v_mov_b32 v9, v12
  s_nop 1
  v_permlane32_swap_b32 v12, v9
  v_max_f32 v12, v12, v9
  v_mov_b32 v9, v12
  s_nop 1
  v_permlane16_swap_b32 v12, v9
  v_max_f32 v12, v12, v9
  v_max_f32 v12, 0, v12
  v_sub_f32 v112, v112, v12
  v_sub_f32 v113, v113, v12
  v_sub_f32 v114, v114, v12
  v_sub_f32 v115, v115, v12
  v_sub_f32 v116, v116, v12
  v_sub_f32 v117, v117, v12
  v_sub_f32 v118, v118, v12
  v_sub_f32 v119, v119, v12
  v_sub_f32 v24, v24, v12
  v_sub_f32 v25, v25, v12
  v_sub_f32 v26, v26, v12
  v_sub_f32 v27, v27, v12
  v_sub_f32 v12, 0, v12
  v_exp_f32 v12, v12
  s_nop 0
  v_mul_f32 v6, v6, v12
  v_max3_f32 v13, v120, v121, v122
  v_max3_f32 v13, v123, v124, v13
  v_max3_f32 v13, v125, v126, v13
  v_max_f32 v13, v127, v13
  v_mov_b32 v9, v13
  s_nop 1
  v_permlane32_swap_b32 v13, v9
  v_max_f32 v13, v13, v9
  v_mov_b32 v9, v13
  s_nop 1
  v_permlane16_swap_b32 v13, v9
  v_max_f32 v13, v13, v9
  v_max_f32 v13, 0, v13
  v_sub_f32 v120, v120, v13
  v_sub_f32 v121, v121, v13
  v_sub_f32 v122, v122, v13
  v_sub_f32 v123, v123, v13
  v_sub_f32 v124, v124, v13
  v_sub_f32 v125, v125, v13
  v_sub_f32 v126, v126, v13
  v_sub_f32 v127, v127, v13
  v_sub_f32 v28, v28, v13
  v_sub_f32 v29, v29, v13
  v_sub_f32 v30, v30, v13
  v_sub_f32 v31, v31, v13
  v_sub_f32 v13, 0, v13
  v_exp_f32 v13, v13
  s_nop 0
  v_mul_f32 v7, v7, v13
  s_branch RAr_S1
RB_S1:
  s_call_b64 s[32:33], RESCALE
  s_branch RBr_S1
RA_L0:
  v_max3_f32 v10, v64, v65, v66
  v_max3_f32 v10, v67, v68, v10
  v_max3_f32 v10, v69, v70, v10
  v_max_f32 v10, v71, v10
  v_mov_b32 v9, v10
  s_nop 1
  v_permlane32_swap_b32 v10, v9
  v_max_f32 v10, v10, v9
  v_mov_b32 v9, v10
  s_nop 1
  v_permlane16_swap_b32 v10, v9
  v_max_f32 v10, v10, v9
  v_max_f32 v10, 0, v10
  v_sub_f32 v64, v64, v10
  v_sub_f32 v65, v65, v10
  v_sub_f32 v66, v66, v10
  v_sub_f32 v67, v67, v10
  v_sub_f32 v68, v68, v10
  v_sub_f32 v69, v69, v10
  v_sub_f32 v70, v70, v10
  v_sub_f32 v71, v71, v10
  v_sub_f32 v16, v16, v10
  v_sub_f32 v17, v17, v10
  v_sub_f32 v18, v18, v10
  v_sub_f32 v19, v19, v10
  v_sub_f32 v10, 0, v10
  v_exp_f32 v10, v10
  s_nop 0
  v_mul_f32 v4, v4, v10
  v_max3_f32 v11, v72, v73, v74
  v_max3_f32 v11, v75, v76, v11
  v_max3_f32 v11, v77, v78, v11
  v_max_f32 v11, v79, v11
  v_mov_b32 v9, v11
  s_nop 1
  v_permlane32_swap_b32 v11, v9
  v_max_f32 v11, v11, v9
  v_mov_b32 v9, v11
  s_nop 1
  v_permlane16_swap_b32 v11, v9
  v_max_f32 v11, v11, v9
  v_max_f32 v11, 0, v11
  v_sub_f32 v72, v72, v11
  v_sub_f32 v73, v73, v11
  v_sub_f32 v74, v74, v11
  v_sub_f32 v75, v75, v11
  v_sub_f32 v76, v76, v11
  v_sub_f32 v77, v77, v11
  v_sub_f32 v78, v78, v11
  v_sub_f32 v79, v79, v11
  v_sub_f32 v20, v20, v11
  v_sub_f32 v21, v21, v11
  v_sub_f32 v22, v22, v11
  v_sub_f32 v23, v23, v11
  v_sub_f32 v11, 0, v11
  v_exp_f32 v11, v11
  s_nop 0
  v_mul_f32 v5, v5, v11
  v_max3_f32 v12, v80, v81, v82
  v_max3_f32 v12, v83, v84, v12
  v_max3_f32 v12, v85, v86, v12
  v_max_f32 v12, v87, v12
  v_mov_b32 v9, v12
  s_nop 1
  v_permlane32_swap_b32 v12, v9
  v_max_f32 v12, v12, v9
  v_mov_b32 v9, v12
  s_nop 1
  v_permlane16_swap_b32 v12, v9
  v_max_f32 v12, v12, v9
  v_max_f32 v12, 0, v12
  v_sub_f32 v80, v80, v12
  v_sub_f32 v81, v81, v12
  v_sub_f32 v82, v82, v12
  v_sub_f32 v83, v83, v12
  v_sub_f32 v84, v84, v12
  v_sub_f32 v85, v85, v12
  v_sub_f32 v86, v86, v12
  v_sub_f32 v87, v87, v12
  v_sub_f32 v24, v24, v12
  v_sub_f32 v25, v25, v12
  v_sub_f32 v26, v26, v12
  v_sub_f32 v27, v27, v12
  v_sub_f32 v12, 0, v12
  v_exp_f32 v12, v12
  s_nop 0
  v_mul_f32 v6, v6, v12
  v_max3_f32 v13, v88, v89, v90
  v_max3_f32 v13, v91, v92, v13
  v_max3_f32 v13, v93, v94, v13
  v_max_f32 v13, v95, v13
  v_mov_b32 v9, v13
  s_nop 1
  v_permlane32_swap_b32 v13, v9
  v_max_f32 v13, v13, v9
  v_mov_b32 v9, v13
  s_nop 1
  v_permlane16_swap_b32 v13, v9
  v_max_f32 v13, v13, v9
  v_max_f32 v13, 0, v13
  v_sub_f32 v88, v88, v13
  v_sub_f32 v89, v89, v13
  v_sub_f32 v90, v90, v13
  v_sub_f32 v91, v91, v13
  v_sub_f32 v92, v92, v13
  v_sub_f32 v93, v93, v13
  v_sub_f32 v94, v94, v13
  v_sub_f32 v95, v95, v13
  v_sub_f32 v28, v28, v13
  v_sub_f32 v29, v29, v13
  v_sub_f32 v30, v30, v13
  v_sub_f32 v31, v31, v13
  v_sub_f32 v13, 0, v13
  v_exp_f32 v13, v13
  s_nop 0
  v_mul_f32 v7, v7, v13
  s_branch RAr_L0
RB_L0:
  s_call_b64 s[32:33], RESCALE
  s_branch RBr_L0
RA_L1:
  v_max3_f32 v10, v96, v97, v98
  v_max3_f32 v10, v99, v100, v10
  v_max3_f32 v10, v101, v102, v10
  v_max_f32 v10, v103, v10
  v_mov_b32 v9, v10
  s_nop 1
  v_permlane32_swap_b32 v10, v9
  v_max_f32 v10, v10, v9
  v_mov_b32 v9, v10
  s_nop 1
  v_permlane16_swap_b32 v10, v9
  v_max_f32 v10, v10, v9
  v_max_f32 v10, 0, v10
  v_sub_f32 v96, v96, v10
  v_sub_f32 v97, v97, v10
  v_sub_f32 v98, v98, v10
  v_sub_f32 v99, v99, v10
  v_sub_f32 v100, v100, v10
  v_sub_f32 v101, v101, v10
  v_sub_f32 v102, v102, v10
  v_sub_f32 v103, v103, v10
  v_sub_f32 v16, v16, v10
  v_sub_f32 v17, v17, v10
  v_sub_f32 v18, v18, v10
  v_sub_f32 v19, v19, v10
  v_sub_f32 v10, 0, v10
  v_exp_f32 v10, v10
  s_nop 0
  v_mul_f32 v4, v4, v10
  v_max3_f32 v11, v104, v105, v106
  v_max3_f32 v11, v107, v108, v11
  v_max3_f32 v11, v109, v110, v11
  v_max_f32 v11, v111, v11
  v_mov_b32 v9, v11
  s_nop 1
  v_permlane32_swap_b32 v11, v9
  v_max_f32 v11, v11, v9
  v_mov_b32 v9, v11
  s_nop 1
  v_permlane16_swap_b32 v11, v9
  v_max_f32 v11, v11, v9
  v_max_f32 v11, 0, v11
  v_sub_f32 v104, v104, v11
  v_sub_f32 v105, v105, v11
  v_sub_f32 v106, v106, v11
  v_sub_f32 v107, v107, v11
  v_sub_f32 v108, v108, v11
  v_sub_f32 v109, v109, v11
  v_sub_f32 v110, v110, v11
  v_sub_f32 v111, v111, v11
  v_sub_f32 v20, v20, v11
  v_sub_f32 v21, v21, v11
  v_sub_f32 v22, v22, v11
  v_sub_f32 v23, v23, v11
  v_sub_f32 v11, 0, v11
  v_exp_f32 v11, v11
  s_nop 0
  v_mul_f32 v5, v5, v11
  v_max3_f32 v12, v112, v113, v114
  v_max3_f32 v12, v115, v116, v12
  v_max3_f32 v12, v117, v118, v12
  v_max_f32 v12, v119, v12
  v_mov_b32 v9, v12
  s_nop 1
  v_permlane32_swap_b32 v12, v9
  v_max_f32 v12, v12, v9
  v_mov_b32 v9, v12
  s_nop 1
  v_permlane16_swap_b32 v12, v9
  v_max_f32 v12, v12, v9
  v_max_f32 v12, 0, v12
  v_sub_f32 v112, v112, v12
  v_sub_f32 v113, v113, v12
  v_sub_f32 v114, v114, v12
  v_sub_f32 v115, v115, v12
  v_sub_f32 v116, v116, v12
  v_sub_f32 v117, v117, v12
  v_sub_f32 v118, v118, v12
  v_sub_f32 v119, v119, v12
  v_sub_f32 v24, v24, v12
  v_sub_f32 v25, v25, v12
  v_sub_f32 v26, v26, v12
  v_sub_f32 v27, v27, v12
  v_sub_f32 v12, 0, v12
  v_exp_f32 v12, v12
  s_nop 0
  v_mul_f32 v6, v6, v12
  v_max3_f32 v13, v120, v121, v122
  v_max3_f32 v13, v123, v124, v13
  v_max3_f32 v13, v125, v126, v13
  v_max_f32 v13, v127, v13
  v_mov_b32 v9, v13
  s_nop 1
  v_permlane32_swap_b32 v13, v9
  v_max_f32 v13, v13, v9
  v_mov_b32 v9, v13
  s_nop 1
  v_permlane16_swap_b32 v13, v9
  v_max_f32 v13, v13, v9
  v_max_f32 v13, 0, v13
  v_sub_f32 v120, v120, v13
  v_sub_f32 v121, v121, v13
  v_sub_f32 v122, v122, v13
  v_sub_f32 v123, v123, v13
  v_sub_f32 v124, v124, v13
  v_sub_f32 v125, v125, v13
  v_sub_f32 v126, v126, v13
  v_sub_f32 v127, v127, v13
  v_sub_f32 v28, v28, v13
  v_sub_f32 v29, v29, v13
  v_sub_f32 v30, v30, v13
  v_sub_f32 v31, v31, v13
  v_sub_f32 v13, 0, v13
  v_exp_f32 v13, v13
  s_nop 0
  v_mul_f32 v7, v7, v13
  s_branch RAr_L1
RB_L1:
  s_call_b64 s[32:33], RESCALE
  s_branch RBr_L1
RA_L2:
  v_max3_f32 v10, v64, v65, v66
  v_max3_f32 v10, v67, v68, v10
  v_max3_f32 v10, v69, v70, v10
  v_max_f32 v10, v71, v10
  v_mov_b32 v9, v10
  s_nop 1
  v_permlane32_swap_b32 v10, v9
  v_max_f32 v10, v10, v9
  v_mov_b32 v9, v10
  s_nop 1
  v_permlane16_swap_b32 v10, v9
  v_max_f32 v10, v10, v9
  v_max_f32 v10, 0, v10
  v_sub_f32 v64, v64, v10
  v_sub_f32 v65, v65, v10
  v_sub_f32 v66, v66, v10
  v_sub_f32 v67, v67, v10
  v_sub_f32 v68, v68, v10
  v_sub_f32 v69, v69, v10
  v_sub_f32 v70, v70, v10
  v_sub_f32 v71, v71, v10
  v_sub_f32 v16, v16, v10
  v_sub_f32 v17, v17, v10
  v_sub_f32 v18, v18, v10
  v_sub_f32 v19, v19, v10
  v_sub_f32 v10, 0, v10
  v_exp_f32 v10, v10
  s_nop 0
  v_mul_f32 v4, v4, v10
  v_max3_f32 v11, v72, v73, v74
  v_max3_f32 v11, v75, v76, v11
  v_max3_f32 v11, v77, v78, v11
  v_max_f32 v11, v79, v11
  v_mov_b32 v9, v11
  s_nop 1
  v_permlane32_swap_b32 v11, v9
  v_max_f32 v11, v11, v9
  v_mov_b32 v9, v11
  s_nop 1
  v_permlane16_swap_b32 v11, v9
  v_max_f32 v11, v11, v9
  v_max_f32 v11, 0, v11
  v_sub_f32 v72, v72, v11
  v_sub_f32 v73, v73, v11
  v_sub_f32 v74, v74, v11
  v_sub_f32 v75, v75, v11
  v_sub_f32 v76, v76, v11
  v_sub_f32 v77, v77, v11
  v_sub_f32 v78, v78, v11
  v_sub_f32 v79, v79, v11
  v_sub_f32 v20, v20, v11
  v_sub_f32 v21, v21, v11
  v_sub_f32 v22, v22, v11
  v_sub_f32 v23, v23, v11
  v_sub_f32 v11, 0, v11
  v_exp_f32 v11, v11
  s_nop 0
  v_mul_f32 v5, v5, v11
  v_max3_f32 v12, v80, v81, v82
  v_max3_f32 v12, v83, v84, v12
  v_max3_f32 v12, v85, v86, v12
  v_max_f32 v12, v87, v12
  v_mov_b32 v9, v12
  s_nop 1
  v_permlane32_swap_b32 v12, v9
  v_max_f32 v12, v12, v9
  v_mov_b32 v9, v12
  s_nop 1
  v_permlane16_swap_b32 v12, v9
  v_max_f32 v12, v12, v9
  v_max_f32 v12, 0, v12
  v_sub_f32 v80, v80, v12
  v_sub_f32 v81, v81, v12
  v_sub_f32 v82, v82, v12
  v_sub_f32 v83, v83, v12
  v_sub_f32 v84, v84, v12
  v_sub_f32 v85, v85, v12
  v_sub_f32 v86, v86, v12
  v_sub_f32 v87, v87, v12
  v_sub_f32 v24, v24, v12
  v_sub_f32 v25, v25, v12
  v_sub_f32 v26, v26, v12
  v_sub_f32 v27, v27, v12
  v_sub_f32 v12, 0, v12
  v_exp_f32 v12, v12
  s_nop 0
  v_mul_f32 v6, v6, v12
  v_max3_f32 v13, v88, v89, v90
  v_max3_f32 v13, v91, v92, v13
  v_max3_f32 v13, v93, v94, v13
  v_max_f32 v13, v95, v13
  v_mov_b32 v9, v13
  s_nop 1
  v_permlane32_swap_b32 v13, v9
  v_max_f32 v13, v13, v9
  v_mov_b32 v9, v13
  s_nop 1
  v_permlane16_swap_b32 v13, v9
  v_max_f32 v13, v13, v9
  v_max_f32 v13, 0, v13
  v_sub_f32 v88, v88, v13
  v_sub_f32 v89, v89, v13
  v_sub_f32 v90, v90, v13
  v_sub_f32 v91, v91, v13
  v_sub_f32 v92, v92, v13
  v_sub_f32 v93, v93, v13
  v_sub_f32 v94, v94, v13
  v_sub_f32 v95, v95, v13
  v_sub_f32 v28, v28, v13
  v_sub_f32 v29, v29, v13
  v_sub_f32 v30, v30, v13
  v_sub_f32 v31, v31, v13
  v_sub_f32 v13, 0, v13
  v_exp_f32 v13, v13
  s_nop 0
  v_mul_f32 v7, v7, v13
  s_branch RAr_L2
RB_L2:
  s_call_b64 s[32:33], RESCALE
  s_branch RBr_L2
RA_L3:
  v_max3_f32 v10, v96, v97, v98
  v_max3_f32 v10, v99, v100, v10
  v_max3_f32 v10, v101, v102, v10
  v_max_f32 v10, v103, v10
  v_mov_b32 v9, v10
  s_nop 1
  v_permlane32_swap_b32 v10, v9
  v_max_f32 v10, v10, v9
  v_mov_b32 v9, v10
  s_nop 1
  v_permlane16_swap_b32 v10, v9
  v_max_f32 v10, v10, v9
  v_max_f32 v10, 0, v10
  v_sub_f32 v96, v96, v10
  v_sub_f32 v97, v97, v10
  v_sub_f32 v98, v98, v10
  v_sub_f32 v99, v99, v10
  v_sub_f32 v100, v100, v10
  v_sub_f32 v101, v101, v10
  v_sub_f32 v102, v102, v10
  v_sub_f32 v103, v103, v10
  v_sub_f32 v16, v16, v10
  v_sub_f32 v17, v17, v10
  v_sub_f32 v18, v18, v10
  v_sub_f32 v19, v19, v10
  v_sub_f32 v10, 0, v10
  v_exp_f32 v10, v10
  s_nop 0
  v_mul_f32 v4, v4, v10
  v_max3_f32 v11, v104, v105, v106
  v_max3_f32 v11, v107, v108, v11
  v_max3_f32 v11, v109, v110, v11
  v_max_f32 v11, v111, v11
  v_mov_b32 v9, v11
  s_nop 1
  v_permlane32_swap_b32 v11, v9
  v_max_f32 v11, v11, v9
  v_mov_b32 v9, v11
  s_nop 1
  v_permlane16_swap_b32 v11, v9
  v_max_f32 v11, v11, v9
  v_max_f32 v11, 0, v11
  v_sub_f32 v104, v104, v11
  v_sub_f32 v105, v105, v11
  v_sub_f32 v106, v106, v11
  v_sub_f32 v107, v107, v11
  v_sub_f32 v108, v108, v11
  v_sub_f32 v109, v109, v11
  v_sub_f32 v110, v110, v11
  v_sub_f32 v111, v111, v11
  v_sub_f32 v20, v20, v11
  v_sub_f32 v21, v21, v11
  v_sub_f32 v22, v22, v11
  v_sub_f32 v23, v23, v11
  v_sub_f32 v11, 0, v11
  v_exp_f32 v11, v11
  s_nop 0
  v_mul_f32 v5, v5, v11
  v_max3_f32 v12, v112, v113, v114
  v_max3_f32 v12, v115, v116, v12
  v_max3_f32 v12, v117, v118, v12
  v_max_f32 v12, v119, v12
  v_mov_b32 v9, v12
  s_nop 1
  v_permlane32_swap_b32 v12, v9
  v_max_f32 v12, v12, v9
  v_mov_b32 v9, v12
  s_nop 1
  v_permlane16_swap_b32 v12, v9
  v_max_f32 v12, v12, v9
  v_max_f32 v12, 0, v12
  v_sub_f32 v112, v112, v12
  v_sub_f32 v113, v113, v12
  v_sub_f32 v114, v114, v12
  v_sub_f32 v115, v115, v12
  v_sub_f32 v116, v116, v12
  v_sub_f32 v117, v117, v12
  v_sub_f32 v118, v118, v12
  v_sub_f32 v119, v119, v12
  v_sub_f32 v24, v24, v12
  v_sub_f32 v25, v25, v12
  v_sub_f32 v26, v26, v12
  v_sub_f32 v27, v27, v12
  v_sub_f32 v12, 0, v12
  v_exp_f32 v12, v12
  s_nop 0
  v_mul_f32 v6, v6, v12
  v_max3_f32 v13, v120, v121, v122
  v_max3_f32 v13, v123, v124, v13
  v_max3_f32 v13, v125, v126, v13
  v_max_f32 v13, v127, v13
  v_mov_b32 v9, v13
  s_nop 1
  v_permlane32_swap_b32 v13, v9
  v_max_f32 v13, v13, v9
  v_mov_b32 v9, v13
  s_nop 1
  v_permlane16_swap_b32 v13, v9
  v_max_f32 v13, v13, v9
  v_max_f32 v13, 0, v13
  v_sub_f32 v120, v120, v13
  v_sub_f32 v121, v121, v13
  v_sub_f32 v122, v122, v13
  v_sub_f32 v123, v123, v13
  v_sub_f32 v124, v124, v13
  v_sub_f32 v125, v125, v13
  v_sub_f32 v126, v126, v13
  v_sub_f32 v127, v127, v13
  v_sub_f32 v28, v28, v13
  v_sub_f32 v29, v29, v13
  v_sub_f32 v30, v30, v13
  v_sub_f32 v31, v31, v13
  v_sub_f32 v13, 0, v13
  v_exp_f32 v13, v13
  s_nop 0
  v_mul_f32 v7, v7, v13
  s_branch RAr_L3
RB_L3:
  s_call_b64 s[32:33], RESCALE
  s_branch RBr_L3
RA_S30:
  v_max3_f32 v10, v64, v65, v66
  v_max3_f32 v10, v67, v68, v10
  v_max3_f32 v10, v69, v70, v10
  v_max_f32 v10, v71, v10
  v_mov_b32 v9, v10
  s_nop 1
  v_permlane32_swap_b32 v10, v9
  v_max_f32 v10, v10, v9
  v_mov_b32 v9, v10
  s_nop 1
  v_permlane16_swap_b32 v10, v9
  v_max_f32 v10, v10, v9
  v_max_f32 v10, 0, v10
  v_sub_f32 v64, v64, v10
  v_sub_f32 v65, v65, v10
  v_sub_f32 v66, v66, v10
  v_sub_f32 v67, v67, v10
  v_sub_f32 v68, v68, v10
  v_sub_f32 v69, v69, v10
  v_sub_f32 v70, v70, v10
  v_sub_f32 v71, v71, v10
  v_sub_f32 v16, v16, v10
  v_sub_f32 v17, v17, v10
  v_sub_f32 v18, v18, v10
  v_sub_f32 v19, v19, v10
  v_sub_f32 v10, 0, v10
  v_exp_f32 v10, v10
  s_nop 0
  v_mul_f32 v4, v4, v10
  v_max3_f32 v11, v72, v73, v74
  v_max3_f32 v11, v75, v76, v11
  v_max3_f32 v11, v77, v78, v11
  v_max_f32 v11, v79, v11
  v_mov_b32 v9, v11
  s_nop 1
  v_permlane32_swap_b32 v11, v9
  v_max_f32 v11, v11, v9
  v_mov_b32 v9, v11
  s_nop 1
  v_permlane16_swap_b32 v11, v9
  v_max_f32 v11, v11, v9
  v_max_f32 v11, 0, v11
  v_sub_f32 v72, v72, v11
  v_sub_f32 v73, v73, v11
  v_sub_f32 v74, v74, v11
  v_sub_f32 v75, v75, v11
  v_sub_f32 v76, v76, v11
  v_sub_f32 v77, v77, v11
  v_sub_f32 v78, v78, v11
  v_sub_f32 v79, v79, v11
  v_sub_f32 v20, v20, v11
  v_sub_f32 v21, v21, v11
  v_sub_f32 v22, v22, v11
  v_sub_f32 v23, v23, v11
  v_sub_f32 v11, 0, v11
  v_exp_f32 v11, v11
  s_nop 0
  v_mul_f32 v5, v5, v11
  v_max3_f32 v12, v80, v81, v82
  v_max3_f32 v12, v83, v84, v12
  v_max3_f32 v12, v85, v86, v12
  v_max_f32 v12, v87, v12
  v_mov_b32 v9, v12
  s_nop 1
  v_permlane32_swap_b32 v12, v9
  v_max_f32 v12, v12, v9
  v_mov_b32 v9, v12
  s_nop 1
  v_permlane16_swap_b32 v12, v9
  v_max_f32 v12, v12, v9
  v_max_f32 v12, 0, v12
  v_sub_f32 v80, v80, v12
  v_sub_f32 v81, v81, v12
  v_sub_f32 v82, v82, v12
  v_sub_f32 v83, v83, v12
  v_sub_f32 v84, v84, v12
  v_sub_f32 v85, v85, v12
  v_sub_f32 v86, v86, v12
  v_sub_f32 v87, v87, v12
  v_sub_f32 v24, v24, v12
  v_sub_f32 v25, v25, v12
  v_sub_f32 v26, v26, v12
  v_sub_f32 v27, v27, v12
  v_sub_f32 v12, 0, v12
  v_exp_f32 v12, v12
  s_nop 0
  v_mul_f32 v6, v6, v12
  v_max3_f32 v13, v88, v89, v90
  v_max3_f32 v13, v91, v92, v13
  v_max3_f32 v13, v93, v94, v13
  v_max_f32 v13, v95, v13
  v_mov_b32 v9, v13
  s_nop 1
  v_permlane32_swap_b32 v13, v9
  v_max_f32 v13, v13, v9
  v_mov_b32 v9, v13
  s_nop 1
  v_permlane16_swap_b32 v13, v9
  v_max_f32 v13, v13, v9
  v_max_f32 v13, 0, v13
  v_sub_f32 v88, v88, v13
  v_sub_f32 v89, v89, v13
  v_sub_f32 v90, v90, v13
  v_sub_f32 v91, v91, v13
  v_sub_f32 v92, v92, v13
  v_sub_f32 v93, v93, v13
  v_sub_f32 v94, v94, v13
  v_sub_f32 v95, v95, v13
  v_sub_f32 v28, v28, v13
  v_sub_f32 v29, v29, v13
  v_sub_f32 v30, v30, v13
  v_sub_f32 v31, v31, v13
  v_sub_f32 v13, 0, v13
  v_exp_f32 v13, v13
  s_nop 0
  v_mul_f32 v7, v7, v13
  s_branch RAr_S30
RB_S30:
  s_call_b64 s[32:33], RESCALE
  s_branch RBr_S30
RA_S31:
  v_max3_f32 v10, v96, v97, v98
  v_max3_f32 v10, v99, v100, v10
  v_max3_f32 v10, v101, v102, v10
  v_max_f32 v10, v103, v10
  v_mov_b32 v9, v10
  s_nop 1
  v_permlane32_swap_b32 v10, v9
  v_max_f32 v10, v10, v9
  v_mov_b32 v9, v10
  s_nop 1
  v_permlane16_swap_b32 v10, v9
  v_max_f32 v10, v10, v9
  v_max_f32 v10, 0, v10
  v_sub_f32 v96, v96, v10
  v_sub_f32 v97, v97, v10
  v_sub_f32 v98, v98, v10
  v_sub_f32 v99, v99, v10
  v_sub_f32 v100, v100, v10
  v_sub_f32 v101, v101, v10
  v_sub_f32 v102, v102, v10
  v_sub_f32 v103, v103, v10
  v_sub_f32 v16, v16, v10
  v_sub_f32 v17, v17, v10
  v_sub_f32 v18, v18, v10
  v_sub_f32 v19, v19, v10
  v_sub_f32 v10, 0, v10
  v_exp_f32 v10, v10
  s_nop 0
  v_mul_f32 v4, v4, v10
  v_max3_f32 v11, v104, v105, v106
  v_max3_f32 v11, v107, v108, v11
  v_max3_f32 v11, v109, v110, v11
  v_max_f32 v11, v111, v11
  v_mov_b32 v9, v11
  s_nop 1
  v_permlane32_swap_b32 v11, v9
  v_max_f32 v11, v11, v9
  v_mov_b32 v9, v11
  s_nop 1
  v_permlane16_swap_b32 v11, v9
  v_max_f32 v11, v11, v9
  v_max_f32 v11, 0, v11
  v_sub_f32 v104, v104, v11
  v_sub_f32 v105, v105, v11
  v_sub_f32 v106, v106, v11
  v_sub_f32 v107, v107, v11
  v_sub_f32 v108, v108, v11
  v_sub_f32 v109, v109, v11
  v_sub_f32 v110, v110, v11
  v_sub_f32 v111, v111, v11
  v_sub_f32 v20, v20, v11
  v_sub_f32 v21, v21, v11
  v_sub_f32 v22, v22, v11
  v_sub_f32 v23, v23, v11
  v_sub_f32 v11, 0, v11
  v_exp_f32 v11, v11
  s_nop 0
  v_mul_f32 v5, v5, v11
  v_max3_f32 v12, v112, v113, v114
  v_max3_f32 v12, v115, v116, v12
  v_max3_f32 v12, v117, v118, v12
  v_max_f32 v12, v119, v12
  v_mov_b32 v9, v12
  s_nop 1
  v_permlane32_swap_b32 v12, v9
  v_max_f32 v12, v12, v9
  v_mov_b32 v9, v12
  s_nop 1
  v_permlane16_swap_b32 v12, v9
  v_max_f32 v12, v12, v9
  v_max_f32 v12, 0, v12
  v_sub_f32 v112, v112, v12
  v_sub_f32 v113, v113, v12
  v_sub_f32 v114, v114, v12
  v_sub_f32 v115, v115, v12
  v_sub_f32 v116, v116, v12
  v_sub_f32 v117, v117, v12
  v_sub_f32 v118, v118, v12
  v_sub_f32 v119, v119, v12
  v_sub_f32 v24, v24, v12
  v_sub_f32 v25, v25, v12
  v_sub_f32 v26, v26, v12
  v_sub_f32 v27, v27, v12
  v_sub_f32 v12, 0, v12
  v_exp_f32 v12, v12
  s_nop 0
  v_mul_f32 v6, v6, v12
  v_max3_f32 v13, v120, v121, v122
  v_max3_f32 v13, v123, v124, v13
  v_max3_f32 v13, v125, v126, v13
  v_max_f32 v13, v127, v13
  v_mov_b32 v9, v13
  s_nop 1
  v_permlane32_swap_b32 v13, v9
  v_max_f32 v13, v13, v9
  v_mov_b32 v9, v13
  s_nop 1
  v_permlane16_swap_b32 v13, v9
  v_max_f32 v13, v13, v9
  v_max_f32 v13, 0, v13
  v_sub_f32 v120, v120, v13
  v_sub_f32 v121, v121, v13
  v_sub_f32 v122, v122, v13
  v_sub_f32 v123, v123, v13
  v_sub_f32 v124, v124, v13
  v_sub_f32 v125, v125, v13
  v_sub_f32 v126, v126, v13
  v_sub_f32 v127, v127, v13
  v_sub_f32 v28, v28, v13
  v_sub_f32 v29, v29, v13
  v_sub_f32 v30, v30, v13
  v_sub_f32 v31, v31, v13
  v_sub_f32 v13, 0, v13
  v_exp_f32 v13, v13
  s_nop 0
  v_mul_f32 v7, v7, v13
  s_branch RAr_S31
RB_S31:
  s_call_b64 s[32:33], RESCALE
  s_branch RBr_S31
RESCALE:
  s_nop 7
  v_accvgpr_read_b32 v9, a0
  v_mul_f32 v9, v9, v10
  v_accvgpr_write_b32 a0, v9
  v_accvgpr_read_b32 v9, a1
  v_mul_f32 v9, v9, v10
  v_accvgpr_write_b32 a1, v9
  v_accvgpr_read_b32 v9, a2
  v_mul_f32 v9, v9, v10
  v_accvgpr_write_b32 a2, v9
  v_accvgpr_read_b32 v9, a3
  v_mul_f32 v9, v9, v10
  v_accvgpr_write_b32 a3, v9
  v_accvgpr_read_b32 v9, a4
  v_mul_f32 v9, v9, v10
  v_accvgpr_write_b32 a4, v9
  v_accvgpr_read_b32 v9, a5
  v_mul_f32 v9, v9, v10
  v_accvgpr_write_b32 a5, v9
  v_accvgpr_read_b32 v9, a6
  v_mul_f32 v9, v9, v10
  v_accvgpr_write_b32 a6, v9
  v_accvgpr_read_b32 v9, a7
  v_mul_f32 v9, v9, v10
  v_accvgpr_write_b32 a7, v9
  v_accvgpr_read_b32 v9, a8
  v_mul_f32 v9, v9, v10
  v_accvgpr_write_b32 a8, v9
  v_accvgpr_read_b32 v9, a9
  v_mul_f32 v9, v9, v10
  v_accvgpr_write_b32 a9, v9
  v_accvgpr_read_b32 v9, a10
  v_mul_f32 v9, v9, v10
  v_accvgpr_write_b32 a10, v9
  v_accvgpr_read_b32 v9, a11
  v_mul_f32 v9, v9, v10
  v_accvgpr_write_b32 a11, v9
  v_accvgpr_read_b32 v9, a12
  v_mul_f32 v9, v9, v10
  v_accvgpr_write_b32 a12, v9
  v_accvgpr_read_b32 v9, a13
  v_mul_f32 v9, v9, v10
  v_accvgpr_write_b32 a13, v9
  v_accvgpr_read_b32 v9, a14
  v_mul_f32 v9, v9, v10
  v_accvgpr_write_b32 a14, v9
  v_accvgpr_read_b32 v9, a15
  v_mul_f32 v9, v9, v10
  v_accvgpr_write_b32 a15, v9
  v_accvgpr_read_b32 v9, a16
  v_mul_f32 v9, v9, v10
  v_accvgpr_write_b32 a16, v9
  v_accvgpr_read_b32 v9, a17
  v_mul_f32 v9, v9, v10
  v_accvgpr_write_b32 a17, v9
  v_accvgpr_read_b32 v9, a18
  v_mul_f32 v9, v9, v10
  v_accvgpr_write_b32 a18, v9
  v_accvgpr_read_b32 v9, a19
  v_mul_f32 v9, v9, v10
  v_accvgpr_write_b32 a19, v9
  v_accvgpr_read_b32 v9, a20
  v_mul_f32 v9, v9, v10
  v_accvgpr_write_b32 a20, v9
  v_accvgpr_read_b32 v9, a21
  v_mul_f32 v9, v9, v10
  v_accvgpr_write_b32 a21, v9
  v_accvgpr_read_b32 v9, a22
  v_mul_f32 v9, v9, v10
  v_accvgpr_write_b32 a22, v9
  v_accvgpr_read_b32 v9, a23
  v_mul_f32 v9, v9, v10
  v_accvgpr_write_b32 a23, v9
  v_accvgpr_read_b32 v9, a24
  v_mul_f32 v9, v9, v10
  v_accvgpr_write_b32 a24, v9
  v_accvgpr_read_b32 v9, a25
  v_mul_f32 v9, v9, v10
  v_accvgpr_write_b32 a25, v9
  v_accvgpr_read_b32 v9, a26
  v_mul_f32 v9, v9, v10
  v_accvgpr_write_b32 a26, v9
  v_accvgpr_read_b32 v9, a27
  v_mul_f32 v9, v9, v10
  v_accvgpr_write_b32 a27, v9
  v_accvgpr_read_b32 v9, a28
  v_mul_f32 v9, v9, v10
  v_accvgpr_write_b32 a28, v9
  v_accvgpr_read_b32 v9, a29
  v_mul_f32 v9, v9, v10
  v_accvgpr_write_b32 a29, v9
  v_accvgpr_read_b32 v9, a30
  v_mul_f32 v9, v9, v10
  v_accvgpr_write_b32 a30, v9
  v_accvgpr_read_b32 v9, a31
  v_mul_f32 v9, v9, v10
  v_accvgpr_write_b32 a31, v9
  v_accvgpr_read_b32 v9, a32
  v_mul_f32 v9, v9, v10
  v_accvgpr_write_b32 a32, v9
  v_accvgpr_read_b32 v9, a33
  v_mul_f32 v9, v9, v10
  v_accvgpr_write_b32 a33, v9
  v_accvgpr_read_b32 v9, a34
  v_mul_f32 v9, v9, v10
  v_accvgpr_write_b32 a34, v9
  v_accvgpr_read_b32 v9, a35
  v_mul_f32 v9, v9, v10
  v_accvgpr_write_b32 a35, v9
  v_accvgpr_read_b32 v9, a36
  v_mul_f32 v9, v9, v10
  v_accvgpr_write_b32 a36, v9
  v_accvgpr_read_b32 v9, a37
  v_mul_f32 v9, v9, v10
  v_accvgpr_write_b32 a37, v9
  v_accvgpr_read_b32 v9, a38
  v_mul_f32 v9, v9, v10
  v_accvgpr_write_b32 a38, v9
  v_accvgpr_read_b32 v9, a39
  v_mul_f32 v9, v9, v10
  v_accvgpr_write_b32 a39, v9
  v_accvgpr_read_b32 v9, a40
  v_mul_f32 v9, v9, v10
  v_accvgpr_write_b32 a40, v9
  v_accvgpr_read_b32 v9, a41
  v_mul_f32 v9, v9, v10
  v_accvgpr_write_b32 a41, v9
  v_accvgpr_read_b32 v9, a42
  v_mul_f32 v9, v9, v10
  v_accvgpr_write_b32 a42, v9
  v_accvgpr_read_b32 v9, a43
  v_mul_f32 v9, v9, v10
  v_accvgpr_write_b32 a43, v9
  v_accvgpr_read_b32 v9, a44
  v_mul_f32 v9, v9, v10
  v_accvgpr_write_b32 a44, v9
  v_accvgpr_read_b32 v9, a45
  v_mul_f32 v9, v9, v10
  v_accvgpr_write_b32 a45, v9
  v_accvgpr_read_b32 v9, a46
  v_mul_f32 v9, v9, v10
  v_accvgpr_write_b32 a46, v9
  v_accvgpr_read_b32 v9, a47
  v_mul_f32 v9, v9, v10
  v_accvgpr_write_b32 a47, v9
  v_accvgpr_read_b32 v9, a48
  v_mul_f32 v9, v9, v10
  v_accvgpr_write_b32 a48, v9
  v_accvgpr_read_b32 v9, a49
  v_mul_f32 v9, v9, v10
  v_accvgpr_write_b32 a49, v9
  v_accvgpr_read_b32 v9, a50
  v_mul_f32 v9, v9, v10
  v_accvgpr_write_b32 a50, v9
  v_accvgpr_read_b32 v9, a51
  v_mul_f32 v9, v9, v10
  v_accvgpr_write_b32 a51, v9
  v_accvgpr_read_b32 v9, a52
  v_mul_f32 v9, v9, v10
  v_accvgpr_write_b32 a52, v9
  v_accvgpr_read_b32 v9, a53
  v_mul_f32 v9, v9, v10
  v_accvgpr_write_b32 a53, v9
  v_accvgpr_read_b32 v9, a54
  v_mul_f32 v9, v9, v10
  v_accvgpr_write_b32 a54, v9
  v_accvgpr_read_b32 v9, a55
  v_mul_f32 v9, v9, v10
  v_accvgpr_write_b32 a55, v9
  v_accvgpr_read_b32 v9, a56
  v_mul_f32 v9, v9, v10
  v_accvgpr_write_b32 a56, v9
  v_accvgpr_read_b32 v9, a57
  v_mul_f32 v9, v9, v10
  v_accvgpr_write_b32 a57, v9
  v_accvgpr_read_b32 v9, a58
  v_mul_f32 v9, v9, v10
  v_accvgpr_write_b32 a58, v9
  v_accvgpr_read_b32 v9, a59
  v_mul_f32 v9, v9, v10
  v_accvgpr_write_b32 a59, v9
  v_accvgpr_read_b32 v9, a60
  v_mul_f32 v9, v9, v10
  v_accvgpr_write_b32 a60, v9
  v_accvgpr_read_b32 v9, a61
  v_mul_f32 v9, v9, v10
  v_accvgpr_write_b32 a61, v9
  v_accvgpr_read_b32 v9, a62
  v_mul_f32 v9, v9, v10
  v_accvgpr_write_b32 a62, v9
  v_accvgpr_read_b32 v9, a63
  v_mul_f32 v9, v9, v10
  v_accvgpr_write_b32 a63, v9
  v_accvgpr_read_b32 v9, a64
  v_mul_f32 v9, v9, v11
  v_accvgpr_write_b32 a64, v9
  v_accvgpr_read_b32 v9, a65
  v_mul_f32 v9, v9, v11
  v_accvgpr_write_b32 a65, v9
  v_accvgpr_read_b32 v9, a66
  v_mul_f32 v9, v9, v11
  v_accvgpr_write_b32 a66, v9
  v_accvgpr_read_b32 v9, a67
  v_mul_f32 v9, v9, v11
  v_accvgpr_write_b32 a67, v9
  v_accvgpr_read_b32 v9, a68
  v_mul_f32 v9, v9, v11
  v_accvgpr_write_b32 a68, v9
  v_accvgpr_read_b32 v9, a69
  v_mul_f32 v9, v9, v11
  v_accvgpr_write_b32 a69, v9
  v_accvgpr_read_b32 v9, a70
  v_mul_f32 v9, v9, v11
  v_accvgpr_write_b32 a70, v9
  v_accvgpr_read_b32 v9, a71
  v_mul_f32 v9, v9, v11
  v_accvgpr_write_b32 a71, v9
  v_accvgpr_read_b32 v9, a72
  v_mul_f32 v9, v9, v11
  v_accvgpr_write_b32 a72, v9
  v_accvgpr_read_b32 v9, a73
  v_mul_f32 v9, v9, v11
  v_accvgpr_write_b32 a73, v9
  v_accvgpr_read_b32 v9, a74
  v_mul_f32 v9, v9, v11
  v_accvgpr_write_b32 a74, v9
  v_accvgpr_read_b32 v9, a75
  v_mul_f32 v9, v9, v11
  v_accvgpr_write_b32 a75, v9
  v_accvgpr_read_b32 v9, a76
  v_mul_f32 v9, v9, v11
  v_accvgpr_write_b32 a76, v9
  v_accvgpr_read_b32 v9, a77
  v_mul_f32 v9, v9, v11
  v_accvgpr_write_b32 a77, v9
  v_accvgpr_read_b32 v9, a78
  v_mul_f32 v9, v9, v11
  v_accvgpr_write_b32 a78, v9
  v_accvgpr_read_b32 v9, a79
  v_mul_f32 v9, v9, v11
  v_accvgpr_write_b32 a79, v9
  v_accvgpr_read_b32 v9, a80
  v_mul_f32 v9, v9, v11
  v_accvgpr_write_b32 a80, v9
  v_accvgpr_read_b32 v9, a81
  v_mul_f32 v9, v9, v11
  v_accvgpr_write_b32 a81, v9
  v_accvgpr_read_b32 v9, a82
  v_mul_f32 v9, v9, v11
  v_accvgpr_write_b32 a82, v9
  v_accvgpr_read_b32 v9, a83
  v_mul_f32 v9, v9, v11
  v_accvgpr_write_b32 a83, v9
  v_accvgpr_read_b32 v9, a84
  v_mul_f32 v9, v9, v11
  v_accvgpr_write_b32 a84, v9
  v_accvgpr_read_b32 v9, a85
  v_mul_f32 v9, v9, v11
  v_accvgpr_write_b32 a85, v9
  v_accvgpr_read_b32 v9, a86
  v_mul_f32 v9, v9, v11
  v_accvgpr_write_b32 a86, v9
  v_accvgpr_read_b32 v9, a87
  v_mul_f32 v9, v9, v11
  v_accvgpr_write_b32 a87, v9
  v_accvgpr_read_b32 v9, a88
  v_mul_f32 v9, v9, v11
  v_accvgpr_write_b32 a88, v9
  v_accvgpr_read_b32 v9, a89
  v_mul_f32 v9, v9, v11
  v_accvgpr_write_b32 a89, v9
  v_accvgpr_read_b32 v9, a90
  v_mul_f32 v9, v9, v11
  v_accvgpr_write_b32 a90, v9
  v_accvgpr_read_b32 v9, a91
  v_mul_f32 v9, v9, v11
  v_accvgpr_write_b32 a91, v9
  v_accvgpr_read_b32 v9, a92
  v_mul_f32 v9, v9, v11
  v_accvgpr_write_b32 a92, v9
  v_accvgpr_read_b32 v9, a93
  v_mul_f32 v9, v9, v11
  v_accvgpr_write_b32 a93, v9
  v_accvgpr_read_b32 v9, a94
  v_mul_f32 v9, v9, v11
  v_accvgpr_write_b32 a94, v9
  v_accvgpr_read_b32 v9, a95
  v_mul_f32 v9, v9, v11
  v_accvgpr_write_b32 a95, v9
  v_accvgpr_read_b32 v9, a96
  v_mul_f32 v9, v9, v11
  v_accvgpr_write_b32 a96, v9
  v_accvgpr_read_b32 v9, a97
  v_mul_f32 v9, v9, v11
  v_accvgpr_write_b32 a97, v9
  v_accvgpr_read_b32 v9, a98
  v_mul_f32 v9, v9, v11
  v_accvgpr_write_b32 a98, v9
  v_accvgpr_read_b32 v9, a99
  v_mul_f32 v9, v9, v11
  v_accvgpr_write_b32 a99, v9
  v_accvgpr_read_b32 v9, a100
  v_mul_f32 v9, v9, v11
  v_accvgpr_write_b32 a100, v9
  v_accvgpr_read_b32 v9, a101
  v_mul_f32 v9, v9, v11
  v_accvgpr_write_b32 a101, v9
  v_accvgpr_read_b32 v9, a102
  v_mul_f32 v9, v9, v11
  v_accvgpr_write_b32 a102, v9
  v_accvgpr_read_b32 v9, a103
  v_mul_f32 v9, v9, v11
  v_accvgpr_write_b32 a103, v9
  v_accvgpr_read_b32 v9, a104
  v_mul_f32 v9, v9, v11
  v_accvgpr_write_b32 a104, v9
  v_accvgpr_read_b32 v9, a105
  v_mul_f32 v9, v9, v11
  v_accvgpr_write_b32 a105, v9
  v_accvgpr_read_b32 v9, a106
  v_mul_f32 v9, v9, v11
  v_accvgpr_write_b32 a106, v9
  v_accvgpr_read_b32 v9, a107
  v_mul_f32 v9, v9, v11
  v_accvgpr_write_b32 a107, v9
  v_accvgpr_read_b32 v9, a108
  v_mul_f32 v9, v9, v11
  v_accvgpr_write_b32 a108, v9
  v_accvgpr_read_b32 v9, a109
  v_mul_f32 v9, v9, v11
  v_accvgpr_write_b32 a109, v9
  v_accvgpr_read_b32 v9, a110
  v_mul_f32 v9, v9, v11
  v_accvgpr_write_b32 a110, v9
  v_accvgpr_read_b32 v9, a111
  v_mul_f32 v9, v9, v11
  v_accvgpr_write_b32 a111, v9
  v_accvgpr_read_b32 v9, a112
  v_mul_f32 v9, v9, v11
  v_accvgpr_write_b32 a112, v9
  v_accvgpr_read_b32 v9, a113
  v_mul_f32 v9, v9, v11
  v_accvgpr_write_b32 a113, v9
  v_accvgpr_read_b32 v9, a114
  v_mul_f32 v9, v9, v11
  v_accvgpr_write_b32 a114, v9
  v_accvgpr_read_b32 v9, a115
  v_mul_f32 v9, v9, v11
  v_accvgpr_write_b32 a115, v9
  v_accvgpr_read_b32 v9, a116
  v_mul_f32 v9, v9, v11
  v_accvgpr_write_b32 a116, v9
  v_accvgpr_read_b32 v9, a117
  v_mul_f32 v9, v9, v11
  v_accvgpr_write_b32 a117, v9
  v_accvgpr_read_b32 v9, a118
  v_mul_f32 v9, v9, v11
  v_accvgpr_write_b32 a118, v9
  v_accvgpr_read_b32 v9, a119
  v_mul_f32 v9, v9, v11
  v_accvgpr_write_b32 a119, v9
  v_accvgpr_read_b32 v9, a120
  v_mul_f32 v9, v9, v11
  v_accvgpr_write_b32 a120, v9
  v_accvgpr_read_b32 v9, a121
  v_mul_f32 v9, v9, v11
  v_accvgpr_write_b32 a121, v9
  v_accvgpr_read_b32 v9, a122
  v_mul_f32 v9, v9, v11
  v_accvgpr_write_b32 a122, v9
  v_accvgpr_read_b32 v9, a123
  v_mul_f32 v9, v9, v11
  v_accvgpr_write_b32 a123, v9
  v_accvgpr_read_b32 v9, a124
  v_mul_f32 v9, v9, v11
  v_accvgpr_write_b32 a124, v9
  v_accvgpr_read_b32 v9, a125
  v_mul_f32 v9, v9, v11
  v_accvgpr_write_b32 a125, v9
  v_accvgpr_read_b32 v9, a126
  v_mul_f32 v9, v9, v11
  v_accvgpr_write_b32 a126, v9
  v_accvgpr_read_b32 v9, a127
  v_mul_f32 v9, v9, v11
  v_accvgpr_write_b32 a127, v9
  v_accvgpr_read_b32 v9, a128
  v_mul_f32 v9, v9, v12
  v_accvgpr_write_b32 a128, v9
  v_accvgpr_read_b32 v9, a129
  v_mul_f32 v9, v9, v12
  v_accvgpr_write_b32 a129, v9
  v_accvgpr_read_b32 v9, a130
  v_mul_f32 v9, v9, v12
  v_accvgpr_write_b32 a130, v9
  v_accvgpr_read_b32 v9, a131
  v_mul_f32 v9, v9, v12
  v_accvgpr_write_b32 a131, v9
  v_accvgpr_read_b32 v9, a132
  v_mul_f32 v9, v9, v12
  v_accvgpr_write_b32 a132, v9
  v_accvgpr_read_b32 v9, a133
  v_mul_f32 v9, v9, v12
  v_accvgpr_write_b32 a133, v9
  v_accvgpr_read_b32 v9, a134
  v_mul_f32 v9, v9, v12
  v_accvgpr_write_b32 a134, v9
  v_accvgpr_read_b32 v9, a135
  v_mul_f32 v9, v9, v12
  v_accvgpr_write_b32 a135, v9
  v_accvgpr_read_b32 v9, a136
  v_mul_f32 v9, v9, v12
  v_accvgpr_write_b32 a136, v9
  v_accvgpr_read_b32 v9, a137
  v_mul_f32 v9, v9, v12
  v_accvgpr_write_b32 a137, v9
  v_accvgpr_read_b32 v9, a138
  v_mul_f32 v9, v9, v12
  v_accvgpr_write_b32 a138, v9
  v_accvgpr_read_b32 v9, a139
  v_mul_f32 v9, v9, v12
  v_accvgpr_write_b32 a139, v9
  v_accvgpr_read_b32 v9, a140
  v_mul_f32 v9, v9, v12
  v_accvgpr_write_b32 a140, v9
  v_accvgpr_read_b32 v9, a141
  v_mul_f32 v9, v9, v12
  v_accvgpr_write_b32 a141, v9
  v_accvgpr_read_b32 v9, a142
  v_mul_f32 v9, v9, v12
  v_accvgpr_write_b32 a142, v9
  v_accvgpr_read_b32 v9, a143
  v_mul_f32 v9, v9, v12
  v_accvgpr_write_b32 a143, v9
  v_accvgpr_read_b32 v9, a144
  v_mul_f32 v9, v9, v12
  v_accvgpr_write_b32 a144, v9
  v_accvgpr_read_b32 v9, a145
  v_mul_f32 v9, v9, v12
  v_accvgpr_write_b32 a145, v9
  v_accvgpr_read_b32 v9, a146
  v_mul_f32 v9, v9, v12
  v_accvgpr_write_b32 a146, v9
  v_accvgpr_read_b32 v9, a147
  v_mul_f32 v9, v9, v12
  v_accvgpr_write_b32 a147, v9
  v_accvgpr_read_b32 v9, a148
  v_mul_f32 v9, v9, v12
  v_accvgpr_write_b32 a148, v9
  v_accvgpr_read_b32 v9, a149
  v_mul_f32 v9, v9, v12
  v_accvgpr_write_b32 a149, v9
  v_accvgpr_read_b32 v9, a150
  v_mul_f32 v9, v9, v12
  v_accvgpr_write_b32 a150, v9
  v_accvgpr_read_b32 v9, a151
  v_mul_f32 v9, v9, v12
  v_accvgpr_write_b32 a151, v9
  v_accvgpr_read_b32 v9, a152
  v_mul_f32 v9, v9, v12
  v_accvgpr_write_b32 a152, v9
  v_accvgpr_read_b32 v9, a153
  v_mul_f32 v9, v9, v12
  v_accvgpr_write_b32 a153, v9
  v_accvgpr_read_b32 v9, a154
  v_mul_f32 v9, v9, v12
  v_accvgpr_write_b32 a154, v9
  v_accvgpr_read_b32 v9, a155
  v_mul_f32 v9, v9, v12
  v_accvgpr_write_b32 a155, v9
  v_accvgpr_read_b32 v9, a156
  v_mul_f32 v9, v9, v12
  v_accvgpr_write_b32 a156, v9
  v_accvgpr_read_b32 v9, a157
  v_mul_f32 v9, v9, v12
  v_accvgpr_write_b32 a157, v9
  v_accvgpr_read_b32 v9, a158
  v_mul_f32 v9, v9, v12
  v_accvgpr_write_b32 a158, v9
  v_accvgpr_read_b32 v9, a159
  v_mul_f32 v9, v9, v12
  v_accvgpr_write_b32 a159, v9
  v_accvgpr_read_b32 v9, a160
  v_mul_f32 v9, v9, v12
  v_accvgpr_write_b32 a160, v9
  v_accvgpr_read_b32 v9, a161
  v_mul_f32 v9, v9, v12
  v_accvgpr_write_b32 a161, v9
  v_accvgpr_read_b32 v9, a162
  v_mul_f32 v9, v9, v12
  v_accvgpr_write_b32 a162, v9
  v_accvgpr_read_b32 v9, a163
  v_mul_f32 v9, v9, v12
  v_accvgpr_write_b32 a163, v9
  v_accvgpr_read_b32 v9, a164
  v_mul_f32 v9, v9, v12
  v_accvgpr_write_b32 a164, v9
  v_accvgpr_read_b32 v9, a165
  v_mul_f32 v9, v9, v12
  v_accvgpr_write_b32 a165, v9
  v_accvgpr_read_b32 v9, a166
  v_mul_f32 v9, v9, v12
  v_accvgpr_write_b32 a166, v9
  v_accvgpr_read_b32 v9, a167
  v_mul_f32 v9, v9, v12
  v_accvgpr_write_b32 a167, v9
  v_accvgpr_read_b32 v9, a168
  v_mul_f32 v9, v9, v12
  v_accvgpr_write_b32 a168, v9
  v_accvgpr_read_b32 v9, a169
  v_mul_f32 v9, v9, v12
  v_accvgpr_write_b32 a169, v9
  v_accvgpr_read_b32 v9, a170
  v_mul_f32 v9, v9, v12
  v_accvgpr_write_b32 a170, v9
  v_accvgpr_read_b32 v9, a171
  v_mul_f32 v9, v9, v12
  v_accvgpr_write_b32 a171, v9
  v_accvgpr_read_b32 v9, a172
  v_mul_f32 v9, v9, v12
  v_accvgpr_write_b32 a172, v9
  v_accvgpr_read_b32 v9, a173
  v_mul_f32 v9, v9, v12
  v_accvgpr_write_b32 a173, v9
  v_accvgpr_read_b32 v9, a174
  v_mul_f32 v9, v9, v12
  v_accvgpr_write_b32 a174, v9
  v_accvgpr_read_b32 v9, a175
  v_mul_f32 v9, v9, v12
  v_accvgpr_write_b32 a175, v9
  v_accvgpr_read_b32 v9, a176
  v_mul_f32 v9, v9, v12
  v_accvgpr_write_b32 a176, v9
  v_accvgpr_read_b32 v9, a177
  v_mul_f32 v9, v9, v12
  v_accvgpr_write_b32 a177, v9
  v_accvgpr_read_b32 v9, a178
  v_mul_f32 v9, v9, v12
  v_accvgpr_write_b32 a178, v9
  v_accvgpr_read_b32 v9, a179
  v_mul_f32 v9, v9, v12
  v_accvgpr_write_b32 a179, v9
  v_accvgpr_read_b32 v9, a180
  v_mul_f32 v9, v9, v12
  v_accvgpr_write_b32 a180, v9
  v_accvgpr_read_b32 v9, a181
  v_mul_f32 v9, v9, v12
  v_accvgpr_write_b32 a181, v9
  v_accvgpr_read_b32 v9, a182
  v_mul_f32 v9, v9, v12
  v_accvgpr_write_b32 a182, v9
  v_accvgpr_read_b32 v9, a183
  v_mul_f32 v9, v9, v12
  v_accvgpr_write_b32 a183, v9
  v_accvgpr_read_b32 v9, a184
  v_mul_f32 v9, v9, v12
  v_accvgpr_write_b32 a184, v9
  v_accvgpr_read_b32 v9, a185
  v_mul_f32 v9, v9, v12
  v_accvgpr_write_b32 a185, v9
  v_accvgpr_read_b32 v9, a186
  v_mul_f32 v9, v9, v12
  v_accvgpr_write_b32 a186, v9
  v_accvgpr_read_b32 v9, a187
  v_mul_f32 v9, v9, v12
  v_accvgpr_write_b32 a187, v9
  v_accvgpr_read_b32 v9, a188
  v_mul_f32 v9, v9, v12
  v_accvgpr_write_b32 a188, v9
  v_accvgpr_read_b32 v9, a189
  v_mul_f32 v9, v9, v12
  v_accvgpr_write_b32 a189, v9
  v_accvgpr_read_b32 v9, a190
  v_mul_f32 v9, v9, v12
  v_accvgpr_write_b32 a190, v9
  v_accvgpr_read_b32 v9, a191
  v_mul_f32 v9, v9, v12
  v_accvgpr_write_b32 a191, v9
  v_accvgpr_read_b32 v9, a192
  v_mul_f32 v9, v9, v13
  v_accvgpr_write_b32 a192, v9
  v_accvgpr_read_b32 v9, a193
  v_mul_f32 v9, v9, v13
  v_accvgpr_write_b32 a193, v9
  v_accvgpr_read_b32 v9, a194
  v_mul_f32 v9, v9, v13
  v_accvgpr_write_b32 a194, v9
  v_accvgpr_read_b32 v9, a195
  v_mul_f32 v9, v9, v13
  v_accvgpr_write_b32 a195, v9
  v_accvgpr_read_b32 v9, a196
  v_mul_f32 v9, v9, v13
  v_accvgpr_write_b32 a196, v9
  v_accvgpr_read_b32 v9, a197
  v_mul_f32 v9, v9, v13
  v_accvgpr_write_b32 a197, v9
  v_accvgpr_read_b32 v9, a198
  v_mul_f32 v9, v9, v13
  v_accvgpr_write_b32 a198, v9
  v_accvgpr_read_b32 v9, a199
  v_mul_f32 v9, v9, v13
  v_accvgpr_write_b32 a199, v9
  v_accvgpr_read_b32 v9, a200
  v_mul_f32 v9, v9, v13
  v_accvgpr_write_b32 a200, v9
  v_accvgpr_read_b32 v9, a201
  v_mul_f32 v9, v9, v13
  v_accvgpr_write_b32 a201, v9
  v_accvgpr_read_b32 v9, a202
  v_mul_f32 v9, v9, v13
  v_accvgpr_write_b32 a202, v9
  v_accvgpr_read_b32 v9, a203
  v_mul_f32 v9, v9, v13
  v_accvgpr_write_b32 a203, v9
  v_accvgpr_read_b32 v9, a204
  v_mul_f32 v9, v9, v13
  v_accvgpr_write_b32 a204, v9
  v_accvgpr_read_b32 v9, a205
  v_mul_f32 v9, v9, v13
  v_accvgpr_write_b32 a205, v9
  v_accvgpr_read_b32 v9, a206
  v_mul_f32 v9, v9, v13
  v_accvgpr_write_b32 a206, v9
  v_accvgpr_read_b32 v9, a207
  v_mul_f32 v9, v9, v13
  v_accvgpr_write_b32 a207, v9
  v_accvgpr_read_b32 v9, a208
  v_mul_f32 v9, v9, v13
  v_accvgpr_write_b32 a208, v9
  v_accvgpr_read_b32 v9, a209
  v_mul_f32 v9, v9, v13
  v_accvgpr_write_b32 a209, v9
  v_accvgpr_read_b32 v9, a210
  v_mul_f32 v9, v9, v13
  v_accvgpr_write_b32 a210, v9
  v_accvgpr_read_b32 v9, a211
  v_mul_f32 v9, v9, v13
  v_accvgpr_write_b32 a211, v9
  v_accvgpr_read_b32 v9, a212
  v_mul_f32 v9, v9, v13
  v_accvgpr_write_b32 a212, v9
  v_accvgpr_read_b32 v9, a213
  v_mul_f32 v9, v9, v13
  v_accvgpr_write_b32 a213, v9
  v_accvgpr_read_b32 v9, a214
  v_mul_f32 v9, v9, v13
  v_accvgpr_write_b32 a214, v9
  v_accvgpr_read_b32 v9, a215
  v_mul_f32 v9, v9, v13
  v_accvgpr_write_b32 a215, v9
  v_accvgpr_read_b32 v9, a216
  v_mul_f32 v9, v9, v13
  v_accvgpr_write_b32 a216, v9
  v_accvgpr_read_b32 v9, a217
  v_mul_f32 v9, v9, v13
  v_accvgpr_write_b32 a217, v9
  v_accvgpr_read_b32 v9, a218
  v_mul_f32 v9, v9, v13
  v_accvgpr_write_b32 a218, v9
  v_accvgpr_read_b32 v9, a219
  v_mul_f32 v9, v9, v13
  v_accvgpr_write_b32 a219, v9
  v_accvgpr_read_b32 v9, a220
  v_mul_f32 v9, v9, v13
  v_accvgpr_write_b32 a220, v9
  v_accvgpr_read_b32 v9, a221
  v_mul_f32 v9, v9, v13
  v_accvgpr_write_b32 a221, v9
  v_accvgpr_read_b32 v9, a222
  v_mul_f32 v9, v9, v13
  v_accvgpr_write_b32 a222, v9
  v_accvgpr_read_b32 v9, a223
  v_mul_f32 v9, v9, v13
  v_accvgpr_write_b32 a223, v9
  v_accvgpr_read_b32 v9, a224
  v_mul_f32 v9, v9, v13
  v_accvgpr_write_b32 a224, v9
  v_accvgpr_read_b32 v9, a225
  v_mul_f32 v9, v9, v13
  v_accvgpr_write_b32 a225, v9
  v_accvgpr_read_b32 v9, a226
  v_mul_f32 v9, v9, v13
  v_accvgpr_write_b32 a226, v9
  v_accvgpr_read_b32 v9, a227
  v_mul_f32 v9, v9, v13
  v_accvgpr_write_b32 a227, v9
  v_accvgpr_read_b32 v9, a228
  v_mul_f32 v9, v9, v13
  v_accvgpr_write_b32 a228, v9
  v_accvgpr_read_b32 v9, a229
  v_mul_f32 v9, v9, v13
  v_accvgpr_write_b32 a229, v9
  v_accvgpr_read_b32 v9, a230
  v_mul_f32 v9, v9, v13
  v_accvgpr_write_b32 a230, v9
  v_accvgpr_read_b32 v9, a231
  v_mul_f32 v9, v9, v13
  v_accvgpr_write_b32 a231, v9
  v_accvgpr_read_b32 v9, a232
  v_mul_f32 v9, v9, v13
  v_accvgpr_write_b32 a232, v9
  v_accvgpr_read_b32 v9, a233
  v_mul_f32 v9, v9, v13
  v_accvgpr_write_b32 a233, v9
  v_accvgpr_read_b32 v9, a234
  v_mul_f32 v9, v9, v13
  v_accvgpr_write_b32 a234, v9
  v_accvgpr_read_b32 v9, a235
  v_mul_f32 v9, v9, v13
  v_accvgpr_write_b32 a235, v9
  v_accvgpr_read_b32 v9, a236
  v_mul_f32 v9, v9, v13
  v_accvgpr_write_b32 a236, v9
  v_accvgpr_read_b32 v9, a237
  v_mul_f32 v9, v9, v13
  v_accvgpr_write_b32 a237, v9
  v_accvgpr_read_b32 v9, a238
  v_mul_f32 v9, v9, v13
  v_accvgpr_write_b32 a238, v9
  v_accvgpr_read_b32 v9, a239
  v_mul_f32 v9, v9, v13
  v_accvgpr_write_b32 a239, v9
  v_accvgpr_read_b32 v9, a240
  v_mul_f32 v9, v9, v13
  v_accvgpr_write_b32 a240, v9
  v_accvgpr_read_b32 v9, a241
  v_mul_f32 v9, v9, v13
  v_accvgpr_write_b32 a241, v9
  v_accvgpr_read_b32 v9, a242
  v_mul_f32 v9, v9, v13
  v_accvgpr_write_b32 a242, v9
  v_accvgpr_read_b32 v9, a243
  v_mul_f32 v9, v9, v13
  v_accvgpr_write_b32 a243, v9
  v_accvgpr_read_b32 v9, a244
  v_mul_f32 v9, v9, v13
  v_accvgpr_write_b32 a244, v9
  v_accvgpr_read_b32 v9, a245
  v_mul_f32 v9, v9, v13
  v_accvgpr_write_b32 a245, v9
  v_accvgpr_read_b32 v9, a246
  v_mul_f32 v9, v9, v13
  v_accvgpr_write_b32 a246, v9
  v_accvgpr_read_b32 v9, a247
  v_mul_f32 v9, v9, v13
  v_accvgpr_write_b32 a247, v9
  v_accvgpr_read_b32 v9, a248
  v_mul_f32 v9, v9, v13
  v_accvgpr_write_b32 a248, v9
  v_accvgpr_read_b32 v9, a249
  v_mul_f32 v9, v9, v13
  v_accvgpr_write_b32 a249, v9
  v_accvgpr_read_b32 v9, a250
  v_mul_f32 v9, v9, v13
  v_accvgpr_write_b32 a250, v9
  v_accvgpr_read_b32 v9, a251
  v_mul_f32 v9, v9, v13
  v_accvgpr_write_b32 a251, v9
  v_accvgpr_read_b32 v9, a252
  v_mul_f32 v9, v9, v13
  v_accvgpr_write_b32 a252, v9
  v_accvgpr_read_b32 v9, a253
  v_mul_f32 v9, v9, v13
  v_accvgpr_write_b32 a253, v9
  v_accvgpr_read_b32 v9, a254
  v_mul_f32 v9, v9, v13
  v_accvgpr_write_b32 a254, v9
  v_accvgpr_read_b32 v9, a255
  v_mul_f32 v9, v9, v13
  v_accvgpr_write_b32 a255, v9
  s_nop 1
  s_setpc_b64 s[32:33]
.section .rodata,"a"
.p2align 6
.amdhsa_kernel concat_heads__gqa_block_cached__gqa_block_cached__near_ridge_kernel
  .amdhsa_next_free_vgpr 512
  .amdhsa_next_free_sgpr 102
  .amdhsa_accum_offset 256
  .amdhsa_group_segment_fixed_size 0
  .amdhsa_kernarg_size 104
  .amdhsa_user_sgpr_count 2
  .amdhsa_user_sgpr_kernarg_segment_ptr 1
  .amdhsa_system_sgpr_workgroup_id_x 1
.end_amdhsa_kernel
```
